```python
import torch

def _softmax(x, axis=-1):
    return torch.softmax(x, dim=axis)

def _gelu(x):
    return torch.nn.functional.gelu(x, approximate='tanh')

def _silu(x):
    return torch.nn.functional.silu(x)

def _sigmoid(x):
    return torch.sigmoid(x)

def _layernorm(x, axis=-1, eps=1e-05):
    m = x.mean(dim=axis, keepdim=True)
    v = x.var(dim=axis, keepdim=True, unbiased=False)
    return (x - m) / torch.sqrt(v + eps)

def _scatter_add(tgt, idx, src, axis=0):
    return tgt.clone().index_add_(axis, idx, src)

def _segment_sum(src, seg, n):
    out = torch.zeros((n,) + src.shape[1:], dtype=src.dtype)
    return out.index_add_(0, seg, src)

def _pad(x, pw):
    flat = tuple((v for pair in reversed(pw) for v in pair))
    return torch.nn.functional.pad(x, flat)
kernel_name = 'adaLN_cond__ssm_conv_s4__mixer_s_mlp__prompt'

def setup_inputs():

    _w = lambda a: (lambda t: t.to(torch.bfloat16) if t.is_floating_point() else t)(torch.as_tensor(a))

    def _A_setup():
        B, L, D, N = (1, 2048, 640, 128)
        A_re = -(lambda _x: torch.exp(torch.as_tensor(_x)))((lambda *s: torch.randn(*s, dtype=torch.bfloat16) * 3.2)(D, N))
        A_im = torch.pi * (lambda *s: torch.randn(*s, dtype=torch.bfloat16) * 0.1)(D, N)
        B_re = (lambda *s: torch.randn(*s, dtype=torch.bfloat16) * 0.2)(D, N)
        B_im = (lambda *s: torch.randn(*s, dtype=torch.bfloat16) * 0.2)(D, N)
        C_re = (lambda *s: torch.randn(*s, dtype=torch.bfloat16) * 0.2)(D, N)
        C_im = (lambda *s: torch.randn(*s, dtype=torch.bfloat16) * 0.2)(D, N)
        log_dt = (lambda *s: torch.randn(*s, dtype=torch.bfloat16) * 0.1)(D) * 0.5 - 4.0
        Dskip = (lambda *s: torch.randn(*s, dtype=torch.bfloat16) * 0.1)(D)
        return {'u': _w((lambda *s: torch.randn(*s, dtype=torch.bfloat16) * 0.05)(B, L, D)), 'A_re': _w(A_re), 'A_im': _w(A_im), 'B_re': _w(B_re), 'B_im': _w(B_im), 'C_re': _w(C_re), 'C_im': _w(C_im), 'log_dt': _w(log_dt), 'Dskip': _w(Dskip)}
    _A_in = _A_setup()

    def _B_setup():
        B, S, D, F = (1, 2048, 640, 1728)
        return {'x': _w((lambda *s: torch.randn(*s, dtype=torch.bfloat16) * 0.05)(B, S, D)), 'w1': _w((lambda *s: torch.randn(*s, dtype=torch.bfloat16) * 3.2)(D, D) * D ** (-0.5)), 'w2': _w((lambda *s: torch.randn(*s, dtype=torch.bfloat16) * 3.2)(D, D) * D ** (-0.5)), 'w3': _w((lambda *s: torch.randn(*s, dtype=torch.bfloat16) * 3.2)(D, F) * D ** (-0.5)), 'w4': _w((lambda *s: torch.randn(*s, dtype=torch.bfloat16) * 3.2)(F, D) * F ** (-0.5))}
    _B_in = _B_setup()
    return {'A_u': _A_in['u'], 'A_A_re': _A_in['A_re'], 'A_A_im': _A_in['A_im'], 'A_B_re': _A_in['B_re'], 'A_B_im': _A_in['B_im'], 'A_C_re': _A_in['C_re'], 'A_C_im': _A_in['C_im'], 'A_log_dt': _A_in['log_dt'], 'A_Dskip': _A_in['Dskip'], 'B_x': _B_in['x'], 'B_w1': _B_in['w1'], 'B_w2': _B_in['w2'], 'B_w3': _B_in['w3'], 'B_w4': _B_in['w4'], 'c': _w((lambda *s: torch.randn(*s, dtype=torch.bfloat16) * 0.1)(1, 640) * 8.0), 'w_mod': _w((lambda *s: torch.randn(*s, dtype=torch.bfloat16) * 0.1)(640, 6 * 640) * 640 ** (-0.5) * 8.0)}

def reference(A_u, A_A_re, A_A_im, A_B_re, A_B_im, A_C_re, A_C_im, A_log_dt, A_Dskip, B_x, B_w1, B_w2, B_w3, B_w4, c, w_mod):

    def _A_ref(u, A_re, A_im, B_re, B_im, C_re, C_im, log_dt, Dskip):
        Bsz, L, D = u.shape
        dt = torch.exp(log_dt)[:, None]
        A = A_re + 1j * A_im
        Bc = B_re + 1j * B_im
        Cc = C_re + 1j * C_im
        logdA = dt * A
        dB = dt * Bc
        l = (lambda x, dt: x.to(dt))(torch.arange(L), A_re.dtype)
        P = torch.exp(logdA[:, :, None] * l[None, None, :])
        K = torch.einsum('dn,dnl,dn->dl', Cc, P, dB).real
        L2 = 2 * L
        Kp = _pad(K, ((0, 0), (0, L)))
        up = (lambda x, *d: x.permute(*d))(u, 0, 2, 1)
        up = _pad(up, ((0, 0), (0, 0), (0, L)))
        Kf = (lambda x, axes=(-2, -1): torch.fft.rfft2(x.float(), dim=axes))(Kp[:, None, :], axes=(-2, -1))
        Uf = (lambda x, axes=(-2, -1): torch.fft.rfft2(x.float(), dim=axes))(up[:, :, None, :], axes=(-2, -1))
        Yf = Uf * Kf[None, :, :, :]
        y = (lambda x, s, axes=(-2, -1): torch.fft.irfft2(x, s=s, dim=axes).to(torch.bfloat16))(Yf, (1, L2), axes=(-2, -1))[:, :, 0, :L]
        y = (lambda x, *d: x.permute(*d))(y, 0, 2, 1) + u * Dskip[None, None, :]
        return y

    def _B_ref(x, w1, w2, w3, w4):
        B, S, D = x.shape
        h = _gelu(_layernorm(x, axis=-1) @ w1)
        c = D // 4
        g0 = _pad(h[:, :, 0 * c:1 * c], ((0, 0), (1, 0), (0, 0)))[:, :S, :]
        g1 = _pad(h[:, :, 1 * c:2 * c], ((0, 0), (0, 1), (0, 0)))[:, 1:, :]
        g2 = _pad(h[:, :, 2 * c:3 * c], ((0, 0), (2, 0), (0, 0)))[:, :S, :]
        g3 = _pad(h[:, :, 3 * c:], ((0, 0), (0, 2), (0, 0)))[:, 2:, :]
        hs = torch.concatenate([g0, g1, g2, g3], axis=-1) @ w2
        x1 = x + hs
        h2 = _gelu(_layernorm(x1, axis=-1) @ w3) @ w4
        return x1 + h2
    x = A_u
    mod = (_silu(c) @ w_mod).reshape(c.shape[0], 6, 1, -1)
    sa, ca, ga, sb, cb, gb = (mod[:, 0].clone(), mod[:, 1].clone(), mod[:, 2].clone(), mod[:, 3].clone(), mod[:, 4].clone(), mod[:, 5].clone())
    h = _layernorm(x, axis=-1) * (1 + ca) + sa
    x = x + ga * _A_ref(h, A_A_re, A_A_im, A_B_re, A_B_im, A_C_re, A_C_im, A_log_dt, A_Dskip)
    h = _layernorm(x, axis=-1) * (1 + cb) + sb
    x = x + gb * _B_ref(h, B_w1, B_w2, B_w3, B_w4)
    return x
```

```asm
; @launch kernel=adaLN_cond__ssm_conv_s4__mixer_s_mlp__prompt_kernel grid=(504,1,1) block=(256,1,1) lds=70720
; @launch kernel=conv_kernel grid=(256,1,1) block=(256,1,1) lds=118272
; @launch kernel=mlp_kernel grid=(256,1,1) block=(512,1,1) lds=133136
.amdgcn_target "amdgcn-amd-amdhsa--gfx950"
.text
.globl adaLN_cond__ssm_conv_s4__mixer_s_mlp__prompt_kernel
.globl conv_kernel
.globl mlp_kernel
.p2align 8
.type adaLN_cond__ssm_conv_s4__mixer_s_mlp__prompt_kernel,@function
adaLN_cond__ssm_conv_s4__mixer_s_mlp__prompt_kernel:
s_cmp_ge_u32 s2, 64
s_cbranch_scc1 L_4
s_mov_b32 s3, s2
s_load_dwordx2 s[8:9], s[0:1], 0
s_mov_b32 s10, 2621440
s_mov_b32 s11, 0x20000
s_load_dwordx2 s[12:13], s[0:1], 144
s_mov_b32 s14, 268435456
s_mov_b32 s15, 0x20000
s_setprio 3
v_and_b32 v1, 63, v0
v_lshrrev_b32 v2, 6, v0
v_and_b32 v3, 15, v0
v_bfe_u32 v4, v0, 4, 2
v_lshlrev_b32 v5, 3, v2
v_add_u32 v5, v5, v4
s_lshl_b32 s4, s3, 5
s_mul_i32 s4, s4, 1280
v_mul_u32_u24 v6, 1280, v5
v_lshlrev_b32 v7, 4, v3
v_add_u32 v6, v6, v7
v_mul_u32_u24 v8, 1312, v5
v_add_u32 v8, v8, v7
s_waitcnt lgkmcnt(0)
buffer_load_dwordx4 v[16:19], v6, s[8:11], s4 offen offset:0
buffer_load_dwordx4 v[20:23], v6, s[8:11], s4 offen offset:256
buffer_load_dwordx4 v[24:27], v6, s[8:11], s4 offen offset:512
buffer_load_dwordx4 v[28:31], v6, s[8:11], s4 offen offset:768
buffer_load_dwordx4 v[32:35], v6, s[8:11], s4 offen offset:1024
v_add_u32 v9, 5120, v6
buffer_load_dwordx4 v[36:39], v9, s[8:11], s4 offen offset:0
buffer_load_dwordx4 v[40:43], v9, s[8:11], s4 offen offset:256
buffer_load_dwordx4 v[44:47], v9, s[8:11], s4 offen offset:512
buffer_load_dwordx4 v[48:51], v9, s[8:11], s4 offen offset:768
buffer_load_dwordx4 v[52:55], v9, s[8:11], s4 offen offset:1024
s_waitcnt vmcnt(5)
ds_write_b128 v8, v[16:19] offset:0
ds_write_b128 v8, v[20:23] offset:256
ds_write_b128 v8, v[24:27] offset:512
ds_write_b128 v8, v[28:31] offset:768
ds_write_b128 v8, v[32:35] offset:1024
v_lshlrev_b32 v64, 16, v16
v_and_b32 v65, 0xffff0000, v16
v_lshlrev_b32 v66, 16, v17
v_and_b32 v67, 0xffff0000, v17
v_lshlrev_b32 v68, 16, v18
v_and_b32 v69, 0xffff0000, v18
v_lshlrev_b32 v70, 16, v19
v_and_b32 v71, 0xffff0000, v19
v_lshlrev_b32 v72, 16, v20
v_and_b32 v73, 0xffff0000, v20
v_lshlrev_b32 v74, 16, v21
v_and_b32 v75, 0xffff0000, v21
v_lshlrev_b32 v76, 16, v22
v_and_b32 v77, 0xffff0000, v22
v_lshlrev_b32 v78, 16, v23
v_and_b32 v79, 0xffff0000, v23
v_lshlrev_b32 v80, 16, v24
v_and_b32 v81, 0xffff0000, v24
v_lshlrev_b32 v82, 16, v25
v_and_b32 v83, 0xffff0000, v25
v_lshlrev_b32 v84, 16, v26
v_and_b32 v85, 0xffff0000, v26
v_lshlrev_b32 v86, 16, v27
v_and_b32 v87, 0xffff0000, v27
v_lshlrev_b32 v88, 16, v28
v_and_b32 v89, 0xffff0000, v28
v_lshlrev_b32 v90, 16, v29
v_and_b32 v91, 0xffff0000, v29
v_lshlrev_b32 v92, 16, v30
v_and_b32 v93, 0xffff0000, v30
v_lshlrev_b32 v94, 16, v31
v_and_b32 v95, 0xffff0000, v31
v_lshlrev_b32 v96, 16, v32
v_and_b32 v97, 0xffff0000, v32
v_lshlrev_b32 v98, 16, v33
v_and_b32 v99, 0xffff0000, v33
v_lshlrev_b32 v100, 16, v34
v_and_b32 v101, 0xffff0000, v34
v_lshlrev_b32 v102, 16, v35
v_and_b32 v103, 0xffff0000, v35
v_add_f32 v10, v64, v65
v_add_f32 v10, v10, v66
v_add_f32 v10, v10, v67
v_add_f32 v10, v10, v68
v_add_f32 v10, v10, v69
v_add_f32 v10, v10, v70
v_add_f32 v10, v10, v71
v_add_f32 v10, v10, v72
v_add_f32 v10, v10, v73
v_add_f32 v10, v10, v74
v_add_f32 v10, v10, v75
v_add_f32 v10, v10, v76
v_add_f32 v10, v10, v77
v_add_f32 v10, v10, v78
v_add_f32 v10, v10, v79
v_add_f32 v10, v10, v80
v_add_f32 v10, v10, v81
v_add_f32 v10, v10, v82
v_add_f32 v10, v10, v83
v_add_f32 v10, v10, v84
v_add_f32 v10, v10, v85
v_add_f32 v10, v10, v86
v_add_f32 v10, v10, v87
v_add_f32 v10, v10, v88
v_add_f32 v10, v10, v89
v_add_f32 v10, v10, v90
v_add_f32 v10, v10, v91
v_add_f32 v10, v10, v92
v_add_f32 v10, v10, v93
v_add_f32 v10, v10, v94
v_add_f32 v10, v10, v95
v_add_f32 v10, v10, v96
v_add_f32 v10, v10, v97
v_add_f32 v10, v10, v98
v_add_f32 v10, v10, v99
v_add_f32 v10, v10, v100
v_add_f32 v10, v10, v101
v_add_f32 v10, v10, v102
v_add_f32 v10, v10, v103
s_nop 1
v_add_f32_dpp v10, v10, v10 row_ror:8 row_mask:0xf bank_mask:0xf
s_nop 1
v_add_f32_dpp v10, v10, v10 row_ror:4 row_mask:0xf bank_mask:0xf
s_nop 1
v_add_f32_dpp v10, v10, v10 row_ror:2 row_mask:0xf bank_mask:0xf
s_nop 1
v_add_f32_dpp v10, v10, v10 row_ror:1 row_mask:0xf bank_mask:0xf
v_mul_f32 v10, 0x3acccccd, v10
v_sub_f32 v64, v64, v10
v_sub_f32 v65, v65, v10
v_sub_f32 v66, v66, v10
v_sub_f32 v67, v67, v10
v_sub_f32 v68, v68, v10
v_sub_f32 v69, v69, v10
v_sub_f32 v70, v70, v10
v_sub_f32 v71, v71, v10
v_sub_f32 v72, v72, v10
v_sub_f32 v73, v73, v10
v_sub_f32 v74, v74, v10
v_sub_f32 v75, v75, v10
v_sub_f32 v76, v76, v10
v_sub_f32 v77, v77, v10
v_sub_f32 v78, v78, v10
v_sub_f32 v79, v79, v10
v_sub_f32 v80, v80, v10
v_sub_f32 v81, v81, v10
v_sub_f32 v82, v82, v10
v_sub_f32 v83, v83, v10
v_sub_f32 v84, v84, v10
v_sub_f32 v85, v85, v10
v_sub_f32 v86, v86, v10
v_sub_f32 v87, v87, v10
v_sub_f32 v88, v88, v10
v_sub_f32 v89, v89, v10
v_sub_f32 v90, v90, v10
v_sub_f32 v91, v91, v10
v_sub_f32 v92, v92, v10
v_sub_f32 v93, v93, v10
v_sub_f32 v94, v94, v10
v_sub_f32 v95, v95, v10
v_sub_f32 v96, v96, v10
v_sub_f32 v97, v97, v10
v_sub_f32 v98, v98, v10
v_sub_f32 v99, v99, v10
v_sub_f32 v100, v100, v10
v_sub_f32 v101, v101, v10
v_sub_f32 v102, v102, v10
v_sub_f32 v103, v103, v10
v_mul_f32 v11, v64, v64
v_fmac_f32 v11, v65, v65
v_fmac_f32 v11, v66, v66
v_fmac_f32 v11, v67, v67
v_fmac_f32 v11, v68, v68
v_fmac_f32 v11, v69, v69
v_fmac_f32 v11, v70, v70
v_fmac_f32 v11, v71, v71
v_fmac_f32 v11, v72, v72
v_fmac_f32 v11, v73, v73
v_fmac_f32 v11, v74, v74
v_fmac_f32 v11, v75, v75
v_fmac_f32 v11, v76, v76
v_fmac_f32 v11, v77, v77
v_fmac_f32 v11, v78, v78
v_fmac_f32 v11, v79, v79
v_fmac_f32 v11, v80, v80
v_fmac_f32 v11, v81, v81
v_fmac_f32 v11, v82, v82
v_fmac_f32 v11, v83, v83
v_fmac_f32 v11, v84, v84
v_fmac_f32 v11, v85, v85
v_fmac_f32 v11, v86, v86
v_fmac_f32 v11, v87, v87
v_fmac_f32 v11, v88, v88
v_fmac_f32 v11, v89, v89
v_fmac_f32 v11, v90, v90
v_fmac_f32 v11, v91, v91
v_fmac_f32 v11, v92, v92
v_fmac_f32 v11, v93, v93
v_fmac_f32 v11, v94, v94
v_fmac_f32 v11, v95, v95
v_fmac_f32 v11, v96, v96
v_fmac_f32 v11, v97, v97
v_fmac_f32 v11, v98, v98
v_fmac_f32 v11, v99, v99
v_fmac_f32 v11, v100, v100
v_fmac_f32 v11, v101, v101
v_fmac_f32 v11, v102, v102
v_fmac_f32 v11, v103, v103
s_nop 1
v_add_f32_dpp v11, v11, v11 row_ror:8 row_mask:0xf bank_mask:0xf
s_nop 1
v_add_f32_dpp v11, v11, v11 row_ror:4 row_mask:0xf bank_mask:0xf
s_nop 1
v_add_f32_dpp v11, v11, v11 row_ror:2 row_mask:0xf bank_mask:0xf
s_nop 1
v_add_f32_dpp v11, v11, v11 row_ror:1 row_mask:0xf bank_mask:0xf
v_mov_b32 v12, 0x3727c5ac
v_fmac_f32 v12, 0x3acccccd, v11
v_rsq_f32 v12, v12
s_nop 0
v_mul_f32 v13, v10, v12
v_sub_f32 v13, 0, v13
v_lshlrev_b32 v14, 3, v5
ds_write_b64 v14, v[12:13] offset:41984
s_waitcnt vmcnt(0)
ds_write_b128 v8, v[36:39] offset:5248
ds_write_b128 v8, v[40:43] offset:5504
ds_write_b128 v8, v[44:47] offset:5760
ds_write_b128 v8, v[48:51] offset:6016
ds_write_b128 v8, v[52:55] offset:6272
v_lshlrev_b32 v64, 16, v36
v_and_b32 v65, 0xffff0000, v36
v_lshlrev_b32 v66, 16, v37
v_and_b32 v67, 0xffff0000, v37
v_lshlrev_b32 v68, 16, v38
v_and_b32 v69, 0xffff0000, v38
v_lshlrev_b32 v70, 16, v39
v_and_b32 v71, 0xffff0000, v39
v_lshlrev_b32 v72, 16, v40
v_and_b32 v73, 0xffff0000, v40
v_lshlrev_b32 v74, 16, v41
v_and_b32 v75, 0xffff0000, v41
v_lshlrev_b32 v76, 16, v42
v_and_b32 v77, 0xffff0000, v42
v_lshlrev_b32 v78, 16, v43
v_and_b32 v79, 0xffff0000, v43
v_lshlrev_b32 v80, 16, v44
v_and_b32 v81, 0xffff0000, v44
v_lshlrev_b32 v82, 16, v45
v_and_b32 v83, 0xffff0000, v45
v_lshlrev_b32 v84, 16, v46
v_and_b32 v85, 0xffff0000, v46
v_lshlrev_b32 v86, 16, v47
v_and_b32 v87, 0xffff0000, v47
v_lshlrev_b32 v88, 16, v48
v_and_b32 v89, 0xffff0000, v48
v_lshlrev_b32 v90, 16, v49
v_and_b32 v91, 0xffff0000, v49
v_lshlrev_b32 v92, 16, v50
v_and_b32 v93, 0xffff0000, v50
v_lshlrev_b32 v94, 16, v51
v_and_b32 v95, 0xffff0000, v51
v_lshlrev_b32 v96, 16, v52
v_and_b32 v97, 0xffff0000, v52
v_lshlrev_b32 v98, 16, v53
v_and_b32 v99, 0xffff0000, v53
v_lshlrev_b32 v100, 16, v54
v_and_b32 v101, 0xffff0000, v54
v_lshlrev_b32 v102, 16, v55
v_and_b32 v103, 0xffff0000, v55
v_add_f32 v10, v64, v65
v_add_f32 v10, v10, v66
v_add_f32 v10, v10, v67
v_add_f32 v10, v10, v68
v_add_f32 v10, v10, v69
v_add_f32 v10, v10, v70
v_add_f32 v10, v10, v71
v_add_f32 v10, v10, v72
v_add_f32 v10, v10, v73
v_add_f32 v10, v10, v74
v_add_f32 v10, v10, v75
v_add_f32 v10, v10, v76
v_add_f32 v10, v10, v77
v_add_f32 v10, v10, v78
v_add_f32 v10, v10, v79
v_add_f32 v10, v10, v80
v_add_f32 v10, v10, v81
v_add_f32 v10, v10, v82
v_add_f32 v10, v10, v83
v_add_f32 v10, v10, v84
v_add_f32 v10, v10, v85
v_add_f32 v10, v10, v86
v_add_f32 v10, v10, v87
v_add_f32 v10, v10, v88
v_add_f32 v10, v10, v89
v_add_f32 v10, v10, v90
v_add_f32 v10, v10, v91
v_add_f32 v10, v10, v92
v_add_f32 v10, v10, v93
v_add_f32 v10, v10, v94
v_add_f32 v10, v10, v95
v_add_f32 v10, v10, v96
v_add_f32 v10, v10, v97
v_add_f32 v10, v10, v98
v_add_f32 v10, v10, v99
v_add_f32 v10, v10, v100
v_add_f32 v10, v10, v101
v_add_f32 v10, v10, v102
v_add_f32 v10, v10, v103
s_nop 1
v_add_f32_dpp v10, v10, v10 row_ror:8 row_mask:0xf bank_mask:0xf
s_nop 1
v_add_f32_dpp v10, v10, v10 row_ror:4 row_mask:0xf bank_mask:0xf
s_nop 1
v_add_f32_dpp v10, v10, v10 row_ror:2 row_mask:0xf bank_mask:0xf
s_nop 1
v_add_f32_dpp v10, v10, v10 row_ror:1 row_mask:0xf bank_mask:0xf
v_mul_f32 v10, 0x3acccccd, v10
v_sub_f32 v64, v64, v10
v_sub_f32 v65, v65, v10
v_sub_f32 v66, v66, v10
v_sub_f32 v67, v67, v10
v_sub_f32 v68, v68, v10
v_sub_f32 v69, v69, v10
v_sub_f32 v70, v70, v10
v_sub_f32 v71, v71, v10
v_sub_f32 v72, v72, v10
v_sub_f32 v73, v73, v10
v_sub_f32 v74, v74, v10
v_sub_f32 v75, v75, v10
v_sub_f32 v76, v76, v10
v_sub_f32 v77, v77, v10
v_sub_f32 v78, v78, v10
v_sub_f32 v79, v79, v10
v_sub_f32 v80, v80, v10
v_sub_f32 v81, v81, v10
v_sub_f32 v82, v82, v10
v_sub_f32 v83, v83, v10
v_sub_f32 v84, v84, v10
v_sub_f32 v85, v85, v10
v_sub_f32 v86, v86, v10
v_sub_f32 v87, v87, v10
v_sub_f32 v88, v88, v10
v_sub_f32 v89, v89, v10
v_sub_f32 v90, v90, v10
v_sub_f32 v91, v91, v10
v_sub_f32 v92, v92, v10
v_sub_f32 v93, v93, v10
v_sub_f32 v94, v94, v10
v_sub_f32 v95, v95, v10
v_sub_f32 v96, v96, v10
v_sub_f32 v97, v97, v10
v_sub_f32 v98, v98, v10
v_sub_f32 v99, v99, v10
v_sub_f32 v100, v100, v10
v_sub_f32 v101, v101, v10
v_sub_f32 v102, v102, v10
v_sub_f32 v103, v103, v10
v_mul_f32 v11, v64, v64
v_fmac_f32 v11, v65, v65
v_fmac_f32 v11, v66, v66
v_fmac_f32 v11, v67, v67
v_fmac_f32 v11, v68, v68
v_fmac_f32 v11, v69, v69
v_fmac_f32 v11, v70, v70
v_fmac_f32 v11, v71, v71
v_fmac_f32 v11, v72, v72
v_fmac_f32 v11, v73, v73
v_fmac_f32 v11, v74, v74
v_fmac_f32 v11, v75, v75
v_fmac_f32 v11, v76, v76
v_fmac_f32 v11, v77, v77
v_fmac_f32 v11, v78, v78
v_fmac_f32 v11, v79, v79
v_fmac_f32 v11, v80, v80
v_fmac_f32 v11, v81, v81
v_fmac_f32 v11, v82, v82
v_fmac_f32 v11, v83, v83
v_fmac_f32 v11, v84, v84
v_fmac_f32 v11, v85, v85
v_fmac_f32 v11, v86, v86
v_fmac_f32 v11, v87, v87
v_fmac_f32 v11, v88, v88
v_fmac_f32 v11, v89, v89
v_fmac_f32 v11, v90, v90
v_fmac_f32 v11, v91, v91
v_fmac_f32 v11, v92, v92
v_fmac_f32 v11, v93, v93
v_fmac_f32 v11, v94, v94
v_fmac_f32 v11, v95, v95
v_fmac_f32 v11, v96, v96
v_fmac_f32 v11, v97, v97
v_fmac_f32 v11, v98, v98
v_fmac_f32 v11, v99, v99
v_fmac_f32 v11, v100, v100
v_fmac_f32 v11, v101, v101
v_fmac_f32 v11, v102, v102
v_fmac_f32 v11, v103, v103
s_nop 1
v_add_f32_dpp v11, v11, v11 row_ror:8 row_mask:0xf bank_mask:0xf
s_nop 1
v_add_f32_dpp v11, v11, v11 row_ror:4 row_mask:0xf bank_mask:0xf
s_nop 1
v_add_f32_dpp v11, v11, v11 row_ror:2 row_mask:0xf bank_mask:0xf
s_nop 1
v_add_f32_dpp v11, v11, v11 row_ror:1 row_mask:0xf bank_mask:0xf
v_mov_b32 v12, 0x3727c5ac
v_fmac_f32 v12, 0x3acccccd, v11
v_rsq_f32 v12, v12
s_nop 0
v_mul_f32 v13, v10, v12
v_sub_f32 v13, 0, v13
v_lshlrev_b32 v14, 3, v5
ds_write_b64 v14, v[12:13] offset:42016
s_waitcnt lgkmcnt(0)
s_barrier
v_bfe_u32 v5, v0, 2, 2
v_lshlrev_b32 v6, 3, v4
v_add_u32 v5, v5, v6
v_mul_u32_u24 v5, 1312, v5
v_and_b32 v6, 3, v0
v_lshlrev_b32 v6, 3, v6
v_add_u32 v5, v5, v6
v_lshlrev_b32 v6, 5, v2
v_add_u32 v5, v5, v6
v_lshlrev_b32 v6, 6, v4
ds_read_b128 v[16:19], v6 offset:41984
ds_read_b128 v[20:23], v6 offset:42000
ds_read_b128 v[24:27], v6 offset:42016
ds_read_b128 v[28:31], v6 offset:42032
v_lshlrev_b32 v7, 4, v2
v_add_u32 v7, v7, v3
v_lshlrev_b32 v7, 12, v7
v_lshlrev_b32 v6, 4, v4
v_add_u32 v7, v7, v6
s_lshl_b32 s4, s3, 6
s_add_u32 s5, s4, 1048576
s_add_u32 s6, s4, 3670016
ds_read_b64_tr_b16 v[32:33], v5 offset:0
ds_read_b64_tr_b16 v[34:35], v5 offset:5248
ds_read_b64_tr_b16 v[36:37], v5 offset:128
ds_read_b64_tr_b16 v[38:39], v5 offset:5376
ds_read_b64_tr_b16 v[40:41], v5 offset:256
ds_read_b64_tr_b16 v[42:43], v5 offset:5504
ds_read_b64_tr_b16 v[44:45], v5 offset:384
ds_read_b64_tr_b16 v[46:47], v5 offset:5632
ds_read_b64_tr_b16 v[48:49], v5 offset:512
ds_read_b64_tr_b16 v[50:51], v5 offset:5760
ds_read_b64_tr_b16 v[52:53], v5 offset:640
ds_read_b64_tr_b16 v[54:55], v5 offset:5888
ds_read_b64_tr_b16 v[56:57], v5 offset:768
ds_read_b64_tr_b16 v[58:59], v5 offset:6016
ds_read_b64_tr_b16 v[60:61], v5 offset:896
ds_read_b64_tr_b16 v[62:63], v5 offset:6144
ds_read_b64_tr_b16 v[64:65], v5 offset:1024
ds_read_b64_tr_b16 v[66:67], v5 offset:6272
ds_read_b64_tr_b16 v[68:69], v5 offset:1152
ds_read_b64_tr_b16 v[70:71], v5 offset:6400
s_waitcnt lgkmcnt(0)
buffer_store_dwordx4 v[32:35], v7, s[12:15], s5 offen sc0 sc1
v_lshlrev_b32 v80, 16, v32
v_and_b32 v81, 0xffff0000, v32
v_lshlrev_b32 v82, 16, v33
v_and_b32 v83, 0xffff0000, v33
v_lshlrev_b32 v84, 16, v34
v_and_b32 v85, 0xffff0000, v34
v_lshlrev_b32 v86, 16, v35
v_and_b32 v87, 0xffff0000, v35
v_fma_f32 v80, v80, v16, v17
v_fma_f32 v81, v81, v18, v19
v_fma_f32 v82, v82, v20, v21
v_fma_f32 v83, v83, v22, v23
v_fma_f32 v84, v84, v24, v25
v_fma_f32 v85, v85, v26, v27
v_fma_f32 v86, v86, v28, v29
v_fma_f32 v87, v87, v30, v31
v_cvt_pk_bf16_f32 v88, v80, v81
v_cvt_pk_bf16_f32 v89, v82, v83
v_cvt_pk_bf16_f32 v90, v84, v85
v_cvt_pk_bf16_f32 v91, v86, v87
buffer_store_dwordx4 v[88:91], v7, s[12:15], s6 offen sc0 sc1
s_add_u32 s5, s5, 262144
s_add_u32 s6, s6, 262144
buffer_store_dwordx4 v[36:39], v7, s[12:15], s5 offen sc0 sc1
v_lshlrev_b32 v92, 16, v36
v_and_b32 v93, 0xffff0000, v36
v_lshlrev_b32 v94, 16, v37
v_and_b32 v95, 0xffff0000, v37
v_lshlrev_b32 v96, 16, v38
v_and_b32 v97, 0xffff0000, v38
v_lshlrev_b32 v98, 16, v39
v_and_b32 v99, 0xffff0000, v39
v_fma_f32 v92, v92, v16, v17
v_fma_f32 v93, v93, v18, v19
v_fma_f32 v94, v94, v20, v21
v_fma_f32 v95, v95, v22, v23
v_fma_f32 v96, v96, v24, v25
v_fma_f32 v97, v97, v26, v27
v_fma_f32 v98, v98, v28, v29
v_fma_f32 v99, v99, v30, v31
v_cvt_pk_bf16_f32 v100, v92, v93
v_cvt_pk_bf16_f32 v101, v94, v95
v_cvt_pk_bf16_f32 v102, v96, v97
v_cvt_pk_bf16_f32 v103, v98, v99
buffer_store_dwordx4 v[100:103], v7, s[12:15], s6 offen sc0 sc1
s_add_u32 s5, s5, 262144
s_add_u32 s6, s6, 262144
buffer_store_dwordx4 v[40:43], v7, s[12:15], s5 offen sc0 sc1
v_lshlrev_b32 v80, 16, v40
v_and_b32 v81, 0xffff0000, v40
v_lshlrev_b32 v82, 16, v41
v_and_b32 v83, 0xffff0000, v41
v_lshlrev_b32 v84, 16, v42
v_and_b32 v85, 0xffff0000, v42
v_lshlrev_b32 v86, 16, v43
v_and_b32 v87, 0xffff0000, v43
v_fma_f32 v80, v80, v16, v17
v_fma_f32 v81, v81, v18, v19
v_fma_f32 v82, v82, v20, v21
v_fma_f32 v83, v83, v22, v23
v_fma_f32 v84, v84, v24, v25
v_fma_f32 v85, v85, v26, v27
v_fma_f32 v86, v86, v28, v29
v_fma_f32 v87, v87, v30, v31
v_cvt_pk_bf16_f32 v88, v80, v81
v_cvt_pk_bf16_f32 v89, v82, v83
v_cvt_pk_bf16_f32 v90, v84, v85
v_cvt_pk_bf16_f32 v91, v86, v87
buffer_store_dwordx4 v[88:91], v7, s[12:15], s6 offen sc0 sc1
s_add_u32 s5, s5, 262144
s_add_u32 s6, s6, 262144
buffer_store_dwordx4 v[44:47], v7, s[12:15], s5 offen sc0 sc1
v_lshlrev_b32 v92, 16, v44
v_and_b32 v93, 0xffff0000, v44
v_lshlrev_b32 v94, 16, v45
v_and_b32 v95, 0xffff0000, v45
v_lshlrev_b32 v96, 16, v46
v_and_b32 v97, 0xffff0000, v46
v_lshlrev_b32 v98, 16, v47
v_and_b32 v99, 0xffff0000, v47
v_fma_f32 v92, v92, v16, v17
v_fma_f32 v93, v93, v18, v19
v_fma_f32 v94, v94, v20, v21
v_fma_f32 v95, v95, v22, v23
v_fma_f32 v96, v96, v24, v25
v_fma_f32 v97, v97, v26, v27
v_fma_f32 v98, v98, v28, v29
v_fma_f32 v99, v99, v30, v31
v_cvt_pk_bf16_f32 v100, v92, v93
v_cvt_pk_bf16_f32 v101, v94, v95
v_cvt_pk_bf16_f32 v102, v96, v97
v_cvt_pk_bf16_f32 v103, v98, v99
buffer_store_dwordx4 v[100:103], v7, s[12:15], s6 offen sc0 sc1
s_add_u32 s5, s5, 262144
s_add_u32 s6, s6, 262144
buffer_store_dwordx4 v[48:51], v7, s[12:15], s5 offen sc0 sc1
v_lshlrev_b32 v80, 16, v48
v_and_b32 v81, 0xffff0000, v48
v_lshlrev_b32 v82, 16, v49
v_and_b32 v83, 0xffff0000, v49
v_lshlrev_b32 v84, 16, v50
v_and_b32 v85, 0xffff0000, v50
v_lshlrev_b32 v86, 16, v51
v_and_b32 v87, 0xffff0000, v51
v_fma_f32 v80, v80, v16, v17
v_fma_f32 v81, v81, v18, v19
v_fma_f32 v82, v82, v20, v21
v_fma_f32 v83, v83, v22, v23
v_fma_f32 v84, v84, v24, v25
v_fma_f32 v85, v85, v26, v27
v_fma_f32 v86, v86, v28, v29
v_fma_f32 v87, v87, v30, v31
v_cvt_pk_bf16_f32 v88, v80, v81
v_cvt_pk_bf16_f32 v89, v82, v83
v_cvt_pk_bf16_f32 v90, v84, v85
v_cvt_pk_bf16_f32 v91, v86, v87
buffer_store_dwordx4 v[88:91], v7, s[12:15], s6 offen sc0 sc1
s_add_u32 s5, s5, 262144
s_add_u32 s6, s6, 262144
buffer_store_dwordx4 v[52:55], v7, s[12:15], s5 offen sc0 sc1
v_lshlrev_b32 v92, 16, v52
v_and_b32 v93, 0xffff0000, v52
v_lshlrev_b32 v94, 16, v53
v_and_b32 v95, 0xffff0000, v53
v_lshlrev_b32 v96, 16, v54
v_and_b32 v97, 0xffff0000, v54
v_lshlrev_b32 v98, 16, v55
v_and_b32 v99, 0xffff0000, v55
v_fma_f32 v92, v92, v16, v17
v_fma_f32 v93, v93, v18, v19
v_fma_f32 v94, v94, v20, v21
v_fma_f32 v95, v95, v22, v23
v_fma_f32 v96, v96, v24, v25
v_fma_f32 v97, v97, v26, v27
v_fma_f32 v98, v98, v28, v29
v_fma_f32 v99, v99, v30, v31
v_cvt_pk_bf16_f32 v100, v92, v93
v_cvt_pk_bf16_f32 v101, v94, v95
v_cvt_pk_bf16_f32 v102, v96, v97
v_cvt_pk_bf16_f32 v103, v98, v99
buffer_store_dwordx4 v[100:103], v7, s[12:15], s6 offen sc0 sc1
s_add_u32 s5, s5, 262144
s_add_u32 s6, s6, 262144
buffer_store_dwordx4 v[56:59], v7, s[12:15], s5 offen sc0 sc1
v_lshlrev_b32 v80, 16, v56
v_and_b32 v81, 0xffff0000, v56
v_lshlrev_b32 v82, 16, v57
v_and_b32 v83, 0xffff0000, v57
v_lshlrev_b32 v84, 16, v58
v_and_b32 v85, 0xffff0000, v58
v_lshlrev_b32 v86, 16, v59
v_and_b32 v87, 0xffff0000, v59
v_fma_f32 v80, v80, v16, v17
v_fma_f32 v81, v81, v18, v19
v_fma_f32 v82, v82, v20, v21
v_fma_f32 v83, v83, v22, v23
v_fma_f32 v84, v84, v24, v25
v_fma_f32 v85, v85, v26, v27
v_fma_f32 v86, v86, v28, v29
v_fma_f32 v87, v87, v30, v31
v_cvt_pk_bf16_f32 v88, v80, v81
v_cvt_pk_bf16_f32 v89, v82, v83
v_cvt_pk_bf16_f32 v90, v84, v85
v_cvt_pk_bf16_f32 v91, v86, v87
buffer_store_dwordx4 v[88:91], v7, s[12:15], s6 offen sc0 sc1
s_add_u32 s5, s5, 262144
s_add_u32 s6, s6, 262144
buffer_store_dwordx4 v[60:63], v7, s[12:15], s5 offen sc0 sc1
v_lshlrev_b32 v92, 16, v60
v_and_b32 v93, 0xffff0000, v60
v_lshlrev_b32 v94, 16, v61
v_and_b32 v95, 0xffff0000, v61
v_lshlrev_b32 v96, 16, v62
v_and_b32 v97, 0xffff0000, v62
v_lshlrev_b32 v98, 16, v63
v_and_b32 v99, 0xffff0000, v63
v_fma_f32 v92, v92, v16, v17
v_fma_f32 v93, v93, v18, v19
v_fma_f32 v94, v94, v20, v21
v_fma_f32 v95, v95, v22, v23
v_fma_f32 v96, v96, v24, v25
v_fma_f32 v97, v97, v26, v27
v_fma_f32 v98, v98, v28, v29
v_fma_f32 v99, v99, v30, v31
v_cvt_pk_bf16_f32 v100, v92, v93
v_cvt_pk_bf16_f32 v101, v94, v95
v_cvt_pk_bf16_f32 v102, v96, v97
v_cvt_pk_bf16_f32 v103, v98, v99
buffer_store_dwordx4 v[100:103], v7, s[12:15], s6 offen sc0 sc1
s_add_u32 s5, s5, 262144
s_add_u32 s6, s6, 262144
buffer_store_dwordx4 v[64:67], v7, s[12:15], s5 offen sc0 sc1
v_lshlrev_b32 v80, 16, v64
v_and_b32 v81, 0xffff0000, v64
v_lshlrev_b32 v82, 16, v65
v_and_b32 v83, 0xffff0000, v65
v_lshlrev_b32 v84, 16, v66
v_and_b32 v85, 0xffff0000, v66
v_lshlrev_b32 v86, 16, v67
v_and_b32 v87, 0xffff0000, v67
v_fma_f32 v80, v80, v16, v17
v_fma_f32 v81, v81, v18, v19
v_fma_f32 v82, v82, v20, v21
v_fma_f32 v83, v83, v22, v23
v_fma_f32 v84, v84, v24, v25
v_fma_f32 v85, v85, v26, v27
v_fma_f32 v86, v86, v28, v29
v_fma_f32 v87, v87, v30, v31
v_cvt_pk_bf16_f32 v88, v80, v81
v_cvt_pk_bf16_f32 v89, v82, v83
v_cvt_pk_bf16_f32 v90, v84, v85
v_cvt_pk_bf16_f32 v91, v86, v87
buffer_store_dwordx4 v[88:91], v7, s[12:15], s6 offen sc0 sc1
s_add_u32 s5, s5, 262144
s_add_u32 s6, s6, 262144
buffer_store_dwordx4 v[68:71], v7, s[12:15], s5 offen sc0 sc1
v_lshlrev_b32 v92, 16, v68
v_and_b32 v93, 0xffff0000, v68
v_lshlrev_b32 v94, 16, v69
v_and_b32 v95, 0xffff0000, v69
v_lshlrev_b32 v96, 16, v70
v_and_b32 v97, 0xffff0000, v70
v_lshlrev_b32 v98, 16, v71
v_and_b32 v99, 0xffff0000, v71
v_fma_f32 v92, v92, v16, v17
v_fma_f32 v93, v93, v18, v19
v_fma_f32 v94, v94, v20, v21
v_fma_f32 v95, v95, v22, v23
v_fma_f32 v96, v96, v24, v25
v_fma_f32 v97, v97, v26, v27
v_fma_f32 v98, v98, v28, v29
v_fma_f32 v99, v99, v30, v31
v_cvt_pk_bf16_f32 v100, v92, v93
v_cvt_pk_bf16_f32 v101, v94, v95
v_cvt_pk_bf16_f32 v102, v96, v97
v_cvt_pk_bf16_f32 v103, v98, v99
buffer_store_dwordx4 v[100:103], v7, s[12:15], s6 offen sc0 sc1
s_add_u32 s5, s5, 262144
s_add_u32 s6, s6, 262144
s_endpgm
L_4:
s_cmp_ge_u32 s2, 384
s_cbranch_scc1 L_2
s_sub_u32 s2, s2, 64
s_load_dwordx2 s[8:9], s[0:1], 8
s_mov_b32 s10, 163840
s_mov_b32 s11, 0x20000
s_load_dwordx2 s[12:13], s[0:1], 16
s_mov_b32 s14, 163840
s_mov_b32 s15, 0x20000
s_load_dwordx2 s[16:17], s[0:1], 24
s_mov_b32 s18, 163840
s_mov_b32 s19, 0x20000
s_load_dwordx2 s[20:21], s[0:1], 32
s_mov_b32 s22, 163840
s_mov_b32 s23, 0x20000
s_load_dwordx2 s[24:25], s[0:1], 40
s_mov_b32 s26, 163840
s_mov_b32 s27, 0x20000
s_load_dwordx2 s[28:29], s[0:1], 48
s_mov_b32 s30, 163840
s_mov_b32 s31, 0x20000
s_load_dwordx2 s[32:33], s[0:1], 56
s_mov_b32 s34, 1280
s_mov_b32 s35, 0x20000
s_load_dwordx2 s[36:37], s[0:1], 144
s_mov_b32 s38, 268435456
s_mov_b32 s39, 0x20000
v_and_b32 v1, 63, v0
v_lshrrev_b32 v2, 6, v0
s_nop 0
v_readfirstlane_b32 s4, v2
s_lshr_b32 s5, s4, 1
s_lshl_b32 s6, s2, 1
s_add_u32 s5, s5, s6
s_and_b32 s6, s4, 1
s_lshl_b32 s7, s5, 8
s_lshl_b32 s40, s6, 7
s_add_u32 s7, s7, s40
v_lshlrev_b32 v3, 1, v1
v_add_u32 v3, s7, v3
s_lshl_b32 s41, s5, 1
v_mov_b32 v4, s41
s_waitcnt lgkmcnt(0)
buffer_load_ushort v8, v3, s[8:11], 0 offen
buffer_load_ushort v9, v3, s[12:15], 0 offen
buffer_load_ushort v10, v3, s[16:19], 0 offen
buffer_load_ushort v11, v3, s[20:23], 0 offen
buffer_load_ushort v12, v3, s[24:27], 0 offen
buffer_load_ushort v13, v3, s[28:31], 0 offen
buffer_load_ushort v14, v4, s[32:35], 0 offen
s_mul_i32 s42, s4, 17680
v_lshlrev_b32 v5, 2, v1
v_add_u32 v5, s42, v5
v_and_b32 v6, 15, v0
v_bfe_u32 v7, v0, 4, 2
v_lshlrev_b32 v15, 4, v7
v_add_u32 v15, s42, v15
v_add_u32 v16, 0, v6
v_cvt_f32_u32 v17, v16
v_mul_u32_u24 v100, 272, v16
v_add_u32 v100, v100, v15
v_mul_f32 v18, 0.5, v17
v_rndne_f32 v18, v18
v_cvt_u32_f32 v18, v18
v_mul_u32_u24 v102, 544, v18
v_add_u32 v102, v102, v15
v_mul_f32 v18, 0x3e800000, v17
v_rndne_f32 v18, v18
v_cvt_u32_f32 v18, v18
v_mul_u32_u24 v104, 1088, v18
v_add_u32 v104, v104, v15
v_mul_f32 v18, 0x3e000000, v17
v_rndne_f32 v18, v18
v_cvt_u32_f32 v18, v18
v_mul_u32_u24 v106, 2176, v18
v_add_u32 v106, v106, v15
v_add_u32 v16, 16, v6
v_cvt_f32_u32 v17, v16
v_mul_u32_u24 v101, 272, v16
v_add_u32 v101, v101, v15
v_mul_f32 v18, 0.5, v17
v_rndne_f32 v18, v18
v_cvt_u32_f32 v18, v18
v_mul_u32_u24 v103, 544, v18
v_add_u32 v103, v103, v15
v_mul_f32 v18, 0x3e800000, v17
v_rndne_f32 v18, v18
v_cvt_u32_f32 v18, v18
v_mul_u32_u24 v105, 1088, v18
v_add_u32 v105, v105, v15
v_mul_f32 v18, 0x3e000000, v17
v_rndne_f32 v18, v18
v_cvt_u32_f32 v18, v18
v_mul_u32_u24 v107, 2176, v18
v_add_u32 v107, v107, v15
v_mul_u32_u24 v108, 272, v6
v_add_u32 v108, v108, v15
v_add_u32 v108, 8976, v108
s_waitcnt vmcnt(0)
s_lshl_b32 s43, s2, 2
s_add_u32 s43, s43, s4
v_lshlrev_b32 v230, 7, v1
s_cmp_ge_u32 s43, 254
s_cbranch_scc1 L_5
s_lshl_b32 s44, s43, 13
s_add_u32 s45, s44, 8994816
s_add_u32 s46, s44, 0
s_sub_u32 s46, s43, 214
s_lshl_b32 s46, s46, 13
s_add_u32 s46, s46, 262144
s_cmp_lt_u32 s43, 214
s_cselect_b32 s45, s45, s46
buffer_load_dword v231, v230, s[36:39], s45 offen
L_5:
v_lshlrev_b32 v8, 16, v8
v_lshlrev_b32 v9, 16, v9
v_lshlrev_b32 v10, 16, v10
v_lshlrev_b32 v11, 16, v11
v_lshlrev_b32 v12, 16, v12
v_lshlrev_b32 v13, 16, v13
v_lshlrev_b32 v14, 16, v14
v_mul_f32 v14, 0x3fb8aa3b, v14
v_exp_f32 v14, v14
s_nop 0
v_cvt_pk_bf16_f32 v14, v14, v14
v_lshlrev_b32 v14, 16, v14
v_mul_f32 v8, v8, v14
v_mul_f32 v9, v9, v14
v_mul_f32 v10, v10, v14
v_mul_f32 v11, v11, v14
v_mul_f32 v8, 0x3fb8aa3b, v8
v_mul_f32 v9, 0x3e22f983, v9
v_mul_f32 v20, v12, v10
v_mul_f32 v21, v12, v11
v_fma_f32 v20, -v13, v11, v20
v_fma_f32 v21, v13, v10, v21
v_sub_f32 v21, 0, v21
v_mul_f32 v16, 0x3f800000, v8
v_mul_f32 v17, 0x3f800000, v9
v_exp_f32 v16, v16
v_fract_f32 v17, v17
v_cos_f32 v24, v17
v_sin_f32 v25, v17
v_mul_f32 v24, v24, v16
v_mul_f32 v25, v25, v16
v_sub_f32 v26, 0, v25
v_mov_b32 v27, v24
v_mul_f32 v16, 0x42000000, v8
v_mul_f32 v17, 0x42000000, v9
v_exp_f32 v16, v16
v_fract_f32 v17, v17
v_cos_f32 v28, v17
v_sin_f32 v29, v17
v_mul_f32 v28, v28, v16
v_mul_f32 v29, v29, v16
v_sub_f32 v29, 0, v29
v_sub_f32 v30, 0, v29
v_mov_b32 v31, v28
v_mov_b32 v32, 1.0
v_mov_b32 v33, 0
v_mul_f32 v16, 0x41800000, v8
v_mul_f32 v17, 0x41800000, v9
v_exp_f32 v16, v16
v_fract_f32 v17, v17
v_cos_f32 v34, v17
v_sin_f32 v35, v17
v_mul_f32 v34, v34, v16
v_mul_f32 v35, v35, v16
v_mov_b32 v36, v20
v_mov_b32 v37, v21
v_mul_f32 v16, 0x44000000, v8
v_mul_f32 v17, 0x44000000, v9
v_exp_f32 v16, v16
v_fract_f32 v17, v17
v_cos_f32 v44, v17
v_sin_f32 v45, v17
v_mul_f32 v44, v44, v16
v_mul_f32 v45, v45, v16
v_sub_f32 v45, 0, v45
v_sub_f32 v46, 0, v45
v_mov_b32 v47, v44
v_pk_mul_f32 v[16:17], v[20:21], v[44:45] op_sel:[0,0] op_sel_hi:[0,1]
s_nop 0
v_pk_fma_f32 v[38:39], v[20:21], v[46:47], v[16:17] op_sel:[1,0,0] op_sel_hi:[1,1,1]
v_mul_f32 v16, 0x44800000, v8
v_mul_f32 v17, 0x44800000, v9
v_exp_f32 v16, v16
v_fract_f32 v17, v17
v_cos_f32 v44, v17
v_sin_f32 v45, v17
v_mul_f32 v44, v44, v16
v_mul_f32 v45, v45, v16
v_sub_f32 v45, 0, v45
v_sub_f32 v46, 0, v45
v_mov_b32 v47, v44
v_pk_mul_f32 v[16:17], v[20:21], v[44:45] op_sel:[0,0] op_sel_hi:[0,1]
s_nop 0
v_pk_fma_f32 v[40:41], v[20:21], v[46:47], v[16:17] op_sel:[1,0,0] op_sel_hi:[1,1,1]
v_mul_f32 v16, 0x44c00000, v8
v_mul_f32 v17, 0x44c00000, v9
v_exp_f32 v16, v16
v_fract_f32 v17, v17
v_cos_f32 v44, v17
v_sin_f32 v45, v17
v_mul_f32 v44, v44, v16
v_mul_f32 v45, v45, v16
v_sub_f32 v45, 0, v45
v_sub_f32 v46, 0, v45
v_mov_b32 v47, v44
v_pk_mul_f32 v[16:17], v[20:21], v[44:45] op_sel:[0,0] op_sel_hi:[0,1]
s_nop 0
v_pk_fma_f32 v[42:43], v[20:21], v[46:47], v[16:17] op_sel:[1,0,0] op_sel_hi:[1,1,1]
v_cvt_pk_bf16_f32 v48, v32, v33
v_pk_mul_f32 v[50:51], v[32:33], v[24:25] op_sel:[0,0] op_sel_hi:[0,1]
s_nop 0
v_pk_fma_f32 v[32:33], v[32:33], v[26:27], v[50:51] op_sel:[1,0,0] op_sel_hi:[1,1,1]
ds_write_b32 v5, v48 offset:0
v_cvt_pk_bf16_f32 v52, v34, v35
v_pk_mul_f32 v[54:55], v[34:35], v[24:25] op_sel:[0,0] op_sel_hi:[0,1]
s_nop 0
v_pk_fma_f32 v[34:35], v[34:35], v[26:27], v[54:55] op_sel:[1,0,0] op_sel_hi:[1,1,1]
ds_write_b32 v5, v52 offset:4352
v_cvt_pk_bf16_f32 v56, v36, v37
v_pk_mul_f32 v[58:59], v[36:37], v[28:29] op_sel:[0,0] op_sel_hi:[0,1]
s_nop 0
v_pk_fma_f32 v[36:37], v[36:37], v[30:31], v[58:59] op_sel:[1,0,0] op_sel_hi:[1,1,1]
ds_write_b32 v5, v56 offset:8976
v_cvt_pk_bf16_f32 v60, v38, v39
v_pk_mul_f32 v[62:63], v[38:39], v[28:29] op_sel:[0,0] op_sel_hi:[0,1]
s_nop 0
v_pk_fma_f32 v[38:39], v[38:39], v[30:31], v[62:63] op_sel:[1,0,0] op_sel_hi:[1,1,1]
ds_write_b32 v5, v60 offset:13328
v_cvt_pk_bf16_f32 v48, v32, v33
v_pk_mul_f32 v[50:51], v[32:33], v[24:25] op_sel:[0,0] op_sel_hi:[0,1]
s_nop 0
v_pk_fma_f32 v[32:33], v[32:33], v[26:27], v[50:51] op_sel:[1,0,0] op_sel_hi:[1,1,1]
ds_write_b32 v5, v48 offset:272
v_cvt_pk_bf16_f32 v52, v34, v35
v_pk_mul_f32 v[54:55], v[34:35], v[24:25] op_sel:[0,0] op_sel_hi:[0,1]
s_nop 0
v_pk_fma_f32 v[34:35], v[34:35], v[26:27], v[54:55] op_sel:[1,0,0] op_sel_hi:[1,1,1]
ds_write_b32 v5, v52 offset:4624
v_cvt_pk_bf16_f32 v56, v36, v37
v_pk_mul_f32 v[58:59], v[36:37], v[28:29] op_sel:[0,0] op_sel_hi:[0,1]
s_nop 0
v_pk_fma_f32 v[36:37], v[36:37], v[30:31], v[58:59] op_sel:[1,0,0] op_sel_hi:[1,1,1]
ds_write_b32 v5, v56 offset:9248
v_cvt_pk_bf16_f32 v60, v38, v39
v_pk_mul_f32 v[62:63], v[38:39], v[28:29] op_sel:[0,0] op_sel_hi:[0,1]
s_nop 0
v_pk_fma_f32 v[38:39], v[38:39], v[30:31], v[62:63] op_sel:[1,0,0] op_sel_hi:[1,1,1]
ds_write_b32 v5, v60 offset:13600
v_cvt_pk_bf16_f32 v48, v32, v33
v_pk_mul_f32 v[50:51], v[32:33], v[24:25] op_sel:[0,0] op_sel_hi:[0,1]
s_nop 0
v_pk_fma_f32 v[32:33], v[32:33], v[26:27], v[50:51] op_sel:[1,0,0] op_sel_hi:[1,1,1]
ds_write_b32 v5, v48 offset:544
v_cvt_pk_bf16_f32 v52, v34, v35
v_pk_mul_f32 v[54:55], v[34:35], v[24:25] op_sel:[0,0] op_sel_hi:[0,1]
s_nop 0
v_pk_fma_f32 v[34:35], v[34:35], v[26:27], v[54:55] op_sel:[1,0,0] op_sel_hi:[1,1,1]
ds_write_b32 v5, v52 offset:4896
v_cvt_pk_bf16_f32 v56, v36, v37
v_pk_mul_f32 v[58:59], v[36:37], v[28:29] op_sel:[0,0] op_sel_hi:[0,1]
s_nop 0
v_pk_fma_f32 v[36:37], v[36:37], v[30:31], v[58:59] op_sel:[1,0,0] op_sel_hi:[1,1,1]
ds_write_b32 v5, v56 offset:9520
v_cvt_pk_bf16_f32 v60, v38, v39
v_pk_mul_f32 v[62:63], v[38:39], v[28:29] op_sel:[0,0] op_sel_hi:[0,1]
s_nop 0
v_pk_fma_f32 v[38:39], v[38:39], v[30:31], v[62:63] op_sel:[1,0,0] op_sel_hi:[1,1,1]
ds_write_b32 v5, v60 offset:13872
v_cvt_pk_bf16_f32 v48, v32, v33
v_pk_mul_f32 v[50:51], v[32:33], v[24:25] op_sel:[0,0] op_sel_hi:[0,1]
s_nop 0
v_pk_fma_f32 v[32:33], v[32:33], v[26:27], v[50:51] op_sel:[1,0,0] op_sel_hi:[1,1,1]
ds_write_b32 v5, v48 offset:816
v_cvt_pk_bf16_f32 v52, v34, v35
v_pk_mul_f32 v[54:55], v[34:35], v[24:25] op_sel:[0,0] op_sel_hi:[0,1]
s_nop 0
v_pk_fma_f32 v[34:35], v[34:35], v[26:27], v[54:55] op_sel:[1,0,0] op_sel_hi:[1,1,1]
ds_write_b32 v5, v52 offset:5168
v_cvt_pk_bf16_f32 v56, v36, v37
v_pk_mul_f32 v[58:59], v[36:37], v[28:29] op_sel:[0,0] op_sel_hi:[0,1]
s_nop 0
v_pk_fma_f32 v[36:37], v[36:37], v[30:31], v[58:59] op_sel:[1,0,0] op_sel_hi:[1,1,1]
ds_write_b32 v5, v56 offset:9792
v_cvt_pk_bf16_f32 v60, v38, v39
v_pk_mul_f32 v[62:63], v[38:39], v[28:29] op_sel:[0,0] op_sel_hi:[0,1]
s_nop 0
v_pk_fma_f32 v[38:39], v[38:39], v[30:31], v[62:63] op_sel:[1,0,0] op_sel_hi:[1,1,1]
ds_write_b32 v5, v60 offset:14144
v_cvt_pk_bf16_f32 v48, v32, v33
v_pk_mul_f32 v[50:51], v[32:33], v[24:25] op_sel:[0,0] op_sel_hi:[0,1]
s_nop 0
v_pk_fma_f32 v[32:33], v[32:33], v[26:27], v[50:51] op_sel:[1,0,0] op_sel_hi:[1,1,1]
ds_write_b32 v5, v48 offset:1088
v_cvt_pk_bf16_f32 v52, v34, v35
v_pk_mul_f32 v[54:55], v[34:35], v[24:25] op_sel:[0,0] op_sel_hi:[0,1]
s_nop 0
v_pk_fma_f32 v[34:35], v[34:35], v[26:27], v[54:55] op_sel:[1,0,0] op_sel_hi:[1,1,1]
ds_write_b32 v5, v52 offset:5440
v_cvt_pk_bf16_f32 v56, v36, v37
v_pk_mul_f32 v[58:59], v[36:37], v[28:29] op_sel:[0,0] op_sel_hi:[0,1]
s_nop 0
v_pk_fma_f32 v[36:37], v[36:37], v[30:31], v[58:59] op_sel:[1,0,0] op_sel_hi:[1,1,1]
ds_write_b32 v5, v56 offset:10064
v_cvt_pk_bf16_f32 v60, v38, v39
v_pk_mul_f32 v[62:63], v[38:39], v[28:29] op_sel:[0,0] op_sel_hi:[0,1]
s_nop 0
v_pk_fma_f32 v[38:39], v[38:39], v[30:31], v[62:63] op_sel:[1,0,0] op_sel_hi:[1,1,1]
ds_write_b32 v5, v60 offset:14416
v_cvt_pk_bf16_f32 v48, v32, v33
v_pk_mul_f32 v[50:51], v[32:33], v[24:25] op_sel:[0,0] op_sel_hi:[0,1]
s_nop 0
v_pk_fma_f32 v[32:33], v[32:33], v[26:27], v[50:51] op_sel:[1,0,0] op_sel_hi:[1,1,1]
ds_write_b32 v5, v48 offset:1360
v_cvt_pk_bf16_f32 v52, v34, v35
v_pk_mul_f32 v[54:55], v[34:35], v[24:25] op_sel:[0,0] op_sel_hi:[0,1]
s_nop 0
v_pk_fma_f32 v[34:35], v[34:35], v[26:27], v[54:55] op_sel:[1,0,0] op_sel_hi:[1,1,1]
ds_write_b32 v5, v52 offset:5712
v_cvt_pk_bf16_f32 v56, v36, v37
v_pk_mul_f32 v[58:59], v[36:37], v[28:29] op_sel:[0,0] op_sel_hi:[0,1]
s_nop 0
v_pk_fma_f32 v[36:37], v[36:37], v[30:31], v[58:59] op_sel:[1,0,0] op_sel_hi:[1,1,1]
ds_write_b32 v5, v56 offset:10336
v_cvt_pk_bf16_f32 v60, v38, v39
v_pk_mul_f32 v[62:63], v[38:39], v[28:29] op_sel:[0,0] op_sel_hi:[0,1]
s_nop 0
v_pk_fma_f32 v[38:39], v[38:39], v[30:31], v[62:63] op_sel:[1,0,0] op_sel_hi:[1,1,1]
ds_write_b32 v5, v60 offset:14688
v_cvt_pk_bf16_f32 v48, v32, v33
v_pk_mul_f32 v[50:51], v[32:33], v[24:25] op_sel:[0,0] op_sel_hi:[0,1]
s_nop 0
v_pk_fma_f32 v[32:33], v[32:33], v[26:27], v[50:51] op_sel:[1,0,0] op_sel_hi:[1,1,1]
ds_write_b32 v5, v48 offset:1632
v_cvt_pk_bf16_f32 v52, v34, v35
v_pk_mul_f32 v[54:55], v[34:35], v[24:25] op_sel:[0,0] op_sel_hi:[0,1]
s_nop 0
v_pk_fma_f32 v[34:35], v[34:35], v[26:27], v[54:55] op_sel:[1,0,0] op_sel_hi:[1,1,1]
ds_write_b32 v5, v52 offset:5984
v_cvt_pk_bf16_f32 v56, v36, v37
v_pk_mul_f32 v[58:59], v[36:37], v[28:29] op_sel:[0,0] op_sel_hi:[0,1]
s_nop 0
v_pk_fma_f32 v[36:37], v[36:37], v[30:31], v[58:59] op_sel:[1,0,0] op_sel_hi:[1,1,1]
ds_write_b32 v5, v56 offset:10608
v_cvt_pk_bf16_f32 v60, v38, v39
v_pk_mul_f32 v[62:63], v[38:39], v[28:29] op_sel:[0,0] op_sel_hi:[0,1]
s_nop 0
v_pk_fma_f32 v[38:39], v[38:39], v[30:31], v[62:63] op_sel:[1,0,0] op_sel_hi:[1,1,1]
ds_write_b32 v5, v60 offset:14960
v_cvt_pk_bf16_f32 v48, v32, v33
v_pk_mul_f32 v[50:51], v[32:33], v[24:25] op_sel:[0,0] op_sel_hi:[0,1]
s_nop 0
v_pk_fma_f32 v[32:33], v[32:33], v[26:27], v[50:51] op_sel:[1,0,0] op_sel_hi:[1,1,1]
ds_write_b32 v5, v48 offset:1904
v_cvt_pk_bf16_f32 v52, v34, v35
v_pk_mul_f32 v[54:55], v[34:35], v[24:25] op_sel:[0,0] op_sel_hi:[0,1]
s_nop 0
v_pk_fma_f32 v[34:35], v[34:35], v[26:27], v[54:55] op_sel:[1,0,0] op_sel_hi:[1,1,1]
ds_write_b32 v5, v52 offset:6256
v_cvt_pk_bf16_f32 v56, v36, v37
v_pk_mul_f32 v[58:59], v[36:37], v[28:29] op_sel:[0,0] op_sel_hi:[0,1]
s_nop 0
v_pk_fma_f32 v[36:37], v[36:37], v[30:31], v[58:59] op_sel:[1,0,0] op_sel_hi:[1,1,1]
ds_write_b32 v5, v56 offset:10880
v_cvt_pk_bf16_f32 v60, v38, v39
v_pk_mul_f32 v[62:63], v[38:39], v[28:29] op_sel:[0,0] op_sel_hi:[0,1]
s_nop 0
v_pk_fma_f32 v[38:39], v[38:39], v[30:31], v[62:63] op_sel:[1,0,0] op_sel_hi:[1,1,1]
ds_write_b32 v5, v60 offset:15232
v_cvt_pk_bf16_f32 v48, v32, v33
v_pk_mul_f32 v[50:51], v[32:33], v[24:25] op_sel:[0,0] op_sel_hi:[0,1]
s_nop 0
v_pk_fma_f32 v[32:33], v[32:33], v[26:27], v[50:51] op_sel:[1,0,0] op_sel_hi:[1,1,1]
ds_write_b32 v5, v48 offset:2176
v_cvt_pk_bf16_f32 v52, v34, v35
v_pk_mul_f32 v[54:55], v[34:35], v[24:25] op_sel:[0,0] op_sel_hi:[0,1]
s_nop 0
v_pk_fma_f32 v[34:35], v[34:35], v[26:27], v[54:55] op_sel:[1,0,0] op_sel_hi:[1,1,1]
ds_write_b32 v5, v52 offset:6528
v_cvt_pk_bf16_f32 v56, v36, v37
v_pk_mul_f32 v[58:59], v[36:37], v[28:29] op_sel:[0,0] op_sel_hi:[0,1]
s_nop 0
v_pk_fma_f32 v[36:37], v[36:37], v[30:31], v[58:59] op_sel:[1,0,0] op_sel_hi:[1,1,1]
ds_write_b32 v5, v56 offset:11152
v_cvt_pk_bf16_f32 v60, v38, v39
v_pk_mul_f32 v[62:63], v[38:39], v[28:29] op_sel:[0,0] op_sel_hi:[0,1]
s_nop 0
v_pk_fma_f32 v[38:39], v[38:39], v[30:31], v[62:63] op_sel:[1,0,0] op_sel_hi:[1,1,1]
ds_write_b32 v5, v60 offset:15504
v_cvt_pk_bf16_f32 v48, v32, v33
v_pk_mul_f32 v[50:51], v[32:33], v[24:25] op_sel:[0,0] op_sel_hi:[0,1]
s_nop 0
v_pk_fma_f32 v[32:33], v[32:33], v[26:27], v[50:51] op_sel:[1,0,0] op_sel_hi:[1,1,1]
ds_write_b32 v5, v48 offset:2448
v_cvt_pk_bf16_f32 v52, v34, v35
v_pk_mul_f32 v[54:55], v[34:35], v[24:25] op_sel:[0,0] op_sel_hi:[0,1]
s_nop 0
v_pk_fma_f32 v[34:35], v[34:35], v[26:27], v[54:55] op_sel:[1,0,0] op_sel_hi:[1,1,1]
ds_write_b32 v5, v52 offset:6800
v_cvt_pk_bf16_f32 v56, v36, v37
v_pk_mul_f32 v[58:59], v[36:37], v[28:29] op_sel:[0,0] op_sel_hi:[0,1]
s_nop 0
v_pk_fma_f32 v[36:37], v[36:37], v[30:31], v[58:59] op_sel:[1,0,0] op_sel_hi:[1,1,1]
ds_write_b32 v5, v56 offset:11424
v_cvt_pk_bf16_f32 v60, v38, v39
v_pk_mul_f32 v[62:63], v[38:39], v[28:29] op_sel:[0,0] op_sel_hi:[0,1]
s_nop 0
v_pk_fma_f32 v[38:39], v[38:39], v[30:31], v[62:63] op_sel:[1,0,0] op_sel_hi:[1,1,1]
ds_write_b32 v5, v60 offset:15776
v_cvt_pk_bf16_f32 v48, v32, v33
v_pk_mul_f32 v[50:51], v[32:33], v[24:25] op_sel:[0,0] op_sel_hi:[0,1]
s_nop 0
v_pk_fma_f32 v[32:33], v[32:33], v[26:27], v[50:51] op_sel:[1,0,0] op_sel_hi:[1,1,1]
ds_write_b32 v5, v48 offset:2720
v_cvt_pk_bf16_f32 v52, v34, v35
v_pk_mul_f32 v[54:55], v[34:35], v[24:25] op_sel:[0,0] op_sel_hi:[0,1]
s_nop 0
v_pk_fma_f32 v[34:35], v[34:35], v[26:27], v[54:55] op_sel:[1,0,0] op_sel_hi:[1,1,1]
ds_write_b32 v5, v52 offset:7072
v_cvt_pk_bf16_f32 v56, v36, v37
v_pk_mul_f32 v[58:59], v[36:37], v[28:29] op_sel:[0,0] op_sel_hi:[0,1]
s_nop 0
v_pk_fma_f32 v[36:37], v[36:37], v[30:31], v[58:59] op_sel:[1,0,0] op_sel_hi:[1,1,1]
ds_write_b32 v5, v56 offset:11696
v_cvt_pk_bf16_f32 v60, v38, v39
v_pk_mul_f32 v[62:63], v[38:39], v[28:29] op_sel:[0,0] op_sel_hi:[0,1]
s_nop 0
v_pk_fma_f32 v[38:39], v[38:39], v[30:31], v[62:63] op_sel:[1,0,0] op_sel_hi:[1,1,1]
ds_write_b32 v5, v60 offset:16048
v_cvt_pk_bf16_f32 v48, v32, v33
v_pk_mul_f32 v[50:51], v[32:33], v[24:25] op_sel:[0,0] op_sel_hi:[0,1]
s_nop 0
v_pk_fma_f32 v[32:33], v[32:33], v[26:27], v[50:51] op_sel:[1,0,0] op_sel_hi:[1,1,1]
ds_write_b32 v5, v48 offset:2992
v_cvt_pk_bf16_f32 v52, v34, v35
v_pk_mul_f32 v[54:55], v[34:35], v[24:25] op_sel:[0,0] op_sel_hi:[0,1]
s_nop 0
v_pk_fma_f32 v[34:35], v[34:35], v[26:27], v[54:55] op_sel:[1,0,0] op_sel_hi:[1,1,1]
ds_write_b32 v5, v52 offset:7344
v_cvt_pk_bf16_f32 v56, v36, v37
v_pk_mul_f32 v[58:59], v[36:37], v[28:29] op_sel:[0,0] op_sel_hi:[0,1]
s_nop 0
v_pk_fma_f32 v[36:37], v[36:37], v[30:31], v[58:59] op_sel:[1,0,0] op_sel_hi:[1,1,1]
ds_write_b32 v5, v56 offset:11968
v_cvt_pk_bf16_f32 v60, v38, v39
v_pk_mul_f32 v[62:63], v[38:39], v[28:29] op_sel:[0,0] op_sel_hi:[0,1]
s_nop 0
v_pk_fma_f32 v[38:39], v[38:39], v[30:31], v[62:63] op_sel:[1,0,0] op_sel_hi:[1,1,1]
ds_write_b32 v5, v60 offset:16320
v_cvt_pk_bf16_f32 v48, v32, v33
v_pk_mul_f32 v[50:51], v[32:33], v[24:25] op_sel:[0,0] op_sel_hi:[0,1]
s_nop 0
v_pk_fma_f32 v[32:33], v[32:33], v[26:27], v[50:51] op_sel:[1,0,0] op_sel_hi:[1,1,1]
ds_write_b32 v5, v48 offset:3264
v_cvt_pk_bf16_f32 v52, v34, v35
v_pk_mul_f32 v[54:55], v[34:35], v[24:25] op_sel:[0,0] op_sel_hi:[0,1]
s_nop 0
v_pk_fma_f32 v[34:35], v[34:35], v[26:27], v[54:55] op_sel:[1,0,0] op_sel_hi:[1,1,1]
ds_write_b32 v5, v52 offset:7616
v_cvt_pk_bf16_f32 v56, v36, v37
v_pk_mul_f32 v[58:59], v[36:37], v[28:29] op_sel:[0,0] op_sel_hi:[0,1]
s_nop 0
v_pk_fma_f32 v[36:37], v[36:37], v[30:31], v[58:59] op_sel:[1,0,0] op_sel_hi:[1,1,1]
ds_write_b32 v5, v56 offset:12240
v_cvt_pk_bf16_f32 v60, v38, v39
v_pk_mul_f32 v[62:63], v[38:39], v[28:29] op_sel:[0,0] op_sel_hi:[0,1]
s_nop 0
v_pk_fma_f32 v[38:39], v[38:39], v[30:31], v[62:63] op_sel:[1,0,0] op_sel_hi:[1,1,1]
ds_write_b32 v5, v60 offset:16592
v_cvt_pk_bf16_f32 v48, v32, v33
v_pk_mul_f32 v[50:51], v[32:33], v[24:25] op_sel:[0,0] op_sel_hi:[0,1]
s_nop 0
v_pk_fma_f32 v[32:33], v[32:33], v[26:27], v[50:51] op_sel:[1,0,0] op_sel_hi:[1,1,1]
ds_write_b32 v5, v48 offset:3536
v_cvt_pk_bf16_f32 v52, v34, v35
v_pk_mul_f32 v[54:55], v[34:35], v[24:25] op_sel:[0,0] op_sel_hi:[0,1]
s_nop 0
v_pk_fma_f32 v[34:35], v[34:35], v[26:27], v[54:55] op_sel:[1,0,0] op_sel_hi:[1,1,1]
ds_write_b32 v5, v52 offset:7888
v_cvt_pk_bf16_f32 v56, v36, v37
v_pk_mul_f32 v[58:59], v[36:37], v[28:29] op_sel:[0,0] op_sel_hi:[0,1]
s_nop 0
v_pk_fma_f32 v[36:37], v[36:37], v[30:31], v[58:59] op_sel:[1,0,0] op_sel_hi:[1,1,1]
ds_write_b32 v5, v56 offset:12512
v_cvt_pk_bf16_f32 v60, v38, v39
v_pk_mul_f32 v[62:63], v[38:39], v[28:29] op_sel:[0,0] op_sel_hi:[0,1]
s_nop 0
v_pk_fma_f32 v[38:39], v[38:39], v[30:31], v[62:63] op_sel:[1,0,0] op_sel_hi:[1,1,1]
ds_write_b32 v5, v60 offset:16864
v_cvt_pk_bf16_f32 v48, v32, v33
v_pk_mul_f32 v[50:51], v[32:33], v[24:25] op_sel:[0,0] op_sel_hi:[0,1]
s_nop 0
v_pk_fma_f32 v[32:33], v[32:33], v[26:27], v[50:51] op_sel:[1,0,0] op_sel_hi:[1,1,1]
ds_write_b32 v5, v48 offset:3808
v_cvt_pk_bf16_f32 v52, v34, v35
v_pk_mul_f32 v[54:55], v[34:35], v[24:25] op_sel:[0,0] op_sel_hi:[0,1]
s_nop 0
v_pk_fma_f32 v[34:35], v[34:35], v[26:27], v[54:55] op_sel:[1,0,0] op_sel_hi:[1,1,1]
ds_write_b32 v5, v52 offset:8160
v_cvt_pk_bf16_f32 v56, v36, v37
v_pk_mul_f32 v[58:59], v[36:37], v[28:29] op_sel:[0,0] op_sel_hi:[0,1]
s_nop 0
v_pk_fma_f32 v[36:37], v[36:37], v[30:31], v[58:59] op_sel:[1,0,0] op_sel_hi:[1,1,1]
ds_write_b32 v5, v56 offset:12784
v_cvt_pk_bf16_f32 v60, v38, v39
v_pk_mul_f32 v[62:63], v[38:39], v[28:29] op_sel:[0,0] op_sel_hi:[0,1]
s_nop 0
v_pk_fma_f32 v[38:39], v[38:39], v[30:31], v[62:63] op_sel:[1,0,0] op_sel_hi:[1,1,1]
ds_write_b32 v5, v60 offset:17136
v_cvt_pk_bf16_f32 v48, v32, v33
ds_write_b32 v5, v48 offset:4080
v_cvt_pk_bf16_f32 v52, v34, v35
v_pk_mul_f32 v[54:55], v[34:35], v[24:25] op_sel:[0,0] op_sel_hi:[0,1]
s_nop 0
v_pk_fma_f32 v[34:35], v[34:35], v[26:27], v[54:55] op_sel:[1,0,0] op_sel_hi:[1,1,1]
ds_write_b32 v5, v52 offset:8432
v_cvt_pk_bf16_f32 v56, v36, v37
ds_write_b32 v5, v56 offset:13056
v_cvt_pk_bf16_f32 v60, v38, v39
ds_write_b32 v5, v60 offset:17408
v_cvt_pk_bf16_f32 v52, v34, v35
ds_write_b32 v5, v52 offset:8704
s_waitcnt lgkmcnt(0)
v_mov_b32 v112, 0
v_mov_b32 v113, 0
v_mov_b32 v114, 0
v_mov_b32 v115, 0
v_mov_b32 v116, 0
v_mov_b32 v117, 0
v_mov_b32 v118, 0
v_mov_b32 v119, 0
v_mov_b32 v120, 0
v_mov_b32 v121, 0
v_mov_b32 v122, 0
v_mov_b32 v123, 0
v_mov_b32 v124, 0
v_mov_b32 v125, 0
v_mov_b32 v126, 0
v_mov_b32 v127, 0
v_mov_b32 v128, 0
v_mov_b32 v129, 0
v_mov_b32 v130, 0
v_mov_b32 v131, 0
v_mov_b32 v132, 0
v_mov_b32 v133, 0
v_mov_b32 v134, 0
v_mov_b32 v135, 0
v_mov_b32 v136, 0
v_mov_b32 v137, 0
v_mov_b32 v138, 0
v_mov_b32 v139, 0
v_mov_b32 v140, 0
v_mov_b32 v141, 0
v_mov_b32 v142, 0
v_mov_b32 v143, 0
v_mov_b32 v144, 0
v_mov_b32 v145, 0
v_mov_b32 v146, 0
v_mov_b32 v147, 0
v_mov_b32 v148, 0
v_mov_b32 v149, 0
v_mov_b32 v150, 0
v_mov_b32 v151, 0
ds_read_b128 v[152:155], v108 offset:0
ds_read_b128 v[168:171], v108 offset:4352
ds_read_b128 v[156:159], v108 offset:64
ds_read_b128 v[172:175], v108 offset:4416
ds_read_b128 v[160:163], v108 offset:128
ds_read_b128 v[176:179], v108 offset:4480
ds_read_b128 v[164:167], v108 offset:192
ds_read_b128 v[180:183], v108 offset:4544
ds_read_b128 v[184:187], v100 offset:0
ds_read_b128 v[188:191], v100 offset:64
ds_read_b128 v[192:195], v100 offset:128
ds_read_b128 v[196:199], v100 offset:192
s_waitcnt lgkmcnt(0)
v_mfma_f32_16x16x32_bf16 v[112:115], v[184:187], v[152:155], v[112:115]
v_mfma_f32_16x16x32_bf16 v[112:115], v[188:191], v[156:159], v[112:115]
v_mfma_f32_16x16x32_bf16 v[112:115], v[192:195], v[160:163], v[112:115]
v_mfma_f32_16x16x32_bf16 v[112:115], v[196:199], v[164:167], v[112:115]
ds_read_b128 v[200:203], v101 offset:0
ds_read_b128 v[204:207], v101 offset:64
ds_read_b128 v[208:211], v101 offset:128
ds_read_b128 v[212:215], v101 offset:192
s_waitcnt lgkmcnt(0)
v_mfma_f32_16x16x32_bf16 v[116:119], v[200:203], v[152:155], v[116:119]
v_mfma_f32_16x16x32_bf16 v[116:119], v[204:207], v[156:159], v[116:119]
v_mfma_f32_16x16x32_bf16 v[116:119], v[208:211], v[160:163], v[116:119]
v_mfma_f32_16x16x32_bf16 v[116:119], v[212:215], v[164:167], v[116:119]
ds_read_b128 v[184:187], v102 offset:0
ds_read_b128 v[188:191], v102 offset:64
ds_read_b128 v[192:195], v102 offset:128
ds_read_b128 v[196:199], v102 offset:192
s_waitcnt lgkmcnt(0)
v_mfma_f32_16x16x32_bf16 v[120:123], v[184:187], v[152:155], v[120:123]
v_mfma_f32_16x16x32_bf16 v[120:123], v[188:191], v[156:159], v[120:123]
v_mfma_f32_16x16x32_bf16 v[120:123], v[192:195], v[160:163], v[120:123]
v_mfma_f32_16x16x32_bf16 v[120:123], v[196:199], v[164:167], v[120:123]
ds_read_b128 v[200:203], v103 offset:0
ds_read_b128 v[204:207], v103 offset:64
ds_read_b128 v[208:211], v103 offset:128
ds_read_b128 v[212:215], v103 offset:192
s_waitcnt lgkmcnt(0)
v_mfma_f32_16x16x32_bf16 v[124:127], v[200:203], v[152:155], v[124:127]
v_mfma_f32_16x16x32_bf16 v[124:127], v[204:207], v[156:159], v[124:127]
v_mfma_f32_16x16x32_bf16 v[124:127], v[208:211], v[160:163], v[124:127]
v_mfma_f32_16x16x32_bf16 v[124:127], v[212:215], v[164:167], v[124:127]
ds_read_b128 v[184:187], v104 offset:0
ds_read_b128 v[188:191], v104 offset:64
ds_read_b128 v[192:195], v104 offset:128
ds_read_b128 v[196:199], v104 offset:192
s_waitcnt lgkmcnt(0)
v_mfma_f32_16x16x32_bf16 v[128:131], v[184:187], v[168:171], v[128:131]
v_mfma_f32_16x16x32_bf16 v[128:131], v[188:191], v[172:175], v[128:131]
v_mfma_f32_16x16x32_bf16 v[128:131], v[192:195], v[176:179], v[128:131]
v_mfma_f32_16x16x32_bf16 v[128:131], v[196:199], v[180:183], v[128:131]
ds_read_b128 v[200:203], v105 offset:0
ds_read_b128 v[204:207], v105 offset:64
ds_read_b128 v[208:211], v105 offset:128
ds_read_b128 v[212:215], v105 offset:192
s_waitcnt lgkmcnt(0)
v_mfma_f32_16x16x32_bf16 v[132:135], v[200:203], v[168:171], v[132:135]
v_mfma_f32_16x16x32_bf16 v[132:135], v[204:207], v[172:175], v[132:135]
v_mfma_f32_16x16x32_bf16 v[132:135], v[208:211], v[176:179], v[132:135]
v_mfma_f32_16x16x32_bf16 v[132:135], v[212:215], v[180:183], v[132:135]
v_cvt_pk_bf16_f32 v56, v40, v41
v_pk_mul_f32 v[58:59], v[40:41], v[28:29] op_sel:[0,0] op_sel_hi:[0,1]
s_nop 0
v_pk_fma_f32 v[40:41], v[40:41], v[30:31], v[58:59] op_sel:[1,0,0] op_sel_hi:[1,1,1]
ds_write_b32 v5, v56 offset:8976
v_cvt_pk_bf16_f32 v60, v42, v43
v_pk_mul_f32 v[62:63], v[42:43], v[28:29] op_sel:[0,0] op_sel_hi:[0,1]
s_nop 0
v_pk_fma_f32 v[42:43], v[42:43], v[30:31], v[62:63] op_sel:[1,0,0] op_sel_hi:[1,1,1]
ds_write_b32 v5, v60 offset:13328
v_cvt_pk_bf16_f32 v56, v40, v41
v_pk_mul_f32 v[58:59], v[40:41], v[28:29] op_sel:[0,0] op_sel_hi:[0,1]
s_nop 0
v_pk_fma_f32 v[40:41], v[40:41], v[30:31], v[58:59] op_sel:[1,0,0] op_sel_hi:[1,1,1]
ds_write_b32 v5, v56 offset:9248
v_cvt_pk_bf16_f32 v60, v42, v43
v_pk_mul_f32 v[62:63], v[42:43], v[28:29] op_sel:[0,0] op_sel_hi:[0,1]
s_nop 0
v_pk_fma_f32 v[42:43], v[42:43], v[30:31], v[62:63] op_sel:[1,0,0] op_sel_hi:[1,1,1]
ds_write_b32 v5, v60 offset:13600
v_cvt_pk_bf16_f32 v56, v40, v41
v_pk_mul_f32 v[58:59], v[40:41], v[28:29] op_sel:[0,0] op_sel_hi:[0,1]
s_nop 0
v_pk_fma_f32 v[40:41], v[40:41], v[30:31], v[58:59] op_sel:[1,0,0] op_sel_hi:[1,1,1]
ds_write_b32 v5, v56 offset:9520
v_cvt_pk_bf16_f32 v60, v42, v43
v_pk_mul_f32 v[62:63], v[42:43], v[28:29] op_sel:[0,0] op_sel_hi:[0,1]
s_nop 0
v_pk_fma_f32 v[42:43], v[42:43], v[30:31], v[62:63] op_sel:[1,0,0] op_sel_hi:[1,1,1]
ds_write_b32 v5, v60 offset:13872
v_cvt_pk_bf16_f32 v56, v40, v41
v_pk_mul_f32 v[58:59], v[40:41], v[28:29] op_sel:[0,0] op_sel_hi:[0,1]
s_nop 0
v_pk_fma_f32 v[40:41], v[40:41], v[30:31], v[58:59] op_sel:[1,0,0] op_sel_hi:[1,1,1]
ds_write_b32 v5, v56 offset:9792
v_cvt_pk_bf16_f32 v60, v42, v43
v_pk_mul_f32 v[62:63], v[42:43], v[28:29] op_sel:[0,0] op_sel_hi:[0,1]
s_nop 0
v_pk_fma_f32 v[42:43], v[42:43], v[30:31], v[62:63] op_sel:[1,0,0] op_sel_hi:[1,1,1]
ds_write_b32 v5, v60 offset:14144
v_cvt_pk_bf16_f32 v56, v40, v41
v_pk_mul_f32 v[58:59], v[40:41], v[28:29] op_sel:[0,0] op_sel_hi:[0,1]
s_nop 0
v_pk_fma_f32 v[40:41], v[40:41], v[30:31], v[58:59] op_sel:[1,0,0] op_sel_hi:[1,1,1]
ds_write_b32 v5, v56 offset:10064
v_cvt_pk_bf16_f32 v60, v42, v43
v_pk_mul_f32 v[62:63], v[42:43], v[28:29] op_sel:[0,0] op_sel_hi:[0,1]
s_nop 0
v_pk_fma_f32 v[42:43], v[42:43], v[30:31], v[62:63] op_sel:[1,0,0] op_sel_hi:[1,1,1]
ds_write_b32 v5, v60 offset:14416
v_cvt_pk_bf16_f32 v56, v40, v41
v_pk_mul_f32 v[58:59], v[40:41], v[28:29] op_sel:[0,0] op_sel_hi:[0,1]
s_nop 0
v_pk_fma_f32 v[40:41], v[40:41], v[30:31], v[58:59] op_sel:[1,0,0] op_sel_hi:[1,1,1]
ds_write_b32 v5, v56 offset:10336
v_cvt_pk_bf16_f32 v60, v42, v43
v_pk_mul_f32 v[62:63], v[42:43], v[28:29] op_sel:[0,0] op_sel_hi:[0,1]
s_nop 0
v_pk_fma_f32 v[42:43], v[42:43], v[30:31], v[62:63] op_sel:[1,0,0] op_sel_hi:[1,1,1]
ds_write_b32 v5, v60 offset:14688
v_cvt_pk_bf16_f32 v56, v40, v41
v_pk_mul_f32 v[58:59], v[40:41], v[28:29] op_sel:[0,0] op_sel_hi:[0,1]
s_nop 0
v_pk_fma_f32 v[40:41], v[40:41], v[30:31], v[58:59] op_sel:[1,0,0] op_sel_hi:[1,1,1]
ds_write_b32 v5, v56 offset:10608
v_cvt_pk_bf16_f32 v60, v42, v43
v_pk_mul_f32 v[62:63], v[42:43], v[28:29] op_sel:[0,0] op_sel_hi:[0,1]
s_nop 0
v_pk_fma_f32 v[42:43], v[42:43], v[30:31], v[62:63] op_sel:[1,0,0] op_sel_hi:[1,1,1]
ds_write_b32 v5, v60 offset:14960
v_cvt_pk_bf16_f32 v56, v40, v41
v_pk_mul_f32 v[58:59], v[40:41], v[28:29] op_sel:[0,0] op_sel_hi:[0,1]
s_nop 0
v_pk_fma_f32 v[40:41], v[40:41], v[30:31], v[58:59] op_sel:[1,0,0] op_sel_hi:[1,1,1]
ds_write_b32 v5, v56 offset:10880
v_cvt_pk_bf16_f32 v60, v42, v43
v_pk_mul_f32 v[62:63], v[42:43], v[28:29] op_sel:[0,0] op_sel_hi:[0,1]
s_nop 0
v_pk_fma_f32 v[42:43], v[42:43], v[30:31], v[62:63] op_sel:[1,0,0] op_sel_hi:[1,1,1]
ds_write_b32 v5, v60 offset:15232
v_cvt_pk_bf16_f32 v56, v40, v41
v_pk_mul_f32 v[58:59], v[40:41], v[28:29] op_sel:[0,0] op_sel_hi:[0,1]
s_nop 0
v_pk_fma_f32 v[40:41], v[40:41], v[30:31], v[58:59] op_sel:[1,0,0] op_sel_hi:[1,1,1]
ds_write_b32 v5, v56 offset:11152
v_cvt_pk_bf16_f32 v60, v42, v43
v_pk_mul_f32 v[62:63], v[42:43], v[28:29] op_sel:[0,0] op_sel_hi:[0,1]
s_nop 0
v_pk_fma_f32 v[42:43], v[42:43], v[30:31], v[62:63] op_sel:[1,0,0] op_sel_hi:[1,1,1]
ds_write_b32 v5, v60 offset:15504
v_cvt_pk_bf16_f32 v56, v40, v41
v_pk_mul_f32 v[58:59], v[40:41], v[28:29] op_sel:[0,0] op_sel_hi:[0,1]
s_nop 0
v_pk_fma_f32 v[40:41], v[40:41], v[30:31], v[58:59] op_sel:[1,0,0] op_sel_hi:[1,1,1]
ds_write_b32 v5, v56 offset:11424
v_cvt_pk_bf16_f32 v60, v42, v43
v_pk_mul_f32 v[62:63], v[42:43], v[28:29] op_sel:[0,0] op_sel_hi:[0,1]
s_nop 0
v_pk_fma_f32 v[42:43], v[42:43], v[30:31], v[62:63] op_sel:[1,0,0] op_sel_hi:[1,1,1]
ds_write_b32 v5, v60 offset:15776
v_cvt_pk_bf16_f32 v56, v40, v41
v_pk_mul_f32 v[58:59], v[40:41], v[28:29] op_sel:[0,0] op_sel_hi:[0,1]
s_nop 0
v_pk_fma_f32 v[40:41], v[40:41], v[30:31], v[58:59] op_sel:[1,0,0] op_sel_hi:[1,1,1]
ds_write_b32 v5, v56 offset:11696
v_cvt_pk_bf16_f32 v60, v42, v43
v_pk_mul_f32 v[62:63], v[42:43], v[28:29] op_sel:[0,0] op_sel_hi:[0,1]
s_nop 0
v_pk_fma_f32 v[42:43], v[42:43], v[30:31], v[62:63] op_sel:[1,0,0] op_sel_hi:[1,1,1]
ds_write_b32 v5, v60 offset:16048
v_cvt_pk_bf16_f32 v56, v40, v41
v_pk_mul_f32 v[58:59], v[40:41], v[28:29] op_sel:[0,0] op_sel_hi:[0,1]
s_nop 0
v_pk_fma_f32 v[40:41], v[40:41], v[30:31], v[58:59] op_sel:[1,0,0] op_sel_hi:[1,1,1]
ds_write_b32 v5, v56 offset:11968
v_cvt_pk_bf16_f32 v60, v42, v43
v_pk_mul_f32 v[62:63], v[42:43], v[28:29] op_sel:[0,0] op_sel_hi:[0,1]
s_nop 0
v_pk_fma_f32 v[42:43], v[42:43], v[30:31], v[62:63] op_sel:[1,0,0] op_sel_hi:[1,1,1]
ds_write_b32 v5, v60 offset:16320
v_cvt_pk_bf16_f32 v56, v40, v41
v_pk_mul_f32 v[58:59], v[40:41], v[28:29] op_sel:[0,0] op_sel_hi:[0,1]
s_nop 0
v_pk_fma_f32 v[40:41], v[40:41], v[30:31], v[58:59] op_sel:[1,0,0] op_sel_hi:[1,1,1]
ds_write_b32 v5, v56 offset:12240
v_cvt_pk_bf16_f32 v60, v42, v43
v_pk_mul_f32 v[62:63], v[42:43], v[28:29] op_sel:[0,0] op_sel_hi:[0,1]
s_nop 0
v_pk_fma_f32 v[42:43], v[42:43], v[30:31], v[62:63] op_sel:[1,0,0] op_sel_hi:[1,1,1]
ds_write_b32 v5, v60 offset:16592
v_cvt_pk_bf16_f32 v56, v40, v41
v_pk_mul_f32 v[58:59], v[40:41], v[28:29] op_sel:[0,0] op_sel_hi:[0,1]
s_nop 0
v_pk_fma_f32 v[40:41], v[40:41], v[30:31], v[58:59] op_sel:[1,0,0] op_sel_hi:[1,1,1]
ds_write_b32 v5, v56 offset:12512
v_cvt_pk_bf16_f32 v60, v42, v43
v_pk_mul_f32 v[62:63], v[42:43], v[28:29] op_sel:[0,0] op_sel_hi:[0,1]
s_nop 0
v_pk_fma_f32 v[42:43], v[42:43], v[30:31], v[62:63] op_sel:[1,0,0] op_sel_hi:[1,1,1]
ds_write_b32 v5, v60 offset:16864
v_cvt_pk_bf16_f32 v56, v40, v41
v_pk_mul_f32 v[58:59], v[40:41], v[28:29] op_sel:[0,0] op_sel_hi:[0,1]
s_nop 0
v_pk_fma_f32 v[40:41], v[40:41], v[30:31], v[58:59] op_sel:[1,0,0] op_sel_hi:[1,1,1]
ds_write_b32 v5, v56 offset:12784
v_cvt_pk_bf16_f32 v60, v42, v43
v_pk_mul_f32 v[62:63], v[42:43], v[28:29] op_sel:[0,0] op_sel_hi:[0,1]
s_nop 0
v_pk_fma_f32 v[42:43], v[42:43], v[30:31], v[62:63] op_sel:[1,0,0] op_sel_hi:[1,1,1]
ds_write_b32 v5, v60 offset:17136
v_cvt_pk_bf16_f32 v56, v40, v41
ds_write_b32 v5, v56 offset:13056
v_cvt_pk_bf16_f32 v60, v42, v43
ds_write_b32 v5, v60 offset:17408
s_waitcnt lgkmcnt(0)
ds_read_b128 v[152:155], v108 offset:0
ds_read_b128 v[168:171], v108 offset:4352
ds_read_b128 v[156:159], v108 offset:64
ds_read_b128 v[172:175], v108 offset:4416
ds_read_b128 v[160:163], v108 offset:128
ds_read_b128 v[176:179], v108 offset:4480
ds_read_b128 v[164:167], v108 offset:192
ds_read_b128 v[180:183], v108 offset:4544
ds_read_b128 v[184:187], v106 offset:0
ds_read_b128 v[188:191], v106 offset:64
ds_read_b128 v[192:195], v106 offset:128
ds_read_b128 v[196:199], v106 offset:192
ds_read_b128 v[200:203], v107 offset:0
ds_read_b128 v[204:207], v107 offset:64
ds_read_b128 v[208:211], v107 offset:128
ds_read_b128 v[212:215], v107 offset:192
s_waitcnt lgkmcnt(0)
v_mfma_f32_16x16x32_bf16 v[136:139], v[184:187], v[152:155], v[136:139]
v_mfma_f32_16x16x32_bf16 v[144:147], v[184:187], v[168:171], v[144:147]
v_mfma_f32_16x16x32_bf16 v[136:139], v[188:191], v[156:159], v[136:139]
v_mfma_f32_16x16x32_bf16 v[144:147], v[188:191], v[172:175], v[144:147]
v_mfma_f32_16x16x32_bf16 v[136:139], v[192:195], v[160:163], v[136:139]
v_mfma_f32_16x16x32_bf16 v[144:147], v[192:195], v[176:179], v[144:147]
v_mfma_f32_16x16x32_bf16 v[136:139], v[196:199], v[164:167], v[136:139]
v_mfma_f32_16x16x32_bf16 v[144:147], v[196:199], v[180:183], v[144:147]
v_mfma_f32_16x16x32_bf16 v[140:143], v[200:203], v[152:155], v[140:143]
v_mfma_f32_16x16x32_bf16 v[148:151], v[200:203], v[168:171], v[148:151]
v_mfma_f32_16x16x32_bf16 v[140:143], v[204:207], v[156:159], v[140:143]
v_mfma_f32_16x16x32_bf16 v[148:151], v[204:207], v[172:175], v[148:151]
v_mfma_f32_16x16x32_bf16 v[140:143], v[208:211], v[160:163], v[140:143]
v_mfma_f32_16x16x32_bf16 v[148:151], v[208:211], v[176:179], v[148:151]
v_mfma_f32_16x16x32_bf16 v[140:143], v[212:215], v[164:167], v[140:143]
v_mfma_f32_16x16x32_bf16 v[148:151], v[212:215], v[180:183], v[148:151]
v_cmp_gt_u32 vcc, 8, v6
s_nop 1
v_cndmask_b32 v120, v120, v112, vcc
v_cndmask_b32 v121, v121, v113, vcc
v_cndmask_b32 v122, v122, v114, vcc
v_cndmask_b32 v123, v123, v115, vcc
v_cndmask_b32 v124, v124, v116, vcc
v_cndmask_b32 v125, v125, v117, vcc
v_cndmask_b32 v126, v126, v118, vcc
v_cndmask_b32 v127, v127, v119, vcc
v_lshlrev_b32 v16, 4, v1
v_add_u32 v16, s42, v16
v_add_u32 v16, 8976, v16
s_xor_b32 s43, s4, 1
s_mul_i32 s43, s43, 17680
v_lshlrev_b32 v17, 4, v1
v_add_u32 v17, s43, v17
v_add_u32 v17, 8976, v17
s_cmp_eq_u32 s6, 0
s_cbranch_scc1 L_6
v_mov_b32 v152, v120
v_mov_b32 v120, v136
v_mov_b32 v153, v121
v_mov_b32 v121, v137
v_mov_b32 v154, v122
v_mov_b32 v122, v138
v_mov_b32 v155, v123
v_mov_b32 v123, v139
v_mov_b32 v156, v124
v_mov_b32 v124, v140
v_mov_b32 v157, v125
v_mov_b32 v125, v141
v_mov_b32 v158, v126
v_mov_b32 v126, v142
v_mov_b32 v159, v127
v_mov_b32 v127, v143
v_mov_b32 v160, v128
v_mov_b32 v128, v144
v_mov_b32 v161, v129
v_mov_b32 v129, v145
v_mov_b32 v162, v130
v_mov_b32 v130, v146
v_mov_b32 v163, v131
v_mov_b32 v131, v147
v_mov_b32 v164, v132
v_mov_b32 v132, v148
v_mov_b32 v165, v133
v_mov_b32 v133, v149
v_mov_b32 v166, v134
v_mov_b32 v134, v150
v_mov_b32 v167, v135
v_mov_b32 v135, v151
s_branch L_7
L_6:
v_mov_b32 v152, v136
v_mov_b32 v153, v137
v_mov_b32 v154, v138
v_mov_b32 v155, v139
v_mov_b32 v156, v140
v_mov_b32 v157, v141
v_mov_b32 v158, v142
v_mov_b32 v159, v143
v_mov_b32 v160, v144
v_mov_b32 v161, v145
v_mov_b32 v162, v146
v_mov_b32 v163, v147
v_mov_b32 v164, v148
v_mov_b32 v165, v149
v_mov_b32 v166, v150
v_mov_b32 v167, v151
L_7:
ds_write_b128 v16, v[152:155] offset:0
ds_write_b128 v16, v[156:159] offset:1024
ds_write_b128 v16, v[160:163] offset:2048
ds_write_b128 v16, v[164:167] offset:3072
s_waitcnt lgkmcnt(0)
s_barrier
ds_read_b128 v[152:155], v17 offset:0
ds_read_b128 v[156:159], v17 offset:1024
ds_read_b128 v[160:163], v17 offset:2048
ds_read_b128 v[164:167], v17 offset:3072
s_mul_i32 s44, s5, 4224
s_add_u32 s44, s44, 6291456
s_lshl_b32 s45, s6, 11
v_lshlrev_b32 v18, 6, v6
v_lshlrev_b32 v19, 3, v7
v_add_u32 v18, v18, v19
v_add_u32 v18, s45, v18
v_sub_u32 v18, 4088, v18
v_subrev_u32 v19, 1056, v18
s_waitcnt lgkmcnt(0)
v_add_f32 v120, v120, v152
v_add_f32 v121, v121, v153
v_add_f32 v122, v122, v154
v_add_f32 v123, v123, v155
v_add_f32 v124, v124, v156
v_add_f32 v125, v125, v157
v_add_f32 v126, v126, v158
v_add_f32 v127, v127, v159
v_add_f32 v128, v128, v160
v_add_f32 v129, v129, v161
v_add_f32 v130, v130, v162
v_add_f32 v131, v131, v163
v_add_f32 v132, v132, v164
v_add_f32 v133, v133, v165
v_add_f32 v134, v134, v166
v_add_f32 v135, v135, v167
v_cvt_pk_bf16_f32 v152, v123, v122
v_cvt_pk_bf16_f32 v153, v121, v120
buffer_store_dwordx2 v[152:153], v19, s[36:39], s44 offen offset:1056
v_cvt_pk_bf16_f32 v154, v127, v126
v_cvt_pk_bf16_f32 v155, v125, v124
buffer_store_dwordx2 v[154:155], v19, s[36:39], s44 offen offset:1024
v_cvt_pk_bf16_f32 v156, v131, v130
v_cvt_pk_bf16_f32 v157, v129, v128
buffer_store_dwordx2 v[156:157], v19, s[36:39], s44 offen offset:32
v_cvt_pk_bf16_f32 v158, v135, v134
v_cvt_pk_bf16_f32 v159, v133, v132
buffer_store_dwordx2 v[158:159], v19, s[36:39], s44 offen offset:0
v_lshlrev_b32 v20, 3, v6
v_add_u32 v20, 4096, v20
v_mov_b32 v22, 0
v_mov_b32 v23, 0
buffer_store_dwordx2 v[22:23], v20, s[36:39], s44 offen
s_endpgm
L_2:
s_cmp_ge_u32 s2, 504
s_cbranch_scc1 L_3
s_sub_u32 s3, s2, 384
s_load_dwordx2 s[8:9], s[0:1], 120
s_mov_b32 s10, 4915200
s_mov_b32 s11, 0x20000
s_load_dwordx2 s[12:13], s[0:1], 144
s_mov_b32 s14, 268435456
s_mov_b32 s15, 0x20000
s_load_dwordx2 s[16:17], s[0:1], 112
s_mov_b32 s18, 1280
s_mov_b32 s19, 0x20000
s_mul_i32 s4, s3, 4370
s_lshr_b32 s4, s4, 16
s_mul_i32 s5, s4, 15
s_sub_u32 s5, s3, s5
v_and_b32 v1, 63, v0
v_lshrrev_b32 v2, 6, v0
s_nop 0
v_readfirstlane_b32 s6, v2
s_mul_i32 s7, s4, 80
s_mul_i32 s6, s6, 20
s_add_u32 s7, s7, s6
v_min_u32 v3, 19, v1
v_add_u32 v3, s7, v3
v_lshlrev_b32 v3, 1, v3
s_mul_i32 s20, s7, 7680
s_lshl_b32 s21, s5, 9
s_add_u32 s20, s20, s21
v_lshlrev_b32 v4, 3, v1
s_waitcnt lgkmcnt(0)
buffer_load_ushort v5, v3, s[16:19], 0 offen
buffer_load_dwordx2 v[16:17], v4, s[8:11], s20 offen
s_add_u32 s20, s20, 7680
buffer_load_dwordx2 v[18:19], v4, s[8:11], s20 offen
s_add_u32 s20, s20, 7680
buffer_load_dwordx2 v[20:21], v4, s[8:11], s20 offen
s_add_u32 s20, s20, 7680
buffer_load_dwordx2 v[22:23], v4, s[8:11], s20 offen
s_add_u32 s20, s20, 7680
buffer_load_dwordx2 v[24:25], v4, s[8:11], s20 offen
s_add_u32 s20, s20, 7680
buffer_load_dwordx2 v[26:27], v4, s[8:11], s20 offen
s_add_u32 s20, s20, 7680
buffer_load_dwordx2 v[28:29], v4, s[8:11], s20 offen
s_add_u32 s20, s20, 7680
buffer_load_dwordx2 v[30:31], v4, s[8:11], s20 offen
s_add_u32 s20, s20, 7680
buffer_load_dwordx2 v[32:33], v4, s[8:11], s20 offen
s_add_u32 s20, s20, 7680
buffer_load_dwordx2 v[34:35], v4, s[8:11], s20 offen
s_add_u32 s20, s20, 7680
buffer_load_dwordx2 v[36:37], v4, s[8:11], s20 offen
s_add_u32 s20, s20, 7680
buffer_load_dwordx2 v[38:39], v4, s[8:11], s20 offen
s_add_u32 s20, s20, 7680
buffer_load_dwordx2 v[40:41], v4, s[8:11], s20 offen
s_add_u32 s20, s20, 7680
buffer_load_dwordx2 v[42:43], v4, s[8:11], s20 offen
s_add_u32 s20, s20, 7680
buffer_load_dwordx2 v[44:45], v4, s[8:11], s20 offen
s_add_u32 s20, s20, 7680
buffer_load_dwordx2 v[46:47], v4, s[8:11], s20 offen
s_add_u32 s20, s20, 7680
buffer_load_dwordx2 v[48:49], v4, s[8:11], s20 offen
s_add_u32 s20, s20, 7680
buffer_load_dwordx2 v[50:51], v4, s[8:11], s20 offen
s_add_u32 s20, s20, 7680
buffer_load_dwordx2 v[52:53], v4, s[8:11], s20 offen
s_add_u32 s20, s20, 7680
buffer_load_dwordx2 v[54:55], v4, s[8:11], s20 offen
s_add_u32 s20, s20, 7680
s_waitcnt vmcnt(20)
v_lshlrev_b32 v5, 16, v5
v_mul_f32 v6, 0xbfb8aa3b, v5
v_exp_f32 v6, v6
s_nop 0
v_add_f32 v6, 1.0, v6
v_rcp_f32 v6, v6
s_nop 0
v_mul_f32 v5, v5, v6
v_cvt_pk_bf16_f32 v5, v5, v5
v_lshlrev_b32 v5, 16, v5
s_nop 0
v_readlane_b32 s24, v5, 0
v_readlane_b32 s25, v5, 1
v_readlane_b32 s26, v5, 2
v_readlane_b32 s27, v5, 3
v_readlane_b32 s28, v5, 4
v_readlane_b32 s29, v5, 5
v_readlane_b32 s30, v5, 6
v_readlane_b32 s31, v5, 7
v_readlane_b32 s32, v5, 8
v_readlane_b32 s33, v5, 9
v_readlane_b32 s34, v5, 10
v_readlane_b32 s35, v5, 11
v_readlane_b32 s36, v5, 12
v_readlane_b32 s37, v5, 13
v_readlane_b32 s38, v5, 14
v_readlane_b32 s39, v5, 15
v_readlane_b32 s40, v5, 16
v_readlane_b32 s41, v5, 17
v_readlane_b32 s42, v5, 18
v_readlane_b32 s43, v5, 19
v_mov_b32 v8, 0
v_mov_b32 v9, 0
v_mov_b32 v10, 0
v_mov_b32 v11, 0
s_waitcnt vmcnt(19)
v_lshlrev_b32 v60, 16, v16
v_and_b32 v61, 0xffff0000, v16
v_lshlrev_b32 v62, 16, v17
v_and_b32 v63, 0xffff0000, v17
v_fmac_f32 v8, s24, v60
v_fmac_f32 v9, s24, v61
v_fmac_f32 v10, s24, v62
v_fmac_f32 v11, s24, v63
s_waitcnt vmcnt(18)
v_lshlrev_b32 v60, 16, v18
v_and_b32 v61, 0xffff0000, v18
v_lshlrev_b32 v62, 16, v19
v_and_b32 v63, 0xffff0000, v19
v_fmac_f32 v8, s25, v60
v_fmac_f32 v9, s25, v61
v_fmac_f32 v10, s25, v62
v_fmac_f32 v11, s25, v63
s_waitcnt vmcnt(17)
v_lshlrev_b32 v60, 16, v20
v_and_b32 v61, 0xffff0000, v20
v_lshlrev_b32 v62, 16, v21
v_and_b32 v63, 0xffff0000, v21
v_fmac_f32 v8, s26, v60
v_fmac_f32 v9, s26, v61
v_fmac_f32 v10, s26, v62
v_fmac_f32 v11, s26, v63
s_waitcnt vmcnt(16)
v_lshlrev_b32 v60, 16, v22
v_and_b32 v61, 0xffff0000, v22
v_lshlrev_b32 v62, 16, v23
v_and_b32 v63, 0xffff0000, v23
v_fmac_f32 v8, s27, v60
v_fmac_f32 v9, s27, v61
v_fmac_f32 v10, s27, v62
v_fmac_f32 v11, s27, v63
s_waitcnt vmcnt(15)
v_lshlrev_b32 v60, 16, v24
v_and_b32 v61, 0xffff0000, v24
v_lshlrev_b32 v62, 16, v25
v_and_b32 v63, 0xffff0000, v25
v_fmac_f32 v8, s28, v60
v_fmac_f32 v9, s28, v61
v_fmac_f32 v10, s28, v62
v_fmac_f32 v11, s28, v63
s_waitcnt vmcnt(14)
v_lshlrev_b32 v60, 16, v26
v_and_b32 v61, 0xffff0000, v26
v_lshlrev_b32 v62, 16, v27
v_and_b32 v63, 0xffff0000, v27
v_fmac_f32 v8, s29, v60
v_fmac_f32 v9, s29, v61
v_fmac_f32 v10, s29, v62
v_fmac_f32 v11, s29, v63
s_waitcnt vmcnt(13)
v_lshlrev_b32 v60, 16, v28
v_and_b32 v61, 0xffff0000, v28
v_lshlrev_b32 v62, 16, v29
v_and_b32 v63, 0xffff0000, v29
v_fmac_f32 v8, s30, v60
v_fmac_f32 v9, s30, v61
v_fmac_f32 v10, s30, v62
v_fmac_f32 v11, s30, v63
s_waitcnt vmcnt(12)
v_lshlrev_b32 v60, 16, v30
v_and_b32 v61, 0xffff0000, v30
v_lshlrev_b32 v62, 16, v31
v_and_b32 v63, 0xffff0000, v31
v_fmac_f32 v8, s31, v60
v_fmac_f32 v9, s31, v61
v_fmac_f32 v10, s31, v62
v_fmac_f32 v11, s31, v63
s_waitcnt vmcnt(11)
v_lshlrev_b32 v60, 16, v32
v_and_b32 v61, 0xffff0000, v32
v_lshlrev_b32 v62, 16, v33
v_and_b32 v63, 0xffff0000, v33
v_fmac_f32 v8, s32, v60
v_fmac_f32 v9, s32, v61
v_fmac_f32 v10, s32, v62
v_fmac_f32 v11, s32, v63
s_waitcnt vmcnt(10)
v_lshlrev_b32 v60, 16, v34
v_and_b32 v61, 0xffff0000, v34
v_lshlrev_b32 v62, 16, v35
v_and_b32 v63, 0xffff0000, v35
v_fmac_f32 v8, s33, v60
v_fmac_f32 v9, s33, v61
v_fmac_f32 v10, s33, v62
v_fmac_f32 v11, s33, v63
s_waitcnt vmcnt(9)
v_lshlrev_b32 v60, 16, v36
v_and_b32 v61, 0xffff0000, v36
v_lshlrev_b32 v62, 16, v37
v_and_b32 v63, 0xffff0000, v37
v_fmac_f32 v8, s34, v60
v_fmac_f32 v9, s34, v61
v_fmac_f32 v10, s34, v62
v_fmac_f32 v11, s34, v63
s_waitcnt vmcnt(8)
v_lshlrev_b32 v60, 16, v38
v_and_b32 v61, 0xffff0000, v38
v_lshlrev_b32 v62, 16, v39
v_and_b32 v63, 0xffff0000, v39
v_fmac_f32 v8, s35, v60
v_fmac_f32 v9, s35, v61
v_fmac_f32 v10, s35, v62
v_fmac_f32 v11, s35, v63
s_waitcnt vmcnt(7)
v_lshlrev_b32 v60, 16, v40
v_and_b32 v61, 0xffff0000, v40
v_lshlrev_b32 v62, 16, v41
v_and_b32 v63, 0xffff0000, v41
v_fmac_f32 v8, s36, v60
v_fmac_f32 v9, s36, v61
v_fmac_f32 v10, s36, v62
v_fmac_f32 v11, s36, v63
s_waitcnt vmcnt(6)
v_lshlrev_b32 v60, 16, v42
v_and_b32 v61, 0xffff0000, v42
v_lshlrev_b32 v62, 16, v43
v_and_b32 v63, 0xffff0000, v43
v_fmac_f32 v8, s37, v60
v_fmac_f32 v9, s37, v61
v_fmac_f32 v10, s37, v62
v_fmac_f32 v11, s37, v63
s_waitcnt vmcnt(5)
v_lshlrev_b32 v60, 16, v44
v_and_b32 v61, 0xffff0000, v44
v_lshlrev_b32 v62, 16, v45
v_and_b32 v63, 0xffff0000, v45
v_fmac_f32 v8, s38, v60
v_fmac_f32 v9, s38, v61
v_fmac_f32 v10, s38, v62
v_fmac_f32 v11, s38, v63
s_waitcnt vmcnt(4)
v_lshlrev_b32 v60, 16, v46
v_and_b32 v61, 0xffff0000, v46
v_lshlrev_b32 v62, 16, v47
v_and_b32 v63, 0xffff0000, v47
v_fmac_f32 v8, s39, v60
v_fmac_f32 v9, s39, v61
v_fmac_f32 v10, s39, v62
v_fmac_f32 v11, s39, v63
s_waitcnt vmcnt(3)
v_lshlrev_b32 v60, 16, v48
v_and_b32 v61, 0xffff0000, v48
v_lshlrev_b32 v62, 16, v49
v_and_b32 v63, 0xffff0000, v49
v_fmac_f32 v8, s40, v60
v_fmac_f32 v9, s40, v61
v_fmac_f32 v10, s40, v62
v_fmac_f32 v11, s40, v63
s_waitcnt vmcnt(2)
v_lshlrev_b32 v60, 16, v50
v_and_b32 v61, 0xffff0000, v50
v_lshlrev_b32 v62, 16, v51
v_and_b32 v63, 0xffff0000, v51
v_fmac_f32 v8, s41, v60
v_fmac_f32 v9, s41, v61
v_fmac_f32 v10, s41, v62
v_fmac_f32 v11, s41, v63
s_waitcnt vmcnt(1)
v_lshlrev_b32 v60, 16, v52
v_and_b32 v61, 0xffff0000, v52
v_lshlrev_b32 v62, 16, v53
v_and_b32 v63, 0xffff0000, v53
v_fmac_f32 v8, s42, v60
v_fmac_f32 v9, s42, v61
v_fmac_f32 v10, s42, v62
v_fmac_f32 v11, s42, v63
s_waitcnt vmcnt(0)
v_lshlrev_b32 v60, 16, v54
v_and_b32 v61, 0xffff0000, v54
v_lshlrev_b32 v62, 16, v55
v_and_b32 v63, 0xffff0000, v55
v_fmac_f32 v8, s43, v60
v_fmac_f32 v9, s43, v61
v_fmac_f32 v10, s43, v62
v_fmac_f32 v11, s43, v63
v_lshlrev_b32 v6, 10, v2
v_lshlrev_b32 v7, 4, v1
v_add_u32 v6, v6, v7
ds_write_b128 v6, v[8:11]
s_waitcnt lgkmcnt(0)
s_barrier
v_lshlrev_b32 v6, 2, v0
ds_read_b32 v8, v6
ds_read_b32 v9, v6 offset:1024
ds_read_b32 v10, v6 offset:2048
ds_read_b32 v11, v6 offset:3072
s_mul_i32 s20, s4, 15360
s_lshl_b32 s21, s5, 10
s_add_u32 s20, s20, s21
s_add_u32 s20, s20, 0
s_waitcnt lgkmcnt(0)
v_add_f32 v8, v8, v9
v_add_f32 v10, v10, v11
v_add_f32 v8, v8, v10
buffer_store_dword v8, v6, s[12:15], s20 offen
s_endpgm
L_3:
s_endpgm
.p2align 8
.type conv_kernel,@function
conv_kernel:
s_cmp_ge_u32 s2, 160
s_cbranch_scc1 L_8
s_load_dwordx2 s[8:9], s[0:1], 144
s_mov_b32 s10, 268435456
s_mov_b32 s11, 0x20000
s_load_dwordx2 s[12:13], s[0:1], 64
s_mov_b32 s14, 1280
s_mov_b32 s15, 0x20000
v_and_b32 v1, 63, v0
v_lshrrev_b32 v2, 6, v0
s_nop 0
v_readfirstlane_b32 s4, v2
s_and_b32 s3, s2, 0xf3
s_bfe_u32 s5, s2, 0x10002
s_lshl_b32 s5, s5, 3
s_or_b32 s3, s3, s5
s_bfe_u32 s5, s2, 0x10003
s_lshl_b32 s5, s5, 2
s_or_b32 s3, s3, s5
s_lshl_b32 s5, s3, 2
s_add_u32 s5, s5, s4
s_mul_i32 s6, s4, 21248
s_mul_i32 s7, s5, 4224
s_add_u32 s7, s7, 6291456
v_lshlrev_b32 v3, 4, v1
s_waitcnt lgkmcnt(0)
s_lshl_b32 s17, s5, 12
s_add_u32 s18, s17, 3670016
s_add_u32 s17, s17, 1048576
v_and_b32 v4, 15, v0
v_bfe_u32 v5, v0, 4, 2
v_lshlrev_b32 v6, 5, v4
v_lshlrev_b32 v7, 3, v5
v_add_u32 v6, v6, v7
v_bfe_u32 v7, v0, 3, 2
v_and_b32 v8, 7, v0
v_cmp_eq_u32 vcc, 3, v7
s_nop 1
v_cndmask_b32 v7, v7, 4, vcc
v_mul_u32_u24 v7, 2560, v7
v_mul_u32_u24 v8, 15360, v8
v_add_u32 v7, v7, v8
s_lshl_b32 s19, s5, 2
s_add_u32 s19, s19, 0
buffer_load_dword v9, v7, s[8:11], s19 offen
s_lshl_b32 s20, s5, 1
v_mov_b32 v10, s20
buffer_load_ushort v11, v10, s[12:15], 0 offen
buffer_load_dwordx4 v[16:19], v3, s[8:11], s18 offen offset:0
buffer_load_dwordx4 v[20:23], v3, s[8:11], s18 offen offset:1024
buffer_load_dwordx4 v[24:27], v3, s[8:11], s18 offen offset:2048
buffer_load_dwordx4 v[28:31], v3, s[8:11], s18 offen offset:3072
s_add_u32 m0, s6, 0
s_add_u32 s16, s7, 0
buffer_load_dwordx4 v3, s[8:11], s16 offen lds
s_add_u32 m0, s6, 1024
s_add_u32 s16, s7, 1024
buffer_load_dwordx4 v3, s[8:11], s16 offen lds
s_add_u32 m0, s6, 2048
s_add_u32 s16, s7, 2048
buffer_load_dwordx4 v3, s[8:11], s16 offen lds
s_add_u32 m0, s6, 3072
s_add_u32 s16, s7, 3072
buffer_load_dwordx4 v3, s[8:11], s16 offen lds
s_add_u32 m0, s6, 4160
s_add_u32 s16, s7, 2
buffer_load_dwordx4 v3, s[8:11], s16 offen lds
s_add_u32 m0, s6, 5184
s_add_u32 s16, s7, 1026
buffer_load_dwordx4 v3, s[8:11], s16 offen lds
s_add_u32 m0, s6, 6208
s_add_u32 s16, s7, 2050
buffer_load_dwordx4 v3, s[8:11], s16 offen lds
s_add_u32 m0, s6, 7232
s_add_u32 s16, s7, 3074
buffer_load_dwordx4 v3, s[8:11], s16 offen lds
s_add_u32 m0, s6, 8320
s_add_u32 s16, s7, 4
buffer_load_dwordx4 v3, s[8:11], s16 offen lds
s_add_u32 m0, s6, 9344
s_add_u32 s16, s7, 1028
buffer_load_dwordx4 v3, s[8:11], s16 offen lds
s_add_u32 m0, s6, 10368
s_add_u32 s16, s7, 2052
buffer_load_dwordx4 v3, s[8:11], s16 offen lds
s_add_u32 m0, s6, 11392
s_add_u32 s16, s7, 3076
buffer_load_dwordx4 v3, s[8:11], s16 offen lds
s_add_u32 m0, s6, 12480
s_add_u32 s16, s7, 6
buffer_load_dwordx4 v3, s[8:11], s16 offen lds
s_add_u32 m0, s6, 13504
s_add_u32 s16, s7, 1030
buffer_load_dwordx4 v3, s[8:11], s16 offen lds
s_add_u32 m0, s6, 14528
s_add_u32 s16, s7, 2054
buffer_load_dwordx4 v3, s[8:11], s16 offen lds
s_add_u32 m0, s6, 15552
s_add_u32 s16, s7, 3078
buffer_load_dwordx4 v3, s[8:11], s16 offen lds
buffer_load_dwordx2 v[32:33], v6, s[8:11], s17 offen offset:0
buffer_load_dwordx2 v[34:35], v6, s[8:11], s17 offen offset:512
buffer_load_dwordx2 v[36:37], v6, s[8:11], s17 offen offset:1024
buffer_load_dwordx2 v[38:39], v6, s[8:11], s17 offen offset:1536
buffer_load_dwordx2 v[40:41], v6, s[8:11], s17 offen offset:2048
buffer_load_dwordx2 v[42:43], v6, s[8:11], s17 offen offset:2560
buffer_load_dwordx2 v[44:45], v6, s[8:11], s17 offen offset:3072
buffer_load_dwordx2 v[46:47], v6, s[8:11], s17 offen offset:3584
v_mov_b32 v12, 0
v_mov_b32 v13, 0
v_mul_u32_u24 v10, 4160, v5
v_lshlrev_b32 v14, 2, v4
v_add_u32 v10, v10, v14
v_add_u32 v10, s6, v10
ds_write_b32 v10, v12 offset:4096
v_lshlrev_b32 v10, 3, v1
v_add_u32 v10, s6, v10
ds_write_b64 v10, v[12:13] offset:16640
s_waitcnt vmcnt(24)
v_add_f32_dpp v9, v9, v9 quad_perm:[1,0,3,2] row_mask:0xf bank_mask:0xf
s_nop 1
v_add_f32_dpp v9, v9, v9 quad_perm:[2,3,0,1] row_mask:0xf bank_mask:0xf
s_nop 1
v_add_f32_dpp v9, v9, v9 row_half_mirror row_mask:0xf bank_mask:0xf
v_cvt_pk_bf16_f32 v9, v9, v9
v_lshlrev_b32 v9, 16, v9
s_nop 0
v_readlane_b32 s24, v9, 0
v_readlane_b32 s25, v9, 8
v_readlane_b32 s26, v9, 16
v_readlane_b32 s27, v9, 24
v_lshlrev_b32 v11, 16, v11
s_nop 0
v_readfirstlane_b32 s28, v11
v_add_f32 v12, 1.0, s25
v_cvt_pk_bf16_f32 v12, v12, v12
v_lshlrev_b32 v12, 16, v12
v_add_f32 v13, 1.0, s27
v_cvt_pk_bf16_f32 v13, v13, v13
v_lshlrev_b32 v13, 16, v13
v_readfirstlane_b32 s25, v12
v_readfirstlane_b32 s27, v13
v_add_u32 v10, s6, v3
v_mov_b32 v14, s24
v_lshlrev_b32 v48, 16, v16
v_and_b32 v49, 0xffff0000, v16
v_lshlrev_b32 v50, 16, v17
v_and_b32 v51, 0xffff0000, v17
v_lshlrev_b32 v52, 16, v18
v_and_b32 v53, 0xffff0000, v18
v_lshlrev_b32 v54, 16, v19
v_and_b32 v55, 0xffff0000, v19
v_fma_f32 v48, v48, s25, v14
v_fma_f32 v49, v49, s25, v14
v_fma_f32 v50, v50, s25, v14
v_fma_f32 v51, v51, s25, v14
v_fma_f32 v52, v52, s25, v14
v_fma_f32 v53, v53, s25, v14
v_fma_f32 v54, v54, s25, v14
v_fma_f32 v55, v55, s25, v14
v_cvt_pk_bf16_f32 v56, v48, v49
v_cvt_pk_bf16_f32 v57, v50, v51
v_cvt_pk_bf16_f32 v58, v52, v53
v_cvt_pk_bf16_f32 v59, v54, v55
ds_write_b128 v10, v[56:59] offset:17152
v_lshlrev_b32 v48, 16, v20
v_and_b32 v49, 0xffff0000, v20
v_lshlrev_b32 v50, 16, v21
v_and_b32 v51, 0xffff0000, v21
v_lshlrev_b32 v52, 16, v22
v_and_b32 v53, 0xffff0000, v22
v_lshlrev_b32 v54, 16, v23
v_and_b32 v55, 0xffff0000, v23
v_fma_f32 v48, v48, s25, v14
v_fma_f32 v49, v49, s25, v14
v_fma_f32 v50, v50, s25, v14
v_fma_f32 v51, v51, s25, v14
v_fma_f32 v52, v52, s25, v14
v_fma_f32 v53, v53, s25, v14
v_fma_f32 v54, v54, s25, v14
v_fma_f32 v55, v55, s25, v14
v_cvt_pk_bf16_f32 v60, v48, v49
v_cvt_pk_bf16_f32 v61, v50, v51
v_cvt_pk_bf16_f32 v62, v52, v53
v_cvt_pk_bf16_f32 v63, v54, v55
ds_write_b128 v10, v[60:63] offset:18176
v_lshlrev_b32 v48, 16, v24
v_and_b32 v49, 0xffff0000, v24
v_lshlrev_b32 v50, 16, v25
v_and_b32 v51, 0xffff0000, v25
v_lshlrev_b32 v52, 16, v26
v_and_b32 v53, 0xffff0000, v26
v_lshlrev_b32 v54, 16, v27
v_and_b32 v55, 0xffff0000, v27
v_fma_f32 v48, v48, s25, v14
v_fma_f32 v49, v49, s25, v14
v_fma_f32 v50, v50, s25, v14
v_fma_f32 v51, v51, s25, v14
v_fma_f32 v52, v52, s25, v14
v_fma_f32 v53, v53, s25, v14
v_fma_f32 v54, v54, s25, v14
v_fma_f32 v55, v55, s25, v14
v_cvt_pk_bf16_f32 v56, v48, v49
v_cvt_pk_bf16_f32 v57, v50, v51
v_cvt_pk_bf16_f32 v58, v52, v53
v_cvt_pk_bf16_f32 v59, v54, v55
ds_write_b128 v10, v[56:59] offset:19200
v_lshlrev_b32 v48, 16, v28
v_and_b32 v49, 0xffff0000, v28
v_lshlrev_b32 v50, 16, v29
v_and_b32 v51, 0xffff0000, v29
v_lshlrev_b32 v52, 16, v30
v_and_b32 v53, 0xffff0000, v30
v_lshlrev_b32 v54, 16, v31
v_and_b32 v55, 0xffff0000, v31
v_fma_f32 v48, v48, s25, v14
v_fma_f32 v49, v49, s25, v14
v_fma_f32 v50, v50, s25, v14
v_fma_f32 v51, v51, s25, v14
v_fma_f32 v52, v52, s25, v14
v_fma_f32 v53, v53, s25, v14
v_fma_f32 v54, v54, s25, v14
v_fma_f32 v55, v55, s25, v14
v_cvt_pk_bf16_f32 v60, v48, v49
v_cvt_pk_bf16_f32 v61, v50, v51
v_cvt_pk_bf16_f32 v62, v52, v53
v_cvt_pk_bf16_f32 v63, v54, v55
ds_write_b128 v10, v[60:63] offset:20224
v_and_b32 v7, 3, v0
v_sub_u32 v7, 3, v7
v_mul_u32_u24 v7, 4160, v7
v_bfe_u32 v8, v0, 2, 2
v_lshlrev_b32 v8, 3, v8
v_sub_u32 v7, v7, v8
v_lshlrev_b32 v8, 4, v5
v_add_u32 v7, v7, v8
v_add_u32 v7, 24, v7
v_add_u32 v7, s6, v7
v_add_u32 v8, 2048, v7
v_lshlrev_b32 v9, 5, v4
v_lshlrev_b32 v10, 4, v5
v_add_u32 v9, v9, v10
v_add_u32 v9, s6, v9
v_add_u32 v9, 16640, v9
v_mov_b32 v64, 0
v_mov_b32 v65, 0
v_mov_b32 v66, 0
v_mov_b32 v67, 0
v_mov_b32 v68, 0
v_mov_b32 v69, 0
v_mov_b32 v70, 0
v_mov_b32 v71, 0
v_mov_b32 v72, 0
v_mov_b32 v73, 0
v_mov_b32 v74, 0
v_mov_b32 v75, 0
v_mov_b32 v76, 0
v_mov_b32 v77, 0
v_mov_b32 v78, 0
v_mov_b32 v79, 0
v_mov_b32 v80, 0
v_mov_b32 v81, 0
v_mov_b32 v82, 0
v_mov_b32 v83, 0
v_mov_b32 v84, 0
v_mov_b32 v85, 0
v_mov_b32 v86, 0
v_mov_b32 v87, 0
v_mov_b32 v88, 0
v_mov_b32 v89, 0
v_mov_b32 v90, 0
v_mov_b32 v91, 0
v_mov_b32 v92, 0
v_mov_b32 v93, 0
v_mov_b32 v94, 0
v_mov_b32 v95, 0
s_waitcnt vmcnt(8) lgkmcnt(0)
ds_read2_b64 v[96:99], v8 offset0:248 offset1:249
ds_read_b128 v[128:131], v9 offset:480
ds_read2_b64 v[100:103], v8 offset0:184 offset1:185
ds_read_b128 v[132:135], v9 offset:992
ds_read2_b64 v[104:107], v8 offset0:120 offset1:121
ds_read_b128 v[136:139], v9 offset:1504
ds_read2_b64 v[108:111], v8 offset0:56 offset1:57
ds_read_b128 v[140:143], v9 offset:2016
ds_read2_b64 v[112:115], v7 offset0:248 offset1:249
ds_read_b128 v[144:147], v9 offset:2528
ds_read2_b64 v[116:119], v7 offset0:184 offset1:185
ds_read_b128 v[148:151], v9 offset:3040
ds_read2_b64 v[120:123], v7 offset0:120 offset1:121
ds_read_b128 v[152:155], v9 offset:3552
ds_read2_b64 v[124:127], v7 offset0:56 offset1:57
ds_read_b128 v[156:159], v9 offset:4064
s_waitcnt lgkmcnt(0)
v_mfma_f32_16x16x32_bf16 v[64:67], v[96:99], v[128:131], v[64:67]
v_mfma_f32_16x16x32_bf16 v[68:71], v[96:99], v[132:135], v[68:71]
ds_read2_b64 v[160:163], v8 offset0:240 offset1:241
v_mfma_f32_16x16x32_bf16 v[72:75], v[96:99], v[136:139], v[72:75]
v_mfma_f32_16x16x32_bf16 v[76:79], v[96:99], v[140:143], v[76:79]
ds_read_b128 v[192:195], v9 offset:416
v_mfma_f32_16x16x32_bf16 v[80:83], v[96:99], v[144:147], v[80:83]
v_mfma_f32_16x16x32_bf16 v[84:87], v[96:99], v[148:151], v[84:87]
ds_read2_b64 v[164:167], v8 offset0:176 offset1:177
v_mfma_f32_16x16x32_bf16 v[88:91], v[96:99], v[152:155], v[88:91]
v_mfma_f32_16x16x32_bf16 v[92:95], v[96:99], v[156:159], v[92:95]
ds_read_b128 v[196:199], v9 offset:928
v_mfma_f32_16x16x32_bf16 v[68:71], v[100:103], v[128:131], v[68:71]
v_mfma_f32_16x16x32_bf16 v[72:75], v[100:103], v[132:135], v[72:75]
ds_read2_b64 v[168:171], v8 offset0:112 offset1:113
v_mfma_f32_16x16x32_bf16 v[76:79], v[100:103], v[136:139], v[76:79]
v_mfma_f32_16x16x32_bf16 v[80:83], v[100:103], v[140:143], v[80:83]
ds_read_b128 v[200:203], v9 offset:1440
v_mfma_f32_16x16x32_bf16 v[84:87], v[100:103], v[144:147], v[84:87]
v_mfma_f32_16x16x32_bf16 v[88:91], v[100:103], v[148:151], v[88:91]
ds_read2_b64 v[172:175], v8 offset0:48 offset1:49
v_mfma_f32_16x16x32_bf16 v[92:95], v[100:103], v[152:155], v[92:95]
v_mfma_f32_16x16x32_bf16 v[72:75], v[104:107], v[128:131], v[72:75]
ds_read_b128 v[204:207], v9 offset:1952
v_mfma_f32_16x16x32_bf16 v[76:79], v[104:107], v[132:135], v[76:79]
v_mfma_f32_16x16x32_bf16 v[80:83], v[104:107], v[136:139], v[80:83]
ds_read2_b64 v[176:179], v7 offset0:240 offset1:241
v_mfma_f32_16x16x32_bf16 v[84:87], v[104:107], v[140:143], v[84:87]
v_mfma_f32_16x16x32_bf16 v[88:91], v[104:107], v[144:147], v[88:91]
ds_read_b128 v[208:211], v9 offset:2464
v_mfma_f32_16x16x32_bf16 v[92:95], v[104:107], v[148:151], v[92:95]
v_mfma_f32_16x16x32_bf16 v[76:79], v[108:111], v[128:131], v[76:79]
ds_read2_b64 v[180:183], v7 offset0:176 offset1:177
v_mfma_f32_16x16x32_bf16 v[80:83], v[108:111], v[132:135], v[80:83]
v_mfma_f32_16x16x32_bf16 v[84:87], v[108:111], v[136:139], v[84:87]
ds_read_b128 v[212:215], v9 offset:2976
v_mfma_f32_16x16x32_bf16 v[88:91], v[108:111], v[140:143], v[88:91]
v_mfma_f32_16x16x32_bf16 v[92:95], v[108:111], v[144:147], v[92:95]
ds_read2_b64 v[184:187], v7 offset0:112 offset1:113
v_mfma_f32_16x16x32_bf16 v[80:83], v[112:115], v[128:131], v[80:83]
v_mfma_f32_16x16x32_bf16 v[84:87], v[112:115], v[132:135], v[84:87]
ds_read_b128 v[216:219], v9 offset:3488
v_mfma_f32_16x16x32_bf16 v[88:91], v[112:115], v[136:139], v[88:91]
v_mfma_f32_16x16x32_bf16 v[92:95], v[112:115], v[140:143], v[92:95]
ds_read2_b64 v[188:191], v7 offset0:48 offset1:49
v_mfma_f32_16x16x32_bf16 v[84:87], v[116:119], v[128:131], v[84:87]
v_mfma_f32_16x16x32_bf16 v[88:91], v[116:119], v[132:135], v[88:91]
ds_read_b128 v[220:223], v9 offset:4000
v_mfma_f32_16x16x32_bf16 v[92:95], v[116:119], v[136:139], v[92:95]
v_mfma_f32_16x16x32_bf16 v[88:91], v[120:123], v[128:131], v[88:91]
v_mfma_f32_16x16x32_bf16 v[92:95], v[120:123], v[132:135], v[92:95]
v_mfma_f32_16x16x32_bf16 v[92:95], v[124:127], v[128:131], v[92:95]
s_waitcnt lgkmcnt(0)
v_mfma_f32_16x16x32_bf16 v[64:67], v[160:163], v[192:195], v[64:67]
v_mfma_f32_16x16x32_bf16 v[68:71], v[160:163], v[196:199], v[68:71]
ds_read2_b64 v[96:99], v8 offset0:232 offset1:233
v_mfma_f32_16x16x32_bf16 v[72:75], v[160:163], v[200:203], v[72:75]
v_mfma_f32_16x16x32_bf16 v[76:79], v[160:163], v[204:207], v[76:79]
ds_read_b128 v[128:131], v9 offset:352
v_mfma_f32_16x16x32_bf16 v[80:83], v[160:163], v[208:211], v[80:83]
v_mfma_f32_16x16x32_bf16 v[84:87], v[160:163], v[212:215], v[84:87]
ds_read2_b64 v[100:103], v8 offset0:168 offset1:169
v_mfma_f32_16x16x32_bf16 v[88:91], v[160:163], v[216:219], v[88:91]
v_mfma_f32_16x16x32_bf16 v[92:95], v[160:163], v[220:223], v[92:95]
ds_read_b128 v[132:135], v9 offset:864
v_mfma_f32_16x16x32_bf16 v[68:71], v[164:167], v[192:195], v[68:71]
v_mfma_f32_16x16x32_bf16 v[72:75], v[164:167], v[196:199], v[72:75]
ds_read2_b64 v[104:107], v8 offset0:104 offset1:105
v_mfma_f32_16x16x32_bf16 v[76:79], v[164:167], v[200:203], v[76:79]
v_mfma_f32_16x16x32_bf16 v[80:83], v[164:167], v[204:207], v[80:83]
ds_read_b128 v[136:139], v9 offset:1376
v_mfma_f32_16x16x32_bf16 v[84:87], v[164:167], v[208:211], v[84:87]
v_mfma_f32_16x16x32_bf16 v[88:91], v[164:167], v[212:215], v[88:91]
ds_read2_b64 v[108:111], v8 offset0:40 offset1:41
v_mfma_f32_16x16x32_bf16 v[92:95], v[164:167], v[216:219], v[92:95]
v_mfma_f32_16x16x32_bf16 v[72:75], v[168:171], v[192:195], v[72:75]
ds_read_b128 v[140:143], v9 offset:1888
v_mfma_f32_16x16x32_bf16 v[76:79], v[168:171], v[196:199], v[76:79]
v_mfma_f32_16x16x32_bf16 v[80:83], v[168:171], v[200:203], v[80:83]
ds_read2_b64 v[112:115], v7 offset0:232 offset1:233
v_mfma_f32_16x16x32_bf16 v[84:87], v[168:171], v[204:207], v[84:87]
v_mfma_f32_16x16x32_bf16 v[88:91], v[168:171], v[208:211], v[88:91]
ds_read_b128 v[144:147], v9 offset:2400
v_mfma_f32_16x16x32_bf16 v[92:95], v[168:171], v[212:215], v[92:95]
v_mfma_f32_16x16x32_bf16 v[76:79], v[172:175], v[192:195], v[76:79]
ds_read2_b64 v[116:119], v7 offset0:168 offset1:169
v_mfma_f32_16x16x32_bf16 v[80:83], v[172:175], v[196:199], v[80:83]
v_mfma_f32_16x16x32_bf16 v[84:87], v[172:175], v[200:203], v[84:87]
ds_read_b128 v[148:151], v9 offset:2912
v_mfma_f32_16x16x32_bf16 v[88:91], v[172:175], v[204:207], v[88:91]
v_mfma_f32_16x16x32_bf16 v[92:95], v[172:175], v[208:211], v[92:95]
ds_read2_b64 v[120:123], v7 offset0:104 offset1:105
v_mfma_f32_16x16x32_bf16 v[80:83], v[176:179], v[192:195], v[80:83]
v_mfma_f32_16x16x32_bf16 v[84:87], v[176:179], v[196:199], v[84:87]
ds_read_b128 v[152:155], v9 offset:3424
v_mfma_f32_16x16x32_bf16 v[88:91], v[176:179], v[200:203], v[88:91]
v_mfma_f32_16x16x32_bf16 v[92:95], v[176:179], v[204:207], v[92:95]
ds_read2_b64 v[124:127], v7 offset0:40 offset1:41
v_mfma_f32_16x16x32_bf16 v[84:87], v[180:183], v[192:195], v[84:87]
v_mfma_f32_16x16x32_bf16 v[88:91], v[180:183], v[196:199], v[88:91]
ds_read_b128 v[156:159], v9 offset:3936
v_mfma_f32_16x16x32_bf16 v[92:95], v[180:183], v[200:203], v[92:95]
v_mfma_f32_16x16x32_bf16 v[88:91], v[184:187], v[192:195], v[88:91]
v_mfma_f32_16x16x32_bf16 v[92:95], v[184:187], v[196:199], v[92:95]
v_mfma_f32_16x16x32_bf16 v[92:95], v[188:191], v[192:195], v[92:95]
s_waitcnt lgkmcnt(0)
v_mfma_f32_16x16x32_bf16 v[64:67], v[96:99], v[128:131], v[64:67]
v_mfma_f32_16x16x32_bf16 v[68:71], v[96:99], v[132:135], v[68:71]
ds_read2_b64 v[160:163], v8 offset0:224 offset1:225
v_mfma_f32_16x16x32_bf16 v[72:75], v[96:99], v[136:139], v[72:75]
v_mfma_f32_16x16x32_bf16 v[76:79], v[96:99], v[140:143], v[76:79]
ds_read_b128 v[192:195], v9 offset:288
v_mfma_f32_16x16x32_bf16 v[80:83], v[96:99], v[144:147], v[80:83]
v_mfma_f32_16x16x32_bf16 v[84:87], v[96:99], v[148:151], v[84:87]
ds_read2_b64 v[164:167], v8 offset0:160 offset1:161
v_mfma_f32_16x16x32_bf16 v[88:91], v[96:99], v[152:155], v[88:91]
v_mfma_f32_16x16x32_bf16 v[92:95], v[96:99], v[156:159], v[92:95]
ds_read_b128 v[196:199], v9 offset:800
v_mfma_f32_16x16x32_bf16 v[68:71], v[100:103], v[128:131], v[68:71]
v_mfma_f32_16x16x32_bf16 v[72:75], v[100:103], v[132:135], v[72:75]
ds_read2_b64 v[168:171], v8 offset0:96 offset1:97
v_mfma_f32_16x16x32_bf16 v[76:79], v[100:103], v[136:139], v[76:79]
v_mfma_f32_16x16x32_bf16 v[80:83], v[100:103], v[140:143], v[80:83]
ds_read_b128 v[200:203], v9 offset:1312
v_mfma_f32_16x16x32_bf16 v[84:87], v[100:103], v[144:147], v[84:87]
v_mfma_f32_16x16x32_bf16 v[88:91], v[100:103], v[148:151], v[88:91]
ds_read2_b64 v[172:175], v8 offset0:32 offset1:33
v_mfma_f32_16x16x32_bf16 v[92:95], v[100:103], v[152:155], v[92:95]
v_mfma_f32_16x16x32_bf16 v[72:75], v[104:107], v[128:131], v[72:75]
ds_read_b128 v[204:207], v9 offset:1824
v_mfma_f32_16x16x32_bf16 v[76:79], v[104:107], v[132:135], v[76:79]
v_mfma_f32_16x16x32_bf16 v[80:83], v[104:107], v[136:139], v[80:83]
ds_read2_b64 v[176:179], v7 offset0:224 offset1:225
v_mfma_f32_16x16x32_bf16 v[84:87], v[104:107], v[140:143], v[84:87]
v_mfma_f32_16x16x32_bf16 v[88:91], v[104:107], v[144:147], v[88:91]
ds_read_b128 v[208:211], v9 offset:2336
v_mfma_f32_16x16x32_bf16 v[92:95], v[104:107], v[148:151], v[92:95]
v_mfma_f32_16x16x32_bf16 v[76:79], v[108:111], v[128:131], v[76:79]
ds_read2_b64 v[180:183], v7 offset0:160 offset1:161
v_mfma_f32_16x16x32_bf16 v[80:83], v[108:111], v[132:135], v[80:83]
v_mfma_f32_16x16x32_bf16 v[84:87], v[108:111], v[136:139], v[84:87]
ds_read_b128 v[212:215], v9 offset:2848
v_mfma_f32_16x16x32_bf16 v[88:91], v[108:111], v[140:143], v[88:91]
v_mfma_f32_16x16x32_bf16 v[92:95], v[108:111], v[144:147], v[92:95]
ds_read2_b64 v[184:187], v7 offset0:96 offset1:97
v_mfma_f32_16x16x32_bf16 v[80:83], v[112:115], v[128:131], v[80:83]
v_mfma_f32_16x16x32_bf16 v[84:87], v[112:115], v[132:135], v[84:87]
ds_read_b128 v[216:219], v9 offset:3360
v_mfma_f32_16x16x32_bf16 v[88:91], v[112:115], v[136:139], v[88:91]
v_mfma_f32_16x16x32_bf16 v[92:95], v[112:115], v[140:143], v[92:95]
ds_read2_b64 v[188:191], v7 offset0:32 offset1:33
v_mfma_f32_16x16x32_bf16 v[84:87], v[116:119], v[128:131], v[84:87]
v_mfma_f32_16x16x32_bf16 v[88:91], v[116:119], v[132:135], v[88:91]
ds_read_b128 v[220:223], v9 offset:3872
v_mfma_f32_16x16x32_bf16 v[92:95], v[116:119], v[136:139], v[92:95]
v_mfma_f32_16x16x32_bf16 v[88:91], v[120:123], v[128:131], v[88:91]
v_mfma_f32_16x16x32_bf16 v[92:95], v[120:123], v[132:135], v[92:95]
v_mfma_f32_16x16x32_bf16 v[92:95], v[124:127], v[128:131], v[92:95]
s_waitcnt lgkmcnt(0)
v_mfma_f32_16x16x32_bf16 v[64:67], v[160:163], v[192:195], v[64:67]
v_mfma_f32_16x16x32_bf16 v[68:71], v[160:163], v[196:199], v[68:71]
ds_read2_b64 v[96:99], v8 offset0:216 offset1:217
v_mfma_f32_16x16x32_bf16 v[72:75], v[160:163], v[200:203], v[72:75]
v_mfma_f32_16x16x32_bf16 v[76:79], v[160:163], v[204:207], v[76:79]
ds_read_b128 v[128:131], v9 offset:224
v_mfma_f32_16x16x32_bf16 v[80:83], v[160:163], v[208:211], v[80:83]
v_mfma_f32_16x16x32_bf16 v[84:87], v[160:163], v[212:215], v[84:87]
ds_read2_b64 v[100:103], v8 offset0:152 offset1:153
v_mfma_f32_16x16x32_bf16 v[88:91], v[160:163], v[216:219], v[88:91]
v_mfma_f32_16x16x32_bf16 v[92:95], v[160:163], v[220:223], v[92:95]
ds_read_b128 v[132:135], v9 offset:736
v_mfma_f32_16x16x32_bf16 v[68:71], v[164:167], v[192:195], v[68:71]
v_mfma_f32_16x16x32_bf16 v[72:75], v[164:167], v[196:199], v[72:75]
ds_read2_b64 v[104:107], v8 offset0:88 offset1:89
v_mfma_f32_16x16x32_bf16 v[76:79], v[164:167], v[200:203], v[76:79]
v_mfma_f32_16x16x32_bf16 v[80:83], v[164:167], v[204:207], v[80:83]
ds_read_b128 v[136:139], v9 offset:1248
v_mfma_f32_16x16x32_bf16 v[84:87], v[164:167], v[208:211], v[84:87]
v_mfma_f32_16x16x32_bf16 v[88:91], v[164:167], v[212:215], v[88:91]
ds_read2_b64 v[108:111], v8 offset0:24 offset1:25
v_mfma_f32_16x16x32_bf16 v[92:95], v[164:167], v[216:219], v[92:95]
v_mfma_f32_16x16x32_bf16 v[72:75], v[168:171], v[192:195], v[72:75]
ds_read_b128 v[140:143], v9 offset:1760
v_mfma_f32_16x16x32_bf16 v[76:79], v[168:171], v[196:199], v[76:79]
v_mfma_f32_16x16x32_bf16 v[80:83], v[168:171], v[200:203], v[80:83]
ds_read2_b64 v[112:115], v7 offset0:216 offset1:217
v_mfma_f32_16x16x32_bf16 v[84:87], v[168:171], v[204:207], v[84:87]
v_mfma_f32_16x16x32_bf16 v[88:91], v[168:171], v[208:211], v[88:91]
ds_read_b128 v[144:147], v9 offset:2272
v_mfma_f32_16x16x32_bf16 v[92:95], v[168:171], v[212:215], v[92:95]
v_mfma_f32_16x16x32_bf16 v[76:79], v[172:175], v[192:195], v[76:79]
ds_read2_b64 v[116:119], v7 offset0:152 offset1:153
v_mfma_f32_16x16x32_bf16 v[80:83], v[172:175], v[196:199], v[80:83]
v_mfma_f32_16x16x32_bf16 v[84:87], v[172:175], v[200:203], v[84:87]
ds_read_b128 v[148:151], v9 offset:2784
v_mfma_f32_16x16x32_bf16 v[88:91], v[172:175], v[204:207], v[88:91]
v_mfma_f32_16x16x32_bf16 v[92:95], v[172:175], v[208:211], v[92:95]
ds_read2_b64 v[120:123], v7 offset0:88 offset1:89
v_mfma_f32_16x16x32_bf16 v[80:83], v[176:179], v[192:195], v[80:83]
v_mfma_f32_16x16x32_bf16 v[84:87], v[176:179], v[196:199], v[84:87]
ds_read_b128 v[152:155], v9 offset:3296
v_mfma_f32_16x16x32_bf16 v[88:91], v[176:179], v[200:203], v[88:91]
v_mfma_f32_16x16x32_bf16 v[92:95], v[176:179], v[204:207], v[92:95]
ds_read2_b64 v[124:127], v7 offset0:24 offset1:25
v_mfma_f32_16x16x32_bf16 v[84:87], v[180:183], v[192:195], v[84:87]
v_mfma_f32_16x16x32_bf16 v[88:91], v[180:183], v[196:199], v[88:91]
ds_read_b128 v[156:159], v9 offset:3808
v_mfma_f32_16x16x32_bf16 v[92:95], v[180:183], v[200:203], v[92:95]
v_mfma_f32_16x16x32_bf16 v[88:91], v[184:187], v[192:195], v[88:91]
v_mfma_f32_16x16x32_bf16 v[92:95], v[184:187], v[196:199], v[92:95]
v_mfma_f32_16x16x32_bf16 v[92:95], v[188:191], v[192:195], v[92:95]
s_waitcnt lgkmcnt(0)
v_mfma_f32_16x16x32_bf16 v[64:67], v[96:99], v[128:131], v[64:67]
v_mfma_f32_16x16x32_bf16 v[68:71], v[96:99], v[132:135], v[68:71]
ds_read2_b64 v[160:163], v8 offset0:208 offset1:209
v_mfma_f32_16x16x32_bf16 v[72:75], v[96:99], v[136:139], v[72:75]
v_mfma_f32_16x16x32_bf16 v[76:79], v[96:99], v[140:143], v[76:79]
ds_read_b128 v[192:195], v9 offset:160
v_mfma_f32_16x16x32_bf16 v[80:83], v[96:99], v[144:147], v[80:83]
v_mfma_f32_16x16x32_bf16 v[84:87], v[96:99], v[148:151], v[84:87]
ds_read2_b64 v[164:167], v8 offset0:144 offset1:145
v_mfma_f32_16x16x32_bf16 v[88:91], v[96:99], v[152:155], v[88:91]
v_mfma_f32_16x16x32_bf16 v[92:95], v[96:99], v[156:159], v[92:95]
ds_read_b128 v[196:199], v9 offset:672
v_mfma_f32_16x16x32_bf16 v[68:71], v[100:103], v[128:131], v[68:71]
v_mfma_f32_16x16x32_bf16 v[72:75], v[100:103], v[132:135], v[72:75]
ds_read2_b64 v[168:171], v8 offset0:80 offset1:81
v_mfma_f32_16x16x32_bf16 v[76:79], v[100:103], v[136:139], v[76:79]
v_mfma_f32_16x16x32_bf16 v[80:83], v[100:103], v[140:143], v[80:83]
ds_read_b128 v[200:203], v9 offset:1184
v_mfma_f32_16x16x32_bf16 v[84:87], v[100:103], v[144:147], v[84:87]
v_mfma_f32_16x16x32_bf16 v[88:91], v[100:103], v[148:151], v[88:91]
ds_read2_b64 v[172:175], v8 offset0:16 offset1:17
v_mfma_f32_16x16x32_bf16 v[92:95], v[100:103], v[152:155], v[92:95]
v_mfma_f32_16x16x32_bf16 v[72:75], v[104:107], v[128:131], v[72:75]
ds_read_b128 v[204:207], v9 offset:1696
v_mfma_f32_16x16x32_bf16 v[76:79], v[104:107], v[132:135], v[76:79]
v_mfma_f32_16x16x32_bf16 v[80:83], v[104:107], v[136:139], v[80:83]
ds_read2_b64 v[176:179], v7 offset0:208 offset1:209
v_mfma_f32_16x16x32_bf16 v[84:87], v[104:107], v[140:143], v[84:87]
v_mfma_f32_16x16x32_bf16 v[88:91], v[104:107], v[144:147], v[88:91]
ds_read_b128 v[208:211], v9 offset:2208
v_mfma_f32_16x16x32_bf16 v[92:95], v[104:107], v[148:151], v[92:95]
v_mfma_f32_16x16x32_bf16 v[76:79], v[108:111], v[128:131], v[76:79]
ds_read2_b64 v[180:183], v7 offset0:144 offset1:145
v_mfma_f32_16x16x32_bf16 v[80:83], v[108:111], v[132:135], v[80:83]
v_mfma_f32_16x16x32_bf16 v[84:87], v[108:111], v[136:139], v[84:87]
ds_read_b128 v[212:215], v9 offset:2720
v_mfma_f32_16x16x32_bf16 v[88:91], v[108:111], v[140:143], v[88:91]
v_mfma_f32_16x16x32_bf16 v[92:95], v[108:111], v[144:147], v[92:95]
ds_read2_b64 v[184:187], v7 offset0:80 offset1:81
v_mfma_f32_16x16x32_bf16 v[80:83], v[112:115], v[128:131], v[80:83]
v_mfma_f32_16x16x32_bf16 v[84:87], v[112:115], v[132:135], v[84:87]
ds_read_b128 v[216:219], v9 offset:3232
v_mfma_f32_16x16x32_bf16 v[88:91], v[112:115], v[136:139], v[88:91]
v_mfma_f32_16x16x32_bf16 v[92:95], v[112:115], v[140:143], v[92:95]
ds_read2_b64 v[188:191], v7 offset0:16 offset1:17
v_mfma_f32_16x16x32_bf16 v[84:87], v[116:119], v[128:131], v[84:87]
v_mfma_f32_16x16x32_bf16 v[88:91], v[116:119], v[132:135], v[88:91]
ds_read_b128 v[220:223], v9 offset:3744
v_mfma_f32_16x16x32_bf16 v[92:95], v[116:119], v[136:139], v[92:95]
v_mfma_f32_16x16x32_bf16 v[88:91], v[120:123], v[128:131], v[88:91]
v_mfma_f32_16x16x32_bf16 v[92:95], v[120:123], v[132:135], v[92:95]
v_mfma_f32_16x16x32_bf16 v[92:95], v[124:127], v[128:131], v[92:95]
s_waitcnt lgkmcnt(0)
v_mfma_f32_16x16x32_bf16 v[64:67], v[160:163], v[192:195], v[64:67]
v_mfma_f32_16x16x32_bf16 v[68:71], v[160:163], v[196:199], v[68:71]
ds_read2_b64 v[96:99], v8 offset0:200 offset1:201
v_mfma_f32_16x16x32_bf16 v[72:75], v[160:163], v[200:203], v[72:75]
v_mfma_f32_16x16x32_bf16 v[76:79], v[160:163], v[204:207], v[76:79]
ds_read_b128 v[128:131], v9 offset:96
v_mfma_f32_16x16x32_bf16 v[80:83], v[160:163], v[208:211], v[80:83]
v_mfma_f32_16x16x32_bf16 v[84:87], v[160:163], v[212:215], v[84:87]
ds_read2_b64 v[100:103], v8 offset0:136 offset1:137
v_mfma_f32_16x16x32_bf16 v[88:91], v[160:163], v[216:219], v[88:91]
v_mfma_f32_16x16x32_bf16 v[92:95], v[160:163], v[220:223], v[92:95]
ds_read_b128 v[132:135], v9 offset:608
v_mfma_f32_16x16x32_bf16 v[68:71], v[164:167], v[192:195], v[68:71]
v_mfma_f32_16x16x32_bf16 v[72:75], v[164:167], v[196:199], v[72:75]
ds_read2_b64 v[104:107], v8 offset0:72 offset1:73
v_mfma_f32_16x16x32_bf16 v[76:79], v[164:167], v[200:203], v[76:79]
v_mfma_f32_16x16x32_bf16 v[80:83], v[164:167], v[204:207], v[80:83]
ds_read_b128 v[136:139], v9 offset:1120
v_mfma_f32_16x16x32_bf16 v[84:87], v[164:167], v[208:211], v[84:87]
v_mfma_f32_16x16x32_bf16 v[88:91], v[164:167], v[212:215], v[88:91]
ds_read2_b64 v[108:111], v8 offset0:8 offset1:9
v_mfma_f32_16x16x32_bf16 v[92:95], v[164:167], v[216:219], v[92:95]
v_mfma_f32_16x16x32_bf16 v[72:75], v[168:171], v[192:195], v[72:75]
ds_read_b128 v[140:143], v9 offset:1632
v_mfma_f32_16x16x32_bf16 v[76:79], v[168:171], v[196:199], v[76:79]
v_mfma_f32_16x16x32_bf16 v[80:83], v[168:171], v[200:203], v[80:83]
ds_read2_b64 v[112:115], v7 offset0:200 offset1:201
v_mfma_f32_16x16x32_bf16 v[84:87], v[168:171], v[204:207], v[84:87]
v_mfma_f32_16x16x32_bf16 v[88:91], v[168:171], v[208:211], v[88:91]
ds_read_b128 v[144:147], v9 offset:2144
v_mfma_f32_16x16x32_bf16 v[92:95], v[168:171], v[212:215], v[92:95]
v_mfma_f32_16x16x32_bf16 v[76:79], v[172:175], v[192:195], v[76:79]
ds_read2_b64 v[116:119], v7 offset0:136 offset1:137
v_mfma_f32_16x16x32_bf16 v[80:83], v[172:175], v[196:199], v[80:83]
v_mfma_f32_16x16x32_bf16 v[84:87], v[172:175], v[200:203], v[84:87]
ds_read_b128 v[148:151], v9 offset:2656
v_mfma_f32_16x16x32_bf16 v[88:91], v[172:175], v[204:207], v[88:91]
v_mfma_f32_16x16x32_bf16 v[92:95], v[172:175], v[208:211], v[92:95]
ds_read2_b64 v[120:123], v7 offset0:72 offset1:73
v_mfma_f32_16x16x32_bf16 v[80:83], v[176:179], v[192:195], v[80:83]
v_mfma_f32_16x16x32_bf16 v[84:87], v[176:179], v[196:199], v[84:87]
ds_read_b128 v[152:155], v9 offset:3168
v_mfma_f32_16x16x32_bf16 v[88:91], v[176:179], v[200:203], v[88:91]
v_mfma_f32_16x16x32_bf16 v[92:95], v[176:179], v[204:207], v[92:95]
ds_read2_b64 v[124:127], v7 offset0:8 offset1:9
v_mfma_f32_16x16x32_bf16 v[84:87], v[180:183], v[192:195], v[84:87]
v_mfma_f32_16x16x32_bf16 v[88:91], v[180:183], v[196:199], v[88:91]
ds_read_b128 v[156:159], v9 offset:3680
v_mfma_f32_16x16x32_bf16 v[92:95], v[180:183], v[200:203], v[92:95]
v_mfma_f32_16x16x32_bf16 v[88:91], v[184:187], v[192:195], v[88:91]
v_mfma_f32_16x16x32_bf16 v[92:95], v[184:187], v[196:199], v[92:95]
v_mfma_f32_16x16x32_bf16 v[92:95], v[188:191], v[192:195], v[92:95]
s_waitcnt lgkmcnt(0)
v_mfma_f32_16x16x32_bf16 v[64:67], v[96:99], v[128:131], v[64:67]
v_mfma_f32_16x16x32_bf16 v[68:71], v[96:99], v[132:135], v[68:71]
ds_read2_b64 v[160:163], v8 offset0:192 offset1:193
v_mfma_f32_16x16x32_bf16 v[72:75], v[96:99], v[136:139], v[72:75]
v_mfma_f32_16x16x32_bf16 v[76:79], v[96:99], v[140:143], v[76:79]
ds_read_b128 v[192:195], v9 offset:32
v_mfma_f32_16x16x32_bf16 v[80:83], v[96:99], v[144:147], v[80:83]
v_mfma_f32_16x16x32_bf16 v[84:87], v[96:99], v[148:151], v[84:87]
ds_read2_b64 v[164:167], v8 offset0:128 offset1:129
v_mfma_f32_16x16x32_bf16 v[88:91], v[96:99], v[152:155], v[88:91]
v_mfma_f32_16x16x32_bf16 v[92:95], v[96:99], v[156:159], v[92:95]
ds_read_b128 v[196:199], v9 offset:544
v_mfma_f32_16x16x32_bf16 v[68:71], v[100:103], v[128:131], v[68:71]
v_mfma_f32_16x16x32_bf16 v[72:75], v[100:103], v[132:135], v[72:75]
ds_read2_b64 v[168:171], v8 offset0:64 offset1:65
v_mfma_f32_16x16x32_bf16 v[76:79], v[100:103], v[136:139], v[76:79]
v_mfma_f32_16x16x32_bf16 v[80:83], v[100:103], v[140:143], v[80:83]
ds_read_b128 v[200:203], v9 offset:1056
v_mfma_f32_16x16x32_bf16 v[84:87], v[100:103], v[144:147], v[84:87]
v_mfma_f32_16x16x32_bf16 v[88:91], v[100:103], v[148:151], v[88:91]
ds_read2_b64 v[172:175], v8 offset0:0 offset1:1
v_mfma_f32_16x16x32_bf16 v[92:95], v[100:103], v[152:155], v[92:95]
v_mfma_f32_16x16x32_bf16 v[72:75], v[104:107], v[128:131], v[72:75]
ds_read_b128 v[204:207], v9 offset:1568
v_mfma_f32_16x16x32_bf16 v[76:79], v[104:107], v[132:135], v[76:79]
v_mfma_f32_16x16x32_bf16 v[80:83], v[104:107], v[136:139], v[80:83]
ds_read2_b64 v[176:179], v7 offset0:192 offset1:193
v_mfma_f32_16x16x32_bf16 v[84:87], v[104:107], v[140:143], v[84:87]
v_mfma_f32_16x16x32_bf16 v[88:91], v[104:107], v[144:147], v[88:91]
ds_read_b128 v[208:211], v9 offset:2080
v_mfma_f32_16x16x32_bf16 v[92:95], v[104:107], v[148:151], v[92:95]
v_mfma_f32_16x16x32_bf16 v[76:79], v[108:111], v[128:131], v[76:79]
ds_read2_b64 v[180:183], v7 offset0:128 offset1:129
v_mfma_f32_16x16x32_bf16 v[80:83], v[108:111], v[132:135], v[80:83]
v_mfma_f32_16x16x32_bf16 v[84:87], v[108:111], v[136:139], v[84:87]
ds_read_b128 v[212:215], v9 offset:2592
v_mfma_f32_16x16x32_bf16 v[88:91], v[108:111], v[140:143], v[88:91]
v_mfma_f32_16x16x32_bf16 v[92:95], v[108:111], v[144:147], v[92:95]
ds_read2_b64 v[184:187], v7 offset0:64 offset1:65
v_mfma_f32_16x16x32_bf16 v[80:83], v[112:115], v[128:131], v[80:83]
v_mfma_f32_16x16x32_bf16 v[84:87], v[112:115], v[132:135], v[84:87]
ds_read_b128 v[216:219], v9 offset:3104
v_mfma_f32_16x16x32_bf16 v[88:91], v[112:115], v[136:139], v[88:91]
v_mfma_f32_16x16x32_bf16 v[92:95], v[112:115], v[140:143], v[92:95]
ds_read2_b64 v[188:191], v7 offset0:0 offset1:1
v_mfma_f32_16x16x32_bf16 v[84:87], v[116:119], v[128:131], v[84:87]
v_mfma_f32_16x16x32_bf16 v[88:91], v[116:119], v[132:135], v[88:91]
ds_read_b128 v[220:223], v9 offset:3616
v_mfma_f32_16x16x32_bf16 v[92:95], v[116:119], v[136:139], v[92:95]
v_mfma_f32_16x16x32_bf16 v[88:91], v[120:123], v[128:131], v[88:91]
v_mfma_f32_16x16x32_bf16 v[92:95], v[120:123], v[132:135], v[92:95]
v_mfma_f32_16x16x32_bf16 v[92:95], v[124:127], v[128:131], v[92:95]
s_waitcnt lgkmcnt(0)
v_mfma_f32_16x16x32_bf16 v[64:67], v[160:163], v[192:195], v[64:67]
v_mfma_f32_16x16x32_bf16 v[68:71], v[160:163], v[196:199], v[68:71]
v_mfma_f32_16x16x32_bf16 v[72:75], v[160:163], v[200:203], v[72:75]
v_mfma_f32_16x16x32_bf16 v[76:79], v[160:163], v[204:207], v[76:79]
v_mfma_f32_16x16x32_bf16 v[80:83], v[160:163], v[208:211], v[80:83]
v_mfma_f32_16x16x32_bf16 v[84:87], v[160:163], v[212:215], v[84:87]
v_mfma_f32_16x16x32_bf16 v[88:91], v[160:163], v[216:219], v[88:91]
v_mfma_f32_16x16x32_bf16 v[92:95], v[160:163], v[220:223], v[92:95]
v_mfma_f32_16x16x32_bf16 v[68:71], v[164:167], v[192:195], v[68:71]
v_mfma_f32_16x16x32_bf16 v[72:75], v[164:167], v[196:199], v[72:75]
v_mfma_f32_16x16x32_bf16 v[76:79], v[164:167], v[200:203], v[76:79]
v_mfma_f32_16x16x32_bf16 v[80:83], v[164:167], v[204:207], v[80:83]
v_mfma_f32_16x16x32_bf16 v[84:87], v[164:167], v[208:211], v[84:87]
v_mfma_f32_16x16x32_bf16 v[88:91], v[164:167], v[212:215], v[88:91]
v_mfma_f32_16x16x32_bf16 v[92:95], v[164:167], v[216:219], v[92:95]
v_mfma_f32_16x16x32_bf16 v[72:75], v[168:171], v[192:195], v[72:75]
v_mfma_f32_16x16x32_bf16 v[76:79], v[168:171], v[196:199], v[76:79]
v_mfma_f32_16x16x32_bf16 v[80:83], v[168:171], v[200:203], v[80:83]
v_mfma_f32_16x16x32_bf16 v[84:87], v[168:171], v[204:207], v[84:87]
v_mfma_f32_16x16x32_bf16 v[88:91], v[168:171], v[208:211], v[88:91]
v_mfma_f32_16x16x32_bf16 v[92:95], v[168:171], v[212:215], v[92:95]
v_mfma_f32_16x16x32_bf16 v[76:79], v[172:175], v[192:195], v[76:79]
v_mfma_f32_16x16x32_bf16 v[80:83], v[172:175], v[196:199], v[80:83]
v_mfma_f32_16x16x32_bf16 v[84:87], v[172:175], v[200:203], v[84:87]
v_mfma_f32_16x16x32_bf16 v[88:91], v[172:175], v[204:207], v[88:91]
v_mfma_f32_16x16x32_bf16 v[92:95], v[172:175], v[208:211], v[92:95]
v_mfma_f32_16x16x32_bf16 v[80:83], v[176:179], v[192:195], v[80:83]
v_mfma_f32_16x16x32_bf16 v[84:87], v[176:179], v[196:199], v[84:87]
v_mfma_f32_16x16x32_bf16 v[88:91], v[176:179], v[200:203], v[88:91]
v_mfma_f32_16x16x32_bf16 v[92:95], v[176:179], v[204:207], v[92:95]
v_mfma_f32_16x16x32_bf16 v[84:87], v[180:183], v[192:195], v[84:87]
v_mfma_f32_16x16x32_bf16 v[88:91], v[180:183], v[196:199], v[88:91]
v_mfma_f32_16x16x32_bf16 v[92:95], v[180:183], v[200:203], v[92:95]
v_mfma_f32_16x16x32_bf16 v[88:91], v[184:187], v[192:195], v[88:91]
v_mfma_f32_16x16x32_bf16 v[92:95], v[184:187], v[196:199], v[92:95]
v_mfma_f32_16x16x32_bf16 v[92:95], v[188:191], v[192:195], v[92:95]
s_waitcnt vmcnt(0)
v_add_u32 v10, s6, v6
ds_read_b64 v[96:97], v10 offset:17152
ds_read_b64 v[98:99], v10 offset:17664
ds_read_b64 v[100:101], v10 offset:18176
ds_read_b64 v[102:103], v10 offset:18688
ds_read_b64 v[104:105], v10 offset:19200
ds_read_b64 v[106:107], v10 offset:19712
ds_read_b64 v[108:109], v10 offset:20224
ds_read_b64 v[110:111], v10 offset:20736
s_mul_i32 s29, s4, 4160
s_add_u32 s29, s29, 84992
v_add_u32 v11, s29, v6
s_waitcnt lgkmcnt(0)
v_lshlrev_b32 v112, 16, v96
v_and_b32 v113, 0xffff0000, v96
v_lshlrev_b32 v114, 16, v97
v_and_b32 v115, 0xffff0000, v97
v_lshlrev_b32 v116, 16, v32
v_and_b32 v117, 0xffff0000, v32
v_lshlrev_b32 v118, 16, v33
v_and_b32 v119, 0xffff0000, v33
v_fma_f32 v112, v112, s28, v64
v_fma_f32 v116, v112, s26, v116
v_fma_f32 v113, v113, s28, v65
v_fma_f32 v117, v113, s26, v117
v_fma_f32 v114, v114, s28, v66
v_fma_f32 v118, v114, s26, v118
v_fma_f32 v115, v115, s28, v67
v_fma_f32 v119, v115, s26, v119
v_cvt_pk_bf16_f32 v120, v116, v117
v_cvt_pk_bf16_f32 v121, v118, v119
v_lshlrev_b32 v112, 16, v120
v_and_b32 v113, 0xffff0000, v120
v_lshlrev_b32 v114, 16, v121
v_and_b32 v115, 0xffff0000, v121
v_mul_f32 v112, s27, v112
v_mul_f32 v113, s27, v113
v_mul_f32 v114, s27, v114
v_mul_f32 v115, s27, v115
v_cvt_pk_bf16_f32 v122, v112, v113
v_cvt_pk_bf16_f32 v123, v114, v115
ds_write_b64 v11, v[120:121] offset:0
ds_write_b64 v11, v[122:123] offset:16640
v_lshlrev_b32 v112, 16, v98
v_and_b32 v113, 0xffff0000, v98
v_lshlrev_b32 v114, 16, v99
v_and_b32 v115, 0xffff0000, v99
v_lshlrev_b32 v116, 16, v34
v_and_b32 v117, 0xffff0000, v34
v_lshlrev_b32 v118, 16, v35
v_and_b32 v119, 0xffff0000, v35
v_fma_f32 v112, v112, s28, v68
v_fma_f32 v116, v112, s26, v116
v_fma_f32 v113, v113, s28, v69
v_fma_f32 v117, v113, s26, v117
v_fma_f32 v114, v114, s28, v70
v_fma_f32 v118, v114, s26, v118
v_fma_f32 v115, v115, s28, v71
v_fma_f32 v119, v115, s26, v119
v_cvt_pk_bf16_f32 v124, v116, v117
v_cvt_pk_bf16_f32 v125, v118, v119
v_lshlrev_b32 v112, 16, v124
v_and_b32 v113, 0xffff0000, v124
v_lshlrev_b32 v114, 16, v125
v_and_b32 v115, 0xffff0000, v125
v_mul_f32 v112, s27, v112
v_mul_f32 v113, s27, v113
v_mul_f32 v114, s27, v114
v_mul_f32 v115, s27, v115
v_cvt_pk_bf16_f32 v126, v112, v113
v_cvt_pk_bf16_f32 v127, v114, v115
ds_write_b64 v11, v[124:125] offset:512
ds_write_b64 v11, v[126:127] offset:17152
v_lshlrev_b32 v112, 16, v100
v_and_b32 v113, 0xffff0000, v100
v_lshlrev_b32 v114, 16, v101
v_and_b32 v115, 0xffff0000, v101
v_lshlrev_b32 v116, 16, v36
v_and_b32 v117, 0xffff0000, v36
v_lshlrev_b32 v118, 16, v37
v_and_b32 v119, 0xffff0000, v37
v_fma_f32 v112, v112, s28, v72
v_fma_f32 v116, v112, s26, v116
v_fma_f32 v113, v113, s28, v73
v_fma_f32 v117, v113, s26, v117
v_fma_f32 v114, v114, s28, v74
v_fma_f32 v118, v114, s26, v118
v_fma_f32 v115, v115, s28, v75
v_fma_f32 v119, v115, s26, v119
v_cvt_pk_bf16_f32 v120, v116, v117
v_cvt_pk_bf16_f32 v121, v118, v119
v_lshlrev_b32 v112, 16, v120
v_and_b32 v113, 0xffff0000, v120
v_lshlrev_b32 v114, 16, v121
v_and_b32 v115, 0xffff0000, v121
v_mul_f32 v112, s27, v112
v_mul_f32 v113, s27, v113
v_mul_f32 v114, s27, v114
v_mul_f32 v115, s27, v115
v_cvt_pk_bf16_f32 v122, v112, v113
v_cvt_pk_bf16_f32 v123, v114, v115
ds_write_b64 v11, v[120:121] offset:1024
ds_write_b64 v11, v[122:123] offset:17664
v_lshlrev_b32 v112, 16, v102
v_and_b32 v113, 0xffff0000, v102
v_lshlrev_b32 v114, 16, v103
v_and_b32 v115, 0xffff0000, v103
v_lshlrev_b32 v116, 16, v38
v_and_b32 v117, 0xffff0000, v38
v_lshlrev_b32 v118, 16, v39
v_and_b32 v119, 0xffff0000, v39
v_fma_f32 v112, v112, s28, v76
v_fma_f32 v116, v112, s26, v116
v_fma_f32 v113, v113, s28, v77
v_fma_f32 v117, v113, s26, v117
v_fma_f32 v114, v114, s28, v78
v_fma_f32 v118, v114, s26, v118
v_fma_f32 v115, v115, s28, v79
v_fma_f32 v119, v115, s26, v119
v_cvt_pk_bf16_f32 v124, v116, v117
v_cvt_pk_bf16_f32 v125, v118, v119
v_lshlrev_b32 v112, 16, v124
v_and_b32 v113, 0xffff0000, v124
v_lshlrev_b32 v114, 16, v125
v_and_b32 v115, 0xffff0000, v125
v_mul_f32 v112, s27, v112
v_mul_f32 v113, s27, v113
v_mul_f32 v114, s27, v114
v_mul_f32 v115, s27, v115
v_cvt_pk_bf16_f32 v126, v112, v113
v_cvt_pk_bf16_f32 v127, v114, v115
ds_write_b64 v11, v[124:125] offset:1536
ds_write_b64 v11, v[126:127] offset:18176
v_lshlrev_b32 v112, 16, v104
v_and_b32 v113, 0xffff0000, v104
v_lshlrev_b32 v114, 16, v105
v_and_b32 v115, 0xffff0000, v105
v_lshlrev_b32 v116, 16, v40
v_and_b32 v117, 0xffff0000, v40
v_lshlrev_b32 v118, 16, v41
v_and_b32 v119, 0xffff0000, v41
v_fma_f32 v112, v112, s28, v80
v_fma_f32 v116, v112, s26, v116
v_fma_f32 v113, v113, s28, v81
v_fma_f32 v117, v113, s26, v117
v_fma_f32 v114, v114, s28, v82
v_fma_f32 v118, v114, s26, v118
v_fma_f32 v115, v115, s28, v83
v_fma_f32 v119, v115, s26, v119
v_cvt_pk_bf16_f32 v120, v116, v117
v_cvt_pk_bf16_f32 v121, v118, v119
v_lshlrev_b32 v112, 16, v120
v_and_b32 v113, 0xffff0000, v120
v_lshlrev_b32 v114, 16, v121
v_and_b32 v115, 0xffff0000, v121
v_mul_f32 v112, s27, v112
v_mul_f32 v113, s27, v113
v_mul_f32 v114, s27, v114
v_mul_f32 v115, s27, v115
v_cvt_pk_bf16_f32 v122, v112, v113
v_cvt_pk_bf16_f32 v123, v114, v115
ds_write_b64 v11, v[120:121] offset:2048
ds_write_b64 v11, v[122:123] offset:18688
v_lshlrev_b32 v112, 16, v106
v_and_b32 v113, 0xffff0000, v106
v_lshlrev_b32 v114, 16, v107
v_and_b32 v115, 0xffff0000, v107
v_lshlrev_b32 v116, 16, v42
v_and_b32 v117, 0xffff0000, v42
v_lshlrev_b32 v118, 16, v43
v_and_b32 v119, 0xffff0000, v43
v_fma_f32 v112, v112, s28, v84
v_fma_f32 v116, v112, s26, v116
v_fma_f32 v113, v113, s28, v85
v_fma_f32 v117, v113, s26, v117
v_fma_f32 v114, v114, s28, v86
v_fma_f32 v118, v114, s26, v118
v_fma_f32 v115, v115, s28, v87
v_fma_f32 v119, v115, s26, v119
v_cvt_pk_bf16_f32 v124, v116, v117
v_cvt_pk_bf16_f32 v125, v118, v119
v_lshlrev_b32 v112, 16, v124
v_and_b32 v113, 0xffff0000, v124
v_lshlrev_b32 v114, 16, v125
v_and_b32 v115, 0xffff0000, v125
v_mul_f32 v112, s27, v112
v_mul_f32 v113, s27, v113
v_mul_f32 v114, s27, v114
v_mul_f32 v115, s27, v115
v_cvt_pk_bf16_f32 v126, v112, v113
v_cvt_pk_bf16_f32 v127, v114, v115
ds_write_b64 v11, v[124:125] offset:2560
ds_write_b64 v11, v[126:127] offset:19200
v_lshlrev_b32 v112, 16, v108
v_and_b32 v113, 0xffff0000, v108
v_lshlrev_b32 v114, 16, v109
v_and_b32 v115, 0xffff0000, v109
v_lshlrev_b32 v116, 16, v44
v_and_b32 v117, 0xffff0000, v44
v_lshlrev_b32 v118, 16, v45
v_and_b32 v119, 0xffff0000, v45
v_fma_f32 v112, v112, s28, v88
v_fma_f32 v116, v112, s26, v116
v_fma_f32 v113, v113, s28, v89
v_fma_f32 v117, v113, s26, v117
v_fma_f32 v114, v114, s28, v90
v_fma_f32 v118, v114, s26, v118
v_fma_f32 v115, v115, s28, v91
v_fma_f32 v119, v115, s26, v119
v_cvt_pk_bf16_f32 v120, v116, v117
v_cvt_pk_bf16_f32 v121, v118, v119
v_lshlrev_b32 v112, 16, v120
v_and_b32 v113, 0xffff0000, v120
v_lshlrev_b32 v114, 16, v121
v_and_b32 v115, 0xffff0000, v121
v_mul_f32 v112, s27, v112
v_mul_f32 v113, s27, v113
v_mul_f32 v114, s27, v114
v_mul_f32 v115, s27, v115
v_cvt_pk_bf16_f32 v122, v112, v113
v_cvt_pk_bf16_f32 v123, v114, v115
ds_write_b64 v11, v[120:121] offset:3072
ds_write_b64 v11, v[122:123] offset:19712
v_lshlrev_b32 v112, 16, v110
v_and_b32 v113, 0xffff0000, v110
v_lshlrev_b32 v114, 16, v111
v_and_b32 v115, 0xffff0000, v111
v_lshlrev_b32 v116, 16, v46
v_and_b32 v117, 0xffff0000, v46
v_lshlrev_b32 v118, 16, v47
v_and_b32 v119, 0xffff0000, v47
v_fma_f32 v112, v112, s28, v92
v_fma_f32 v116, v112, s26, v116
v_fma_f32 v113, v113, s28, v93
v_fma_f32 v117, v113, s26, v117
v_fma_f32 v114, v114, s28, v94
v_fma_f32 v118, v114, s26, v118
v_fma_f32 v115, v115, s28, v95
v_fma_f32 v119, v115, s26, v119
v_cvt_pk_bf16_f32 v124, v116, v117
v_cvt_pk_bf16_f32 v125, v118, v119
v_lshlrev_b32 v112, 16, v124
v_and_b32 v113, 0xffff0000, v124
v_lshlrev_b32 v114, 16, v125
v_and_b32 v115, 0xffff0000, v125
v_mul_f32 v112, s27, v112
v_mul_f32 v113, s27, v113
v_mul_f32 v114, s27, v114
v_mul_f32 v115, s27, v115
v_cvt_pk_bf16_f32 v126, v112, v113
v_cvt_pk_bf16_f32 v127, v114, v115
ds_write_b64 v11, v[124:125] offset:3584
ds_write_b64 v11, v[126:127] offset:20224
s_waitcnt lgkmcnt(0)
s_barrier
v_bfe_u32 v7, v0, 2, 2
v_mul_u32_u24 v7, 4160, v7
v_and_b32 v8, 3, v0
v_lshlrev_b32 v8, 3, v8
v_add_u32 v7, v7, v8
v_lshlrev_b32 v8, 5, v5
v_add_u32 v7, v7, v8
s_lshl_b32 s29, s4, 10
s_add_u32 s29, s29, 84992
v_add_u32 v7, s29, v7
ds_read_b64_tr_b16 v[16:17], v7 offset:0
ds_read_b64_tr_b16 v[32:33], v7 offset:16640
ds_read_b64_tr_b16 v[18:19], v7 offset:128
ds_read_b64_tr_b16 v[34:35], v7 offset:16768
ds_read_b64_tr_b16 v[20:21], v7 offset:256
ds_read_b64_tr_b16 v[36:37], v7 offset:16896
ds_read_b64_tr_b16 v[22:23], v7 offset:384
ds_read_b64_tr_b16 v[38:39], v7 offset:17024
ds_read_b64_tr_b16 v[24:25], v7 offset:512
ds_read_b64_tr_b16 v[40:41], v7 offset:17152
ds_read_b64_tr_b16 v[26:27], v7 offset:640
ds_read_b64_tr_b16 v[42:43], v7 offset:17280
ds_read_b64_tr_b16 v[28:29], v7 offset:768
ds_read_b64_tr_b16 v[44:45], v7 offset:17408
ds_read_b64_tr_b16 v[30:31], v7 offset:896
ds_read_b64_tr_b16 v[46:47], v7 offset:17536
v_mul_u32_u24 v8, 20480, v5
v_lshlrev_b32 v9, 4, v4
v_add_u32 v8, v8, v9
s_lshr_b32 s30, s3, 3
s_lshl_b32 s30, s30, 10
s_and_b32 s31, s3, 3
s_lshl_b32 s31, s31, 8
s_add_u32 s30, s30, s31
s_bfe_u32 s31, s3, 0x10002
s_lshl_b32 s31, s31, 3
s_add_u32 s30, s30, s31
s_mul_i32 s31, s4, 655360
s_add_u32 s30, s30, s31
s_add_u32 s31, s30, 14680064
s_add_u32 s30, s30, 11534336
s_waitcnt lgkmcnt(0)
buffer_store_dwordx2 v[16:17], v8, s[8:11], s30 offen
buffer_store_dwordx2 v[32:33], v8, s[8:11], s31 offen
s_add_u32 s30, s30, 81920
s_add_u32 s31, s31, 81920
buffer_store_dwordx2 v[18:19], v8, s[8:11], s30 offen
buffer_store_dwordx2 v[34:35], v8, s[8:11], s31 offen
s_add_u32 s30, s30, 81920
s_add_u32 s31, s31, 81920
buffer_store_dwordx2 v[20:21], v8, s[8:11], s30 offen
buffer_store_dwordx2 v[36:37], v8, s[8:11], s31 offen
s_add_u32 s30, s30, 81920
s_add_u32 s31, s31, 81920
buffer_store_dwordx2 v[22:23], v8, s[8:11], s30 offen
buffer_store_dwordx2 v[38:39], v8, s[8:11], s31 offen
s_add_u32 s30, s30, 81920
s_add_u32 s31, s31, 81920
buffer_store_dwordx2 v[24:25], v8, s[8:11], s30 offen
buffer_store_dwordx2 v[40:41], v8, s[8:11], s31 offen
s_add_u32 s30, s30, 81920
s_add_u32 s31, s31, 81920
buffer_store_dwordx2 v[26:27], v8, s[8:11], s30 offen
buffer_store_dwordx2 v[42:43], v8, s[8:11], s31 offen
s_add_u32 s30, s30, 81920
s_add_u32 s31, s31, 81920
buffer_store_dwordx2 v[28:29], v8, s[8:11], s30 offen
buffer_store_dwordx2 v[44:45], v8, s[8:11], s31 offen
s_add_u32 s30, s30, 81920
s_add_u32 s31, s31, 81920
buffer_store_dwordx2 v[30:31], v8, s[8:11], s30 offen
buffer_store_dwordx2 v[46:47], v8, s[8:11], s31 offen
s_add_u32 s30, s30, 81920
s_add_u32 s31, s31, 81920
s_waitcnt vmcnt(0)
s_endpgm
L_8:
s_cmp_ge_u32 s2, 256
s_cbranch_scc1 L_9
s_sub_u32 s3, s2, 160
s_load_dwordx2 s[8:9], s[0:1], 144
s_mov_b32 s10, 268435456
s_mov_b32 s11, 0x20000
s_load_dwordx2 s[12:13], s[0:1], 80
s_mov_b32 s14, 819200
s_mov_b32 s15, 0x20000
s_load_dwordx2 s[16:17], s[0:1], 88
s_mov_b32 s18, 819200
s_mov_b32 s19, 0x20000
s_load_dwordx2 s[20:21], s[0:1], 96
s_mov_b32 s22, 2211840
s_mov_b32 s23, 0x20000
s_load_dwordx2 s[24:25], s[0:1], 104
s_mov_b32 s26, 2211840
s_mov_b32 s27, 0x20000
v_and_b32 v1, 63, v0
v_lshrrev_b32 v2, 6, v0
s_nop 0
v_readfirstlane_b32 s4, v2
v_and_b32 v4, 15, v0
v_bfe_u32 v5, v0, 4, 2
s_waitcnt lgkmcnt(0)
s_cmp_lg_u32 s3, 95
s_cbranch_scc1 L_10
v_lshlrev_b32 v6, 4, v0
v_mov_b32 v8, 0
v_mov_b32 v9, 0
v_mov_b32 v10, 0
v_mov_b32 v11, 0
s_mov_b32 s45, 163840
buffer_store_dwordx4 v[8:11], v6, s[8:11], s45 offen
buffer_store_dwordx4 v[8:11], v6, s[8:11], s45 offen offset:2048
s_mov_b32 s45, 196608
buffer_store_dwordx4 v[8:11], v6, s[8:11], s45 offen
s_add_u32 s45, s45, 4096
buffer_store_dwordx4 v[8:11], v6, s[8:11], s45 offen
s_add_u32 s45, s45, 4096
buffer_store_dwordx4 v[8:11], v6, s[8:11], s45 offen
s_add_u32 s45, s45, 4096
buffer_store_dwordx4 v[8:11], v6, s[8:11], s45 offen
s_add_u32 s45, s45, 4096
buffer_store_dwordx4 v[8:11], v6, s[8:11], s45 offen
s_add_u32 s45, s45, 4096
buffer_store_dwordx4 v[8:11], v6, s[8:11], s45 offen
s_add_u32 s45, s45, 4096
buffer_store_dwordx4 v[8:11], v6, s[8:11], s45 offen
s_add_u32 s45, s45, 4096
buffer_store_dwordx4 v[8:11], v6, s[8:11], s45 offen
s_add_u32 s45, s45, 4096
buffer_store_dwordx4 v[8:11], v6, s[8:11], s45 offen
s_add_u32 s45, s45, 4096
buffer_store_dwordx4 v[8:11], v6, s[8:11], s45 offen
s_add_u32 s45, s45, 4096
buffer_store_dwordx4 v[8:11], v6, s[8:11], s45 offen
s_add_u32 s45, s45, 4096
buffer_store_dwordx4 v[8:11], v6, s[8:11], s45 offen
s_add_u32 s45, s45, 4096
buffer_store_dwordx4 v[8:11], v6, s[8:11], s45 offen
s_add_u32 s45, s45, 4096
buffer_store_dwordx4 v[8:11], v6, s[8:11], s45 offen
s_add_u32 s45, s45, 4096
buffer_store_dwordx4 v[8:11], v6, s[8:11], s45 offen
s_add_u32 s45, s45, 4096
buffer_store_dwordx4 v[8:11], v6, s[8:11], s45 offen
s_add_u32 s45, s45, 4096
L_10:
L_11:
s_cmp_ge_u32 s3, 20
s_cbranch_scc1 L_13
s_mov_b32 s28, s12
s_mov_b32 s29, s13
s_mov_b32 s30, s14
s_mov_b32 s31, s15
s_mov_b32 s38, s3
s_mov_b32 s32, 1280
s_lshl_b32 s33, s38, 6
s_mov_b32 s34, 20
s_mul_i32 s35, s38, 40960
s_add_u32 s35, s35, 30408704
s_mov_b32 s36, 20480
s_mov_b32 s37, 0
s_branch L_16
L_13:
s_cmp_ge_u32 s3, 40
s_cbranch_scc1 L_14
s_mov_b32 s28, s16
s_mov_b32 s29, s17
s_mov_b32 s30, s18
s_mov_b32 s31, s19
s_sub_u32 s38, s3, 20
s_mov_b32 s32, 1280
s_lshl_b32 s33, s38, 6
s_mov_b32 s34, 20
s_mul_i32 s35, s38, 40960
s_add_u32 s35, s35, 31457280
s_mov_b32 s36, 20480
s_mov_b32 s37, 2
s_branch L_16
L_14:
s_cmp_ge_u32 s3, 94
s_cbranch_scc1 L_15
s_mov_b32 s28, s20
s_mov_b32 s29, s21
s_mov_b32 s30, s22
s_mov_b32 s31, s23
s_sub_u32 s38, s3, 40
s_mov_b32 s32, 3456
s_lshl_b32 s33, s38, 6
s_mov_b32 s34, 20
s_mul_i32 s35, s38, 40960
s_add_u32 s35, s35, 32505856
s_mov_b32 s36, 20480
s_mov_b32 s37, 1
s_branch L_16
L_15:
s_mov_b32 s28, s24
s_mov_b32 s29, s25
s_mov_b32 s30, s26
s_mov_b32 s31, s27
s_sub_u32 s39, s3, 94
s_mul_i32 s38, s39, 21846
s_lshr_b32 s38, s38, 16
s_mul_i32 s40, s38, 3
s_sub_u32 s39, s39, s40
s_mov_b32 s32, 1280
s_lshl_b32 s33, s38, 6
s_mul_i32 s40, s39, 737280
s_add_u32 s33, s33, s40
s_mov_b32 s34, 18
s_mul_i32 s35, s38, 110592
s_mul_i32 s40, s39, 18432
s_add_u32 s35, s35, s40
s_add_u32 s35, s35, 35651584
s_mov_b32 s36, 55296
s_mov_b32 s37, 2
L_16:
v_lshrrev_b32 v6, 2, v1
v_mul_lo_u32 v6, v6, s32
v_and_b32 v7, 3, v0
v_lshlrev_b32 v7, 4, v7
v_add_u32 v6, v6, v7
s_lshl_b32 s40, s32, 4
s_mul_i32 s41, s40, s4
s_add_u32 s41, s41, s33
s_lshl_b32 s42, s4, 10
s_lshl_b32 s40, s40, 2
s_lshl_b32 s43, s34, 1
s_mov_b32 s44, s4
L_17:
s_mov_b32 m0, s42
s_nop 0
buffer_load_dwordx4 v6, s[28:31], s41 offen lds
s_add_u32 s41, s41, s40
s_add_u32 s42, s42, 4096
s_add_u32 s44, s44, 4
s_cmp_lt_u32 s44, s43
s_cbranch_scc1 L_17
s_cmp_lg_u32 s37, 0
s_cbranch_scc1 L_18
v_add_u32 v8, 0, v0
v_min_u32 v8, 639, v8
v_lshlrev_b32 v9, 2, v8
s_mov_b32 s45, 7680
buffer_load_dword v16, v9, s[8:11], s45 offen
s_mov_b32 s45, 23040
buffer_load_dword v17, v9, s[8:11], s45 offen
s_mov_b32 s45, 38400
buffer_load_dword v18, v9, s[8:11], s45 offen
s_mov_b32 s45, 53760
buffer_load_dword v19, v9, s[8:11], s45 offen
s_mov_b32 s45, 69120
buffer_load_dword v20, v9, s[8:11], s45 offen
s_mov_b32 s45, 84480
buffer_load_dword v21, v9, s[8:11], s45 offen
s_mov_b32 s45, 99840
buffer_load_dword v22, v9, s[8:11], s45 offen
s_mov_b32 s45, 115200
buffer_load_dword v23, v9, s[8:11], s45 offen
s_mov_b32 s45, 10240
buffer_load_dword v24, v9, s[8:11], s45 offen
s_mov_b32 s45, 25600
buffer_load_dword v25, v9, s[8:11], s45 offen
s_mov_b32 s45, 40960
buffer_load_dword v26, v9, s[8:11], s45 offen
s_mov_b32 s45, 56320
buffer_load_dword v27, v9, s[8:11], s45 offen
s_mov_b32 s45, 71680
buffer_load_dword v28, v9, s[8:11], s45 offen
s_mov_b32 s45, 87040
buffer_load_dword v29, v9, s[8:11], s45 offen
s_mov_b32 s45, 102400
buffer_load_dword v30, v9, s[8:11], s45 offen
s_mov_b32 s45, 117760
buffer_load_dword v31, v9, s[8:11], s45 offen
s_mov_b32 s45, 12800
buffer_load_dword v32, v9, s[8:11], s45 offen
s_mov_b32 s45, 28160
buffer_load_dword v33, v9, s[8:11], s45 offen
s_mov_b32 s45, 43520
buffer_load_dword v34, v9, s[8:11], s45 offen
s_mov_b32 s45, 58880
buffer_load_dword v35, v9, s[8:11], s45 offen
s_mov_b32 s45, 74240
buffer_load_dword v36, v9, s[8:11], s45 offen
s_mov_b32 s45, 89600
buffer_load_dword v37, v9, s[8:11], s45 offen
s_mov_b32 s45, 104960
buffer_load_dword v38, v9, s[8:11], s45 offen
s_mov_b32 s45, 120320
buffer_load_dword v39, v9, s[8:11], s45 offen
v_add_u32 v8, 256, v0
v_min_u32 v8, 639, v8
v_lshlrev_b32 v9, 2, v8
s_mov_b32 s45, 7680
buffer_load_dword v40, v9, s[8:11], s45 offen
s_mov_b32 s45, 23040
buffer_load_dword v41, v9, s[8:11], s45 offen
s_mov_b32 s45, 38400
buffer_load_dword v42, v9, s[8:11], s45 offen
s_mov_b32 s45, 53760
buffer_load_dword v43, v9, s[8:11], s45 offen
s_mov_b32 s45, 69120
buffer_load_dword v44, v9, s[8:11], s45 offen
s_mov_b32 s45, 84480
buffer_load_dword v45, v9, s[8:11], s45 offen
s_mov_b32 s45, 99840
buffer_load_dword v46, v9, s[8:11], s45 offen
s_mov_b32 s45, 115200
buffer_load_dword v47, v9, s[8:11], s45 offen
s_mov_b32 s45, 10240
buffer_load_dword v48, v9, s[8:11], s45 offen
s_mov_b32 s45, 25600
buffer_load_dword v49, v9, s[8:11], s45 offen
s_mov_b32 s45, 40960
buffer_load_dword v50, v9, s[8:11], s45 offen
s_mov_b32 s45, 56320
buffer_load_dword v51, v9, s[8:11], s45 offen
s_mov_b32 s45, 71680
buffer_load_dword v52, v9, s[8:11], s45 offen
s_mov_b32 s45, 87040
buffer_load_dword v53, v9, s[8:11], s45 offen
s_mov_b32 s45, 102400
buffer_load_dword v54, v9, s[8:11], s45 offen
s_mov_b32 s45, 117760
buffer_load_dword v55, v9, s[8:11], s45 offen
s_mov_b32 s45, 12800
buffer_load_dword v56, v9, s[8:11], s45 offen
s_mov_b32 s45, 28160
buffer_load_dword v57, v9, s[8:11], s45 offen
s_mov_b32 s45, 43520
buffer_load_dword v58, v9, s[8:11], s45 offen
s_mov_b32 s45, 58880
buffer_load_dword v59, v9, s[8:11], s45 offen
s_mov_b32 s45, 74240
buffer_load_dword v60, v9, s[8:11], s45 offen
s_mov_b32 s45, 89600
buffer_load_dword v61, v9, s[8:11], s45 offen
s_mov_b32 s45, 104960
buffer_load_dword v62, v9, s[8:11], s45 offen
s_mov_b32 s45, 120320
buffer_load_dword v63, v9, s[8:11], s45 offen
v_add_u32 v8, 512, v0
v_min_u32 v8, 639, v8
v_lshlrev_b32 v9, 2, v8
s_mov_b32 s45, 7680
buffer_load_dword v64, v9, s[8:11], s45 offen
s_mov_b32 s45, 23040
buffer_load_dword v65, v9, s[8:11], s45 offen
s_mov_b32 s45, 38400
buffer_load_dword v66, v9, s[8:11], s45 offen
s_mov_b32 s45, 53760
buffer_load_dword v67, v9, s[8:11], s45 offen
s_mov_b32 s45, 69120
buffer_load_dword v68, v9, s[8:11], s45 offen
s_mov_b32 s45, 84480
buffer_load_dword v69, v9, s[8:11], s45 offen
s_mov_b32 s45, 99840
buffer_load_dword v70, v9, s[8:11], s45 offen
s_mov_b32 s45, 115200
buffer_load_dword v71, v9, s[8:11], s45 offen
s_mov_b32 s45, 10240
buffer_load_dword v72, v9, s[8:11], s45 offen
s_mov_b32 s45, 25600
buffer_load_dword v73, v9, s[8:11], s45 offen
s_mov_b32 s45, 40960
buffer_load_dword v74, v9, s[8:11], s45 offen
s_mov_b32 s45, 56320
buffer_load_dword v75, v9, s[8:11], s45 offen
s_mov_b32 s45, 71680
buffer_load_dword v76, v9, s[8:11], s45 offen
s_mov_b32 s45, 87040
buffer_load_dword v77, v9, s[8:11], s45 offen
s_mov_b32 s45, 102400
buffer_load_dword v78, v9, s[8:11], s45 offen
s_mov_b32 s45, 117760
buffer_load_dword v79, v9, s[8:11], s45 offen
s_mov_b32 s45, 12800
buffer_load_dword v80, v9, s[8:11], s45 offen
s_mov_b32 s45, 28160
buffer_load_dword v81, v9, s[8:11], s45 offen
s_mov_b32 s45, 43520
buffer_load_dword v82, v9, s[8:11], s45 offen
s_mov_b32 s45, 58880
buffer_load_dword v83, v9, s[8:11], s45 offen
s_mov_b32 s45, 74240
buffer_load_dword v84, v9, s[8:11], s45 offen
s_mov_b32 s45, 89600
buffer_load_dword v85, v9, s[8:11], s45 offen
s_mov_b32 s45, 104960
buffer_load_dword v86, v9, s[8:11], s45 offen
s_mov_b32 s45, 120320
buffer_load_dword v87, v9, s[8:11], s45 offen
s_waitcnt vmcnt(0)
v_add_u32 v8, 0, v0
v_min_u32 v8, 639, v8
v_lshlrev_b32 v9, 2, v8
v_add_f32 v16, v16, v17
v_add_f32 v16, v16, v18
v_add_f32 v16, v16, v19
v_add_f32 v16, v16, v20
v_add_f32 v16, v16, v21
v_add_f32 v16, v16, v22
v_add_f32 v16, v16, v23
v_cvt_pk_bf16_f32 v16, v16, v16
v_lshlrev_b32 v16, 16, v16
v_add_f32 v24, v24, v25
v_add_f32 v24, v24, v26
v_add_f32 v24, v24, v27
v_add_f32 v24, v24, v28
v_add_f32 v24, v24, v29
v_add_f32 v24, v24, v30
v_add_f32 v24, v24, v31
v_cvt_pk_bf16_f32 v24, v24, v24
v_lshlrev_b32 v24, 16, v24
v_add_f32 v32, v32, v33
v_add_f32 v32, v32, v34
v_add_f32 v32, v32, v35
v_add_f32 v32, v32, v36
v_add_f32 v32, v32, v37
v_add_f32 v32, v32, v38
v_add_f32 v32, v32, v39
v_cvt_pk_bf16_f32 v32, v32, v32
v_lshlrev_b32 v32, 16, v32
v_add_f32 v24, 1.0, v24
v_cvt_pk_bf16_f32 v24, v24, v24
v_lshlrev_b32 v24, 16, v24
v_lshlrev_b32 v10, 1, v8
v_lshrrev_b32 v11, 16, v24
ds_write_b16 v10, v11 offset:41984
v_lshrrev_b32 v11, 16, v16
ds_write_b16 v10, v11 offset:43280
v_mov_b32 v11, 0x3f80
ds_write_b16 v10, v11 offset:44576
s_cmp_lg_u32 s3, 0
s_cbranch_scc1 L_19
s_mov_b32 s45, 147456
buffer_store_dword v24, v9, s[8:11], s45 offen
s_mov_b32 s45, 150016
buffer_store_dword v16, v9, s[8:11], s45 offen
s_mov_b32 s45, 152576
buffer_store_dword v32, v9, s[8:11], s45 offen
v_and_b32 v10, 0xffffffe3, v8
v_bfe_u32 v11, v8, 2, 2
v_lshlrev_b32 v11, 3, v11
v_add_u32 v10, v10, v11
v_bfe_u32 v11, v8, 4, 1
v_lshlrev_b32 v11, 2, v11
v_add_u32 v10, v10, v11
v_lshlrev_b32 v10, 2, v10
s_mov_b32 s45, 155648
buffer_store_dword v24, v10, s[8:11], s45 offen
s_mov_b32 s45, 158208
buffer_store_dword v16, v10, s[8:11], s45 offen
L_19:
v_add_u32 v8, 256, v0
v_min_u32 v8, 639, v8
v_lshlrev_b32 v9, 2, v8
v_add_f32 v40, v40, v41
v_add_f32 v40, v40, v42
v_add_f32 v40, v40, v43
v_add_f32 v40, v40, v44
v_add_f32 v40, v40, v45
v_add_f32 v40, v40, v46
v_add_f32 v40, v40, v47
v_cvt_pk_bf16_f32 v40, v40, v40
v_lshlrev_b32 v40, 16, v40
v_add_f32 v48, v48, v49
v_add_f32 v48, v48, v50
v_add_f32 v48, v48, v51
v_add_f32 v48, v48, v52
v_add_f32 v48, v48, v53
v_add_f32 v48, v48, v54
v_add_f32 v48, v48, v55
v_cvt_pk_bf16_f32 v48, v48, v48
v_lshlrev_b32 v48, 16, v48
v_add_f32 v56, v56, v57
v_add_f32 v56, v56, v58
v_add_f32 v56, v56, v59
v_add_f32 v56, v56, v60
v_add_f32 v56, v56, v61
v_add_f32 v56, v56, v62
v_add_f32 v56, v56, v63
v_cvt_pk_bf16_f32 v56, v56, v56
v_lshlrev_b32 v56, 16, v56
v_add_f32 v48, 1.0, v48
v_cvt_pk_bf16_f32 v48, v48, v48
v_lshlrev_b32 v48, 16, v48
v_lshlrev_b32 v10, 1, v8
v_lshrrev_b32 v11, 16, v48
ds_write_b16 v10, v11 offset:41984
v_lshrrev_b32 v11, 16, v40
ds_write_b16 v10, v11 offset:43280
v_mov_b32 v11, 0x3f80
ds_write_b16 v10, v11 offset:44576
s_cmp_lg_u32 s3, 0
s_cbranch_scc1 L_20
s_mov_b32 s45, 147456
buffer_store_dword v48, v9, s[8:11], s45 offen
s_mov_b32 s45, 150016
buffer_store_dword v40, v9, s[8:11], s45 offen
s_mov_b32 s45, 152576
buffer_store_dword v56, v9, s[8:11], s45 offen
v_and_b32 v10, 0xffffffe3, v8
v_bfe_u32 v11, v8, 2, 2
v_lshlrev_b32 v11, 3, v11
v_add_u32 v10, v10, v11
v_bfe_u32 v11, v8, 4, 1
v_lshlrev_b32 v11, 2, v11
v_add_u32 v10, v10, v11
v_lshlrev_b32 v10, 2, v10
s_mov_b32 s45, 155648
buffer_store_dword v48, v10, s[8:11], s45 offen
s_mov_b32 s45, 158208
buffer_store_dword v40, v10, s[8:11], s45 offen
L_20:
v_add_u32 v8, 512, v0
v_min_u32 v8, 639, v8
v_lshlrev_b32 v9, 2, v8
v_add_f32 v64, v64, v65
v_add_f32 v64, v64, v66
v_add_f32 v64, v64, v67
v_add_f32 v64, v64, v68
v_add_f32 v64, v64, v69
v_add_f32 v64, v64, v70
v_add_f32 v64, v64, v71
v_cvt_pk_bf16_f32 v64, v64, v64
v_lshlrev_b32 v64, 16, v64
v_add_f32 v72, v72, v73
v_add_f32 v72, v72, v74
v_add_f32 v72, v72, v75
v_add_f32 v72, v72, v76
v_add_f32 v72, v72, v77
v_add_f32 v72, v72, v78
v_add_f32 v72, v72, v79
v_cvt_pk_bf16_f32 v72, v72, v72
v_lshlrev_b32 v72, 16, v72
v_add_f32 v80, v80, v81
v_add_f32 v80, v80, v82
v_add_f32 v80, v80, v83
v_add_f32 v80, v80, v84
v_add_f32 v80, v80, v85
v_add_f32 v80, v80, v86
v_add_f32 v80, v80, v87
v_cvt_pk_bf16_f32 v80, v80, v80
v_lshlrev_b32 v80, 16, v80
v_add_f32 v72, 1.0, v72
v_cvt_pk_bf16_f32 v72, v72, v72
v_lshlrev_b32 v72, 16, v72
v_lshlrev_b32 v10, 1, v8
v_lshrrev_b32 v11, 16, v72
ds_write_b16 v10, v11 offset:41984
v_lshrrev_b32 v11, 16, v64
ds_write_b16 v10, v11 offset:43280
v_mov_b32 v11, 0x3f80
ds_write_b16 v10, v11 offset:44576
s_cmp_lg_u32 s3, 0
s_cbranch_scc1 L_21
s_mov_b32 s45, 147456
buffer_store_dword v72, v9, s[8:11], s45 offen
s_mov_b32 s45, 150016
buffer_store_dword v64, v9, s[8:11], s45 offen
s_mov_b32 s45, 152576
buffer_store_dword v80, v9, s[8:11], s45 offen
v_and_b32 v10, 0xffffffe3, v8
v_bfe_u32 v11, v8, 2, 2
v_lshlrev_b32 v11, 3, v11
v_add_u32 v10, v10, v11
v_bfe_u32 v11, v8, 4, 1
v_lshlrev_b32 v11, 2, v11
v_add_u32 v10, v10, v11
v_lshlrev_b32 v10, 2, v10
s_mov_b32 s45, 155648
buffer_store_dword v72, v10, s[8:11], s45 offen
s_mov_b32 s45, 158208
buffer_store_dword v64, v10, s[8:11], s45 offen
L_21:
L_18:
s_waitcnt vmcnt(0) lgkmcnt(0)
s_barrier
v_lshlrev_b32 v6, 2, v5
v_bfe_u32 v7, v0, 2, 2
v_add_u32 v6, v6, v7
v_lshlrev_b32 v6, 6, v6
v_and_b32 v7, 3, v0
v_lshlrev_b32 v7, 3, v7
v_add_u32 v6, v6, v7
s_lshl_b32 s40, s4, 11
v_add_u32 v6, s40, v6
v_min_u32 v7, 2, v4
v_mul_u32_u24 v7, 1296, v7
v_lshlrev_b32 v8, 3, v5
v_add_u32 v7, v7, v8
s_lshl_b32 s40, s4, 6
v_add_u32 v7, s40, v7
v_add_u32 v7, 41984, v7
v_lshlrev_b32 v9, 4, v1
s_lshl_b32 s40, s4, 10
s_add_u32 s41, s35, s40
s_add_u32 s42, s41, s36
s_mov_b32 s44, s4
v_mov_b32 v40, 0
v_mov_b32 v41, 0
v_mov_b32 v42, 0
v_mov_b32 v43, 0
v_mov_b32 v44, 0
v_mov_b32 v45, 0
v_mov_b32 v46, 0
v_mov_b32 v47, 0
v_mov_b32 v48, 0x3f803f80
v_mov_b32 v49, 0x3f803f80
v_mov_b32 v50, 0x3f803f80
v_mov_b32 v51, 0x3f803f80
L_22:
ds_read_b64_tr_b16 v[16:17], v6
ds_read_b64_tr_b16 v[18:19], v6 offset:1024
ds_read_b64_tr_b16 v[20:21], v6 offset:32
ds_read_b64_tr_b16 v[22:23], v6 offset:1056
s_cmp_lg_u32 s37, 0
s_cbranch_scc1 L_23
ds_read_b64 v[48:49], v7
ds_read_b64 v[50:51], v7 offset:32
L_23:
s_waitcnt lgkmcnt(0)
buffer_store_dwordx4 v[16:19], v9, s[8:11], s41 offen sc0 sc1
buffer_store_dwordx4 v[20:23], v9, s[8:11], s42 offen sc0 sc1
v_mfma_f32_16x16x32_bf16 v[40:43], v[16:19], v[48:51], v[40:43]
v_mfma_f32_16x16x32_bf16 v[44:47], v[20:23], v[48:51], v[44:47]
v_add_u32 v6, 8192, v6
v_add_u32 v7, 256, v7
s_add_u32 s41, s41, 4096
s_add_u32 s42, s42, 4096
s_add_u32 s44, s44, 4
s_cmp_lt_u32 s44, s34
s_nop 4
s_cbranch_scc1 L_22
s_cmp_eq_u32 s37, 2
s_cbranch_scc1 L_24
s_nop 7
v_lshlrev_b32 v10, 5, v1
s_lshl_b32 s40, s4, 11
v_add_u32 v10, s40, v10
ds_write_b128 v10, v[40:43] offset:46080
ds_write_b128 v10, v[44:47] offset:46096
s_waitcnt lgkmcnt(0)
s_barrier
v_lshlrev_b32 v10, 5, v1
ds_read_b128 v[52:55], v10 offset:46080
ds_read_b128 v[56:59], v10 offset:46096
ds_read_b128 v[60:63], v10 offset:48128
ds_read_b128 v[64:67], v10 offset:48144
ds_read_b128 v[68:71], v10 offset:50176
ds_read_b128 v[72:75], v10 offset:50192
ds_read_b128 v[76:79], v10 offset:52224
ds_read_b128 v[80:83], v10 offset:52240
s_waitcnt lgkmcnt(0)
v_add_f32 v52, v52, v60
v_add_f32 v68, v68, v76
v_add_f32 v52, v52, v68
v_add_f32 v53, v53, v61
v_add_f32 v69, v69, v77
v_add_f32 v53, v53, v69
v_add_f32 v54, v54, v62
v_add_f32 v70, v70, v78
v_add_f32 v54, v54, v70
v_add_f32 v55, v55, v63
v_add_f32 v71, v71, v79
v_add_f32 v55, v55, v71
v_add_f32 v56, v56, v64
v_add_f32 v72, v72, v80
v_add_f32 v56, v56, v72
v_add_f32 v57, v57, v65
v_add_f32 v73, v73, v81
v_add_f32 v57, v57, v73
v_add_f32 v58, v58, v66
v_add_f32 v74, v74, v82
v_add_f32 v58, v58, v74
v_add_f32 v59, v59, v67
v_add_f32 v75, v75, v83
v_add_f32 v59, v59, v75
v_mul_u32_u24 v10, 2560, v4
v_lshlrev_b32 v11, 4, v5
v_add_u32 v10, v10, v11
s_lshl_b32 s40, s38, 7
s_cmp_eq_u32 s37, 1
s_cbranch_scc1 L_25
s_add_u32 s40, s40, 131072
v_cmp_gt_u32 vcc, 3, v4
s_branch L_26
L_25:
s_add_u32 s40, s40, 138752
v_cmp_gt_u32 vcc, 1, v4
L_26:
s_nop 1
s_and_saveexec_b64 s[46:47], vcc
s_cmp_lg_u32 s4, 0
s_cbranch_scc1 L_24x
buffer_store_dwordx4 v[52:55], v10, s[8:11], s40 offen
buffer_store_dwordx4 v[56:59], v10, s[8:11], s40 offen offset:64
L_24x:
s_mov_b64 exec, s[46:47]
L_24:
s_sub_u32 s40, s3, 20
s_cmp_ge_u32 s40, 58
s_cbranch_scc1 L_12
s_add_u32 s3, s3, 76
s_waitcnt lgkmcnt(0)
s_barrier
s_branch L_11
L_12:
s_endpgm
L_9:
s_endpgm
.p2align 8
.type mlp_kernel,@function
mlp_kernel:
s_cmp_ge_u32 s2, 256
s_cbranch_scc1 L_27
s_load_dwordx2 s[8:9], s[0:1], 144
s_mov_b32 s10, 268435456
s_mov_b32 s11, 0x20000
s_load_dwordx2 s[12:13], s[0:1], 128
s_mov_b32 s14, 2621440
s_mov_b32 s15, 0x20000
s_and_b32 s24, s2, 7
s_lshl_b32 s24, s24, 2
s_bfe_u32 s25, s2, 0x20003
s_add_u32 s16, s24, s25
s_lshr_b32 s17, s2, 5
s_lshl_b32 s19, s16, 6
v_lshrrev_b32 v46, 6, v0
v_and_b32 v1, 63, v0
v_readfirstlane_b32 s18, v46
v_and_b32 v4, 15, v0
v_bfe_u32 v5, v0, 4, 2
v_lshlrev_b32 v1, 4, v1
v_mov_b32 v2, v1
v_add_u32 v3, 0x10000, v1
s_lshl_b32 s21, s18, 10
s_lshr_b32 s24, s17, 2
s_add_u32 s24, s24, 1
s_sub_u32 s25, 0, s24
s_bitcmp1_b32 s17, 1
s_cselect_b32 s27, s24, s25
s_getreg_b32 s43, hwreg(HW_REG_XCC_ID, 0, 4)
s_add_u32 s43, s43, 1
s_mov_b32 s40, 0xbdd2d3e8
v_mov_b32 v63, 0xc0135761
s_waitcnt lgkmcnt(0)
s_cmp_ge_u32 s18, 5
s_cbranch_scc1 L_28
s_setprio 2
s_mul_i32 s31, s17, 5
s_add_u32 s31, s31, s18
s_lshl_b32 s24, s17, 3
s_add_u32 s24, s24, s18
s_add_u32 s44, s24, s19
s_lshr_b32 s24, s44, 4
s_mul_i32 s24, s24, 20480
s_and_b32 s25, s44, 15
s_lshl_b32 s25, s25, 4
s_add_u32 s24, s24, s25
s_add_u32 s24, s24, 11534336
v_lshrrev_b32 v50, 4, v1
v_min_u32 v50, 39, v50
v_lshrrev_b32 v51, 1, v50
v_lshlrev_b32 v51, 10, v51
v_and_b32 v52, 1, v50
v_lshlrev_b32 v52, 9, v52
v_add_u32 v51, v51, v52
v_lshlrev_b32 v52, 6, v50
buffer_load_dwordx4 v[240:243], v51, s[8:11], s24 offen
buffer_load_dwordx4 v[244:247], v51, s[8:11], s24 offen offset:256
s_mov_b32 s25, 155648
s_mov_b32 s26, 158208
buffer_load_dwordx4 v[112:115], v52, s[8:11], s25 offen offset:0
buffer_load_dwordx4 v[224:227], v52, s[8:11], s26 offen offset:0
buffer_load_dwordx4 v[116:119], v52, s[8:11], s25 offen offset:16
buffer_load_dwordx4 v[228:231], v52, s[8:11], s26 offen offset:16
buffer_load_dwordx4 v[120:123], v52, s[8:11], s25 offen offset:32
buffer_load_dwordx4 v[232:235], v52, s[8:11], s26 offen offset:32
buffer_load_dwordx4 v[124:127], v52, s[8:11], s25 offen offset:48
buffer_load_dwordx4 v[236:239], v52, s[8:11], s26 offen offset:48
s_mul_i32 s37, s17, 14
s_sub_u32 s24, s17, 4
s_max_i32 s24, s24, 0
s_sub_u32 s37, s37, s24
s_add_u32 s38, s37, s18
s_add_u32 s39, s38, 8
s_mul_i32 s41, s38, 20480
s_add_u32 s41, s41, 32505856
s_mul_i32 s42, s39, 20480
s_add_u32 s42, s42, 32505856
s_mul_i32 s49, s31, 20480
s_add_u32 s49, s49, 31457280
s_mul_i32 s50, s31, 55296
s_add_u32 s50, s50, 35651584
s_lshr_b32 s24, s31, 1
s_lshl_b32 s24, s24, 10
s_and_b32 s25, s31, 1
s_lshl_b32 s25, s25, 3
s_add_u32 s24, s24, s25
s_mul_i32 s25, s16, 81920
s_add_u32 s24, s24, s25
s_add_u32 s33, s24, 0
s_mul_i32 s52, s17, 5
s_mul_i32 s32, s31, 20480
s_add_u32 s32, s32, 30408704
s_lshl_b32 s24, s31, 6
v_lshlrev_b32 v59, 4, v5
v_add_u32 v59, s24, v59
s_mov_b32 s25, 131072
buffer_load_dwordx4 v[30:33], v59, s[8:11], s25 offen
s_mov_b32 s25, 133632
buffer_load_dwordx4 v[34:37], v59, s[8:11], s25 offen
s_mov_b32 s25, 136192
buffer_load_dwordx4 v[38:41], v59, s[8:11], s25 offen
s_and_b32 s24, s18, 3
s_lshl_b32 s24, s24, 4
s_add_u32 s24, s24, s19
v_add_u32 v46, s24, v4
v_add_u32 v46, s27, v46
v_min_i32 v46, 2047, v46
v_max_i32 v46, 0, v46
v_lshrrev_b32 v47, 4, v46
v_mul_u32_u24 v47, 20480, v47
v_and_b32 v46, 15, v46
v_lshlrev_b32 v46, 4, v46
v_add_u32 v47, v47, v46
v_lshlrev_b32 v46, 8, v5
v_add_u32 v42, v47, v46
s_lshr_b32 s24, s18, 2
s_lshl_b32 s24, s24, 10
s_add_u32 s28, s24, 14680064
s_add_u32 m0, s21, 0
s_add_u32 s22, s28, 0
buffer_load_dwordx4 v42, s[8:11], s22 offen  lds
s_add_u32 m0, s21, 8192
s_add_u32 s22, s28, 2048
buffer_load_dwordx4 v42, s[8:11], s22 offen  lds
s_add_u32 m0, s21, 16384
s_add_u32 s22, s28, 4096
buffer_load_dwordx4 v42, s[8:11], s22 offen  lds
s_add_u32 m0, s21, 24576
s_add_u32 s22, s28, 6144
buffer_load_dwordx4 v42, s[8:11], s22 offen  lds
s_add_u32 m0, s21, 32768
s_add_u32 s22, s28, 8192
buffer_load_dwordx4 v42, s[8:11], s22 offen  lds
s_add_u32 m0, s21, 40960
s_add_u32 s22, s28, 10240
buffer_load_dwordx4 v42, s[8:11], s22 offen  lds
s_add_u32 m0, s21, 49152
s_add_u32 s22, s28, 12288
buffer_load_dwordx4 v42, s[8:11], s22 offen  lds
s_add_u32 m0, s21, 57344
s_add_u32 s22, s28, 14336
buffer_load_dwordx4 v42, s[8:11], s22 offen  lds
s_add_u32 m0, s21, 65536
s_add_u32 s22, s28, 16384
buffer_load_dwordx4 v42, s[8:11], s22 offen  lds
s_add_u32 m0, s21, 73728
s_add_u32 s22, s28, 18432
buffer_load_dwordx4 v42, s[8:11], s22 offen  lds
s_add_u32 s23, s32, 0
buffer_load_dwordx4 v[128:131], v1, s[8:11], s23 offen
s_add_u32 s23, s32, 1024
buffer_load_dwordx4 v[132:135], v1, s[8:11], s23 offen
s_add_u32 s23, s32, 2048
buffer_load_dwordx4 v[136:139], v1, s[8:11], s23 offen
s_add_u32 s23, s32, 3072
buffer_load_dwordx4 v[140:143], v1, s[8:11], s23 offen
s_add_u32 s23, s32, 4096
buffer_load_dwordx4 v[144:147], v1, s[8:11], s23 offen
s_add_u32 s23, s32, 5120
buffer_load_dwordx4 v[148:151], v1, s[8:11], s23 offen
s_add_u32 s23, s32, 6144
buffer_load_dwordx4 v[152:155], v1, s[8:11], s23 offen
s_add_u32 s23, s32, 7168
buffer_load_dwordx4 v[156:159], v1, s[8:11], s23 offen
s_add_u32 s23, s32, 8192
buffer_load_dwordx4 v[160:163], v1, s[8:11], s23 offen
s_add_u32 s23, s32, 9216
buffer_load_dwordx4 v[164:167], v1, s[8:11], s23 offen
s_add_u32 s23, s32, 10240
buffer_load_dwordx4 v[168:171], v1, s[8:11], s23 offen
s_add_u32 s23, s32, 11264
buffer_load_dwordx4 v[172:175], v1, s[8:11], s23 offen
s_add_u32 s23, s32, 12288
buffer_load_dwordx4 v[176:179], v1, s[8:11], s23 offen
s_add_u32 s23, s32, 13312
buffer_load_dwordx4 v[180:183], v1, s[8:11], s23 offen
s_add_u32 s23, s32, 14336
buffer_load_dwordx4 v[184:187], v1, s[8:11], s23 offen
s_add_u32 s23, s32, 15360
buffer_load_dwordx4 v[188:191], v1, s[8:11], s23 offen
s_add_u32 s23, s32, 16384
buffer_load_dwordx4 v[192:195], v1, s[8:11], s23 offen
s_add_u32 s23, s32, 17408
buffer_load_dwordx4 v[196:199], v1, s[8:11], s23 offen
s_add_u32 s23, s32, 18432
buffer_load_dwordx4 v[200:203], v1, s[8:11], s23 offen
s_add_u32 s23, s32, 19456
buffer_load_dwordx4 v[204:207], v1, s[8:11], s23 offen
s_add_u32 s34, s33, 11534336
buffer_load_dwordx2 v[6:7], v1, s[8:11], s34 offen
s_add_u32 s34, s34, 20480
buffer_load_dwordx2 v[8:9], v1, s[8:11], s34 offen
s_add_u32 s34, s34, 20480
buffer_load_dwordx2 v[10:11], v1, s[8:11], s34 offen
s_add_u32 s34, s34, 20480
buffer_load_dwordx2 v[12:13], v1, s[8:11], s34 offen
s_add_u32 s34, s34, 20480
s_waitcnt vmcnt(37)
v_cmp_gt_u32 vcc, 640, v1
v_lshlrev_b32 v96, 16, v240
v_and_b32 v97, 0xffff0000, v240
v_lshlrev_b32 v98, 16, v241
v_and_b32 v99, 0xffff0000, v241
v_lshlrev_b32 v100, 16, v242
v_and_b32 v101, 0xffff0000, v242
v_lshlrev_b32 v102, 16, v243
v_and_b32 v103, 0xffff0000, v243
v_lshlrev_b32 v104, 16, v244
v_and_b32 v105, 0xffff0000, v244
v_lshlrev_b32 v106, 16, v245
v_and_b32 v107, 0xffff0000, v245
v_lshlrev_b32 v108, 16, v246
v_and_b32 v109, 0xffff0000, v246
v_lshlrev_b32 v110, 16, v247
v_and_b32 v111, 0xffff0000, v247
v_add_f32 v53, v96, v98
v_add_f32 v54, v97, v99
v_add_f32 v53, v53, v100
v_add_f32 v54, v54, v101
v_add_f32 v53, v53, v102
v_add_f32 v54, v54, v103
v_add_f32 v53, v53, v104
v_add_f32 v54, v54, v105
v_add_f32 v53, v53, v106
v_add_f32 v54, v54, v107
v_add_f32 v53, v53, v108
v_add_f32 v54, v54, v109
v_add_f32 v53, v53, v110
v_add_f32 v54, v54, v111
v_add_f32 v53, v53, v54
v_cndmask_b32 v53, 0, v53, vcc
s_nop 1
v_add_f32_dpp v53, v53, v53 row_ror:8 row_mask:0xf bank_mask:0xf
s_nop 1
v_add_f32_dpp v53, v53, v53 row_ror:4 row_mask:0xf bank_mask:0xf
s_nop 1
v_add_f32_dpp v53, v53, v53 row_ror:2 row_mask:0xf bank_mask:0xf
s_nop 1
v_add_f32_dpp v53, v53, v53 row_ror:1 row_mask:0xf bank_mask:0xf
s_nop 1
v_add_f32_dpp v53, v53, v53 row_bcast:15 row_mask:0xa bank_mask:0xf
s_nop 1
v_add_f32_dpp v53, v53, v53 row_bcast:31 row_mask:0xc bank_mask:0xf
v_mul_f32 v53, 0x3acccccd, v53
s_nop 0
v_readlane_b32 s45, v53, 63
s_nop 1
v_subrev_f32 v96, s45, v96
v_subrev_f32 v97, s45, v97
v_subrev_f32 v98, s45, v98
v_subrev_f32 v99, s45, v99
v_subrev_f32 v100, s45, v100
v_subrev_f32 v101, s45, v101
v_subrev_f32 v102, s45, v102
v_subrev_f32 v103, s45, v103
v_subrev_f32 v104, s45, v104
v_subrev_f32 v105, s45, v105
v_subrev_f32 v106, s45, v106
v_subrev_f32 v107, s45, v107
v_subrev_f32 v108, s45, v108
v_subrev_f32 v109, s45, v109
v_subrev_f32 v110, s45, v110
v_subrev_f32 v111, s45, v111
v_mul_f32 v53, v96, v96
v_mul_f32 v54, v97, v97
v_fmac_f32 v53, v98, v98
v_fmac_f32 v54, v99, v99
v_fmac_f32 v53, v100, v100
v_fmac_f32 v54, v101, v101
v_fmac_f32 v53, v102, v102
v_fmac_f32 v54, v103, v103
v_fmac_f32 v53, v104, v104
v_fmac_f32 v54, v105, v105
v_fmac_f32 v53, v106, v106
v_fmac_f32 v54, v107, v107
v_fmac_f32 v53, v108, v108
v_fmac_f32 v54, v109, v109
v_fmac_f32 v53, v110, v110
v_fmac_f32 v54, v111, v111
v_add_f32 v53, v53, v54
v_cndmask_b32 v53, 0, v53, vcc
s_nop 1
v_add_f32_dpp v53, v53, v53 row_ror:8 row_mask:0xf bank_mask:0xf
s_nop 1
v_add_f32_dpp v53, v53, v53 row_ror:4 row_mask:0xf bank_mask:0xf
s_nop 1
v_add_f32_dpp v53, v53, v53 row_ror:2 row_mask:0xf bank_mask:0xf
s_nop 1
v_add_f32_dpp v53, v53, v53 row_ror:1 row_mask:0xf bank_mask:0xf
s_nop 1
v_add_f32_dpp v53, v53, v53 row_bcast:15 row_mask:0xa bank_mask:0xf
s_nop 1
v_add_f32_dpp v53, v53, v53 row_bcast:31 row_mask:0xc bank_mask:0xf
v_mov_b32 v54, 0x3727c5ac
v_fmac_f32 v54, 0x3acccccd, v53
v_rsq_f32 v54, v54
s_nop 0
v_readlane_b32 s46, v54, 63
s_nop 1
v_mul_f32 v112, s46, v112
v_mul_f32 v113, s46, v113
v_mul_f32 v114, s46, v114
v_mul_f32 v115, s46, v115
v_mul_f32 v116, s46, v116
v_mul_f32 v117, s46, v117
v_mul_f32 v118, s46, v118
v_mul_f32 v119, s46, v119
v_mul_f32 v120, s46, v120
v_mul_f32 v121, s46, v121
v_mul_f32 v122, s46, v122
v_mul_f32 v123, s46, v123
v_mul_f32 v124, s46, v124
v_mul_f32 v125, s46, v125
v_mul_f32 v126, s46, v126
v_mul_f32 v127, s46, v127
v_fma_f32 v96, v96, v112, v224
v_fma_f32 v97, v97, v113, v225
v_fma_f32 v98, v98, v114, v226
v_fma_f32 v99, v99, v115, v227
v_fma_f32 v100, v100, v116, v228
v_fma_f32 v101, v101, v117, v229
v_fma_f32 v102, v102, v118, v230
v_fma_f32 v103, v103, v119, v231
v_fma_f32 v104, v104, v120, v232
v_fma_f32 v105, v105, v121, v233
v_fma_f32 v106, v106, v122, v234
v_fma_f32 v107, v107, v123, v235
v_fma_f32 v108, v108, v124, v236
v_fma_f32 v109, v109, v125, v237
v_fma_f32 v110, v110, v126, v238
v_fma_f32 v111, v111, v127, v239
v_add_f32 v53, v96, v98
v_add_f32 v54, v97, v99
v_add_f32 v53, v53, v100
v_add_f32 v54, v54, v101
v_add_f32 v53, v53, v102
v_add_f32 v54, v54, v103
v_add_f32 v53, v53, v104
v_add_f32 v54, v54, v105
v_add_f32 v53, v53, v106
v_add_f32 v54, v54, v107
v_add_f32 v53, v53, v108
v_add_f32 v54, v54, v109
v_add_f32 v53, v53, v110
v_add_f32 v54, v54, v111
v_add_f32 v53, v53, v54
v_cndmask_b32 v53, 0, v53, vcc
s_nop 1
v_add_f32_dpp v53, v53, v53 row_ror:8 row_mask:0xf bank_mask:0xf
s_nop 1
v_add_f32_dpp v53, v53, v53 row_ror:4 row_mask:0xf bank_mask:0xf
s_nop 1
v_add_f32_dpp v53, v53, v53 row_ror:2 row_mask:0xf bank_mask:0xf
s_nop 1
v_add_f32_dpp v53, v53, v53 row_ror:1 row_mask:0xf bank_mask:0xf
s_nop 1
v_add_f32_dpp v53, v53, v53 row_bcast:15 row_mask:0xa bank_mask:0xf
s_nop 1
v_add_f32_dpp v53, v53, v53 row_bcast:31 row_mask:0xc bank_mask:0xf
v_mul_f32 v53, 0x3acccccd, v53
s_nop 0
v_readlane_b32 s47, v53, 63
s_nop 1
v_subrev_f32 v96, s47, v96
v_subrev_f32 v97, s47, v97
v_subrev_f32 v98, s47, v98
v_subrev_f32 v99, s47, v99
v_subrev_f32 v100, s47, v100
v_subrev_f32 v101, s47, v101
v_subrev_f32 v102, s47, v102
v_subrev_f32 v103, s47, v103
v_subrev_f32 v104, s47, v104
v_subrev_f32 v105, s47, v105
v_subrev_f32 v106, s47, v106
v_subrev_f32 v107, s47, v107
v_subrev_f32 v108, s47, v108
v_subrev_f32 v109, s47, v109
v_subrev_f32 v110, s47, v110
v_subrev_f32 v111, s47, v111
v_mul_f32 v53, v96, v96
v_mul_f32 v54, v97, v97
v_fmac_f32 v53, v98, v98
v_fmac_f32 v54, v99, v99
v_fmac_f32 v53, v100, v100
v_fmac_f32 v54, v101, v101
v_fmac_f32 v53, v102, v102
v_fmac_f32 v54, v103, v103
v_fmac_f32 v53, v104, v104
v_fmac_f32 v54, v105, v105
v_fmac_f32 v53, v106, v106
v_fmac_f32 v54, v107, v107
v_fmac_f32 v53, v108, v108
v_fmac_f32 v54, v109, v109
v_fmac_f32 v53, v110, v110
v_fmac_f32 v54, v111, v111
v_add_f32 v53, v53, v54
v_cndmask_b32 v53, 0, v53, vcc
s_nop 1
v_add_f32_dpp v53, v53, v53 row_ror:8 row_mask:0xf bank_mask:0xf
s_nop 1
v_add_f32_dpp v53, v53, v53 row_ror:4 row_mask:0xf bank_mask:0xf
s_nop 1
v_add_f32_dpp v53, v53, v53 row_ror:2 row_mask:0xf bank_mask:0xf
s_nop 1
v_add_f32_dpp v53, v53, v53 row_ror:1 row_mask:0xf bank_mask:0xf
s_nop 1
v_add_f32_dpp v53, v53, v53 row_bcast:15 row_mask:0xa bank_mask:0xf
s_nop 1
v_add_f32_dpp v53, v53, v53 row_bcast:31 row_mask:0xc bank_mask:0xf
v_mov_b32 v54, 0x3727c5ac
v_fmac_f32 v54, 0x3acccccd, v53
v_rsq_f32 v54, v54
s_nop 0
v_readlane_b32 s48, v54, 63
v_mov_b32 v228, s46
s_nop 0
v_mov_b32 v226, s48
v_mul_f32 v224, s48, v228
v_mul_f32 v225, s45, v224
v_sub_f32 v225, 0, v225
v_mul_f32 v227, s47, v226
v_sub_f32 v227, 0, v227
v_mul_f32 v229, s45, v228
v_mov_b32 v230, s43
v_mov_b32 v231, 0
s_lshl_b32 s24, s44, 5
s_add_u32 s24, s24, 196608
v_mov_b32 v53, 0
s_mov_b64 exec, 1
buffer_store_dwordx4 v[224:227], v53, s[8:11], s24 offen sc0 sc1
buffer_store_dwordx4 v[228:231], v53, s[8:11], s24 offen offset:16 sc0 sc1
s_mov_b64 exec, -1
v_mov_b32 v64, 0
v_mov_b32 v65, 0
v_mov_b32 v66, 0
v_mov_b32 v67, 0
v_mov_b32 v68, 0
v_mov_b32 v69, 0
v_mov_b32 v70, 0
v_mov_b32 v71, 0
v_mov_b32 v72, 0
v_mov_b32 v73, 0
v_mov_b32 v74, 0
v_mov_b32 v75, 0
v_mov_b32 v76, 0
v_mov_b32 v77, 0
v_mov_b32 v78, 0
v_mov_b32 v79, 0
s_waitcnt vmcnt(24)
s_barrier
ds_read_b128 v[96:99], v2 offset:0
ds_read_b128 v[100:103], v2 offset:1024
ds_read_b128 v[104:107], v2 offset:2048
ds_read_b128 v[108:111], v2 offset:3072
ds_read_b128 v[112:115], v2 offset:4096
ds_read_b128 v[116:119], v2 offset:5120
ds_read_b128 v[120:123], v2 offset:6144
ds_read_b128 v[124:127], v2 offset:7168
s_waitcnt vmcnt(23)
s_waitcnt lgkmcnt(4)
v_mfma_f32_16x16x32_bf16 v[64:67], v[128:131], v[96:99], v[64:67]
v_mfma_f32_16x16x32_bf16 v[68:71], v[128:131], v[100:103], v[68:71]
v_mfma_f32_16x16x32_bf16 v[72:75], v[128:131], v[104:107], v[72:75]
v_mfma_f32_16x16x32_bf16 v[76:79], v[128:131], v[108:111], v[76:79]
s_add_u32 s23, s49, 0
buffer_load_dwordx4 v[128:131], v1, s[8:11], s23 offen
ds_read_b128 v[96:99], v2 offset:8192
ds_read_b128 v[100:103], v2 offset:9216
ds_read_b128 v[104:107], v2 offset:10240
ds_read_b128 v[108:111], v2 offset:11264
s_waitcnt vmcnt(23)
s_waitcnt lgkmcnt(4)
v_mfma_f32_16x16x32_bf16 v[64:67], v[132:135], v[112:115], v[64:67]
v_mfma_f32_16x16x32_bf16 v[68:71], v[132:135], v[116:119], v[68:71]
v_mfma_f32_16x16x32_bf16 v[72:75], v[132:135], v[120:123], v[72:75]
v_mfma_f32_16x16x32_bf16 v[76:79], v[132:135], v[124:127], v[76:79]
s_add_u32 s23, s49, 1024
buffer_load_dwordx4 v[132:135], v1, s[8:11], s23 offen
ds_read_b128 v[112:115], v2 offset:12288
ds_read_b128 v[116:119], v2 offset:13312
ds_read_b128 v[120:123], v2 offset:14336
ds_read_b128 v[124:127], v2 offset:15360
s_waitcnt vmcnt(23)
s_waitcnt lgkmcnt(4)
v_mfma_f32_16x16x32_bf16 v[64:67], v[136:139], v[96:99], v[64:67]
v_mfma_f32_16x16x32_bf16 v[68:71], v[136:139], v[100:103], v[68:71]
v_mfma_f32_16x16x32_bf16 v[72:75], v[136:139], v[104:107], v[72:75]
v_mfma_f32_16x16x32_bf16 v[76:79], v[136:139], v[108:111], v[76:79]
s_add_u32 s23, s49, 2048
buffer_load_dwordx4 v[136:139], v1, s[8:11], s23 offen
ds_read_b128 v[96:99], v2 offset:16384
ds_read_b128 v[100:103], v2 offset:17408
ds_read_b128 v[104:107], v2 offset:18432
ds_read_b128 v[108:111], v2 offset:19456
s_waitcnt vmcnt(23)
s_waitcnt lgkmcnt(4)
v_mfma_f32_16x16x32_bf16 v[64:67], v[140:143], v[112:115], v[64:67]
v_mfma_f32_16x16x32_bf16 v[68:71], v[140:143], v[116:119], v[68:71]
v_mfma_f32_16x16x32_bf16 v[72:75], v[140:143], v[120:123], v[72:75]
v_mfma_f32_16x16x32_bf16 v[76:79], v[140:143], v[124:127], v[76:79]
s_add_u32 s23, s49, 3072
buffer_load_dwordx4 v[140:143], v1, s[8:11], s23 offen
ds_read_b128 v[112:115], v2 offset:20480
ds_read_b128 v[116:119], v2 offset:21504
ds_read_b128 v[120:123], v2 offset:22528
ds_read_b128 v[124:127], v2 offset:23552
s_waitcnt vmcnt(23)
s_waitcnt lgkmcnt(4)
v_mfma_f32_16x16x32_bf16 v[64:67], v[144:147], v[96:99], v[64:67]
v_mfma_f32_16x16x32_bf16 v[68:71], v[144:147], v[100:103], v[68:71]
v_mfma_f32_16x16x32_bf16 v[72:75], v[144:147], v[104:107], v[72:75]
v_mfma_f32_16x16x32_bf16 v[76:79], v[144:147], v[108:111], v[76:79]
s_add_u32 s23, s49, 4096
buffer_load_dwordx4 v[144:147], v1, s[8:11], s23 offen
ds_read_b128 v[96:99], v2 offset:24576
ds_read_b128 v[100:103], v2 offset:25600
ds_read_b128 v[104:107], v2 offset:26624
ds_read_b128 v[108:111], v2 offset:27648
s_waitcnt vmcnt(23)
s_waitcnt lgkmcnt(4)
v_mfma_f32_16x16x32_bf16 v[64:67], v[148:151], v[112:115], v[64:67]
v_mfma_f32_16x16x32_bf16 v[68:71], v[148:151], v[116:119], v[68:71]
v_mfma_f32_16x16x32_bf16 v[72:75], v[148:151], v[120:123], v[72:75]
v_mfma_f32_16x16x32_bf16 v[76:79], v[148:151], v[124:127], v[76:79]
s_add_u32 s23, s49, 5120
buffer_load_dwordx4 v[148:151], v1, s[8:11], s23 offen
ds_read_b128 v[112:115], v2 offset:28672
ds_read_b128 v[116:119], v2 offset:29696
ds_read_b128 v[120:123], v2 offset:30720
ds_read_b128 v[124:127], v2 offset:31744
s_waitcnt vmcnt(23)
s_waitcnt lgkmcnt(4)
v_mfma_f32_16x16x32_bf16 v[64:67], v[152:155], v[96:99], v[64:67]
v_mfma_f32_16x16x32_bf16 v[68:71], v[152:155], v[100:103], v[68:71]
v_mfma_f32_16x16x32_bf16 v[72:75], v[152:155], v[104:107], v[72:75]
v_mfma_f32_16x16x32_bf16 v[76:79], v[152:155], v[108:111], v[76:79]
s_add_u32 s23, s49, 6144
buffer_load_dwordx4 v[152:155], v1, s[8:11], s23 offen
ds_read_b128 v[96:99], v2 offset:32768
ds_read_b128 v[100:103], v2 offset:33792
ds_read_b128 v[104:107], v2 offset:34816
ds_read_b128 v[108:111], v2 offset:35840
s_waitcnt vmcnt(23)
s_waitcnt lgkmcnt(4)
v_mfma_f32_16x16x32_bf16 v[64:67], v[156:159], v[112:115], v[64:67]
v_mfma_f32_16x16x32_bf16 v[68:71], v[156:159], v[116:119], v[68:71]
v_mfma_f32_16x16x32_bf16 v[72:75], v[156:159], v[120:123], v[72:75]
v_mfma_f32_16x16x32_bf16 v[76:79], v[156:159], v[124:127], v[76:79]
s_add_u32 s23, s49, 7168
buffer_load_dwordx4 v[156:159], v1, s[8:11], s23 offen
ds_read_b128 v[112:115], v2 offset:36864
ds_read_b128 v[116:119], v2 offset:37888
ds_read_b128 v[120:123], v2 offset:38912
ds_read_b128 v[124:127], v2 offset:39936
s_waitcnt vmcnt(23)
s_waitcnt lgkmcnt(4)
v_mfma_f32_16x16x32_bf16 v[64:67], v[160:163], v[96:99], v[64:67]
v_mfma_f32_16x16x32_bf16 v[68:71], v[160:163], v[100:103], v[68:71]
v_mfma_f32_16x16x32_bf16 v[72:75], v[160:163], v[104:107], v[72:75]
v_mfma_f32_16x16x32_bf16 v[76:79], v[160:163], v[108:111], v[76:79]
s_add_u32 s23, s49, 8192
buffer_load_dwordx4 v[160:163], v1, s[8:11], s23 offen
ds_read_b128 v[96:99], v2 offset:40960
ds_read_b128 v[100:103], v2 offset:41984
ds_read_b128 v[104:107], v2 offset:43008
ds_read_b128 v[108:111], v2 offset:44032
s_waitcnt vmcnt(23)
s_waitcnt lgkmcnt(4)
v_mfma_f32_16x16x32_bf16 v[64:67], v[164:167], v[112:115], v[64:67]
v_mfma_f32_16x16x32_bf16 v[68:71], v[164:167], v[116:119], v[68:71]
v_mfma_f32_16x16x32_bf16 v[72:75], v[164:167], v[120:123], v[72:75]
v_mfma_f32_16x16x32_bf16 v[76:79], v[164:167], v[124:127], v[76:79]
s_add_u32 s23, s49, 9216
buffer_load_dwordx4 v[164:167], v1, s[8:11], s23 offen
ds_read_b128 v[112:115], v2 offset:45056
ds_read_b128 v[116:119], v2 offset:46080
ds_read_b128 v[120:123], v2 offset:47104
ds_read_b128 v[124:127], v2 offset:48128
s_waitcnt vmcnt(23)
s_waitcnt lgkmcnt(4)
v_mfma_f32_16x16x32_bf16 v[64:67], v[168:171], v[96:99], v[64:67]
v_mfma_f32_16x16x32_bf16 v[68:71], v[168:171], v[100:103], v[68:71]
v_mfma_f32_16x16x32_bf16 v[72:75], v[168:171], v[104:107], v[72:75]
v_mfma_f32_16x16x32_bf16 v[76:79], v[168:171], v[108:111], v[76:79]
s_add_u32 s23, s49, 10240
buffer_load_dwordx4 v[168:171], v1, s[8:11], s23 offen
ds_read_b128 v[96:99], v2 offset:49152
ds_read_b128 v[100:103], v2 offset:50176
ds_read_b128 v[104:107], v2 offset:51200
ds_read_b128 v[108:111], v2 offset:52224
s_waitcnt vmcnt(23)
s_waitcnt lgkmcnt(4)
v_mfma_f32_16x16x32_bf16 v[64:67], v[172:175], v[112:115], v[64:67]
v_mfma_f32_16x16x32_bf16 v[68:71], v[172:175], v[116:119], v[68:71]
v_mfma_f32_16x16x32_bf16 v[72:75], v[172:175], v[120:123], v[72:75]
v_mfma_f32_16x16x32_bf16 v[76:79], v[172:175], v[124:127], v[76:79]
s_add_u32 s23, s49, 11264
buffer_load_dwordx4 v[172:175], v1, s[8:11], s23 offen
ds_read_b128 v[112:115], v2 offset:53248
ds_read_b128 v[116:119], v2 offset:54272
ds_read_b128 v[120:123], v2 offset:55296
ds_read_b128 v[124:127], v2 offset:56320
s_waitcnt vmcnt(23)
s_waitcnt lgkmcnt(4)
v_mfma_f32_16x16x32_bf16 v[64:67], v[176:179], v[96:99], v[64:67]
v_mfma_f32_16x16x32_bf16 v[68:71], v[176:179], v[100:103], v[68:71]
v_mfma_f32_16x16x32_bf16 v[72:75], v[176:179], v[104:107], v[72:75]
v_mfma_f32_16x16x32_bf16 v[76:79], v[176:179], v[108:111], v[76:79]
s_add_u32 s23, s49, 12288
buffer_load_dwordx4 v[176:179], v1, s[8:11], s23 offen
ds_read_b128 v[96:99], v2 offset:57344
ds_read_b128 v[100:103], v2 offset:58368
ds_read_b128 v[104:107], v2 offset:59392
ds_read_b128 v[108:111], v2 offset:60416
s_waitcnt vmcnt(23)
s_waitcnt lgkmcnt(4)
v_mfma_f32_16x16x32_bf16 v[64:67], v[180:183], v[112:115], v[64:67]
v_mfma_f32_16x16x32_bf16 v[68:71], v[180:183], v[116:119], v[68:71]
v_mfma_f32_16x16x32_bf16 v[72:75], v[180:183], v[120:123], v[72:75]
v_mfma_f32_16x16x32_bf16 v[76:79], v[180:183], v[124:127], v[76:79]
s_add_u32 s23, s49, 13312
buffer_load_dwordx4 v[180:183], v1, s[8:11], s23 offen
ds_read_b128 v[112:115], v2 offset:61440
ds_read_b128 v[116:119], v2 offset:62464
ds_read_b128 v[120:123], v2 offset:63488
ds_read_b128 v[124:127], v2 offset:64512
s_waitcnt vmcnt(23)
s_waitcnt lgkmcnt(4)
v_mfma_f32_16x16x32_bf16 v[64:67], v[184:187], v[96:99], v[64:67]
v_mfma_f32_16x16x32_bf16 v[68:71], v[184:187], v[100:103], v[68:71]
v_mfma_f32_16x16x32_bf16 v[72:75], v[184:187], v[104:107], v[72:75]
v_mfma_f32_16x16x32_bf16 v[76:79], v[184:187], v[108:111], v[76:79]
s_add_u32 s23, s49, 14336
buffer_load_dwordx4 v[184:187], v1, s[8:11], s23 offen
ds_read_b128 v[96:99], v3 offset:0
ds_read_b128 v[100:103], v3 offset:1024
ds_read_b128 v[104:107], v3 offset:2048
ds_read_b128 v[108:111], v3 offset:3072
s_waitcnt vmcnt(23)
s_waitcnt lgkmcnt(4)
v_mfma_f32_16x16x32_bf16 v[64:67], v[188:191], v[112:115], v[64:67]
v_mfma_f32_16x16x32_bf16 v[68:71], v[188:191], v[116:119], v[68:71]
v_mfma_f32_16x16x32_bf16 v[72:75], v[188:191], v[120:123], v[72:75]
v_mfma_f32_16x16x32_bf16 v[76:79], v[188:191], v[124:127], v[76:79]
s_add_u32 s23, s49, 15360
buffer_load_dwordx4 v[188:191], v1, s[8:11], s23 offen
ds_read_b128 v[112:115], v3 offset:4096
ds_read_b128 v[116:119], v3 offset:5120
ds_read_b128 v[120:123], v3 offset:6144
ds_read_b128 v[124:127], v3 offset:7168
s_waitcnt vmcnt(23)
s_waitcnt lgkmcnt(4)
v_mfma_f32_16x16x32_bf16 v[64:67], v[192:195], v[96:99], v[64:67]
v_mfma_f32_16x16x32_bf16 v[68:71], v[192:195], v[100:103], v[68:71]
v_mfma_f32_16x16x32_bf16 v[72:75], v[192:195], v[104:107], v[72:75]
v_mfma_f32_16x16x32_bf16 v[76:79], v[192:195], v[108:111], v[76:79]
s_add_u32 s23, s49, 16384
buffer_load_dwordx4 v[192:195], v1, s[8:11], s23 offen
ds_read_b128 v[96:99], v3 offset:8192
ds_read_b128 v[100:103], v3 offset:9216
ds_read_b128 v[104:107], v3 offset:10240
ds_read_b128 v[108:111], v3 offset:11264
s_waitcnt vmcnt(23)
s_waitcnt lgkmcnt(4)
v_mfma_f32_16x16x32_bf16 v[64:67], v[196:199], v[112:115], v[64:67]
v_mfma_f32_16x16x32_bf16 v[68:71], v[196:199], v[116:119], v[68:71]
v_mfma_f32_16x16x32_bf16 v[72:75], v[196:199], v[120:123], v[72:75]
v_mfma_f32_16x16x32_bf16 v[76:79], v[196:199], v[124:127], v[76:79]
s_add_u32 s23, s49, 17408
buffer_load_dwordx4 v[196:199], v1, s[8:11], s23 offen
ds_read_b128 v[112:115], v3 offset:12288
ds_read_b128 v[116:119], v3 offset:13312
ds_read_b128 v[120:123], v3 offset:14336
ds_read_b128 v[124:127], v3 offset:15360
s_waitcnt vmcnt(23)
s_waitcnt lgkmcnt(4)
v_mfma_f32_16x16x32_bf16 v[64:67], v[200:203], v[96:99], v[64:67]
v_mfma_f32_16x16x32_bf16 v[68:71], v[200:203], v[100:103], v[68:71]
v_mfma_f32_16x16x32_bf16 v[72:75], v[200:203], v[104:107], v[72:75]
v_mfma_f32_16x16x32_bf16 v[76:79], v[200:203], v[108:111], v[76:79]
s_add_u32 s23, s49, 18432
buffer_load_dwordx4 v[200:203], v1, s[8:11], s23 offen
s_waitcnt vmcnt(23)
s_waitcnt lgkmcnt(0)
v_mfma_f32_16x16x32_bf16 v[64:67], v[204:207], v[112:115], v[64:67]
v_mfma_f32_16x16x32_bf16 v[68:71], v[204:207], v[116:119], v[68:71]
v_mfma_f32_16x16x32_bf16 v[72:75], v[204:207], v[120:123], v[72:75]
v_mfma_f32_16x16x32_bf16 v[76:79], v[204:207], v[124:127], v[76:79]
s_add_u32 s23, s49, 19456
buffer_load_dwordx4 v[204:207], v1, s[8:11], s23 offen
s_barrier
v_mov_b32 v48, 133120
ds_read_b32 v48, v48
s_waitcnt lgkmcnt(0)
v_readfirstlane_b32 s24, v48
s_cmp_eq_u32 s24, 0
s_cbranch_scc1 L_30
v_lshlrev_b32 v60, 4, v4
v_add_u32 v60, 131072, v60
ds_read_b128 v[224:227], v60 offset:0
ds_read_b128 v[228:231], v60 offset:256
ds_read_b128 v[232:235], v60 offset:512
ds_read_b128 v[236:239], v60 offset:768
s_add_u32 s34, s33, 1048576
s_waitcnt lgkmcnt(0)
v_mul_f32 v64, v64, v224
v_mul_f32 v65, v65, v224
v_mul_f32 v66, v66, v224
v_mul_f32 v67, v67, v224
v_fmac_f32 v64, v225, v30
v_fmac_f32 v65, v225, v31
v_fmac_f32 v66, v225, v32
v_fmac_f32 v67, v225, v33
v_fmac_f32 v64, v226, v34
v_fmac_f32 v65, v226, v35
v_fmac_f32 v66, v226, v36
v_fmac_f32 v67, v226, v37
v_fmac_f32 v64, v227, v38
v_fmac_f32 v65, v227, v39
v_fmac_f32 v66, v227, v40
v_fmac_f32 v67, v227, v41
v_mul_f32 v240, v64, v64
v_mul_f32 v241, v65, v65
v_mul_f32 v242, v66, v66
v_mul_f32 v243, v67, v67
v_fma_f32 v240, v240, s40, v63
v_fma_f32 v241, v241, s40, v63
v_fma_f32 v242, v242, s40, v63
v_fma_f32 v243, v243, s40, v63
v_mul_f32 v240, v240, v64
v_mul_f32 v241, v241, v65
v_mul_f32 v242, v242, v66
v_mul_f32 v243, v243, v67
v_exp_f32 v240, v240
v_exp_f32 v241, v241
v_exp_f32 v242, v242
v_exp_f32 v243, v243
v_add_f32 v240, 1.0, v240
v_add_f32 v241, 1.0, v241
v_add_f32 v242, 1.0, v242
v_add_f32 v243, 1.0, v243
v_rcp_f32 v240, v240
v_rcp_f32 v241, v241
v_rcp_f32 v242, v242
v_rcp_f32 v243, v243
v_mul_f32 v64, v64, v240
v_mul_f32 v65, v65, v241
v_mul_f32 v66, v66, v242
v_mul_f32 v67, v67, v243
v_cvt_pk_bf16_f32 v244, v64, v65
v_cvt_pk_bf16_f32 v245, v66, v67
buffer_store_dwordx2 v[244:245], v1, s[8:11], s34 offen
s_add_u32 s34, s34, 20480
v_mul_f32 v68, v68, v228
v_mul_f32 v69, v69, v228
v_mul_f32 v70, v70, v228
v_mul_f32 v71, v71, v228
v_fmac_f32 v68, v229, v30
v_fmac_f32 v69, v229, v31
v_fmac_f32 v70, v229, v32
v_fmac_f32 v71, v229, v33
v_fmac_f32 v68, v230, v34
v_fmac_f32 v69, v230, v35
v_fmac_f32 v70, v230, v36
v_fmac_f32 v71, v230, v37
v_fmac_f32 v68, v231, v38
v_fmac_f32 v69, v231, v39
v_fmac_f32 v70, v231, v40
v_fmac_f32 v71, v231, v41
v_mul_f32 v240, v68, v68
v_mul_f32 v241, v69, v69
v_mul_f32 v242, v70, v70
v_mul_f32 v243, v71, v71
v_fma_f32 v240, v240, s40, v63
v_fma_f32 v241, v241, s40, v63
v_fma_f32 v242, v242, s40, v63
v_fma_f32 v243, v243, s40, v63
v_mul_f32 v240, v240, v68
v_mul_f32 v241, v241, v69
v_mul_f32 v242, v242, v70
v_mul_f32 v243, v243, v71
v_exp_f32 v240, v240
v_exp_f32 v241, v241
v_exp_f32 v242, v242
v_exp_f32 v243, v243
v_add_f32 v240, 1.0, v240
v_add_f32 v241, 1.0, v241
v_add_f32 v242, 1.0, v242
v_add_f32 v243, 1.0, v243
v_rcp_f32 v240, v240
v_rcp_f32 v241, v241
v_rcp_f32 v242, v242
v_rcp_f32 v243, v243
v_mul_f32 v68, v68, v240
v_mul_f32 v69, v69, v241
v_mul_f32 v70, v70, v242
v_mul_f32 v71, v71, v243
v_cvt_pk_bf16_f32 v246, v68, v69
v_cvt_pk_bf16_f32 v247, v70, v71
buffer_store_dwordx2 v[246:247], v1, s[8:11], s34 offen
s_add_u32 s34, s34, 20480
v_mul_f32 v72, v72, v232
v_mul_f32 v73, v73, v232
v_mul_f32 v74, v74, v232
v_mul_f32 v75, v75, v232
v_fmac_f32 v72, v233, v30
v_fmac_f32 v73, v233, v31
v_fmac_f32 v74, v233, v32
v_fmac_f32 v75, v233, v33
v_fmac_f32 v72, v234, v34
v_fmac_f32 v73, v234, v35
v_fmac_f32 v74, v234, v36
v_fmac_f32 v75, v234, v37
v_fmac_f32 v72, v235, v38
v_fmac_f32 v73, v235, v39
v_fmac_f32 v74, v235, v40
v_fmac_f32 v75, v235, v41
v_mul_f32 v240, v72, v72
v_mul_f32 v241, v73, v73
v_mul_f32 v242, v74, v74
v_mul_f32 v243, v75, v75
v_fma_f32 v240, v240, s40, v63
v_fma_f32 v241, v241, s40, v63
v_fma_f32 v242, v242, s40, v63
v_fma_f32 v243, v243, s40, v63
v_mul_f32 v240, v240, v72
v_mul_f32 v241, v241, v73
v_mul_f32 v242, v242, v74
v_mul_f32 v243, v243, v75
v_exp_f32 v240, v240
v_exp_f32 v241, v241
v_exp_f32 v242, v242
v_exp_f32 v243, v243
v_add_f32 v240, 1.0, v240
v_add_f32 v241, 1.0, v241
v_add_f32 v242, 1.0, v242
v_add_f32 v243, 1.0, v243
v_rcp_f32 v240, v240
v_rcp_f32 v241, v241
v_rcp_f32 v242, v242
v_rcp_f32 v243, v243
v_mul_f32 v72, v72, v240
v_mul_f32 v73, v73, v241
v_mul_f32 v74, v74, v242
v_mul_f32 v75, v75, v243
v_cvt_pk_bf16_f32 v248, v72, v73
v_cvt_pk_bf16_f32 v249, v74, v75
buffer_store_dwordx2 v[248:249], v1, s[8:11], s34 offen
s_add_u32 s34, s34, 20480
v_mul_f32 v76, v76, v236
v_mul_f32 v77, v77, v236
v_mul_f32 v78, v78, v236
v_mul_f32 v79, v79, v236
v_fmac_f32 v76, v237, v30
v_fmac_f32 v77, v237, v31
v_fmac_f32 v78, v237, v32
v_fmac_f32 v79, v237, v33
v_fmac_f32 v76, v238, v34
v_fmac_f32 v77, v238, v35
v_fmac_f32 v78, v238, v36
v_fmac_f32 v79, v238, v37
v_fmac_f32 v76, v239, v38
v_fmac_f32 v77, v239, v39
v_fmac_f32 v78, v239, v40
v_fmac_f32 v79, v239, v41
v_mul_f32 v240, v76, v76
v_mul_f32 v241, v77, v77
v_mul_f32 v242, v78, v78
v_mul_f32 v243, v79, v79
v_fma_f32 v240, v240, s40, v63
v_fma_f32 v241, v241, s40, v63
v_fma_f32 v242, v242, s40, v63
v_fma_f32 v243, v243, s40, v63
v_mul_f32 v240, v240, v76
v_mul_f32 v241, v241, v77
v_mul_f32 v242, v242, v78
v_mul_f32 v243, v243, v79
v_exp_f32 v240, v240
v_exp_f32 v241, v241
v_exp_f32 v242, v242
v_exp_f32 v243, v243
v_add_f32 v240, 1.0, v240
v_add_f32 v241, 1.0, v241
v_add_f32 v242, 1.0, v242
v_add_f32 v243, 1.0, v243
v_rcp_f32 v240, v240
v_rcp_f32 v241, v241
v_rcp_f32 v242, v242
v_rcp_f32 v243, v243
v_mul_f32 v76, v76, v240
v_mul_f32 v77, v77, v241
v_mul_f32 v78, v78, v242
v_mul_f32 v79, v79, v243
v_cvt_pk_bf16_f32 v250, v76, v77
v_cvt_pk_bf16_f32 v251, v78, v79
buffer_store_dwordx2 v[250:251], v1, s[8:11], s34 offen
s_add_u32 s34, s34, 20480
s_mov_b32 s25, 147456
buffer_load_dwordx4 v[30:33], v59, s[8:11], s25 offen
s_mov_b32 s25, 150016
buffer_load_dwordx4 v[34:37], v59, s[8:11], s25 offen
s_mov_b32 s25, 152576
buffer_load_dwordx4 v[38:41], v59, s[8:11], s25 offen
s_lshl_b32 s35, s16, 5
s_add_u32 s35, s35, 165888
s_lshl_b32 s24, s17, 2
s_add_u32 s36, s35, s24
s_waitcnt vmcnt(0)
s_barrier
s_cmp_lg_u32 s18, 0
s_cbranch_scc1 L_31
v_mov_b32 v46, 0
v_mov_b32 v47, 1
buffer_store_dword v47, v46, s[8:11], s36 offen
L_31:
s_and_b32 s24, s18, 3
s_lshl_b32 s24, s24, 4
s_add_u32 s24, s24, s19
v_add_u32 v46, s24, v4
v_lshrrev_b32 v47, 4, v46
v_mul_u32_u24 v47, 20480, v47
v_and_b32 v46, 15, v46
v_lshlrev_b32 v46, 4, v46
v_add_u32 v47, v47, v46
v_lshlrev_b32 v46, 8, v5
v_add_u32 v42, v47, v46
s_lshr_b32 s24, s18, 2
s_lshl_b32 s24, s24, 10
s_add_u32 s28, s24, 1048576
v_lshrrev_b32 v46, 2, v1
v_min_u32 v46, 28, v46
s_mov_b32 s30, 40000
L_32:
buffer_load_dword v47, v46, s[8:11], s35 offen sc1
s_waitcnt vmcnt(0)
v_cmp_ne_u32 vcc, 1, v47
s_nop 4
s_cbranch_vccz L_33
s_sub_u32 s30, s30, 1
s_cmp_lg_u32 s30, 0
s_cbranch_scc1 L_32
L_33:
s_add_u32 m0, s21, 0
s_add_u32 s22, s28, 0
buffer_load_dwordx4 v42, s[8:11], s22 offen  lds
s_add_u32 m0, s21, 8192
s_add_u32 s22, s28, 2048
buffer_load_dwordx4 v42, s[8:11], s22 offen  lds
s_add_u32 m0, s21, 16384
s_add_u32 s22, s28, 4096
buffer_load_dwordx4 v42, s[8:11], s22 offen  lds
s_add_u32 m0, s21, 24576
s_add_u32 s22, s28, 6144
buffer_load_dwordx4 v42, s[8:11], s22 offen  lds
s_add_u32 m0, s21, 32768
s_add_u32 s22, s28, 8192
buffer_load_dwordx4 v42, s[8:11], s22 offen  lds
s_add_u32 m0, s21, 40960
s_add_u32 s22, s28, 10240
buffer_load_dwordx4 v42, s[8:11], s22 offen  lds
s_add_u32 m0, s21, 49152
s_add_u32 s22, s28, 12288
buffer_load_dwordx4 v42, s[8:11], s22 offen  lds
s_add_u32 m0, s21, 57344
s_add_u32 s22, s28, 14336
buffer_load_dwordx4 v42, s[8:11], s22 offen  lds
s_add_u32 m0, s21, 65536
s_add_u32 s22, s28, 16384
buffer_load_dwordx4 v42, s[8:11], s22 offen  lds
s_add_u32 m0, s21, 73728
s_add_u32 s22, s28, 18432
buffer_load_dwordx4 v42, s[8:11], s22 offen  lds
v_mov_b32 v64, 0
v_mov_b32 v65, 0
v_mov_b32 v66, 0
v_mov_b32 v67, 0
v_mov_b32 v68, 0
v_mov_b32 v69, 0
v_mov_b32 v70, 0
v_mov_b32 v71, 0
v_mov_b32 v72, 0
v_mov_b32 v73, 0
v_mov_b32 v74, 0
v_mov_b32 v75, 0
v_mov_b32 v76, 0
v_mov_b32 v77, 0
v_mov_b32 v78, 0
v_mov_b32 v79, 0
s_waitcnt vmcnt(8)
s_barrier
ds_read_b128 v[96:99], v2 offset:0
ds_read_b128 v[100:103], v2 offset:1024
ds_read_b128 v[104:107], v2 offset:2048
ds_read_b128 v[108:111], v2 offset:3072
ds_read_b128 v[112:115], v2 offset:4096
ds_read_b128 v[116:119], v2 offset:5120
ds_read_b128 v[120:123], v2 offset:6144
ds_read_b128 v[124:127], v2 offset:7168
s_waitcnt lgkmcnt(4)
v_mfma_f32_16x16x32_bf16 v[64:67], v[128:131], v[96:99], v[64:67]
v_mfma_f32_16x16x32_bf16 v[68:71], v[128:131], v[100:103], v[68:71]
v_mfma_f32_16x16x32_bf16 v[72:75], v[128:131], v[104:107], v[72:75]
v_mfma_f32_16x16x32_bf16 v[76:79], v[128:131], v[108:111], v[76:79]
s_add_u32 s23, s41, 0
buffer_load_dwordx4 v[128:131], v1, s[8:11], s23 offen
ds_read_b128 v[96:99], v2 offset:8192
ds_read_b128 v[100:103], v2 offset:9216
ds_read_b128 v[104:107], v2 offset:10240
ds_read_b128 v[108:111], v2 offset:11264
s_waitcnt lgkmcnt(4)
v_mfma_f32_16x16x32_bf16 v[64:67], v[132:135], v[112:115], v[64:67]
v_mfma_f32_16x16x32_bf16 v[68:71], v[132:135], v[116:119], v[68:71]
v_mfma_f32_16x16x32_bf16 v[72:75], v[132:135], v[120:123], v[72:75]
v_mfma_f32_16x16x32_bf16 v[76:79], v[132:135], v[124:127], v[76:79]
s_add_u32 s23, s42, 0
buffer_load_dwordx4 v[132:135], v1, s[8:11], s23 offen
ds_read_b128 v[112:115], v2 offset:12288
ds_read_b128 v[116:119], v2 offset:13312
ds_read_b128 v[120:123], v2 offset:14336
ds_read_b128 v[124:127], v2 offset:15360
s_waitcnt lgkmcnt(4)
v_mfma_f32_16x16x32_bf16 v[64:67], v[136:139], v[96:99], v[64:67]
v_mfma_f32_16x16x32_bf16 v[68:71], v[136:139], v[100:103], v[68:71]
v_mfma_f32_16x16x32_bf16 v[72:75], v[136:139], v[104:107], v[72:75]
v_mfma_f32_16x16x32_bf16 v[76:79], v[136:139], v[108:111], v[76:79]
s_add_u32 s23, s41, 1024
buffer_load_dwordx4 v[136:139], v1, s[8:11], s23 offen
s_waitcnt vmcnt(9)
s_barrier
ds_read_b128 v[96:99], v2 offset:16384
ds_read_b128 v[100:103], v2 offset:17408
ds_read_b128 v[104:107], v2 offset:18432
ds_read_b128 v[108:111], v2 offset:19456
s_waitcnt lgkmcnt(4)
v_mfma_f32_16x16x32_bf16 v[64:67], v[140:143], v[112:115], v[64:67]
v_mfma_f32_16x16x32_bf16 v[68:71], v[140:143], v[116:119], v[68:71]
v_mfma_f32_16x16x32_bf16 v[72:75], v[140:143], v[120:123], v[72:75]
v_mfma_f32_16x16x32_bf16 v[76:79], v[140:143], v[124:127], v[76:79]
s_add_u32 s23, s42, 1024
buffer_load_dwordx4 v[140:143], v1, s[8:11], s23 offen
ds_read_b128 v[112:115], v2 offset:20480
ds_read_b128 v[116:119], v2 offset:21504
ds_read_b128 v[120:123], v2 offset:22528
ds_read_b128 v[124:127], v2 offset:23552
s_waitcnt lgkmcnt(4)
v_mfma_f32_16x16x32_bf16 v[64:67], v[144:147], v[96:99], v[64:67]
v_mfma_f32_16x16x32_bf16 v[68:71], v[144:147], v[100:103], v[68:71]
v_mfma_f32_16x16x32_bf16 v[72:75], v[144:147], v[104:107], v[72:75]
v_mfma_f32_16x16x32_bf16 v[76:79], v[144:147], v[108:111], v[76:79]
s_add_u32 s23, s41, 2048
buffer_load_dwordx4 v[144:147], v1, s[8:11], s23 offen
ds_read_b128 v[96:99], v2 offset:24576
ds_read_b128 v[100:103], v2 offset:25600
ds_read_b128 v[104:107], v2 offset:26624
ds_read_b128 v[108:111], v2 offset:27648
s_waitcnt lgkmcnt(4)
v_mfma_f32_16x16x32_bf16 v[64:67], v[148:151], v[112:115], v[64:67]
v_mfma_f32_16x16x32_bf16 v[68:71], v[148:151], v[116:119], v[68:71]
v_mfma_f32_16x16x32_bf16 v[72:75], v[148:151], v[120:123], v[72:75]
v_mfma_f32_16x16x32_bf16 v[76:79], v[148:151], v[124:127], v[76:79]
s_add_u32 s23, s42, 2048
buffer_load_dwordx4 v[148:151], v1, s[8:11], s23 offen
ds_read_b128 v[112:115], v2 offset:28672
ds_read_b128 v[116:119], v2 offset:29696
ds_read_b128 v[120:123], v2 offset:30720
ds_read_b128 v[124:127], v2 offset:31744
s_waitcnt lgkmcnt(4)
v_mfma_f32_16x16x32_bf16 v[64:67], v[152:155], v[96:99], v[64:67]
v_mfma_f32_16x16x32_bf16 v[68:71], v[152:155], v[100:103], v[68:71]
v_mfma_f32_16x16x32_bf16 v[72:75], v[152:155], v[104:107], v[72:75]
v_mfma_f32_16x16x32_bf16 v[76:79], v[152:155], v[108:111], v[76:79]
s_add_u32 s23, s41, 3072
buffer_load_dwordx4 v[152:155], v1, s[8:11], s23 offen
s_waitcnt vmcnt(11)
s_barrier
ds_read_b128 v[96:99], v2 offset:32768
ds_read_b128 v[100:103], v2 offset:33792
ds_read_b128 v[104:107], v2 offset:34816
ds_read_b128 v[108:111], v2 offset:35840
s_waitcnt lgkmcnt(4)
v_mfma_f32_16x16x32_bf16 v[64:67], v[156:159], v[112:115], v[64:67]
v_mfma_f32_16x16x32_bf16 v[68:71], v[156:159], v[116:119], v[68:71]
v_mfma_f32_16x16x32_bf16 v[72:75], v[156:159], v[120:123], v[72:75]
v_mfma_f32_16x16x32_bf16 v[76:79], v[156:159], v[124:127], v[76:79]
s_add_u32 s23, s42, 3072
buffer_load_dwordx4 v[156:159], v1, s[8:11], s23 offen
ds_read_b128 v[112:115], v2 offset:36864
ds_read_b128 v[116:119], v2 offset:37888
ds_read_b128 v[120:123], v2 offset:38912
ds_read_b128 v[124:127], v2 offset:39936
s_waitcnt lgkmcnt(4)
v_mfma_f32_16x16x32_bf16 v[64:67], v[160:163], v[96:99], v[64:67]
v_mfma_f32_16x16x32_bf16 v[68:71], v[160:163], v[100:103], v[68:71]
v_mfma_f32_16x16x32_bf16 v[72:75], v[160:163], v[104:107], v[72:75]
v_mfma_f32_16x16x32_bf16 v[76:79], v[160:163], v[108:111], v[76:79]
s_add_u32 s23, s41, 4096
buffer_load_dwordx4 v[160:163], v1, s[8:11], s23 offen
ds_read_b128 v[96:99], v2 offset:40960
ds_read_b128 v[100:103], v2 offset:41984
ds_read_b128 v[104:107], v2 offset:43008
ds_read_b128 v[108:111], v2 offset:44032
s_waitcnt lgkmcnt(4)
v_mfma_f32_16x16x32_bf16 v[64:67], v[164:167], v[112:115], v[64:67]
v_mfma_f32_16x16x32_bf16 v[68:71], v[164:167], v[116:119], v[68:71]
v_mfma_f32_16x16x32_bf16 v[72:75], v[164:167], v[120:123], v[72:75]
v_mfma_f32_16x16x32_bf16 v[76:79], v[164:167], v[124:127], v[76:79]
s_add_u32 s23, s42, 4096
buffer_load_dwordx4 v[164:167], v1, s[8:11], s23 offen
ds_read_b128 v[112:115], v2 offset:45056
ds_read_b128 v[116:119], v2 offset:46080
ds_read_b128 v[120:123], v2 offset:47104
ds_read_b128 v[124:127], v2 offset:48128
s_waitcnt lgkmcnt(4)
v_mfma_f32_16x16x32_bf16 v[64:67], v[168:171], v[96:99], v[64:67]
v_mfma_f32_16x16x32_bf16 v[68:71], v[168:171], v[100:103], v[68:71]
v_mfma_f32_16x16x32_bf16 v[72:75], v[168:171], v[104:107], v[72:75]
v_mfma_f32_16x16x32_bf16 v[76:79], v[168:171], v[108:111], v[76:79]
s_add_u32 s23, s41, 5120
buffer_load_dwordx4 v[168:171], v1, s[8:11], s23 offen
s_waitcnt vmcnt(13)
s_barrier
ds_read_b128 v[96:99], v2 offset:49152
ds_read_b128 v[100:103], v2 offset:50176
ds_read_b128 v[104:107], v2 offset:51200
ds_read_b128 v[108:111], v2 offset:52224
s_waitcnt lgkmcnt(4)
v_mfma_f32_16x16x32_bf16 v[64:67], v[172:175], v[112:115], v[64:67]
v_mfma_f32_16x16x32_bf16 v[68:71], v[172:175], v[116:119], v[68:71]
v_mfma_f32_16x16x32_bf16 v[72:75], v[172:175], v[120:123], v[72:75]
v_mfma_f32_16x16x32_bf16 v[76:79], v[172:175], v[124:127], v[76:79]
s_add_u32 s23, s42, 5120
buffer_load_dwordx4 v[172:175], v1, s[8:11], s23 offen
ds_read_b128 v[112:115], v2 offset:53248
ds_read_b128 v[116:119], v2 offset:54272
ds_read_b128 v[120:123], v2 offset:55296
ds_read_b128 v[124:127], v2 offset:56320
s_waitcnt lgkmcnt(4)
v_mfma_f32_16x16x32_bf16 v[64:67], v[176:179], v[96:99], v[64:67]
v_mfma_f32_16x16x32_bf16 v[68:71], v[176:179], v[100:103], v[68:71]
v_mfma_f32_16x16x32_bf16 v[72:75], v[176:179], v[104:107], v[72:75]
v_mfma_f32_16x16x32_bf16 v[76:79], v[176:179], v[108:111], v[76:79]
s_add_u32 s23, s41, 6144
buffer_load_dwordx4 v[176:179], v1, s[8:11], s23 offen
ds_read_b128 v[96:99], v2 offset:57344
ds_read_b128 v[100:103], v2 offset:58368
ds_read_b128 v[104:107], v2 offset:59392
ds_read_b128 v[108:111], v2 offset:60416
s_waitcnt lgkmcnt(4)
v_mfma_f32_16x16x32_bf16 v[64:67], v[180:183], v[112:115], v[64:67]
v_mfma_f32_16x16x32_bf16 v[68:71], v[180:183], v[116:119], v[68:71]
v_mfma_f32_16x16x32_bf16 v[72:75], v[180:183], v[120:123], v[72:75]
v_mfma_f32_16x16x32_bf16 v[76:79], v[180:183], v[124:127], v[76:79]
s_add_u32 s23, s42, 6144
buffer_load_dwordx4 v[180:183], v1, s[8:11], s23 offen
ds_read_b128 v[112:115], v2 offset:61440
ds_read_b128 v[116:119], v2 offset:62464
ds_read_b128 v[120:123], v2 offset:63488
ds_read_b128 v[124:127], v2 offset:64512
s_waitcnt lgkmcnt(4)
v_mfma_f32_16x16x32_bf16 v[64:67], v[184:187], v[96:99], v[64:67]
v_mfma_f32_16x16x32_bf16 v[68:71], v[184:187], v[100:103], v[68:71]
v_mfma_f32_16x16x32_bf16 v[72:75], v[184:187], v[104:107], v[72:75]
v_mfma_f32_16x16x32_bf16 v[76:79], v[184:187], v[108:111], v[76:79]
s_add_u32 s23, s41, 7168
buffer_load_dwordx4 v[184:187], v1, s[8:11], s23 offen
s_waitcnt vmcnt(15)
s_barrier
ds_read_b128 v[96:99], v3 offset:0
ds_read_b128 v[100:103], v3 offset:1024
ds_read_b128 v[104:107], v3 offset:2048
ds_read_b128 v[108:111], v3 offset:3072
s_waitcnt lgkmcnt(4)
v_mfma_f32_16x16x32_bf16 v[64:67], v[188:191], v[112:115], v[64:67]
v_mfma_f32_16x16x32_bf16 v[68:71], v[188:191], v[116:119], v[68:71]
v_mfma_f32_16x16x32_bf16 v[72:75], v[188:191], v[120:123], v[72:75]
v_mfma_f32_16x16x32_bf16 v[76:79], v[188:191], v[124:127], v[76:79]
s_add_u32 s23, s42, 7168
buffer_load_dwordx4 v[188:191], v1, s[8:11], s23 offen
ds_read_b128 v[112:115], v3 offset:4096
ds_read_b128 v[116:119], v3 offset:5120
ds_read_b128 v[120:123], v3 offset:6144
ds_read_b128 v[124:127], v3 offset:7168
s_waitcnt lgkmcnt(4)
v_mfma_f32_16x16x32_bf16 v[64:67], v[192:195], v[96:99], v[64:67]
v_mfma_f32_16x16x32_bf16 v[68:71], v[192:195], v[100:103], v[68:71]
v_mfma_f32_16x16x32_bf16 v[72:75], v[192:195], v[104:107], v[72:75]
v_mfma_f32_16x16x32_bf16 v[76:79], v[192:195], v[108:111], v[76:79]
s_add_u32 s23, s41, 8192
buffer_load_dwordx4 v[192:195], v1, s[8:11], s23 offen
ds_read_b128 v[96:99], v3 offset:8192
ds_read_b128 v[100:103], v3 offset:9216
ds_read_b128 v[104:107], v3 offset:10240
ds_read_b128 v[108:111], v3 offset:11264
s_waitcnt lgkmcnt(4)
v_mfma_f32_16x16x32_bf16 v[64:67], v[196:199], v[112:115], v[64:67]
v_mfma_f32_16x16x32_bf16 v[68:71], v[196:199], v[116:119], v[68:71]
v_mfma_f32_16x16x32_bf16 v[72:75], v[196:199], v[120:123], v[72:75]
v_mfma_f32_16x16x32_bf16 v[76:79], v[196:199], v[124:127], v[76:79]
s_add_u32 s23, s42, 8192
buffer_load_dwordx4 v[196:199], v1, s[8:11], s23 offen
ds_read_b128 v[112:115], v3 offset:12288
ds_read_b128 v[116:119], v3 offset:13312
ds_read_b128 v[120:123], v3 offset:14336
ds_read_b128 v[124:127], v3 offset:15360
s_waitcnt lgkmcnt(4)
v_mfma_f32_16x16x32_bf16 v[64:67], v[200:203], v[96:99], v[64:67]
v_mfma_f32_16x16x32_bf16 v[68:71], v[200:203], v[100:103], v[68:71]
v_mfma_f32_16x16x32_bf16 v[72:75], v[200:203], v[104:107], v[72:75]
v_mfma_f32_16x16x32_bf16 v[76:79], v[200:203], v[108:111], v[76:79]
s_add_u32 s23, s41, 9216
buffer_load_dwordx4 v[200:203], v1, s[8:11], s23 offen
s_waitcnt lgkmcnt(0)
v_mfma_f32_16x16x32_bf16 v[64:67], v[204:207], v[112:115], v[64:67]
v_mfma_f32_16x16x32_bf16 v[68:71], v[204:207], v[116:119], v[68:71]
v_mfma_f32_16x16x32_bf16 v[72:75], v[204:207], v[120:123], v[72:75]
v_mfma_f32_16x16x32_bf16 v[76:79], v[204:207], v[124:127], v[76:79]
s_add_u32 s23, s42, 9216
buffer_load_dwordx4 v[204:207], v1, s[8:11], s23 offen
s_add_u32 s23, s41, 10240
buffer_load_dwordx4 v[208:211], v1, s[8:11], s23 offen
s_add_u32 s23, s42, 10240
buffer_load_dwordx4 v[212:215], v1, s[8:11], s23 offen
s_add_u32 s23, s41, 11264
buffer_load_dwordx4 v[216:219], v1, s[8:11], s23 offen
s_add_u32 s23, s42, 11264
buffer_load_dwordx4 v[220:223], v1, s[8:11], s23 offen
v_lshlrev_b32 v60, 3, v4
v_add_u32 v60, 132096, v60
ds_read_b64 v[224:225], v60 offset:0
ds_read_b64 v[226:227], v60 offset:128
ds_read_b64 v[228:229], v60 offset:256
ds_read_b64 v[230:231], v60 offset:384
v_cmp_eq_u32 vcc, 0, v4
v_mov_b32 v46, 0x3f803f80
s_nop 0
v_cndmask_b32 v232, 0, v46, vcc
v_mov_b32 v233, v232
v_cmp_eq_u32 vcc, 1, v4
s_nop 1
v_cndmask_b32 v234, 0, v46, vcc
v_mov_b32 v235, v234
s_add_u32 s34, s33, 11534336
v_add_u32 v61, s19, v4
v_mul_u32_u24 v61, 320, v61
s_lshl_b32 s24, s31, 3
s_add_u32 s24, s24, 262144
s_waitcnt lgkmcnt(0)
v_lshlrev_b32 v14, 16, v6
v_and_b32 v15, 0xffff0000, v6
v_lshlrev_b32 v16, 16, v7
v_and_b32 v17, 0xffff0000, v7
v_fma_f32 v14, v14, v224, -v225
v_fma_f32 v15, v15, v224, -v225
v_fma_f32 v16, v16, v224, -v225
v_fma_f32 v17, v17, v224, -v225
v_fma_f32 v14, v14, v30, v34
v_fma_f32 v15, v15, v31, v35
v_fma_f32 v16, v16, v32, v36
v_fma_f32 v17, v17, v33, v37
v_add_f32 v14, v14, v64
v_add_f32 v15, v15, v65
v_add_f32 v16, v16, v66
v_add_f32 v17, v17, v67
v_mul_f32 v64, v14, v14
v_mul_f32 v65, v15, v15
v_mul_f32 v66, v16, v16
v_mul_f32 v67, v17, v17
v_cvt_pk_bf16_f32 v236, v14, v15
v_cvt_pk_bf16_f32 v237, v16, v17
v_cvt_pk_bf16_f32 v238, v64, v65
v_cvt_pk_bf16_f32 v239, v66, v67
buffer_store_dwordx2 v[236:237], v1, s[8:11], s34 offen
s_add_u32 s34, s34, 20480
v_mfma_f32_16x16x32_bf16 v[244:247], v[232:235], v[236:239], 0
s_nop 7
s_mov_b64 exec, 0xffff
buffer_store_dwordx2 v[244:245], v61, s[8:11], s24 offen
s_mov_b64 exec, -1
s_add_u32 s24, s24, 5120
v_lshlrev_b32 v18, 16, v8
v_and_b32 v19, 0xffff0000, v8
v_lshlrev_b32 v20, 16, v9
v_and_b32 v21, 0xffff0000, v9
v_fma_f32 v18, v18, v226, -v227
v_fma_f32 v19, v19, v226, -v227
v_fma_f32 v20, v20, v226, -v227
v_fma_f32 v21, v21, v226, -v227
v_fma_f32 v18, v18, v30, v34
v_fma_f32 v19, v19, v31, v35
v_fma_f32 v20, v20, v32, v36
v_fma_f32 v21, v21, v33, v37
v_add_f32 v18, v18, v68
v_add_f32 v19, v19, v69
v_add_f32 v20, v20, v70
v_add_f32 v21, v21, v71
v_mul_f32 v68, v18, v18
v_mul_f32 v69, v19, v19
v_mul_f32 v70, v20, v20
v_mul_f32 v71, v21, v21
v_cvt_pk_bf16_f32 v240, v18, v19
v_cvt_pk_bf16_f32 v241, v20, v21
v_cvt_pk_bf16_f32 v242, v68, v69
v_cvt_pk_bf16_f32 v243, v70, v71
buffer_store_dwordx2 v[240:241], v1, s[8:11], s34 offen
s_add_u32 s34, s34, 20480
v_mfma_f32_16x16x32_bf16 v[244:247], v[232:235], v[240:243], 0
s_nop 7
s_mov_b64 exec, 0xffff
buffer_store_dwordx2 v[244:245], v61, s[8:11], s24 offen
s_mov_b64 exec, -1
s_add_u32 s24, s24, 5120
v_lshlrev_b32 v22, 16, v10
v_and_b32 v23, 0xffff0000, v10
v_lshlrev_b32 v24, 16, v11
v_and_b32 v25, 0xffff0000, v11
v_fma_f32 v22, v22, v228, -v229
v_fma_f32 v23, v23, v228, -v229
v_fma_f32 v24, v24, v228, -v229
v_fma_f32 v25, v25, v228, -v229
v_fma_f32 v22, v22, v30, v34
v_fma_f32 v23, v23, v31, v35
v_fma_f32 v24, v24, v32, v36
v_fma_f32 v25, v25, v33, v37
v_add_f32 v22, v22, v72
v_add_f32 v23, v23, v73
v_add_f32 v24, v24, v74
v_add_f32 v25, v25, v75
v_mul_f32 v72, v22, v22
v_mul_f32 v73, v23, v23
v_mul_f32 v74, v24, v24
v_mul_f32 v75, v25, v25
v_cvt_pk_bf16_f32 v236, v22, v23
v_cvt_pk_bf16_f32 v237, v24, v25
v_cvt_pk_bf16_f32 v238, v72, v73
v_cvt_pk_bf16_f32 v239, v74, v75
buffer_store_dwordx2 v[236:237], v1, s[8:11], s34 offen
s_add_u32 s34, s34, 20480
v_mfma_f32_16x16x32_bf16 v[244:247], v[232:235], v[236:239], 0
s_nop 7
s_mov_b64 exec, 0xffff
buffer_store_dwordx2 v[244:245], v61, s[8:11], s24 offen
s_mov_b64 exec, -1
s_add_u32 s24, s24, 5120
v_lshlrev_b32 v26, 16, v12
v_and_b32 v27, 0xffff0000, v12
v_lshlrev_b32 v28, 16, v13
v_and_b32 v29, 0xffff0000, v13
v_fma_f32 v26, v26, v230, -v231
v_fma_f32 v27, v27, v230, -v231
v_fma_f32 v28, v28, v230, -v231
v_fma_f32 v29, v29, v230, -v231
v_fma_f32 v26, v26, v30, v34
v_fma_f32 v27, v27, v31, v35
v_fma_f32 v28, v28, v32, v36
v_fma_f32 v29, v29, v33, v37
v_add_f32 v26, v26, v76
v_add_f32 v27, v27, v77
v_add_f32 v28, v28, v78
v_add_f32 v29, v29, v79
v_mul_f32 v76, v26, v26
v_mul_f32 v77, v27, v27
v_mul_f32 v78, v28, v28
v_mul_f32 v79, v29, v29
v_cvt_pk_bf16_f32 v240, v26, v27
v_cvt_pk_bf16_f32 v241, v28, v29
v_cvt_pk_bf16_f32 v242, v76, v77
v_cvt_pk_bf16_f32 v243, v78, v79
buffer_store_dwordx2 v[240:241], v1, s[8:11], s34 offen
s_add_u32 s34, s34, 20480
v_mfma_f32_16x16x32_bf16 v[244:247], v[232:235], v[240:243], 0
s_nop 7
s_mov_b64 exec, 0xffff
buffer_store_dwordx2 v[244:245], v61, s[8:11], s24 offen
s_mov_b64 exec, -1
s_add_u32 s24, s24, 5120
s_add_u32 s35, s35, 1024
s_add_u32 s36, s36, 1024
s_waitcnt vmcnt(0)
s_barrier
s_cmp_lg_u32 s18, 0
s_cbranch_scc1 L_36
v_mov_b32 v46, 0
v_mov_b32 v47, 1
buffer_store_dword v47, v46, s[8:11], s36 offen
L_36:
s_and_b32 s24, s18, 3
s_lshl_b32 s24, s24, 4
s_add_u32 s24, s24, s19
v_add_u32 v46, s24, v4
v_lshrrev_b32 v47, 4, v46
v_mul_u32_u24 v47, 20480, v47
v_and_b32 v46, 15, v46
v_lshlrev_b32 v46, 4, v46
v_add_u32 v47, v47, v46
v_lshlrev_b32 v46, 8, v5
v_add_u32 v42, v47, v46
s_lshr_b32 s24, s18, 2
s_lshl_b32 s24, s24, 10
s_add_u32 s28, s24, 11534336
v_lshrrev_b32 v46, 2, v1
v_min_u32 v46, 28, v46
s_mov_b32 s30, 40000
L_37:
buffer_load_dword v47, v46, s[8:11], s35 offen sc1
s_waitcnt vmcnt(0)
v_cmp_ne_u32 vcc, 1, v47
s_nop 4
s_cbranch_vccz L_38
s_sub_u32 s30, s30, 1
s_cmp_lg_u32 s30, 0
s_cbranch_scc1 L_37
L_38:
s_add_u32 m0, s21, 0
s_add_u32 s22, s28, 0
buffer_load_dwordx4 v42, s[8:11], s22 offen sc1 lds
s_add_u32 m0, s21, 8192
s_add_u32 s22, s28, 2048
buffer_load_dwordx4 v42, s[8:11], s22 offen sc1 lds
s_add_u32 m0, s21, 16384
s_add_u32 s22, s28, 4096
buffer_load_dwordx4 v42, s[8:11], s22 offen sc1 lds
s_add_u32 m0, s21, 24576
s_add_u32 s22, s28, 6144
buffer_load_dwordx4 v42, s[8:11], s22 offen sc1 lds
s_add_u32 m0, s21, 32768
s_add_u32 s22, s28, 8192
buffer_load_dwordx4 v42, s[8:11], s22 offen sc1 lds
s_add_u32 m0, s21, 40960
s_add_u32 s22, s28, 10240
buffer_load_dwordx4 v42, s[8:11], s22 offen sc1 lds
s_add_u32 m0, s21, 49152
s_add_u32 s22, s28, 12288
buffer_load_dwordx4 v42, s[8:11], s22 offen sc1 lds
s_add_u32 m0, s21, 57344
s_add_u32 s22, s28, 14336
buffer_load_dwordx4 v42, s[8:11], s22 offen sc1 lds
s_add_u32 m0, s21, 65536
s_add_u32 s22, s28, 16384
buffer_load_dwordx4 v42, s[8:11], s22 offen sc1 lds
s_add_u32 m0, s21, 73728
s_add_u32 s22, s28, 18432
buffer_load_dwordx4 v42, s[8:11], s22 offen sc1 lds
v_mov_b32 v64, 0
v_mov_b32 v65, 0
v_mov_b32 v66, 0
v_mov_b32 v67, 0
v_mov_b32 v68, 0
v_mov_b32 v69, 0
v_mov_b32 v70, 0
v_mov_b32 v71, 0
v_mov_b32 v72, 0
v_mov_b32 v73, 0
v_mov_b32 v74, 0
v_mov_b32 v75, 0
v_mov_b32 v76, 0
v_mov_b32 v77, 0
v_mov_b32 v78, 0
v_mov_b32 v79, 0
v_mov_b32 v80, 0
v_mov_b32 v81, 0
v_mov_b32 v82, 0
v_mov_b32 v83, 0
v_mov_b32 v84, 0
v_mov_b32 v85, 0
v_mov_b32 v86, 0
v_mov_b32 v87, 0
v_mov_b32 v88, 0
v_mov_b32 v89, 0
v_mov_b32 v90, 0
v_mov_b32 v91, 0
v_mov_b32 v92, 0
v_mov_b32 v93, 0
v_mov_b32 v94, 0
v_mov_b32 v95, 0
s_waitcnt vmcnt(8)
s_barrier
ds_read_b128 v[96:99], v2 offset:0
ds_read_b128 v[100:103], v2 offset:1024
ds_read_b128 v[104:107], v2 offset:2048
ds_read_b128 v[108:111], v2 offset:3072
ds_read_b128 v[112:115], v2 offset:4096
ds_read_b128 v[116:119], v2 offset:5120
ds_read_b128 v[120:123], v2 offset:6144
ds_read_b128 v[124:127], v2 offset:7168
s_waitcnt lgkmcnt(4)
v_mfma_f32_16x16x32_bf16 v[64:67], v[128:131], v[96:99], v[64:67]
v_mfma_f32_16x16x32_bf16 v[68:71], v[128:131], v[100:103], v[68:71]
v_mfma_f32_16x16x32_bf16 v[72:75], v[128:131], v[104:107], v[72:75]
v_mfma_f32_16x16x32_bf16 v[76:79], v[128:131], v[108:111], v[76:79]
v_mfma_f32_16x16x32_bf16 v[80:83], v[132:135], v[96:99], v[80:83]
v_mfma_f32_16x16x32_bf16 v[84:87], v[132:135], v[100:103], v[84:87]
v_mfma_f32_16x16x32_bf16 v[88:91], v[132:135], v[104:107], v[88:91]
v_mfma_f32_16x16x32_bf16 v[92:95], v[132:135], v[108:111], v[92:95]
s_add_u32 s23, s41, 12288
buffer_load_dwordx4 v[128:131], v1, s[8:11], s23 offen
s_add_u32 s23, s42, 12288
buffer_load_dwordx4 v[132:135], v1, s[8:11], s23 offen
ds_read_b128 v[96:99], v2 offset:8192
ds_read_b128 v[100:103], v2 offset:9216
ds_read_b128 v[104:107], v2 offset:10240
ds_read_b128 v[108:111], v2 offset:11264
s_waitcnt lgkmcnt(4)
v_mfma_f32_16x16x32_bf16 v[64:67], v[136:139], v[112:115], v[64:67]
v_mfma_f32_16x16x32_bf16 v[68:71], v[136:139], v[116:119], v[68:71]
v_mfma_f32_16x16x32_bf16 v[72:75], v[136:139], v[120:123], v[72:75]
v_mfma_f32_16x16x32_bf16 v[76:79], v[136:139], v[124:127], v[76:79]
v_mfma_f32_16x16x32_bf16 v[80:83], v[140:143], v[112:115], v[80:83]
v_mfma_f32_16x16x32_bf16 v[84:87], v[140:143], v[116:119], v[84:87]
v_mfma_f32_16x16x32_bf16 v[88:91], v[140:143], v[120:123], v[88:91]
v_mfma_f32_16x16x32_bf16 v[92:95], v[140:143], v[124:127], v[92:95]
s_add_u32 s23, s41, 13312
buffer_load_dwordx4 v[136:139], v1, s[8:11], s23 offen
s_add_u32 s23, s42, 13312
buffer_load_dwordx4 v[140:143], v1, s[8:11], s23 offen
ds_read_b128 v[112:115], v2 offset:12288
ds_read_b128 v[116:119], v2 offset:13312
ds_read_b128 v[120:123], v2 offset:14336
ds_read_b128 v[124:127], v2 offset:15360
s_waitcnt lgkmcnt(4)
v_mfma_f32_16x16x32_bf16 v[64:67], v[144:147], v[96:99], v[64:67]
v_mfma_f32_16x16x32_bf16 v[68:71], v[144:147], v[100:103], v[68:71]
v_mfma_f32_16x16x32_bf16 v[72:75], v[144:147], v[104:107], v[72:75]
v_mfma_f32_16x16x32_bf16 v[76:79], v[144:147], v[108:111], v[76:79]
v_mfma_f32_16x16x32_bf16 v[80:83], v[148:151], v[96:99], v[80:83]
v_mfma_f32_16x16x32_bf16 v[84:87], v[148:151], v[100:103], v[84:87]
v_mfma_f32_16x16x32_bf16 v[88:91], v[148:151], v[104:107], v[88:91]
v_mfma_f32_16x16x32_bf16 v[92:95], v[148:151], v[108:111], v[92:95]
s_add_u32 s23, s41, 14336
buffer_load_dwordx4 v[144:147], v1, s[8:11], s23 offen
s_add_u32 s23, s42, 14336
buffer_load_dwordx4 v[148:151], v1, s[8:11], s23 offen
s_waitcnt vmcnt(12)
s_barrier
ds_read_b128 v[96:99], v2 offset:16384
ds_read_b128 v[100:103], v2 offset:17408
ds_read_b128 v[104:107], v2 offset:18432
ds_read_b128 v[108:111], v2 offset:19456
s_waitcnt lgkmcnt(4)
v_mfma_f32_16x16x32_bf16 v[64:67], v[152:155], v[112:115], v[64:67]
v_mfma_f32_16x16x32_bf16 v[68:71], v[152:155], v[116:119], v[68:71]
v_mfma_f32_16x16x32_bf16 v[72:75], v[152:155], v[120:123], v[72:75]
v_mfma_f32_16x16x32_bf16 v[76:79], v[152:155], v[124:127], v[76:79]
v_mfma_f32_16x16x32_bf16 v[80:83], v[156:159], v[112:115], v[80:83]
v_mfma_f32_16x16x32_bf16 v[84:87], v[156:159], v[116:119], v[84:87]
v_mfma_f32_16x16x32_bf16 v[88:91], v[156:159], v[120:123], v[88:91]
v_mfma_f32_16x16x32_bf16 v[92:95], v[156:159], v[124:127], v[92:95]
s_add_u32 s23, s41, 15360
buffer_load_dwordx4 v[152:155], v1, s[8:11], s23 offen
s_add_u32 s23, s42, 15360
buffer_load_dwordx4 v[156:159], v1, s[8:11], s23 offen
ds_read_b128 v[112:115], v2 offset:20480
ds_read_b128 v[116:119], v2 offset:21504
ds_read_b128 v[120:123], v2 offset:22528
ds_read_b128 v[124:127], v2 offset:23552
s_waitcnt lgkmcnt(4)
v_mfma_f32_16x16x32_bf16 v[64:67], v[160:163], v[96:99], v[64:67]
v_mfma_f32_16x16x32_bf16 v[68:71], v[160:163], v[100:103], v[68:71]
v_mfma_f32_16x16x32_bf16 v[72:75], v[160:163], v[104:107], v[72:75]
v_mfma_f32_16x16x32_bf16 v[76:79], v[160:163], v[108:111], v[76:79]
v_mfma_f32_16x16x32_bf16 v[80:83], v[164:167], v[96:99], v[80:83]
v_mfma_f32_16x16x32_bf16 v[84:87], v[164:167], v[100:103], v[84:87]
v_mfma_f32_16x16x32_bf16 v[88:91], v[164:167], v[104:107], v[88:91]
v_mfma_f32_16x16x32_bf16 v[92:95], v[164:167], v[108:111], v[92:95]
s_add_u32 s23, s41, 16384
buffer_load_dwordx4 v[160:163], v1, s[8:11], s23 offen
s_add_u32 s23, s42, 16384
buffer_load_dwordx4 v[164:167], v1, s[8:11], s23 offen
ds_read_b128 v[96:99], v2 offset:24576
ds_read_b128 v[100:103], v2 offset:25600
ds_read_b128 v[104:107], v2 offset:26624
ds_read_b128 v[108:111], v2 offset:27648
s_waitcnt lgkmcnt(4)
v_mfma_f32_16x16x32_bf16 v[64:67], v[168:171], v[112:115], v[64:67]
v_mfma_f32_16x16x32_bf16 v[68:71], v[168:171], v[116:119], v[68:71]
v_mfma_f32_16x16x32_bf16 v[72:75], v[168:171], v[120:123], v[72:75]
v_mfma_f32_16x16x32_bf16 v[76:79], v[168:171], v[124:127], v[76:79]
v_mfma_f32_16x16x32_bf16 v[80:83], v[172:175], v[112:115], v[80:83]
v_mfma_f32_16x16x32_bf16 v[84:87], v[172:175], v[116:119], v[84:87]
v_mfma_f32_16x16x32_bf16 v[88:91], v[172:175], v[120:123], v[88:91]
v_mfma_f32_16x16x32_bf16 v[92:95], v[172:175], v[124:127], v[92:95]
s_add_u32 s23, s41, 17408
buffer_load_dwordx4 v[168:171], v1, s[8:11], s23 offen
s_add_u32 s23, s42, 17408
buffer_load_dwordx4 v[172:175], v1, s[8:11], s23 offen
ds_read_b128 v[112:115], v2 offset:28672
ds_read_b128 v[116:119], v2 offset:29696
ds_read_b128 v[120:123], v2 offset:30720
ds_read_b128 v[124:127], v2 offset:31744
s_waitcnt lgkmcnt(4)
v_mfma_f32_16x16x32_bf16 v[64:67], v[176:179], v[96:99], v[64:67]
v_mfma_f32_16x16x32_bf16 v[68:71], v[176:179], v[100:103], v[68:71]
v_mfma_f32_16x16x32_bf16 v[72:75], v[176:179], v[104:107], v[72:75]
v_mfma_f32_16x16x32_bf16 v[76:79], v[176:179], v[108:111], v[76:79]
v_mfma_f32_16x16x32_bf16 v[80:83], v[180:183], v[96:99], v[80:83]
v_mfma_f32_16x16x32_bf16 v[84:87], v[180:183], v[100:103], v[84:87]
v_mfma_f32_16x16x32_bf16 v[88:91], v[180:183], v[104:107], v[88:91]
v_mfma_f32_16x16x32_bf16 v[92:95], v[180:183], v[108:111], v[92:95]
s_add_u32 s23, s41, 18432
buffer_load_dwordx4 v[176:179], v1, s[8:11], s23 offen
s_add_u32 s23, s42, 18432
buffer_load_dwordx4 v[180:183], v1, s[8:11], s23 offen
s_waitcnt vmcnt(18)
s_barrier
ds_read_b128 v[96:99], v2 offset:32768
ds_read_b128 v[100:103], v2 offset:33792
ds_read_b128 v[104:107], v2 offset:34816
ds_read_b128 v[108:111], v2 offset:35840
s_waitcnt lgkmcnt(4)
v_mfma_f32_16x16x32_bf16 v[64:67], v[184:187], v[112:115], v[64:67]
v_mfma_f32_16x16x32_bf16 v[68:71], v[184:187], v[116:119], v[68:71]
v_mfma_f32_16x16x32_bf16 v[72:75], v[184:187], v[120:123], v[72:75]
v_mfma_f32_16x16x32_bf16 v[76:79], v[184:187], v[124:127], v[76:79]
v_mfma_f32_16x16x32_bf16 v[80:83], v[188:191], v[112:115], v[80:83]
v_mfma_f32_16x16x32_bf16 v[84:87], v[188:191], v[116:119], v[84:87]
v_mfma_f32_16x16x32_bf16 v[88:91], v[188:191], v[120:123], v[88:91]
v_mfma_f32_16x16x32_bf16 v[92:95], v[188:191], v[124:127], v[92:95]
s_add_u32 s23, s41, 19456
buffer_load_dwordx4 v[184:187], v1, s[8:11], s23 offen
s_add_u32 s23, s42, 19456
buffer_load_dwordx4 v[188:191], v1, s[8:11], s23 offen
ds_read_b128 v[112:115], v2 offset:36864
ds_read_b128 v[116:119], v2 offset:37888
ds_read_b128 v[120:123], v2 offset:38912
ds_read_b128 v[124:127], v2 offset:39936
s_waitcnt lgkmcnt(4)
v_mfma_f32_16x16x32_bf16 v[64:67], v[192:195], v[96:99], v[64:67]
v_mfma_f32_16x16x32_bf16 v[68:71], v[192:195], v[100:103], v[68:71]
v_mfma_f32_16x16x32_bf16 v[72:75], v[192:195], v[104:107], v[72:75]
v_mfma_f32_16x16x32_bf16 v[76:79], v[192:195], v[108:111], v[76:79]
v_mfma_f32_16x16x32_bf16 v[80:83], v[196:199], v[96:99], v[80:83]
v_mfma_f32_16x16x32_bf16 v[84:87], v[196:199], v[100:103], v[84:87]
v_mfma_f32_16x16x32_bf16 v[88:91], v[196:199], v[104:107], v[88:91]
v_mfma_f32_16x16x32_bf16 v[92:95], v[196:199], v[108:111], v[92:95]
s_add_u32 s23, s50, 16384
buffer_load_dwordx4 v[192:195], v1, s[8:11], s23 offen
s_add_u32 s23, s50, 17408
buffer_load_dwordx4 v[196:199], v1, s[8:11], s23 offen
ds_read_b128 v[96:99], v2 offset:40960
ds_read_b128 v[100:103], v2 offset:41984
ds_read_b128 v[104:107], v2 offset:43008
ds_read_b128 v[108:111], v2 offset:44032
s_waitcnt lgkmcnt(4)
v_mfma_f32_16x16x32_bf16 v[64:67], v[200:203], v[112:115], v[64:67]
v_mfma_f32_16x16x32_bf16 v[68:71], v[200:203], v[116:119], v[68:71]
v_mfma_f32_16x16x32_bf16 v[72:75], v[200:203], v[120:123], v[72:75]
v_mfma_f32_16x16x32_bf16 v[76:79], v[200:203], v[124:127], v[76:79]
v_mfma_f32_16x16x32_bf16 v[80:83], v[204:207], v[112:115], v[80:83]
v_mfma_f32_16x16x32_bf16 v[84:87], v[204:207], v[116:119], v[84:87]
v_mfma_f32_16x16x32_bf16 v[88:91], v[204:207], v[120:123], v[88:91]
v_mfma_f32_16x16x32_bf16 v[92:95], v[204:207], v[124:127], v[92:95]
s_add_u32 s23, s50, 18432
buffer_load_dwordx4 v[200:203], v1, s[8:11], s23 offen
s_add_u32 s23, s50, 19456
buffer_load_dwordx4 v[204:207], v1, s[8:11], s23 offen
ds_read_b128 v[112:115], v2 offset:45056
ds_read_b128 v[116:119], v2 offset:46080
ds_read_b128 v[120:123], v2 offset:47104
ds_read_b128 v[124:127], v2 offset:48128
s_waitcnt lgkmcnt(4)
v_mfma_f32_16x16x32_bf16 v[64:67], v[208:211], v[96:99], v[64:67]
v_mfma_f32_16x16x32_bf16 v[68:71], v[208:211], v[100:103], v[68:71]
v_mfma_f32_16x16x32_bf16 v[72:75], v[208:211], v[104:107], v[72:75]
v_mfma_f32_16x16x32_bf16 v[76:79], v[208:211], v[108:111], v[76:79]
v_mfma_f32_16x16x32_bf16 v[80:83], v[212:215], v[96:99], v[80:83]
v_mfma_f32_16x16x32_bf16 v[84:87], v[212:215], v[100:103], v[84:87]
v_mfma_f32_16x16x32_bf16 v[88:91], v[212:215], v[104:107], v[88:91]
v_mfma_f32_16x16x32_bf16 v[92:95], v[212:215], v[108:111], v[92:95]
s_add_u32 s23, s50, 20480
buffer_load_dwordx4 v[208:211], v1, s[8:11], s23 offen
s_add_u32 s23, s50, 21504
buffer_load_dwordx4 v[212:215], v1, s[8:11], s23 offen
s_waitcnt vmcnt(24)
s_barrier
ds_read_b128 v[96:99], v2 offset:49152
ds_read_b128 v[100:103], v2 offset:50176
ds_read_b128 v[104:107], v2 offset:51200
ds_read_b128 v[108:111], v2 offset:52224
s_waitcnt lgkmcnt(4)
v_mfma_f32_16x16x32_bf16 v[64:67], v[216:219], v[112:115], v[64:67]
v_mfma_f32_16x16x32_bf16 v[68:71], v[216:219], v[116:119], v[68:71]
v_mfma_f32_16x16x32_bf16 v[72:75], v[216:219], v[120:123], v[72:75]
v_mfma_f32_16x16x32_bf16 v[76:79], v[216:219], v[124:127], v[76:79]
v_mfma_f32_16x16x32_bf16 v[80:83], v[220:223], v[112:115], v[80:83]
v_mfma_f32_16x16x32_bf16 v[84:87], v[220:223], v[116:119], v[84:87]
v_mfma_f32_16x16x32_bf16 v[88:91], v[220:223], v[120:123], v[88:91]
v_mfma_f32_16x16x32_bf16 v[92:95], v[220:223], v[124:127], v[92:95]
s_add_u32 s23, s50, 22528
buffer_load_dwordx4 v[216:219], v1, s[8:11], s23 offen
s_add_u32 s23, s50, 23552
buffer_load_dwordx4 v[220:223], v1, s[8:11], s23 offen
ds_read_b128 v[112:115], v2 offset:53248
ds_read_b128 v[116:119], v2 offset:54272
ds_read_b128 v[120:123], v2 offset:55296
ds_read_b128 v[124:127], v2 offset:56320
s_waitcnt vmcnt(22)
s_waitcnt lgkmcnt(4)
v_mfma_f32_16x16x32_bf16 v[64:67], v[128:131], v[96:99], v[64:67]
v_mfma_f32_16x16x32_bf16 v[68:71], v[128:131], v[100:103], v[68:71]
v_mfma_f32_16x16x32_bf16 v[72:75], v[128:131], v[104:107], v[72:75]
v_mfma_f32_16x16x32_bf16 v[76:79], v[128:131], v[108:111], v[76:79]
v_mfma_f32_16x16x32_bf16 v[80:83], v[132:135], v[96:99], v[80:83]
v_mfma_f32_16x16x32_bf16 v[84:87], v[132:135], v[100:103], v[84:87]
v_mfma_f32_16x16x32_bf16 v[88:91], v[132:135], v[104:107], v[88:91]
v_mfma_f32_16x16x32_bf16 v[92:95], v[132:135], v[108:111], v[92:95]
s_add_u32 s23, s50, 0
buffer_load_dwordx4 v[128:131], v1, s[8:11], s23 offen
s_add_u32 s23, s50, 1024
buffer_load_dwordx4 v[132:135], v1, s[8:11], s23 offen
ds_read_b128 v[96:99], v2 offset:57344
ds_read_b128 v[100:103], v2 offset:58368
ds_read_b128 v[104:107], v2 offset:59392
ds_read_b128 v[108:111], v2 offset:60416
s_waitcnt vmcnt(22)
s_waitcnt lgkmcnt(4)
v_mfma_f32_16x16x32_bf16 v[64:67], v[136:139], v[112:115], v[64:67]
v_mfma_f32_16x16x32_bf16 v[68:71], v[136:139], v[116:119], v[68:71]
v_mfma_f32_16x16x32_bf16 v[72:75], v[136:139], v[120:123], v[72:75]
v_mfma_f32_16x16x32_bf16 v[76:79], v[136:139], v[124:127], v[76:79]
v_mfma_f32_16x16x32_bf16 v[80:83], v[140:143], v[112:115], v[80:83]
v_mfma_f32_16x16x32_bf16 v[84:87], v[140:143], v[116:119], v[84:87]
v_mfma_f32_16x16x32_bf16 v[88:91], v[140:143], v[120:123], v[88:91]
v_mfma_f32_16x16x32_bf16 v[92:95], v[140:143], v[124:127], v[92:95]
s_add_u32 s23, s50, 2048
buffer_load_dwordx4 v[136:139], v1, s[8:11], s23 offen
s_add_u32 s23, s50, 3072
buffer_load_dwordx4 v[140:143], v1, s[8:11], s23 offen
ds_read_b128 v[112:115], v2 offset:61440
ds_read_b128 v[116:119], v2 offset:62464
ds_read_b128 v[120:123], v2 offset:63488
ds_read_b128 v[124:127], v2 offset:64512
s_waitcnt vmcnt(22)
s_waitcnt lgkmcnt(4)
v_mfma_f32_16x16x32_bf16 v[64:67], v[144:147], v[96:99], v[64:67]
v_mfma_f32_16x16x32_bf16 v[68:71], v[144:147], v[100:103], v[68:71]
v_mfma_f32_16x16x32_bf16 v[72:75], v[144:147], v[104:107], v[72:75]
v_mfma_f32_16x16x32_bf16 v[76:79], v[144:147], v[108:111], v[76:79]
v_mfma_f32_16x16x32_bf16 v[80:83], v[148:151], v[96:99], v[80:83]
v_mfma_f32_16x16x32_bf16 v[84:87], v[148:151], v[100:103], v[84:87]
v_mfma_f32_16x16x32_bf16 v[88:91], v[148:151], v[104:107], v[88:91]
v_mfma_f32_16x16x32_bf16 v[92:95], v[148:151], v[108:111], v[92:95]
s_add_u32 s23, s50, 4096
buffer_load_dwordx4 v[144:147], v1, s[8:11], s23 offen
s_add_u32 s23, s50, 5120
buffer_load_dwordx4 v[148:151], v1, s[8:11], s23 offen
s_waitcnt vmcnt(30)
s_barrier
s_lshl_b32 s24, s38, 6
s_add_u32 s24, s24, 138752
v_lshlrev_b32 v48, 4, v5
buffer_load_dwordx4 v[248:251], v48, s[8:11], s24 offen
s_lshl_b32 s24, s39, 6
s_add_u32 s24, s24, 138752
v_lshlrev_b32 v48, 4, v5
buffer_load_dwordx4 v[252:255], v48, s[8:11], s24 offen
ds_read_b128 v[96:99], v3 offset:0
ds_read_b128 v[100:103], v3 offset:1024
ds_read_b128 v[104:107], v3 offset:2048
ds_read_b128 v[108:111], v3 offset:3072
s_waitcnt vmcnt(24)
s_waitcnt lgkmcnt(4)
v_mfma_f32_16x16x32_bf16 v[64:67], v[152:155], v[112:115], v[64:67]
v_mfma_f32_16x16x32_bf16 v[68:71], v[152:155], v[116:119], v[68:71]
v_mfma_f32_16x16x32_bf16 v[72:75], v[152:155], v[120:123], v[72:75]
v_mfma_f32_16x16x32_bf16 v[76:79], v[152:155], v[124:127], v[76:79]
v_mfma_f32_16x16x32_bf16 v[80:83], v[156:159], v[112:115], v[80:83]
v_mfma_f32_16x16x32_bf16 v[84:87], v[156:159], v[116:119], v[84:87]
v_mfma_f32_16x16x32_bf16 v[88:91], v[156:159], v[120:123], v[88:91]
v_mfma_f32_16x16x32_bf16 v[92:95], v[156:159], v[124:127], v[92:95]
s_add_u32 s23, s50, 6144
buffer_load_dwordx4 v[152:155], v1, s[8:11], s23 offen
s_add_u32 s23, s50, 7168
buffer_load_dwordx4 v[156:159], v1, s[8:11], s23 offen
ds_read_b128 v[112:115], v3 offset:4096
ds_read_b128 v[116:119], v3 offset:5120
ds_read_b128 v[120:123], v3 offset:6144
ds_read_b128 v[124:127], v3 offset:7168
s_waitcnt vmcnt(24)
s_waitcnt lgkmcnt(4)
v_mfma_f32_16x16x32_bf16 v[64:67], v[160:163], v[96:99], v[64:67]
v_mfma_f32_16x16x32_bf16 v[68:71], v[160:163], v[100:103], v[68:71]
v_mfma_f32_16x16x32_bf16 v[72:75], v[160:163], v[104:107], v[72:75]
v_mfma_f32_16x16x32_bf16 v[76:79], v[160:163], v[108:111], v[76:79]
v_mfma_f32_16x16x32_bf16 v[80:83], v[164:167], v[96:99], v[80:83]
v_mfma_f32_16x16x32_bf16 v[84:87], v[164:167], v[100:103], v[84:87]
v_mfma_f32_16x16x32_bf16 v[88:91], v[164:167], v[104:107], v[88:91]
v_mfma_f32_16x16x32_bf16 v[92:95], v[164:167], v[108:111], v[92:95]
s_add_u32 s23, s50, 8192
buffer_load_dwordx4 v[160:163], v1, s[8:11], s23 offen
s_add_u32 s23, s50, 9216
buffer_load_dwordx4 v[164:167], v1, s[8:11], s23 offen
ds_read_b128 v[96:99], v3 offset:8192
ds_read_b128 v[100:103], v3 offset:9216
ds_read_b128 v[104:107], v3 offset:10240
ds_read_b128 v[108:111], v3 offset:11264
s_waitcnt vmcnt(24)
s_waitcnt lgkmcnt(4)
v_mfma_f32_16x16x32_bf16 v[64:67], v[168:171], v[112:115], v[64:67]
v_mfma_f32_16x16x32_bf16 v[68:71], v[168:171], v[116:119], v[68:71]
v_mfma_f32_16x16x32_bf16 v[72:75], v[168:171], v[120:123], v[72:75]
v_mfma_f32_16x16x32_bf16 v[76:79], v[168:171], v[124:127], v[76:79]
v_mfma_f32_16x16x32_bf16 v[80:83], v[172:175], v[112:115], v[80:83]
v_mfma_f32_16x16x32_bf16 v[84:87], v[172:175], v[116:119], v[84:87]
v_mfma_f32_16x16x32_bf16 v[88:91], v[172:175], v[120:123], v[88:91]
v_mfma_f32_16x16x32_bf16 v[92:95], v[172:175], v[124:127], v[92:95]
s_add_u32 s23, s50, 10240
buffer_load_dwordx4 v[168:171], v1, s[8:11], s23 offen
s_add_u32 s23, s50, 11264
buffer_load_dwordx4 v[172:175], v1, s[8:11], s23 offen
ds_read_b128 v[112:115], v3 offset:12288
ds_read_b128 v[116:119], v3 offset:13312
ds_read_b128 v[120:123], v3 offset:14336
ds_read_b128 v[124:127], v3 offset:15360
s_waitcnt vmcnt(24)
s_waitcnt lgkmcnt(4)
v_mfma_f32_16x16x32_bf16 v[64:67], v[176:179], v[96:99], v[64:67]
v_mfma_f32_16x16x32_bf16 v[68:71], v[176:179], v[100:103], v[68:71]
v_mfma_f32_16x16x32_bf16 v[72:75], v[176:179], v[104:107], v[72:75]
v_mfma_f32_16x16x32_bf16 v[76:79], v[176:179], v[108:111], v[76:79]
v_mfma_f32_16x16x32_bf16 v[80:83], v[180:183], v[96:99], v[80:83]
v_mfma_f32_16x16x32_bf16 v[84:87], v[180:183], v[100:103], v[84:87]
v_mfma_f32_16x16x32_bf16 v[88:91], v[180:183], v[104:107], v[88:91]
v_mfma_f32_16x16x32_bf16 v[92:95], v[180:183], v[108:111], v[92:95]
s_add_u32 s23, s50, 12288
buffer_load_dwordx4 v[176:179], v1, s[8:11], s23 offen
s_add_u32 s23, s50, 13312
buffer_load_dwordx4 v[180:183], v1, s[8:11], s23 offen
s_waitcnt vmcnt(24)
s_waitcnt lgkmcnt(0)
v_mfma_f32_16x16x32_bf16 v[64:67], v[184:187], v[112:115], v[64:67]
v_mfma_f32_16x16x32_bf16 v[68:71], v[184:187], v[116:119], v[68:71]
v_mfma_f32_16x16x32_bf16 v[72:75], v[184:187], v[120:123], v[72:75]
v_mfma_f32_16x16x32_bf16 v[76:79], v[184:187], v[124:127], v[76:79]
v_mfma_f32_16x16x32_bf16 v[80:83], v[188:191], v[112:115], v[80:83]
v_mfma_f32_16x16x32_bf16 v[84:87], v[188:191], v[116:119], v[84:87]
v_mfma_f32_16x16x32_bf16 v[88:91], v[188:191], v[120:123], v[88:91]
v_mfma_f32_16x16x32_bf16 v[92:95], v[188:191], v[124:127], v[92:95]
s_add_u32 s23, s50, 14336
buffer_load_dwordx4 v[184:187], v1, s[8:11], s23 offen
s_add_u32 s23, s50, 15360
buffer_load_dwordx4 v[188:191], v1, s[8:11], s23 offen
s_waitcnt vmcnt(10)
v_lshlrev_b32 v60, 3, v4
v_add_u32 v60, 132608, v60
ds_read_b64 v[224:225], v60 offset:0
ds_read_b64 v[226:227], v60 offset:128
ds_read_b64 v[228:229], v60 offset:256
ds_read_b64 v[230:231], v60 offset:384
s_waitcnt lgkmcnt(0)
s_lshr_b32 s24, s38, 1
s_lshl_b32 s24, s24, 10
s_and_b32 s25, s38, 1
s_lshl_b32 s25, s25, 3
s_add_u32 s24, s24, s25
s_mul_i32 s25, s16, 221184
s_add_u32 s24, s24, s25
s_add_u32 s34, s24, 0
s_add_u32 s34, s34, 3670016
v_mul_f32 v64, v64, v224
v_mul_f32 v65, v65, v224
v_mul_f32 v66, v66, v224
v_mul_f32 v67, v67, v224
v_fmac_f32 v64, v225, v248
v_fmac_f32 v65, v225, v249
v_fmac_f32 v66, v225, v250
v_fmac_f32 v67, v225, v251
v_mul_f32 v240, v64, v64
v_mul_f32 v241, v65, v65
v_mul_f32 v242, v66, v66
v_mul_f32 v243, v67, v67
v_fma_f32 v240, v240, s40, v63
v_fma_f32 v241, v241, s40, v63
v_fma_f32 v242, v242, s40, v63
v_fma_f32 v243, v243, s40, v63
v_mul_f32 v240, v240, v64
v_mul_f32 v241, v241, v65
v_mul_f32 v242, v242, v66
v_mul_f32 v243, v243, v67
v_exp_f32 v240, v240
v_exp_f32 v241, v241
v_exp_f32 v242, v242
v_exp_f32 v243, v243
v_add_f32 v240, 1.0, v240
v_add_f32 v241, 1.0, v241
v_add_f32 v242, 1.0, v242
v_add_f32 v243, 1.0, v243
v_rcp_f32 v240, v240
v_rcp_f32 v241, v241
v_rcp_f32 v242, v242
v_rcp_f32 v243, v243
v_mul_f32 v64, v64, v240
v_mul_f32 v65, v65, v241
v_mul_f32 v66, v66, v242
v_mul_f32 v67, v67, v243
v_cvt_pk_bf16_f32 v232, v64, v65
v_cvt_pk_bf16_f32 v233, v66, v67
buffer_store_dwordx2 v[232:233], v1, s[8:11], s34 offen
s_add_u32 s34, s34, 55296
v_mul_f32 v68, v68, v226
v_mul_f32 v69, v69, v226
v_mul_f32 v70, v70, v226
v_mul_f32 v71, v71, v226
v_fmac_f32 v68, v227, v248
v_fmac_f32 v69, v227, v249
v_fmac_f32 v70, v227, v250
v_fmac_f32 v71, v227, v251
v_mul_f32 v240, v68, v68
v_mul_f32 v241, v69, v69
v_mul_f32 v242, v70, v70
v_mul_f32 v243, v71, v71
v_fma_f32 v240, v240, s40, v63
v_fma_f32 v241, v241, s40, v63
v_fma_f32 v242, v242, s40, v63
v_fma_f32 v243, v243, s40, v63
v_mul_f32 v240, v240, v68
v_mul_f32 v241, v241, v69
v_mul_f32 v242, v242, v70
v_mul_f32 v243, v243, v71
v_exp_f32 v240, v240
v_exp_f32 v241, v241
v_exp_f32 v242, v242
v_exp_f32 v243, v243
v_add_f32 v240, 1.0, v240
v_add_f32 v241, 1.0, v241
v_add_f32 v242, 1.0, v242
v_add_f32 v243, 1.0, v243
v_rcp_f32 v240, v240
v_rcp_f32 v241, v241
v_rcp_f32 v242, v242
v_rcp_f32 v243, v243
v_mul_f32 v68, v68, v240
v_mul_f32 v69, v69, v241
v_mul_f32 v70, v70, v242
v_mul_f32 v71, v71, v243
v_cvt_pk_bf16_f32 v234, v68, v69
v_cvt_pk_bf16_f32 v235, v70, v71
buffer_store_dwordx2 v[234:235], v1, s[8:11], s34 offen
s_add_u32 s34, s34, 55296
v_mul_f32 v72, v72, v228
v_mul_f32 v73, v73, v228
v_mul_f32 v74, v74, v228
v_mul_f32 v75, v75, v228
v_fmac_f32 v72, v229, v248
v_fmac_f32 v73, v229, v249
v_fmac_f32 v74, v229, v250
v_fmac_f32 v75, v229, v251
v_mul_f32 v240, v72, v72
v_mul_f32 v241, v73, v73
v_mul_f32 v242, v74, v74
v_mul_f32 v243, v75, v75
v_fma_f32 v240, v240, s40, v63
v_fma_f32 v241, v241, s40, v63
v_fma_f32 v242, v242, s40, v63
v_fma_f32 v243, v243, s40, v63
v_mul_f32 v240, v240, v72
v_mul_f32 v241, v241, v73
v_mul_f32 v242, v242, v74
v_mul_f32 v243, v243, v75
v_exp_f32 v240, v240
v_exp_f32 v241, v241
v_exp_f32 v242, v242
v_exp_f32 v243, v243
v_add_f32 v240, 1.0, v240
v_add_f32 v241, 1.0, v241
v_add_f32 v242, 1.0, v242
v_add_f32 v243, 1.0, v243
v_rcp_f32 v240, v240
v_rcp_f32 v241, v241
v_rcp_f32 v242, v242
v_rcp_f32 v243, v243
v_mul_f32 v72, v72, v240
v_mul_f32 v73, v73, v241
v_mul_f32 v74, v74, v242
v_mul_f32 v75, v75, v243
v_cvt_pk_bf16_f32 v236, v72, v73
v_cvt_pk_bf16_f32 v237, v74, v75
buffer_store_dwordx2 v[236:237], v1, s[8:11], s34 offen
s_add_u32 s34, s34, 55296
v_mul_f32 v76, v76, v230
v_mul_f32 v77, v77, v230
v_mul_f32 v78, v78, v230
v_mul_f32 v79, v79, v230
v_fmac_f32 v76, v231, v248
v_fmac_f32 v77, v231, v249
v_fmac_f32 v78, v231, v250
v_fmac_f32 v79, v231, v251
v_mul_f32 v240, v76, v76
v_mul_f32 v241, v77, v77
v_mul_f32 v242, v78, v78
v_mul_f32 v243, v79, v79
v_fma_f32 v240, v240, s40, v63
v_fma_f32 v241, v241, s40, v63
v_fma_f32 v242, v242, s40, v63
v_fma_f32 v243, v243, s40, v63
v_mul_f32 v240, v240, v76
v_mul_f32 v241, v241, v77
v_mul_f32 v242, v242, v78
v_mul_f32 v243, v243, v79
v_exp_f32 v240, v240
v_exp_f32 v241, v241
v_exp_f32 v242, v242
v_exp_f32 v243, v243
v_add_f32 v240, 1.0, v240
v_add_f32 v241, 1.0, v241
v_add_f32 v242, 1.0, v242
v_add_f32 v243, 1.0, v243
v_rcp_f32 v240, v240
v_rcp_f32 v241, v241
v_rcp_f32 v242, v242
v_rcp_f32 v243, v243
v_mul_f32 v76, v76, v240
v_mul_f32 v77, v77, v241
v_mul_f32 v78, v78, v242
v_mul_f32 v79, v79, v243
v_cvt_pk_bf16_f32 v238, v76, v77
v_cvt_pk_bf16_f32 v239, v78, v79
buffer_store_dwordx2 v[238:239], v1, s[8:11], s34 offen
s_add_u32 s34, s34, 55296
s_lshr_b32 s24, s39, 1
s_lshl_b32 s24, s24, 10
s_and_b32 s25, s39, 1
s_lshl_b32 s25, s25, 3
s_add_u32 s24, s24, s25
s_mul_i32 s25, s16, 221184
s_add_u32 s24, s24, s25
s_add_u32 s34, s24, 0
s_add_u32 s34, s34, 3670016
v_mul_f32 v80, v80, v224
v_mul_f32 v81, v81, v224
v_mul_f32 v82, v82, v224
v_mul_f32 v83, v83, v224
v_fmac_f32 v80, v225, v252
v_fmac_f32 v81, v225, v253
v_fmac_f32 v82, v225, v254
v_fmac_f32 v83, v225, v255
v_mul_f32 v240, v80, v80
v_mul_f32 v241, v81, v81
v_mul_f32 v242, v82, v82
v_mul_f32 v243, v83, v83
v_fma_f32 v240, v240, s40, v63
v_fma_f32 v241, v241, s40, v63
v_fma_f32 v242, v242, s40, v63
v_fma_f32 v243, v243, s40, v63
v_mul_f32 v240, v240, v80
v_mul_f32 v241, v241, v81
v_mul_f32 v242, v242, v82
v_mul_f32 v243, v243, v83
v_exp_f32 v240, v240
v_exp_f32 v241, v241
v_exp_f32 v242, v242
v_exp_f32 v243, v243
v_add_f32 v240, 1.0, v240
v_add_f32 v241, 1.0, v241
v_add_f32 v242, 1.0, v242
v_add_f32 v243, 1.0, v243
v_rcp_f32 v240, v240
v_rcp_f32 v241, v241
v_rcp_f32 v242, v242
v_rcp_f32 v243, v243
v_mul_f32 v80, v80, v240
v_mul_f32 v81, v81, v241
v_mul_f32 v82, v82, v242
v_mul_f32 v83, v83, v243
v_cvt_pk_bf16_f32 v232, v80, v81
v_cvt_pk_bf16_f32 v233, v82, v83
buffer_store_dwordx2 v[232:233], v1, s[8:11], s34 offen
s_add_u32 s34, s34, 55296
v_mul_f32 v84, v84, v226
v_mul_f32 v85, v85, v226
v_mul_f32 v86, v86, v226
v_mul_f32 v87, v87, v226
v_fmac_f32 v84, v227, v252
v_fmac_f32 v85, v227, v253
v_fmac_f32 v86, v227, v254
v_fmac_f32 v87, v227, v255
v_mul_f32 v240, v84, v84
v_mul_f32 v241, v85, v85
v_mul_f32 v242, v86, v86
v_mul_f32 v243, v87, v87
v_fma_f32 v240, v240, s40, v63
v_fma_f32 v241, v241, s40, v63
v_fma_f32 v242, v242, s40, v63
v_fma_f32 v243, v243, s40, v63
v_mul_f32 v240, v240, v84
v_mul_f32 v241, v241, v85
v_mul_f32 v242, v242, v86
v_mul_f32 v243, v243, v87
v_exp_f32 v240, v240
v_exp_f32 v241, v241
v_exp_f32 v242, v242
v_exp_f32 v243, v243
v_add_f32 v240, 1.0, v240
v_add_f32 v241, 1.0, v241
v_add_f32 v242, 1.0, v242
v_add_f32 v243, 1.0, v243
v_rcp_f32 v240, v240
v_rcp_f32 v241, v241
v_rcp_f32 v242, v242
v_rcp_f32 v243, v243
v_mul_f32 v84, v84, v240
v_mul_f32 v85, v85, v241
v_mul_f32 v86, v86, v242
v_mul_f32 v87, v87, v243
v_cvt_pk_bf16_f32 v234, v84, v85
v_cvt_pk_bf16_f32 v235, v86, v87
buffer_store_dwordx2 v[234:235], v1, s[8:11], s34 offen
s_add_u32 s34, s34, 55296
v_mul_f32 v88, v88, v228
v_mul_f32 v89, v89, v228
v_mul_f32 v90, v90, v228
v_mul_f32 v91, v91, v228
v_fmac_f32 v88, v229, v252
v_fmac_f32 v89, v229, v253
v_fmac_f32 v90, v229, v254
v_fmac_f32 v91, v229, v255
v_mul_f32 v240, v88, v88
v_mul_f32 v241, v89, v89
v_mul_f32 v242, v90, v90
v_mul_f32 v243, v91, v91
v_fma_f32 v240, v240, s40, v63
v_fma_f32 v241, v241, s40, v63
v_fma_f32 v242, v242, s40, v63
v_fma_f32 v243, v243, s40, v63
v_mul_f32 v240, v240, v88
v_mul_f32 v241, v241, v89
v_mul_f32 v242, v242, v90
v_mul_f32 v243, v243, v91
v_exp_f32 v240, v240
v_exp_f32 v241, v241
v_exp_f32 v242, v242
v_exp_f32 v243, v243
v_add_f32 v240, 1.0, v240
v_add_f32 v241, 1.0, v241
v_add_f32 v242, 1.0, v242
v_add_f32 v243, 1.0, v243
v_rcp_f32 v240, v240
v_rcp_f32 v241, v241
v_rcp_f32 v242, v242
v_rcp_f32 v243, v243
v_mul_f32 v88, v88, v240
v_mul_f32 v89, v89, v241
v_mul_f32 v90, v90, v242
v_mul_f32 v91, v91, v243
v_cvt_pk_bf16_f32 v236, v88, v89
v_cvt_pk_bf16_f32 v237, v90, v91
buffer_store_dwordx2 v[236:237], v1, s[8:11], s34 offen
s_add_u32 s34, s34, 55296
v_mul_f32 v92, v92, v230
v_mul_f32 v93, v93, v230
v_mul_f32 v94, v94, v230
v_mul_f32 v95, v95, v230
v_fmac_f32 v92, v231, v252
v_fmac_f32 v93, v231, v253
v_fmac_f32 v94, v231, v254
v_fmac_f32 v95, v231, v255
v_mul_f32 v240, v92, v92
v_mul_f32 v241, v93, v93
v_mul_f32 v242, v94, v94
v_mul_f32 v243, v95, v95
v_fma_f32 v240, v240, s40, v63
v_fma_f32 v241, v241, s40, v63
v_fma_f32 v242, v242, s40, v63
v_fma_f32 v243, v243, s40, v63
v_mul_f32 v240, v240, v92
v_mul_f32 v241, v241, v93
v_mul_f32 v242, v242, v94
v_mul_f32 v243, v243, v95
v_exp_f32 v240, v240
v_exp_f32 v241, v241
v_exp_f32 v242, v242
v_exp_f32 v243, v243
v_add_f32 v240, 1.0, v240
v_add_f32 v241, 1.0, v241
v_add_f32 v242, 1.0, v242
v_add_f32 v243, 1.0, v243
v_rcp_f32 v240, v240
v_rcp_f32 v241, v241
v_rcp_f32 v242, v242
v_rcp_f32 v243, v243
v_mul_f32 v92, v92, v240
v_mul_f32 v93, v93, v241
v_mul_f32 v94, v94, v242
v_mul_f32 v95, v95, v243
v_cvt_pk_bf16_f32 v238, v92, v93
v_cvt_pk_bf16_f32 v239, v94, v95
buffer_store_dwordx2 v[238:239], v1, s[8:11], s34 offen
s_add_u32 s34, s34, 55296
s_add_u32 s35, s35, 1024
s_add_u32 s36, s36, 1024
s_waitcnt vmcnt(0)
s_barrier
s_cmp_lg_u32 s18, 0
s_cbranch_scc1 L_39
v_mov_b32 v46, 0
v_mov_b32 v47, 1
buffer_store_dword v47, v46, s[8:11], s36 offen
L_39:
s_and_b32 s24, s18, 3
s_lshl_b32 s24, s24, 4
s_add_u32 s24, s24, s19
v_add_u32 v46, s24, v4
v_lshrrev_b32 v47, 4, v46
v_mul_u32_u24 v47, 55296, v47
v_and_b32 v46, 15, v46
v_lshlrev_b32 v46, 4, v46
v_add_u32 v47, v47, v46
v_lshlrev_b32 v46, 8, v5
v_add_u32 v42, v47, v46
s_lshr_b32 s24, s18, 2
s_lshl_b32 s24, s24, 10
s_add_u32 s28, s24, 3670016
v_lshrrev_b32 v46, 2, v1
v_min_u32 v46, 28, v46
s_mov_b32 s30, 40000
L_40:
buffer_load_dword v47, v46, s[8:11], s35 offen sc1
s_waitcnt vmcnt(0)
v_cmp_ne_u32 vcc, 1, v47
s_nop 4
s_cbranch_vccz L_41
s_sub_u32 s30, s30, 1
s_cmp_lg_u32 s30, 0
s_cbranch_scc1 L_40
L_41:
s_add_u32 m0, s21, 0
s_add_u32 s22, s28, 0
buffer_load_dwordx4 v42, s[8:11], s22 offen  lds
s_add_u32 m0, s21, 8192
s_add_u32 s22, s28, 2048
buffer_load_dwordx4 v42, s[8:11], s22 offen  lds
s_add_u32 m0, s21, 16384
s_add_u32 s22, s28, 4096
buffer_load_dwordx4 v42, s[8:11], s22 offen  lds
s_add_u32 m0, s21, 24576
s_add_u32 s22, s28, 6144
buffer_load_dwordx4 v42, s[8:11], s22 offen  lds
s_add_u32 m0, s21, 32768
s_add_u32 s22, s28, 8192
buffer_load_dwordx4 v42, s[8:11], s22 offen  lds
s_add_u32 m0, s21, 40960
s_add_u32 s22, s28, 10240
buffer_load_dwordx4 v42, s[8:11], s22 offen  lds
s_add_u32 m0, s21, 49152
s_add_u32 s22, s28, 12288
buffer_load_dwordx4 v42, s[8:11], s22 offen  lds
s_add_u32 m0, s21, 57344
s_add_u32 s22, s28, 14336
buffer_load_dwordx4 v42, s[8:11], s22 offen  lds
s_add_u32 m0, s21, 65536
s_add_u32 s22, s28, 16384
buffer_load_dwordx4 v42, s[8:11], s22 offen  lds
s_add_u32 m0, s21, 73728
s_add_u32 s22, s28, 18432
buffer_load_dwordx4 v42, s[8:11], s22 offen  lds
s_add_u32 m0, s21, 81920
s_add_u32 s22, s28, 20480
buffer_load_dwordx4 v42, s[8:11], s22 offen  lds
s_add_u32 m0, s21, 90112
s_add_u32 s22, s28, 22528
buffer_load_dwordx4 v42, s[8:11], s22 offen  lds
s_add_u32 m0, s21, 98304
s_add_u32 s22, s28, 24576
buffer_load_dwordx4 v42, s[8:11], s22 offen  lds
s_add_u32 m0, s21, 106496
s_add_u32 s22, s28, 26624
buffer_load_dwordx4 v42, s[8:11], s22 offen  lds
s_add_u32 m0, s21, 114688
s_add_u32 s22, s28, 28672
buffer_load_dwordx4 v42, s[8:11], s22 offen  lds
s_add_u32 m0, s21, 122880
s_add_u32 s22, s28, 30720
buffer_load_dwordx4 v42, s[8:11], s22 offen  lds
v_mov_b32 v64, 0
v_mov_b32 v65, 0
v_mov_b32 v66, 0
v_mov_b32 v67, 0
v_mov_b32 v68, 0
v_mov_b32 v69, 0
v_mov_b32 v70, 0
v_mov_b32 v71, 0
v_mov_b32 v72, 0
v_mov_b32 v73, 0
v_mov_b32 v74, 0
v_mov_b32 v75, 0
v_mov_b32 v76, 0
v_mov_b32 v77, 0
v_mov_b32 v78, 0
v_mov_b32 v79, 0
s_waitcnt vmcnt(14)
s_barrier
ds_read_b128 v[96:99], v2 offset:0
ds_read_b128 v[100:103], v2 offset:1024
ds_read_b128 v[104:107], v2 offset:2048
ds_read_b128 v[108:111], v2 offset:3072
ds_read_b128 v[112:115], v2 offset:4096
ds_read_b128 v[116:119], v2 offset:5120
ds_read_b128 v[120:123], v2 offset:6144
ds_read_b128 v[124:127], v2 offset:7168
s_waitcnt lgkmcnt(4)
v_mfma_f32_16x16x32_bf16 v[64:67], v[128:131], v[96:99], v[64:67]
v_mfma_f32_16x16x32_bf16 v[68:71], v[128:131], v[100:103], v[68:71]
v_mfma_f32_16x16x32_bf16 v[72:75], v[128:131], v[104:107], v[72:75]
v_mfma_f32_16x16x32_bf16 v[76:79], v[128:131], v[108:111], v[76:79]
s_add_u32 s23, s50, 24576
buffer_load_dwordx4 v[128:131], v1, s[8:11], s23 offen
ds_read_b128 v[96:99], v2 offset:8192
ds_read_b128 v[100:103], v2 offset:9216
ds_read_b128 v[104:107], v2 offset:10240
ds_read_b128 v[108:111], v2 offset:11264
s_waitcnt lgkmcnt(4)
v_mfma_f32_16x16x32_bf16 v[64:67], v[132:135], v[112:115], v[64:67]
v_mfma_f32_16x16x32_bf16 v[68:71], v[132:135], v[116:119], v[68:71]
v_mfma_f32_16x16x32_bf16 v[72:75], v[132:135], v[120:123], v[72:75]
v_mfma_f32_16x16x32_bf16 v[76:79], v[132:135], v[124:127], v[76:79]
s_add_u32 s23, s50, 25600
buffer_load_dwordx4 v[132:135], v1, s[8:11], s23 offen
ds_read_b128 v[112:115], v2 offset:12288
ds_read_b128 v[116:119], v2 offset:13312
ds_read_b128 v[120:123], v2 offset:14336
ds_read_b128 v[124:127], v2 offset:15360
s_waitcnt lgkmcnt(4)
v_mfma_f32_16x16x32_bf16 v[64:67], v[136:139], v[96:99], v[64:67]
v_mfma_f32_16x16x32_bf16 v[68:71], v[136:139], v[100:103], v[68:71]
v_mfma_f32_16x16x32_bf16 v[72:75], v[136:139], v[104:107], v[72:75]
v_mfma_f32_16x16x32_bf16 v[76:79], v[136:139], v[108:111], v[76:79]
s_add_u32 s23, s50, 26624
buffer_load_dwordx4 v[136:139], v1, s[8:11], s23 offen
s_waitcnt vmcnt(15)
s_barrier
ds_read_b128 v[96:99], v2 offset:16384
ds_read_b128 v[100:103], v2 offset:17408
ds_read_b128 v[104:107], v2 offset:18432
ds_read_b128 v[108:111], v2 offset:19456
s_waitcnt lgkmcnt(4)
v_mfma_f32_16x16x32_bf16 v[64:67], v[140:143], v[112:115], v[64:67]
v_mfma_f32_16x16x32_bf16 v[68:71], v[140:143], v[116:119], v[68:71]
v_mfma_f32_16x16x32_bf16 v[72:75], v[140:143], v[120:123], v[72:75]
v_mfma_f32_16x16x32_bf16 v[76:79], v[140:143], v[124:127], v[76:79]
s_add_u32 s23, s50, 27648
buffer_load_dwordx4 v[140:143], v1, s[8:11], s23 offen
ds_read_b128 v[112:115], v2 offset:20480
ds_read_b128 v[116:119], v2 offset:21504
ds_read_b128 v[120:123], v2 offset:22528
ds_read_b128 v[124:127], v2 offset:23552
s_waitcnt lgkmcnt(4)
v_mfma_f32_16x16x32_bf16 v[64:67], v[144:147], v[96:99], v[64:67]
v_mfma_f32_16x16x32_bf16 v[68:71], v[144:147], v[100:103], v[68:71]
v_mfma_f32_16x16x32_bf16 v[72:75], v[144:147], v[104:107], v[72:75]
v_mfma_f32_16x16x32_bf16 v[76:79], v[144:147], v[108:111], v[76:79]
s_add_u32 s23, s50, 28672
buffer_load_dwordx4 v[144:147], v1, s[8:11], s23 offen
ds_read_b128 v[96:99], v2 offset:24576
ds_read_b128 v[100:103], v2 offset:25600
ds_read_b128 v[104:107], v2 offset:26624
ds_read_b128 v[108:111], v2 offset:27648
s_waitcnt lgkmcnt(4)
v_mfma_f32_16x16x32_bf16 v[64:67], v[148:151], v[112:115], v[64:67]
v_mfma_f32_16x16x32_bf16 v[68:71], v[148:151], v[116:119], v[68:71]
v_mfma_f32_16x16x32_bf16 v[72:75], v[148:151], v[120:123], v[72:75]
v_mfma_f32_16x16x32_bf16 v[76:79], v[148:151], v[124:127], v[76:79]
s_add_u32 s23, s50, 29696
buffer_load_dwordx4 v[148:151], v1, s[8:11], s23 offen
ds_read_b128 v[112:115], v2 offset:28672
ds_read_b128 v[116:119], v2 offset:29696
ds_read_b128 v[120:123], v2 offset:30720
ds_read_b128 v[124:127], v2 offset:31744
s_waitcnt lgkmcnt(4)
v_mfma_f32_16x16x32_bf16 v[64:67], v[152:155], v[96:99], v[64:67]
v_mfma_f32_16x16x32_bf16 v[68:71], v[152:155], v[100:103], v[68:71]
v_mfma_f32_16x16x32_bf16 v[72:75], v[152:155], v[104:107], v[72:75]
v_mfma_f32_16x16x32_bf16 v[76:79], v[152:155], v[108:111], v[76:79]
s_add_u32 s23, s50, 30720
buffer_load_dwordx4 v[152:155], v1, s[8:11], s23 offen
s_waitcnt vmcnt(17)
s_barrier
s_add_u32 m0, s21, 0
s_add_u32 s22, s28, 32768
buffer_load_dwordx4 v42, s[8:11], s22 offen  lds
s_add_u32 m0, s21, 8192
s_add_u32 s22, s28, 34816
buffer_load_dwordx4 v42, s[8:11], s22 offen  lds
ds_read_b128 v[96:99], v2 offset:32768
ds_read_b128 v[100:103], v2 offset:33792
ds_read_b128 v[104:107], v2 offset:34816
ds_read_b128 v[108:111], v2 offset:35840
s_waitcnt lgkmcnt(4)
v_mfma_f32_16x16x32_bf16 v[64:67], v[156:159], v[112:115], v[64:67]
v_mfma_f32_16x16x32_bf16 v[68:71], v[156:159], v[116:119], v[68:71]
v_mfma_f32_16x16x32_bf16 v[72:75], v[156:159], v[120:123], v[72:75]
v_mfma_f32_16x16x32_bf16 v[76:79], v[156:159], v[124:127], v[76:79]
s_add_u32 s23, s50, 31744
buffer_load_dwordx4 v[156:159], v1, s[8:11], s23 offen
ds_read_b128 v[112:115], v2 offset:36864
ds_read_b128 v[116:119], v2 offset:37888
ds_read_b128 v[120:123], v2 offset:38912
ds_read_b128 v[124:127], v2 offset:39936
s_waitcnt lgkmcnt(4)
v_mfma_f32_16x16x32_bf16 v[64:67], v[160:163], v[96:99], v[64:67]
v_mfma_f32_16x16x32_bf16 v[68:71], v[160:163], v[100:103], v[68:71]
v_mfma_f32_16x16x32_bf16 v[72:75], v[160:163], v[104:107], v[72:75]
v_mfma_f32_16x16x32_bf16 v[76:79], v[160:163], v[108:111], v[76:79]
s_add_u32 s23, s50, 32768
buffer_load_dwordx4 v[160:163], v1, s[8:11], s23 offen
ds_read_b128 v[96:99], v2 offset:40960
ds_read_b128 v[100:103], v2 offset:41984
ds_read_b128 v[104:107], v2 offset:43008
ds_read_b128 v[108:111], v2 offset:44032
s_waitcnt lgkmcnt(4)
v_mfma_f32_16x16x32_bf16 v[64:67], v[164:167], v[112:115], v[64:67]
v_mfma_f32_16x16x32_bf16 v[68:71], v[164:167], v[116:119], v[68:71]
v_mfma_f32_16x16x32_bf16 v[72:75], v[164:167], v[120:123], v[72:75]
v_mfma_f32_16x16x32_bf16 v[76:79], v[164:167], v[124:127], v[76:79]
s_add_u32 s23, s50, 33792
buffer_load_dwordx4 v[164:167], v1, s[8:11], s23 offen
ds_read_b128 v[112:115], v2 offset:45056
ds_read_b128 v[116:119], v2 offset:46080
ds_read_b128 v[120:123], v2 offset:47104
ds_read_b128 v[124:127], v2 offset:48128
s_waitcnt lgkmcnt(4)
v_mfma_f32_16x16x32_bf16 v[64:67], v[168:171], v[96:99], v[64:67]
v_mfma_f32_16x16x32_bf16 v[68:71], v[168:171], v[100:103], v[68:71]
v_mfma_f32_16x16x32_bf16 v[72:75], v[168:171], v[104:107], v[72:75]
v_mfma_f32_16x16x32_bf16 v[76:79], v[168:171], v[108:111], v[76:79]
s_add_u32 s23, s50, 34816
buffer_load_dwordx4 v[168:171], v1, s[8:11], s23 offen
s_waitcnt vmcnt(21)
s_barrier
s_add_u32 m0, s21, 16384
s_add_u32 s22, s28, 36864
buffer_load_dwordx4 v42, s[8:11], s22 offen  lds
s_add_u32 m0, s21, 24576
s_add_u32 s22, s28, 38912
buffer_load_dwordx4 v42, s[8:11], s22 offen  lds
ds_read_b128 v[96:99], v2 offset:49152
ds_read_b128 v[100:103], v2 offset:50176
ds_read_b128 v[104:107], v2 offset:51200
ds_read_b128 v[108:111], v2 offset:52224
s_waitcnt lgkmcnt(4)
v_mfma_f32_16x16x32_bf16 v[64:67], v[172:175], v[112:115], v[64:67]
v_mfma_f32_16x16x32_bf16 v[68:71], v[172:175], v[116:119], v[68:71]
v_mfma_f32_16x16x32_bf16 v[72:75], v[172:175], v[120:123], v[72:75]
v_mfma_f32_16x16x32_bf16 v[76:79], v[172:175], v[124:127], v[76:79]
s_add_u32 s23, s50, 35840
buffer_load_dwordx4 v[172:175], v1, s[8:11], s23 offen
ds_read_b128 v[112:115], v2 offset:53248
ds_read_b128 v[116:119], v2 offset:54272
ds_read_b128 v[120:123], v2 offset:55296
ds_read_b128 v[124:127], v2 offset:56320
s_waitcnt lgkmcnt(4)
v_mfma_f32_16x16x32_bf16 v[64:67], v[176:179], v[96:99], v[64:67]
v_mfma_f32_16x16x32_bf16 v[68:71], v[176:179], v[100:103], v[68:71]
v_mfma_f32_16x16x32_bf16 v[72:75], v[176:179], v[104:107], v[72:75]
v_mfma_f32_16x16x32_bf16 v[76:79], v[176:179], v[108:111], v[76:79]
s_add_u32 s23, s50, 36864
buffer_load_dwordx4 v[176:179], v1, s[8:11], s23 offen
ds_read_b128 v[96:99], v2 offset:57344
ds_read_b128 v[100:103], v2 offset:58368
ds_read_b128 v[104:107], v2 offset:59392
ds_read_b128 v[108:111], v2 offset:60416
s_waitcnt lgkmcnt(4)
v_mfma_f32_16x16x32_bf16 v[64:67], v[180:183], v[112:115], v[64:67]
v_mfma_f32_16x16x32_bf16 v[68:71], v[180:183], v[116:119], v[68:71]
v_mfma_f32_16x16x32_bf16 v[72:75], v[180:183], v[120:123], v[72:75]
v_mfma_f32_16x16x32_bf16 v[76:79], v[180:183], v[124:127], v[76:79]
s_add_u32 s23, s50, 37888
buffer_load_dwordx4 v[180:183], v1, s[8:11], s23 offen
ds_read_b128 v[112:115], v2 offset:61440
ds_read_b128 v[116:119], v2 offset:62464
ds_read_b128 v[120:123], v2 offset:63488
ds_read_b128 v[124:127], v2 offset:64512
s_waitcnt lgkmcnt(4)
v_mfma_f32_16x16x32_bf16 v[64:67], v[184:187], v[96:99], v[64:67]
v_mfma_f32_16x16x32_bf16 v[68:71], v[184:187], v[100:103], v[68:71]
v_mfma_f32_16x16x32_bf16 v[72:75], v[184:187], v[104:107], v[72:75]
v_mfma_f32_16x16x32_bf16 v[76:79], v[184:187], v[108:111], v[76:79]
s_add_u32 s23, s50, 38912
buffer_load_dwordx4 v[184:187], v1, s[8:11], s23 offen
s_waitcnt vmcnt(25)
s_barrier
s_add_u32 m0, s21, 32768
s_add_u32 s22, s28, 40960
buffer_load_dwordx4 v42, s[8:11], s22 offen  lds
s_add_u32 m0, s21, 40960
s_add_u32 s22, s28, 43008
buffer_load_dwordx4 v42, s[8:11], s22 offen  lds
ds_read_b128 v[96:99], v3 offset:0
ds_read_b128 v[100:103], v3 offset:1024
ds_read_b128 v[104:107], v3 offset:2048
ds_read_b128 v[108:111], v3 offset:3072
s_waitcnt lgkmcnt(4)
v_mfma_f32_16x16x32_bf16 v[64:67], v[188:191], v[112:115], v[64:67]
v_mfma_f32_16x16x32_bf16 v[68:71], v[188:191], v[116:119], v[68:71]
v_mfma_f32_16x16x32_bf16 v[72:75], v[188:191], v[120:123], v[72:75]
v_mfma_f32_16x16x32_bf16 v[76:79], v[188:191], v[124:127], v[76:79]
s_add_u32 s23, s50, 39936
buffer_load_dwordx4 v[188:191], v1, s[8:11], s23 offen
ds_read_b128 v[112:115], v3 offset:4096
ds_read_b128 v[116:119], v3 offset:5120
ds_read_b128 v[120:123], v3 offset:6144
ds_read_b128 v[124:127], v3 offset:7168
s_waitcnt lgkmcnt(4)
v_mfma_f32_16x16x32_bf16 v[64:67], v[192:195], v[96:99], v[64:67]
v_mfma_f32_16x16x32_bf16 v[68:71], v[192:195], v[100:103], v[68:71]
v_mfma_f32_16x16x32_bf16 v[72:75], v[192:195], v[104:107], v[72:75]
v_mfma_f32_16x16x32_bf16 v[76:79], v[192:195], v[108:111], v[76:79]
s_add_u32 s23, s50, 40960
buffer_load_dwordx4 v[192:195], v1, s[8:11], s23 offen
ds_read_b128 v[96:99], v3 offset:8192
ds_read_b128 v[100:103], v3 offset:9216
ds_read_b128 v[104:107], v3 offset:10240
ds_read_b128 v[108:111], v3 offset:11264
s_waitcnt lgkmcnt(4)
v_mfma_f32_16x16x32_bf16 v[64:67], v[196:199], v[112:115], v[64:67]
v_mfma_f32_16x16x32_bf16 v[68:71], v[196:199], v[116:119], v[68:71]
v_mfma_f32_16x16x32_bf16 v[72:75], v[196:199], v[120:123], v[72:75]
v_mfma_f32_16x16x32_bf16 v[76:79], v[196:199], v[124:127], v[76:79]
s_add_u32 s23, s50, 41984
buffer_load_dwordx4 v[196:199], v1, s[8:11], s23 offen
ds_read_b128 v[112:115], v3 offset:12288
ds_read_b128 v[116:119], v3 offset:13312
ds_read_b128 v[120:123], v3 offset:14336
ds_read_b128 v[124:127], v3 offset:15360
s_waitcnt lgkmcnt(4)
v_mfma_f32_16x16x32_bf16 v[64:67], v[200:203], v[96:99], v[64:67]
v_mfma_f32_16x16x32_bf16 v[68:71], v[200:203], v[100:103], v[68:71]
v_mfma_f32_16x16x32_bf16 v[72:75], v[200:203], v[104:107], v[72:75]
v_mfma_f32_16x16x32_bf16 v[76:79], v[200:203], v[108:111], v[76:79]
s_add_u32 s23, s50, 43008
buffer_load_dwordx4 v[200:203], v1, s[8:11], s23 offen
s_waitcnt vmcnt(29)
s_barrier
s_add_u32 m0, s21, 49152
s_add_u32 s22, s28, 45056
buffer_load_dwordx4 v42, s[8:11], s22 offen  lds
s_add_u32 m0, s21, 57344
s_add_u32 s22, s28, 47104
buffer_load_dwordx4 v42, s[8:11], s22 offen  lds
ds_read_b128 v[96:99], v3 offset:16384
ds_read_b128 v[100:103], v3 offset:17408
ds_read_b128 v[104:107], v3 offset:18432
ds_read_b128 v[108:111], v3 offset:19456
s_waitcnt lgkmcnt(4)
v_mfma_f32_16x16x32_bf16 v[64:67], v[204:207], v[112:115], v[64:67]
v_mfma_f32_16x16x32_bf16 v[68:71], v[204:207], v[116:119], v[68:71]
v_mfma_f32_16x16x32_bf16 v[72:75], v[204:207], v[120:123], v[72:75]
v_mfma_f32_16x16x32_bf16 v[76:79], v[204:207], v[124:127], v[76:79]
s_add_u32 s23, s50, 44032
buffer_load_dwordx4 v[204:207], v1, s[8:11], s23 offen
ds_read_b128 v[112:115], v3 offset:20480
ds_read_b128 v[116:119], v3 offset:21504
ds_read_b128 v[120:123], v3 offset:22528
ds_read_b128 v[124:127], v3 offset:23552
s_waitcnt lgkmcnt(4)
v_mfma_f32_16x16x32_bf16 v[64:67], v[208:211], v[96:99], v[64:67]
v_mfma_f32_16x16x32_bf16 v[68:71], v[208:211], v[100:103], v[68:71]
v_mfma_f32_16x16x32_bf16 v[72:75], v[208:211], v[104:107], v[72:75]
v_mfma_f32_16x16x32_bf16 v[76:79], v[208:211], v[108:111], v[76:79]
s_add_u32 s23, s50, 45056
buffer_load_dwordx4 v[208:211], v1, s[8:11], s23 offen
ds_read_b128 v[96:99], v3 offset:24576
ds_read_b128 v[100:103], v3 offset:25600
ds_read_b128 v[104:107], v3 offset:26624
ds_read_b128 v[108:111], v3 offset:27648
s_waitcnt lgkmcnt(4)
v_mfma_f32_16x16x32_bf16 v[64:67], v[212:215], v[112:115], v[64:67]
v_mfma_f32_16x16x32_bf16 v[68:71], v[212:215], v[116:119], v[68:71]
v_mfma_f32_16x16x32_bf16 v[72:75], v[212:215], v[120:123], v[72:75]
v_mfma_f32_16x16x32_bf16 v[76:79], v[212:215], v[124:127], v[76:79]
s_add_u32 s23, s50, 46080
buffer_load_dwordx4 v[212:215], v1, s[8:11], s23 offen
ds_read_b128 v[112:115], v3 offset:28672
ds_read_b128 v[116:119], v3 offset:29696
ds_read_b128 v[120:123], v3 offset:30720
ds_read_b128 v[124:127], v3 offset:31744
s_waitcnt lgkmcnt(4)
v_mfma_f32_16x16x32_bf16 v[64:67], v[216:219], v[96:99], v[64:67]
v_mfma_f32_16x16x32_bf16 v[68:71], v[216:219], v[100:103], v[68:71]
v_mfma_f32_16x16x32_bf16 v[72:75], v[216:219], v[104:107], v[72:75]
v_mfma_f32_16x16x32_bf16 v[76:79], v[216:219], v[108:111], v[76:79]
s_add_u32 s23, s50, 47104
buffer_load_dwordx4 v[216:219], v1, s[8:11], s23 offen
s_waitcnt vmcnt(33)
s_barrier
s_add_u32 m0, s21, 65536
s_add_u32 s22, s28, 49152
buffer_load_dwordx4 v42, s[8:11], s22 offen  lds
s_add_u32 m0, s21, 73728
s_add_u32 s22, s28, 51200
buffer_load_dwordx4 v42, s[8:11], s22 offen  lds
ds_read_b128 v[96:99], v3 offset:32768
ds_read_b128 v[100:103], v3 offset:33792
ds_read_b128 v[104:107], v3 offset:34816
ds_read_b128 v[108:111], v3 offset:35840
s_waitcnt lgkmcnt(4)
v_mfma_f32_16x16x32_bf16 v[64:67], v[220:223], v[112:115], v[64:67]
v_mfma_f32_16x16x32_bf16 v[68:71], v[220:223], v[116:119], v[68:71]
v_mfma_f32_16x16x32_bf16 v[72:75], v[220:223], v[120:123], v[72:75]
v_mfma_f32_16x16x32_bf16 v[76:79], v[220:223], v[124:127], v[76:79]
s_add_u32 s23, s50, 48128
buffer_load_dwordx4 v[220:223], v1, s[8:11], s23 offen
ds_read_b128 v[112:115], v3 offset:36864
ds_read_b128 v[116:119], v3 offset:37888
ds_read_b128 v[120:123], v3 offset:38912
ds_read_b128 v[124:127], v3 offset:39936
s_waitcnt vmcnt(33)
s_waitcnt lgkmcnt(4)
v_mfma_f32_16x16x32_bf16 v[64:67], v[128:131], v[96:99], v[64:67]
v_mfma_f32_16x16x32_bf16 v[68:71], v[128:131], v[100:103], v[68:71]
v_mfma_f32_16x16x32_bf16 v[72:75], v[128:131], v[104:107], v[72:75]
v_mfma_f32_16x16x32_bf16 v[76:79], v[128:131], v[108:111], v[76:79]
s_add_u32 s23, s50, 49152
buffer_load_dwordx4 v[128:131], v1, s[8:11], s23 offen
ds_read_b128 v[96:99], v3 offset:40960
ds_read_b128 v[100:103], v3 offset:41984
ds_read_b128 v[104:107], v3 offset:43008
ds_read_b128 v[108:111], v3 offset:44032
s_waitcnt vmcnt(33)
s_waitcnt lgkmcnt(4)
v_mfma_f32_16x16x32_bf16 v[64:67], v[132:135], v[112:115], v[64:67]
v_mfma_f32_16x16x32_bf16 v[68:71], v[132:135], v[116:119], v[68:71]
v_mfma_f32_16x16x32_bf16 v[72:75], v[132:135], v[120:123], v[72:75]
v_mfma_f32_16x16x32_bf16 v[76:79], v[132:135], v[124:127], v[76:79]
s_add_u32 s23, s50, 50176
buffer_load_dwordx4 v[132:135], v1, s[8:11], s23 offen
ds_read_b128 v[112:115], v3 offset:45056
ds_read_b128 v[116:119], v3 offset:46080
ds_read_b128 v[120:123], v3 offset:47104
ds_read_b128 v[124:127], v3 offset:48128
s_waitcnt vmcnt(33)
s_waitcnt lgkmcnt(4)
v_mfma_f32_16x16x32_bf16 v[64:67], v[136:139], v[96:99], v[64:67]
v_mfma_f32_16x16x32_bf16 v[68:71], v[136:139], v[100:103], v[68:71]
v_mfma_f32_16x16x32_bf16 v[72:75], v[136:139], v[104:107], v[72:75]
v_mfma_f32_16x16x32_bf16 v[76:79], v[136:139], v[108:111], v[76:79]
s_add_u32 s23, s50, 51200
buffer_load_dwordx4 v[136:139], v1, s[8:11], s23 offen
s_waitcnt vmcnt(37)
s_barrier
s_add_u32 m0, s21, 81920
s_add_u32 s22, s28, 53248
buffer_load_dwordx4 v42, s[8:11], s22 offen  lds
ds_read_b128 v[96:99], v3 offset:49152
ds_read_b128 v[100:103], v3 offset:50176
ds_read_b128 v[104:107], v3 offset:51200
ds_read_b128 v[108:111], v3 offset:52224
s_waitcnt vmcnt(34)
s_waitcnt lgkmcnt(4)
v_mfma_f32_16x16x32_bf16 v[64:67], v[140:143], v[112:115], v[64:67]
v_mfma_f32_16x16x32_bf16 v[68:71], v[140:143], v[116:119], v[68:71]
v_mfma_f32_16x16x32_bf16 v[72:75], v[140:143], v[120:123], v[72:75]
v_mfma_f32_16x16x32_bf16 v[76:79], v[140:143], v[124:127], v[76:79]
s_add_u32 s23, s50, 52224
buffer_load_dwordx4 v[140:143], v1, s[8:11], s23 offen
ds_read_b128 v[112:115], v3 offset:53248
ds_read_b128 v[116:119], v3 offset:54272
ds_read_b128 v[120:123], v3 offset:55296
ds_read_b128 v[124:127], v3 offset:56320
s_waitcnt vmcnt(34)
s_waitcnt lgkmcnt(4)
v_mfma_f32_16x16x32_bf16 v[64:67], v[144:147], v[96:99], v[64:67]
v_mfma_f32_16x16x32_bf16 v[68:71], v[144:147], v[100:103], v[68:71]
v_mfma_f32_16x16x32_bf16 v[72:75], v[144:147], v[104:107], v[72:75]
v_mfma_f32_16x16x32_bf16 v[76:79], v[144:147], v[108:111], v[76:79]
s_add_u32 s23, s50, 53248
buffer_load_dwordx4 v[144:147], v1, s[8:11], s23 offen
ds_read_b128 v[96:99], v3 offset:57344
ds_read_b128 v[100:103], v3 offset:58368
ds_read_b128 v[104:107], v3 offset:59392
ds_read_b128 v[108:111], v3 offset:60416
s_waitcnt vmcnt(34)
s_waitcnt lgkmcnt(4)
v_mfma_f32_16x16x32_bf16 v[64:67], v[148:151], v[112:115], v[64:67]
v_mfma_f32_16x16x32_bf16 v[68:71], v[148:151], v[116:119], v[68:71]
v_mfma_f32_16x16x32_bf16 v[72:75], v[148:151], v[120:123], v[72:75]
v_mfma_f32_16x16x32_bf16 v[76:79], v[148:151], v[124:127], v[76:79]
s_add_u32 s23, s50, 54272
buffer_load_dwordx4 v[148:151], v1, s[8:11], s23 offen
ds_read_b128 v[112:115], v3 offset:61440
ds_read_b128 v[116:119], v3 offset:62464
ds_read_b128 v[120:123], v3 offset:63488
ds_read_b128 v[124:127], v3 offset:64512
s_waitcnt vmcnt(34)
s_waitcnt lgkmcnt(4)
v_mfma_f32_16x16x32_bf16 v[64:67], v[152:155], v[96:99], v[64:67]
v_mfma_f32_16x16x32_bf16 v[68:71], v[152:155], v[100:103], v[68:71]
v_mfma_f32_16x16x32_bf16 v[72:75], v[152:155], v[104:107], v[72:75]
v_mfma_f32_16x16x32_bf16 v[76:79], v[152:155], v[108:111], v[76:79]
s_waitcnt vmcnt(32)
s_barrier
ds_read_b128 v[96:99], v2 offset:0
ds_read_b128 v[100:103], v2 offset:1024
ds_read_b128 v[104:107], v2 offset:2048
ds_read_b128 v[108:111], v2 offset:3072
s_waitcnt vmcnt(31)
s_waitcnt lgkmcnt(4)
v_mfma_f32_16x16x32_bf16 v[64:67], v[156:159], v[112:115], v[64:67]
v_mfma_f32_16x16x32_bf16 v[68:71], v[156:159], v[116:119], v[68:71]
v_mfma_f32_16x16x32_bf16 v[72:75], v[156:159], v[120:123], v[72:75]
v_mfma_f32_16x16x32_bf16 v[76:79], v[156:159], v[124:127], v[76:79]
ds_read_b128 v[112:115], v2 offset:4096
ds_read_b128 v[116:119], v2 offset:5120
ds_read_b128 v[120:123], v2 offset:6144
ds_read_b128 v[124:127], v2 offset:7168
s_waitcnt vmcnt(30)
s_waitcnt lgkmcnt(4)
v_mfma_f32_16x16x32_bf16 v[64:67], v[160:163], v[96:99], v[64:67]
v_mfma_f32_16x16x32_bf16 v[68:71], v[160:163], v[100:103], v[68:71]
v_mfma_f32_16x16x32_bf16 v[72:75], v[160:163], v[104:107], v[72:75]
v_mfma_f32_16x16x32_bf16 v[76:79], v[160:163], v[108:111], v[76:79]
ds_read_b128 v[96:99], v2 offset:8192
ds_read_b128 v[100:103], v2 offset:9216
ds_read_b128 v[104:107], v2 offset:10240
ds_read_b128 v[108:111], v2 offset:11264
s_waitcnt vmcnt(29)
s_waitcnt lgkmcnt(4)
v_mfma_f32_16x16x32_bf16 v[64:67], v[164:167], v[112:115], v[64:67]
v_mfma_f32_16x16x32_bf16 v[68:71], v[164:167], v[116:119], v[68:71]
v_mfma_f32_16x16x32_bf16 v[72:75], v[164:167], v[120:123], v[72:75]
v_mfma_f32_16x16x32_bf16 v[76:79], v[164:167], v[124:127], v[76:79]
ds_read_b128 v[112:115], v2 offset:12288
ds_read_b128 v[116:119], v2 offset:13312
ds_read_b128 v[120:123], v2 offset:14336
ds_read_b128 v[124:127], v2 offset:15360
s_waitcnt vmcnt(28)
s_waitcnt lgkmcnt(4)
v_mfma_f32_16x16x32_bf16 v[64:67], v[168:171], v[96:99], v[64:67]
v_mfma_f32_16x16x32_bf16 v[68:71], v[168:171], v[100:103], v[68:71]
v_mfma_f32_16x16x32_bf16 v[72:75], v[168:171], v[104:107], v[72:75]
v_mfma_f32_16x16x32_bf16 v[76:79], v[168:171], v[108:111], v[76:79]
s_waitcnt vmcnt(26)
s_barrier
ds_read_b128 v[96:99], v2 offset:16384
ds_read_b128 v[100:103], v2 offset:17408
ds_read_b128 v[104:107], v2 offset:18432
ds_read_b128 v[108:111], v2 offset:19456
s_waitcnt vmcnt(25)
s_waitcnt lgkmcnt(4)
v_mfma_f32_16x16x32_bf16 v[64:67], v[172:175], v[112:115], v[64:67]
v_mfma_f32_16x16x32_bf16 v[68:71], v[172:175], v[116:119], v[68:71]
v_mfma_f32_16x16x32_bf16 v[72:75], v[172:175], v[120:123], v[72:75]
v_mfma_f32_16x16x32_bf16 v[76:79], v[172:175], v[124:127], v[76:79]
ds_read_b128 v[112:115], v2 offset:20480
ds_read_b128 v[116:119], v2 offset:21504
ds_read_b128 v[120:123], v2 offset:22528
ds_read_b128 v[124:127], v2 offset:23552
s_waitcnt vmcnt(24)
s_waitcnt lgkmcnt(4)
v_mfma_f32_16x16x32_bf16 v[64:67], v[176:179], v[96:99], v[64:67]
v_mfma_f32_16x16x32_bf16 v[68:71], v[176:179], v[100:103], v[68:71]
v_mfma_f32_16x16x32_bf16 v[72:75], v[176:179], v[104:107], v[72:75]
v_mfma_f32_16x16x32_bf16 v[76:79], v[176:179], v[108:111], v[76:79]
ds_read_b128 v[96:99], v2 offset:24576
ds_read_b128 v[100:103], v2 offset:25600
ds_read_b128 v[104:107], v2 offset:26624
ds_read_b128 v[108:111], v2 offset:27648
s_waitcnt vmcnt(23)
s_waitcnt lgkmcnt(4)
v_mfma_f32_16x16x32_bf16 v[64:67], v[180:183], v[112:115], v[64:67]
v_mfma_f32_16x16x32_bf16 v[68:71], v[180:183], v[116:119], v[68:71]
v_mfma_f32_16x16x32_bf16 v[72:75], v[180:183], v[120:123], v[72:75]
v_mfma_f32_16x16x32_bf16 v[76:79], v[180:183], v[124:127], v[76:79]
ds_read_b128 v[112:115], v2 offset:28672
ds_read_b128 v[116:119], v2 offset:29696
ds_read_b128 v[120:123], v2 offset:30720
ds_read_b128 v[124:127], v2 offset:31744
s_waitcnt vmcnt(22)
s_waitcnt lgkmcnt(4)
v_mfma_f32_16x16x32_bf16 v[64:67], v[184:187], v[96:99], v[64:67]
v_mfma_f32_16x16x32_bf16 v[68:71], v[184:187], v[100:103], v[68:71]
v_mfma_f32_16x16x32_bf16 v[72:75], v[184:187], v[104:107], v[72:75]
v_mfma_f32_16x16x32_bf16 v[76:79], v[184:187], v[108:111], v[76:79]
s_waitcnt vmcnt(20)
s_barrier
ds_read_b128 v[96:99], v2 offset:32768
ds_read_b128 v[100:103], v2 offset:33792
ds_read_b128 v[104:107], v2 offset:34816
ds_read_b128 v[108:111], v2 offset:35840
s_waitcnt vmcnt(19)
s_waitcnt lgkmcnt(4)
v_mfma_f32_16x16x32_bf16 v[64:67], v[188:191], v[112:115], v[64:67]
v_mfma_f32_16x16x32_bf16 v[68:71], v[188:191], v[116:119], v[68:71]
v_mfma_f32_16x16x32_bf16 v[72:75], v[188:191], v[120:123], v[72:75]
v_mfma_f32_16x16x32_bf16 v[76:79], v[188:191], v[124:127], v[76:79]
ds_read_b128 v[112:115], v2 offset:36864
ds_read_b128 v[116:119], v2 offset:37888
ds_read_b128 v[120:123], v2 offset:38912
ds_read_b128 v[124:127], v2 offset:39936
s_waitcnt vmcnt(18)
s_waitcnt lgkmcnt(4)
v_mfma_f32_16x16x32_bf16 v[64:67], v[192:195], v[96:99], v[64:67]
v_mfma_f32_16x16x32_bf16 v[68:71], v[192:195], v[100:103], v[68:71]
v_mfma_f32_16x16x32_bf16 v[72:75], v[192:195], v[104:107], v[72:75]
v_mfma_f32_16x16x32_bf16 v[76:79], v[192:195], v[108:111], v[76:79]
ds_read_b128 v[96:99], v2 offset:40960
ds_read_b128 v[100:103], v2 offset:41984
ds_read_b128 v[104:107], v2 offset:43008
ds_read_b128 v[108:111], v2 offset:44032
s_waitcnt vmcnt(17)
s_waitcnt lgkmcnt(4)
v_mfma_f32_16x16x32_bf16 v[64:67], v[196:199], v[112:115], v[64:67]
v_mfma_f32_16x16x32_bf16 v[68:71], v[196:199], v[116:119], v[68:71]
v_mfma_f32_16x16x32_bf16 v[72:75], v[196:199], v[120:123], v[72:75]
v_mfma_f32_16x16x32_bf16 v[76:79], v[196:199], v[124:127], v[76:79]
ds_read_b128 v[112:115], v2 offset:45056
ds_read_b128 v[116:119], v2 offset:46080
ds_read_b128 v[120:123], v2 offset:47104
ds_read_b128 v[124:127], v2 offset:48128
s_waitcnt vmcnt(16)
s_waitcnt lgkmcnt(4)
v_mfma_f32_16x16x32_bf16 v[64:67], v[200:203], v[96:99], v[64:67]
v_mfma_f32_16x16x32_bf16 v[68:71], v[200:203], v[100:103], v[68:71]
v_mfma_f32_16x16x32_bf16 v[72:75], v[200:203], v[104:107], v[72:75]
v_mfma_f32_16x16x32_bf16 v[76:79], v[200:203], v[108:111], v[76:79]
s_waitcnt vmcnt(14)
s_barrier
ds_read_b128 v[96:99], v2 offset:49152
ds_read_b128 v[100:103], v2 offset:50176
ds_read_b128 v[104:107], v2 offset:51200
ds_read_b128 v[108:111], v2 offset:52224
s_waitcnt vmcnt(13)
s_waitcnt lgkmcnt(4)
v_mfma_f32_16x16x32_bf16 v[64:67], v[204:207], v[112:115], v[64:67]
v_mfma_f32_16x16x32_bf16 v[68:71], v[204:207], v[116:119], v[68:71]
v_mfma_f32_16x16x32_bf16 v[72:75], v[204:207], v[120:123], v[72:75]
v_mfma_f32_16x16x32_bf16 v[76:79], v[204:207], v[124:127], v[76:79]
ds_read_b128 v[112:115], v2 offset:53248
ds_read_b128 v[116:119], v2 offset:54272
ds_read_b128 v[120:123], v2 offset:55296
ds_read_b128 v[124:127], v2 offset:56320
s_waitcnt vmcnt(12)
s_waitcnt lgkmcnt(4)
v_mfma_f32_16x16x32_bf16 v[64:67], v[208:211], v[96:99], v[64:67]
v_mfma_f32_16x16x32_bf16 v[68:71], v[208:211], v[100:103], v[68:71]
v_mfma_f32_16x16x32_bf16 v[72:75], v[208:211], v[104:107], v[72:75]
v_mfma_f32_16x16x32_bf16 v[76:79], v[208:211], v[108:111], v[76:79]
ds_read_b128 v[96:99], v2 offset:57344
ds_read_b128 v[100:103], v2 offset:58368
ds_read_b128 v[104:107], v2 offset:59392
ds_read_b128 v[108:111], v2 offset:60416
s_waitcnt vmcnt(11)
s_waitcnt lgkmcnt(4)
v_mfma_f32_16x16x32_bf16 v[64:67], v[212:215], v[112:115], v[64:67]
v_mfma_f32_16x16x32_bf16 v[68:71], v[212:215], v[116:119], v[68:71]
v_mfma_f32_16x16x32_bf16 v[72:75], v[212:215], v[120:123], v[72:75]
v_mfma_f32_16x16x32_bf16 v[76:79], v[212:215], v[124:127], v[76:79]
ds_read_b128 v[112:115], v2 offset:61440
ds_read_b128 v[116:119], v2 offset:62464
ds_read_b128 v[120:123], v2 offset:63488
ds_read_b128 v[124:127], v2 offset:64512
s_waitcnt vmcnt(10)
s_waitcnt lgkmcnt(4)
v_mfma_f32_16x16x32_bf16 v[64:67], v[216:219], v[96:99], v[64:67]
v_mfma_f32_16x16x32_bf16 v[68:71], v[216:219], v[100:103], v[68:71]
v_mfma_f32_16x16x32_bf16 v[72:75], v[216:219], v[104:107], v[72:75]
v_mfma_f32_16x16x32_bf16 v[76:79], v[216:219], v[108:111], v[76:79]
s_waitcnt vmcnt(8)
s_barrier
ds_read_b128 v[96:99], v3 offset:0
ds_read_b128 v[100:103], v3 offset:1024
ds_read_b128 v[104:107], v3 offset:2048
ds_read_b128 v[108:111], v3 offset:3072
s_waitcnt vmcnt(7)
s_waitcnt lgkmcnt(4)
v_mfma_f32_16x16x32_bf16 v[64:67], v[220:223], v[112:115], v[64:67]
v_mfma_f32_16x16x32_bf16 v[68:71], v[220:223], v[116:119], v[68:71]
v_mfma_f32_16x16x32_bf16 v[72:75], v[220:223], v[120:123], v[72:75]
v_mfma_f32_16x16x32_bf16 v[76:79], v[220:223], v[124:127], v[76:79]
ds_read_b128 v[112:115], v3 offset:4096
ds_read_b128 v[116:119], v3 offset:5120
ds_read_b128 v[120:123], v3 offset:6144
ds_read_b128 v[124:127], v3 offset:7168
s_waitcnt vmcnt(6)
s_waitcnt lgkmcnt(4)
v_mfma_f32_16x16x32_bf16 v[64:67], v[128:131], v[96:99], v[64:67]
v_mfma_f32_16x16x32_bf16 v[68:71], v[128:131], v[100:103], v[68:71]
v_mfma_f32_16x16x32_bf16 v[72:75], v[128:131], v[104:107], v[72:75]
v_mfma_f32_16x16x32_bf16 v[76:79], v[128:131], v[108:111], v[76:79]
ds_read_b128 v[96:99], v3 offset:8192
ds_read_b128 v[100:103], v3 offset:9216
ds_read_b128 v[104:107], v3 offset:10240
ds_read_b128 v[108:111], v3 offset:11264
s_waitcnt vmcnt(5)
s_waitcnt lgkmcnt(4)
v_mfma_f32_16x16x32_bf16 v[64:67], v[132:135], v[112:115], v[64:67]
v_mfma_f32_16x16x32_bf16 v[68:71], v[132:135], v[116:119], v[68:71]
v_mfma_f32_16x16x32_bf16 v[72:75], v[132:135], v[120:123], v[72:75]
v_mfma_f32_16x16x32_bf16 v[76:79], v[132:135], v[124:127], v[76:79]
ds_read_b128 v[112:115], v3 offset:12288
ds_read_b128 v[116:119], v3 offset:13312
ds_read_b128 v[120:123], v3 offset:14336
ds_read_b128 v[124:127], v3 offset:15360
s_waitcnt vmcnt(4)
s_waitcnt lgkmcnt(4)
v_mfma_f32_16x16x32_bf16 v[64:67], v[136:139], v[96:99], v[64:67]
v_mfma_f32_16x16x32_bf16 v[68:71], v[136:139], v[100:103], v[68:71]
v_mfma_f32_16x16x32_bf16 v[72:75], v[136:139], v[104:107], v[72:75]
v_mfma_f32_16x16x32_bf16 v[76:79], v[136:139], v[108:111], v[76:79]
s_waitcnt vmcnt(3)
s_barrier
ds_read_b128 v[96:99], v3 offset:16384
ds_read_b128 v[100:103], v3 offset:17408
ds_read_b128 v[104:107], v3 offset:18432
ds_read_b128 v[108:111], v3 offset:19456
s_waitcnt vmcnt(2)
s_waitcnt lgkmcnt(4)
v_mfma_f32_16x16x32_bf16 v[64:67], v[140:143], v[112:115], v[64:67]
v_mfma_f32_16x16x32_bf16 v[68:71], v[140:143], v[116:119], v[68:71]
v_mfma_f32_16x16x32_bf16 v[72:75], v[140:143], v[120:123], v[72:75]
v_mfma_f32_16x16x32_bf16 v[76:79], v[140:143], v[124:127], v[76:79]
ds_read_b128 v[112:115], v3 offset:20480
ds_read_b128 v[116:119], v3 offset:21504
ds_read_b128 v[120:123], v3 offset:22528
ds_read_b128 v[124:127], v3 offset:23552
s_waitcnt vmcnt(1)
s_waitcnt lgkmcnt(4)
v_mfma_f32_16x16x32_bf16 v[64:67], v[144:147], v[96:99], v[64:67]
v_mfma_f32_16x16x32_bf16 v[68:71], v[144:147], v[100:103], v[68:71]
v_mfma_f32_16x16x32_bf16 v[72:75], v[144:147], v[104:107], v[72:75]
v_mfma_f32_16x16x32_bf16 v[76:79], v[144:147], v[108:111], v[76:79]
s_waitcnt vmcnt(0)
s_waitcnt lgkmcnt(0)
v_mfma_f32_16x16x32_bf16 v[64:67], v[148:151], v[112:115], v[64:67]
v_mfma_f32_16x16x32_bf16 v[68:71], v[148:151], v[116:119], v[68:71]
v_mfma_f32_16x16x32_bf16 v[72:75], v[148:151], v[120:123], v[72:75]
v_mfma_f32_16x16x32_bf16 v[76:79], v[148:151], v[124:127], v[76:79]
v_add_u32 v61, s19, v4
v_mul_u32_u24 v61, 1280, v61
v_lshlrev_b32 v60, 3, v5
v_add_u32 v61, v61, v60
s_lshl_b32 s24, s31, 5
v_lshlrev_b32 v224, 16, v6
v_and_b32 v225, 0xffff0000, v6
v_lshlrev_b32 v226, 16, v7
v_and_b32 v227, 0xffff0000, v7
v_add_f32 v64, v64, v14
v_add_f32 v65, v65, v15
v_add_f32 v66, v66, v16
v_add_f32 v67, v67, v17
v_fmac_f32 v224, v64, v38
v_fmac_f32 v225, v65, v39
v_fmac_f32 v226, v66, v40
v_fmac_f32 v227, v67, v41
v_cvt_pk_bf16_f32 v232, v224, v225
v_cvt_pk_bf16_f32 v233, v226, v227
buffer_store_dwordx2 v[232:233], v61, s[12:15], s24 offen
s_add_u32 s24, s24, 20480
v_lshlrev_b32 v228, 16, v8
v_and_b32 v229, 0xffff0000, v8
v_lshlrev_b32 v230, 16, v9
v_and_b32 v231, 0xffff0000, v9
v_add_f32 v68, v68, v18
v_add_f32 v69, v69, v19
v_add_f32 v70, v70, v20
v_add_f32 v71, v71, v21
v_fmac_f32 v228, v68, v38
v_fmac_f32 v229, v69, v39
v_fmac_f32 v230, v70, v40
v_fmac_f32 v231, v71, v41
v_cvt_pk_bf16_f32 v234, v228, v229
v_cvt_pk_bf16_f32 v235, v230, v231
buffer_store_dwordx2 v[234:235], v61, s[12:15], s24 offen
s_add_u32 s24, s24, 20480
v_lshlrev_b32 v224, 16, v10
v_and_b32 v225, 0xffff0000, v10
v_lshlrev_b32 v226, 16, v11
v_and_b32 v227, 0xffff0000, v11
v_add_f32 v72, v72, v22
v_add_f32 v73, v73, v23
v_add_f32 v74, v74, v24
v_add_f32 v75, v75, v25
v_fmac_f32 v224, v72, v38
v_fmac_f32 v225, v73, v39
v_fmac_f32 v226, v74, v40
v_fmac_f32 v227, v75, v41
v_cvt_pk_bf16_f32 v236, v224, v225
v_cvt_pk_bf16_f32 v237, v226, v227
buffer_store_dwordx2 v[236:237], v61, s[12:15], s24 offen
s_add_u32 s24, s24, 20480
v_lshlrev_b32 v228, 16, v12
v_and_b32 v229, 0xffff0000, v12
v_lshlrev_b32 v230, 16, v13
v_and_b32 v231, 0xffff0000, v13
v_add_f32 v76, v76, v26
v_add_f32 v77, v77, v27
v_add_f32 v78, v78, v28
v_add_f32 v79, v79, v29
v_fmac_f32 v228, v76, v38
v_fmac_f32 v229, v77, v39
v_fmac_f32 v230, v78, v40
v_fmac_f32 v231, v79, v41
v_cvt_pk_bf16_f32 v238, v228, v229
v_cvt_pk_bf16_f32 v239, v230, v231
buffer_store_dwordx2 v[238:239], v61, s[12:15], s24 offen
s_add_u32 s24, s24, 20480
s_endpgm
L_30:
v_lshlrev_b32 v60, 4, v4
v_add_u32 v60, 131072, v60
ds_read_b128 v[224:227], v60 offset:0
ds_read_b128 v[228:231], v60 offset:256
ds_read_b128 v[232:235], v60 offset:512
ds_read_b128 v[236:239], v60 offset:768
s_add_u32 s34, s33, 1048576
s_waitcnt lgkmcnt(0)
v_mul_f32 v64, v64, v224
v_mul_f32 v65, v65, v224
v_mul_f32 v66, v66, v224
v_mul_f32 v67, v67, v224
v_fmac_f32 v64, v225, v30
v_fmac_f32 v65, v225, v31
v_fmac_f32 v66, v225, v32
v_fmac_f32 v67, v225, v33
v_fmac_f32 v64, v226, v34
v_fmac_f32 v65, v226, v35
v_fmac_f32 v66, v226, v36
v_fmac_f32 v67, v226, v37
v_fmac_f32 v64, v227, v38
v_fmac_f32 v65, v227, v39
v_fmac_f32 v66, v227, v40
v_fmac_f32 v67, v227, v41
v_mul_f32 v240, v64, v64
v_mul_f32 v241, v65, v65
v_mul_f32 v242, v66, v66
v_mul_f32 v243, v67, v67
v_fma_f32 v240, v240, s40, v63
v_fma_f32 v241, v241, s40, v63
v_fma_f32 v242, v242, s40, v63
v_fma_f32 v243, v243, s40, v63
v_mul_f32 v240, v240, v64
v_mul_f32 v241, v241, v65
v_mul_f32 v242, v242, v66
v_mul_f32 v243, v243, v67
v_exp_f32 v240, v240
v_exp_f32 v241, v241
v_exp_f32 v242, v242
v_exp_f32 v243, v243
v_add_f32 v240, 1.0, v240
v_add_f32 v241, 1.0, v241
v_add_f32 v242, 1.0, v242
v_add_f32 v243, 1.0, v243
v_rcp_f32 v240, v240
v_rcp_f32 v241, v241
v_rcp_f32 v242, v242
v_rcp_f32 v243, v243
v_mul_f32 v64, v64, v240
v_mul_f32 v65, v65, v241
v_mul_f32 v66, v66, v242
v_mul_f32 v67, v67, v243
v_cvt_pk_bf16_f32 v244, v64, v65
v_cvt_pk_bf16_f32 v245, v66, v67
buffer_store_dwordx2 v[244:245], v1, s[8:11], s34 offen sc0 sc1
s_add_u32 s34, s34, 20480
v_mul_f32 v68, v68, v228
v_mul_f32 v69, v69, v228
v_mul_f32 v70, v70, v228
v_mul_f32 v71, v71, v228
v_fmac_f32 v68, v229, v30
v_fmac_f32 v69, v229, v31
v_fmac_f32 v70, v229, v32
v_fmac_f32 v71, v229, v33
v_fmac_f32 v68, v230, v34
v_fmac_f32 v69, v230, v35
v_fmac_f32 v70, v230, v36
v_fmac_f32 v71, v230, v37
v_fmac_f32 v68, v231, v38
v_fmac_f32 v69, v231, v39
v_fmac_f32 v70, v231, v40
v_fmac_f32 v71, v231, v41
v_mul_f32 v240, v68, v68
v_mul_f32 v241, v69, v69
v_mul_f32 v242, v70, v70
v_mul_f32 v243, v71, v71
v_fma_f32 v240, v240, s40, v63
v_fma_f32 v241, v241, s40, v63
v_fma_f32 v242, v242, s40, v63
v_fma_f32 v243, v243, s40, v63
v_mul_f32 v240, v240, v68
v_mul_f32 v241, v241, v69
v_mul_f32 v242, v242, v70
v_mul_f32 v243, v243, v71
v_exp_f32 v240, v240
v_exp_f32 v241, v241
v_exp_f32 v242, v242
v_exp_f32 v243, v243
v_add_f32 v240, 1.0, v240
v_add_f32 v241, 1.0, v241
v_add_f32 v242, 1.0, v242
v_add_f32 v243, 1.0, v243
v_rcp_f32 v240, v240
v_rcp_f32 v241, v241
v_rcp_f32 v242, v242
v_rcp_f32 v243, v243
v_mul_f32 v68, v68, v240
v_mul_f32 v69, v69, v241
v_mul_f32 v70, v70, v242
v_mul_f32 v71, v71, v243
v_cvt_pk_bf16_f32 v246, v68, v69
v_cvt_pk_bf16_f32 v247, v70, v71
buffer_store_dwordx2 v[246:247], v1, s[8:11], s34 offen sc0 sc1
s_add_u32 s34, s34, 20480
v_mul_f32 v72, v72, v232
v_mul_f32 v73, v73, v232
v_mul_f32 v74, v74, v232
v_mul_f32 v75, v75, v232
v_fmac_f32 v72, v233, v30
v_fmac_f32 v73, v233, v31
v_fmac_f32 v74, v233, v32
v_fmac_f32 v75, v233, v33
v_fmac_f32 v72, v234, v34
v_fmac_f32 v73, v234, v35
v_fmac_f32 v74, v234, v36
v_fmac_f32 v75, v234, v37
v_fmac_f32 v72, v235, v38
v_fmac_f32 v73, v235, v39
v_fmac_f32 v74, v235, v40
v_fmac_f32 v75, v235, v41
v_mul_f32 v240, v72, v72
v_mul_f32 v241, v73, v73
v_mul_f32 v242, v74, v74
v_mul_f32 v243, v75, v75
v_fma_f32 v240, v240, s40, v63
v_fma_f32 v241, v241, s40, v63
v_fma_f32 v242, v242, s40, v63
v_fma_f32 v243, v243, s40, v63
v_mul_f32 v240, v240, v72
v_mul_f32 v241, v241, v73
v_mul_f32 v242, v242, v74
v_mul_f32 v243, v243, v75
v_exp_f32 v240, v240
v_exp_f32 v241, v241
v_exp_f32 v242, v242
v_exp_f32 v243, v243
v_add_f32 v240, 1.0, v240
v_add_f32 v241, 1.0, v241
v_add_f32 v242, 1.0, v242
v_add_f32 v243, 1.0, v243
v_rcp_f32 v240, v240
v_rcp_f32 v241, v241
v_rcp_f32 v242, v242
v_rcp_f32 v243, v243
v_mul_f32 v72, v72, v240
v_mul_f32 v73, v73, v241
v_mul_f32 v74, v74, v242
v_mul_f32 v75, v75, v243
v_cvt_pk_bf16_f32 v248, v72, v73
v_cvt_pk_bf16_f32 v249, v74, v75
buffer_store_dwordx2 v[248:249], v1, s[8:11], s34 offen sc0 sc1
s_add_u32 s34, s34, 20480
v_mul_f32 v76, v76, v236
v_mul_f32 v77, v77, v236
v_mul_f32 v78, v78, v236
v_mul_f32 v79, v79, v236
v_fmac_f32 v76, v237, v30
v_fmac_f32 v77, v237, v31
v_fmac_f32 v78, v237, v32
v_fmac_f32 v79, v237, v33
v_fmac_f32 v76, v238, v34
v_fmac_f32 v77, v238, v35
v_fmac_f32 v78, v238, v36
v_fmac_f32 v79, v238, v37
v_fmac_f32 v76, v239, v38
v_fmac_f32 v77, v239, v39
v_fmac_f32 v78, v239, v40
v_fmac_f32 v79, v239, v41
v_mul_f32 v240, v76, v76
v_mul_f32 v241, v77, v77
v_mul_f32 v242, v78, v78
v_mul_f32 v243, v79, v79
v_fma_f32 v240, v240, s40, v63
v_fma_f32 v241, v241, s40, v63
v_fma_f32 v242, v242, s40, v63
v_fma_f32 v243, v243, s40, v63
v_mul_f32 v240, v240, v76
v_mul_f32 v241, v241, v77
v_mul_f32 v242, v242, v78
v_mul_f32 v243, v243, v79
v_exp_f32 v240, v240
v_exp_f32 v241, v241
v_exp_f32 v242, v242
v_exp_f32 v243, v243
v_add_f32 v240, 1.0, v240
v_add_f32 v241, 1.0, v241
v_add_f32 v242, 1.0, v242
v_add_f32 v243, 1.0, v243
v_rcp_f32 v240, v240
v_rcp_f32 v241, v241
v_rcp_f32 v242, v242
v_rcp_f32 v243, v243
v_mul_f32 v76, v76, v240
v_mul_f32 v77, v77, v241
v_mul_f32 v78, v78, v242
v_mul_f32 v79, v79, v243
v_cvt_pk_bf16_f32 v250, v76, v77
v_cvt_pk_bf16_f32 v251, v78, v79
buffer_store_dwordx2 v[250:251], v1, s[8:11], s34 offen sc0 sc1
s_add_u32 s34, s34, 20480
s_mov_b32 s25, 147456
buffer_load_dwordx4 v[30:33], v59, s[8:11], s25 offen
s_mov_b32 s25, 150016
buffer_load_dwordx4 v[34:37], v59, s[8:11], s25 offen
s_mov_b32 s25, 152576
buffer_load_dwordx4 v[38:41], v59, s[8:11], s25 offen
s_lshl_b32 s35, s16, 5
s_add_u32 s35, s35, 165888
s_lshl_b32 s24, s17, 2
s_add_u32 s36, s35, s24
s_waitcnt vmcnt(0)
s_barrier
s_cmp_lg_u32 s18, 0
s_cbranch_scc1 L_42
v_mov_b32 v46, 0
v_mov_b32 v47, 1
buffer_store_dword v47, v46, s[8:11], s36 offen sc0 sc1
L_42:
s_and_b32 s24, s18, 3
s_lshl_b32 s24, s24, 4
s_add_u32 s24, s24, s19
v_add_u32 v46, s24, v4
v_lshrrev_b32 v47, 4, v46
v_mul_u32_u24 v47, 20480, v47
v_and_b32 v46, 15, v46
v_lshlrev_b32 v46, 4, v46
v_add_u32 v47, v47, v46
v_lshlrev_b32 v46, 8, v5
v_add_u32 v42, v47, v46
s_lshr_b32 s24, s18, 2
s_lshl_b32 s24, s24, 10
s_add_u32 s28, s24, 1048576
v_lshrrev_b32 v46, 2, v1
v_min_u32 v46, 28, v46
s_mov_b32 s30, 40000
L_43:
buffer_load_dword v47, v46, s[8:11], s35 offen sc0 sc1
s_waitcnt vmcnt(0)
v_cmp_ne_u32 vcc, 1, v47
s_nop 4
s_cbranch_vccz L_44
s_sub_u32 s30, s30, 1
s_cmp_lg_u32 s30, 0
s_cbranch_scc1 L_43
L_44:
s_add_u32 m0, s21, 0
s_add_u32 s22, s28, 0
buffer_load_dwordx4 v42, s[8:11], s22 offen sc0 sc1 lds
s_add_u32 m0, s21, 8192
s_add_u32 s22, s28, 2048
buffer_load_dwordx4 v42, s[8:11], s22 offen sc0 sc1 lds
s_add_u32 m0, s21, 16384
s_add_u32 s22, s28, 4096
buffer_load_dwordx4 v42, s[8:11], s22 offen sc0 sc1 lds
s_add_u32 m0, s21, 24576
s_add_u32 s22, s28, 6144
buffer_load_dwordx4 v42, s[8:11], s22 offen sc0 sc1 lds
s_add_u32 m0, s21, 32768
s_add_u32 s22, s28, 8192
buffer_load_dwordx4 v42, s[8:11], s22 offen sc0 sc1 lds
s_add_u32 m0, s21, 40960
s_add_u32 s22, s28, 10240
buffer_load_dwordx4 v42, s[8:11], s22 offen sc0 sc1 lds
s_add_u32 m0, s21, 49152
s_add_u32 s22, s28, 12288
buffer_load_dwordx4 v42, s[8:11], s22 offen sc0 sc1 lds
s_add_u32 m0, s21, 57344
s_add_u32 s22, s28, 14336
buffer_load_dwordx4 v42, s[8:11], s22 offen sc0 sc1 lds
s_add_u32 m0, s21, 65536
s_add_u32 s22, s28, 16384
buffer_load_dwordx4 v42, s[8:11], s22 offen sc0 sc1 lds
s_add_u32 m0, s21, 73728
s_add_u32 s22, s28, 18432
buffer_load_dwordx4 v42, s[8:11], s22 offen sc0 sc1 lds
v_mov_b32 v64, 0
v_mov_b32 v65, 0
v_mov_b32 v66, 0
v_mov_b32 v67, 0
v_mov_b32 v68, 0
v_mov_b32 v69, 0
v_mov_b32 v70, 0
v_mov_b32 v71, 0
v_mov_b32 v72, 0
v_mov_b32 v73, 0
v_mov_b32 v74, 0
v_mov_b32 v75, 0
v_mov_b32 v76, 0
v_mov_b32 v77, 0
v_mov_b32 v78, 0
v_mov_b32 v79, 0
s_waitcnt vmcnt(8)
s_barrier
ds_read_b128 v[96:99], v2 offset:0
ds_read_b128 v[100:103], v2 offset:1024
ds_read_b128 v[104:107], v2 offset:2048
ds_read_b128 v[108:111], v2 offset:3072
ds_read_b128 v[112:115], v2 offset:4096
ds_read_b128 v[116:119], v2 offset:5120
ds_read_b128 v[120:123], v2 offset:6144
ds_read_b128 v[124:127], v2 offset:7168
s_waitcnt lgkmcnt(4)
v_mfma_f32_16x16x32_bf16 v[64:67], v[128:131], v[96:99], v[64:67]
v_mfma_f32_16x16x32_bf16 v[68:71], v[128:131], v[100:103], v[68:71]
v_mfma_f32_16x16x32_bf16 v[72:75], v[128:131], v[104:107], v[72:75]
v_mfma_f32_16x16x32_bf16 v[76:79], v[128:131], v[108:111], v[76:79]
s_add_u32 s23, s41, 0
buffer_load_dwordx4 v[128:131], v1, s[8:11], s23 offen
ds_read_b128 v[96:99], v2 offset:8192
ds_read_b128 v[100:103], v2 offset:9216
ds_read_b128 v[104:107], v2 offset:10240
ds_read_b128 v[108:111], v2 offset:11264
s_waitcnt lgkmcnt(4)
v_mfma_f32_16x16x32_bf16 v[64:67], v[132:135], v[112:115], v[64:67]
v_mfma_f32_16x16x32_bf16 v[68:71], v[132:135], v[116:119], v[68:71]
v_mfma_f32_16x16x32_bf16 v[72:75], v[132:135], v[120:123], v[72:75]
v_mfma_f32_16x16x32_bf16 v[76:79], v[132:135], v[124:127], v[76:79]
s_add_u32 s23, s42, 0
buffer_load_dwordx4 v[132:135], v1, s[8:11], s23 offen
ds_read_b128 v[112:115], v2 offset:12288
ds_read_b128 v[116:119], v2 offset:13312
ds_read_b128 v[120:123], v2 offset:14336
ds_read_b128 v[124:127], v2 offset:15360
s_waitcnt lgkmcnt(4)
v_mfma_f32_16x16x32_bf16 v[64:67], v[136:139], v[96:99], v[64:67]
v_mfma_f32_16x16x32_bf16 v[68:71], v[136:139], v[100:103], v[68:71]
v_mfma_f32_16x16x32_bf16 v[72:75], v[136:139], v[104:107], v[72:75]
v_mfma_f32_16x16x32_bf16 v[76:79], v[136:139], v[108:111], v[76:79]
s_add_u32 s23, s41, 1024
buffer_load_dwordx4 v[136:139], v1, s[8:11], s23 offen
s_waitcnt vmcnt(9)
s_barrier
ds_read_b128 v[96:99], v2 offset:16384
ds_read_b128 v[100:103], v2 offset:17408
ds_read_b128 v[104:107], v2 offset:18432
ds_read_b128 v[108:111], v2 offset:19456
s_waitcnt lgkmcnt(4)
v_mfma_f32_16x16x32_bf16 v[64:67], v[140:143], v[112:115], v[64:67]
v_mfma_f32_16x16x32_bf16 v[68:71], v[140:143], v[116:119], v[68:71]
v_mfma_f32_16x16x32_bf16 v[72:75], v[140:143], v[120:123], v[72:75]
v_mfma_f32_16x16x32_bf16 v[76:79], v[140:143], v[124:127], v[76:79]
s_add_u32 s23, s42, 1024
buffer_load_dwordx4 v[140:143], v1, s[8:11], s23 offen
ds_read_b128 v[112:115], v2 offset:20480
ds_read_b128 v[116:119], v2 offset:21504
ds_read_b128 v[120:123], v2 offset:22528
ds_read_b128 v[124:127], v2 offset:23552
s_waitcnt lgkmcnt(4)
v_mfma_f32_16x16x32_bf16 v[64:67], v[144:147], v[96:99], v[64:67]
v_mfma_f32_16x16x32_bf16 v[68:71], v[144:147], v[100:103], v[68:71]
v_mfma_f32_16x16x32_bf16 v[72:75], v[144:147], v[104:107], v[72:75]
v_mfma_f32_16x16x32_bf16 v[76:79], v[144:147], v[108:111], v[76:79]
s_add_u32 s23, s41, 2048
buffer_load_dwordx4 v[144:147], v1, s[8:11], s23 offen
ds_read_b128 v[96:99], v2 offset:24576
ds_read_b128 v[100:103], v2 offset:25600
ds_read_b128 v[104:107], v2 offset:26624
ds_read_b128 v[108:111], v2 offset:27648
s_waitcnt lgkmcnt(4)
v_mfma_f32_16x16x32_bf16 v[64:67], v[148:151], v[112:115], v[64:67]
v_mfma_f32_16x16x32_bf16 v[68:71], v[148:151], v[116:119], v[68:71]
v_mfma_f32_16x16x32_bf16 v[72:75], v[148:151], v[120:123], v[72:75]
v_mfma_f32_16x16x32_bf16 v[76:79], v[148:151], v[124:127], v[76:79]
s_add_u32 s23, s42, 2048
buffer_load_dwordx4 v[148:151], v1, s[8:11], s23 offen
ds_read_b128 v[112:115], v2 offset:28672
ds_read_b128 v[116:119], v2 offset:29696
ds_read_b128 v[120:123], v2 offset:30720
ds_read_b128 v[124:127], v2 offset:31744
s_waitcnt lgkmcnt(4)
v_mfma_f32_16x16x32_bf16 v[64:67], v[152:155], v[96:99], v[64:67]
v_mfma_f32_16x16x32_bf16 v[68:71], v[152:155], v[100:103], v[68:71]
v_mfma_f32_16x16x32_bf16 v[72:75], v[152:155], v[104:107], v[72:75]
v_mfma_f32_16x16x32_bf16 v[76:79], v[152:155], v[108:111], v[76:79]
s_add_u32 s23, s41, 3072
buffer_load_dwordx4 v[152:155], v1, s[8:11], s23 offen
s_waitcnt vmcnt(11)
s_barrier
ds_read_b128 v[96:99], v2 offset:32768
ds_read_b128 v[100:103], v2 offset:33792
ds_read_b128 v[104:107], v2 offset:34816
ds_read_b128 v[108:111], v2 offset:35840
s_waitcnt lgkmcnt(4)
v_mfma_f32_16x16x32_bf16 v[64:67], v[156:159], v[112:115], v[64:67]
v_mfma_f32_16x16x32_bf16 v[68:71], v[156:159], v[116:119], v[68:71]
v_mfma_f32_16x16x32_bf16 v[72:75], v[156:159], v[120:123], v[72:75]
v_mfma_f32_16x16x32_bf16 v[76:79], v[156:159], v[124:127], v[76:79]
s_add_u32 s23, s42, 3072
buffer_load_dwordx4 v[156:159], v1, s[8:11], s23 offen
ds_read_b128 v[112:115], v2 offset:36864
ds_read_b128 v[116:119], v2 offset:37888
ds_read_b128 v[120:123], v2 offset:38912
ds_read_b128 v[124:127], v2 offset:39936
s_waitcnt lgkmcnt(4)
v_mfma_f32_16x16x32_bf16 v[64:67], v[160:163], v[96:99], v[64:67]
v_mfma_f32_16x16x32_bf16 v[68:71], v[160:163], v[100:103], v[68:71]
v_mfma_f32_16x16x32_bf16 v[72:75], v[160:163], v[104:107], v[72:75]
v_mfma_f32_16x16x32_bf16 v[76:79], v[160:163], v[108:111], v[76:79]
s_add_u32 s23, s41, 4096
buffer_load_dwordx4 v[160:163], v1, s[8:11], s23 offen
ds_read_b128 v[96:99], v2 offset:40960
ds_read_b128 v[100:103], v2 offset:41984
ds_read_b128 v[104:107], v2 offset:43008
ds_read_b128 v[108:111], v2 offset:44032
s_waitcnt lgkmcnt(4)
v_mfma_f32_16x16x32_bf16 v[64:67], v[164:167], v[112:115], v[64:67]
v_mfma_f32_16x16x32_bf16 v[68:71], v[164:167], v[116:119], v[68:71]
v_mfma_f32_16x16x32_bf16 v[72:75], v[164:167], v[120:123], v[72:75]
v_mfma_f32_16x16x32_bf16 v[76:79], v[164:167], v[124:127], v[76:79]
s_add_u32 s23, s42, 4096
buffer_load_dwordx4 v[164:167], v1, s[8:11], s23 offen
ds_read_b128 v[112:115], v2 offset:45056
ds_read_b128 v[116:119], v2 offset:46080
ds_read_b128 v[120:123], v2 offset:47104
ds_read_b128 v[124:127], v2 offset:48128
s_waitcnt lgkmcnt(4)
v_mfma_f32_16x16x32_bf16 v[64:67], v[168:171], v[96:99], v[64:67]
v_mfma_f32_16x16x32_bf16 v[68:71], v[168:171], v[100:103], v[68:71]
v_mfma_f32_16x16x32_bf16 v[72:75], v[168:171], v[104:107], v[72:75]
v_mfma_f32_16x16x32_bf16 v[76:79], v[168:171], v[108:111], v[76:79]
s_add_u32 s23, s41, 5120
buffer_load_dwordx4 v[168:171], v1, s[8:11], s23 offen
s_waitcnt vmcnt(13)
s_barrier
ds_read_b128 v[96:99], v2 offset:49152
ds_read_b128 v[100:103], v2 offset:50176
ds_read_b128 v[104:107], v2 offset:51200
ds_read_b128 v[108:111], v2 offset:52224
s_waitcnt lgkmcnt(4)
v_mfma_f32_16x16x32_bf16 v[64:67], v[172:175], v[112:115], v[64:67]
v_mfma_f32_16x16x32_bf16 v[68:71], v[172:175], v[116:119], v[68:71]
v_mfma_f32_16x16x32_bf16 v[72:75], v[172:175], v[120:123], v[72:75]
v_mfma_f32_16x16x32_bf16 v[76:79], v[172:175], v[124:127], v[76:79]
s_add_u32 s23, s42, 5120
buffer_load_dwordx4 v[172:175], v1, s[8:11], s23 offen
ds_read_b128 v[112:115], v2 offset:53248
ds_read_b128 v[116:119], v2 offset:54272
ds_read_b128 v[120:123], v2 offset:55296
ds_read_b128 v[124:127], v2 offset:56320
s_waitcnt lgkmcnt(4)
v_mfma_f32_16x16x32_bf16 v[64:67], v[176:179], v[96:99], v[64:67]
v_mfma_f32_16x16x32_bf16 v[68:71], v[176:179], v[100:103], v[68:71]
v_mfma_f32_16x16x32_bf16 v[72:75], v[176:179], v[104:107], v[72:75]
v_mfma_f32_16x16x32_bf16 v[76:79], v[176:179], v[108:111], v[76:79]
s_add_u32 s23, s41, 6144
buffer_load_dwordx4 v[176:179], v1, s[8:11], s23 offen
ds_read_b128 v[96:99], v2 offset:57344
ds_read_b128 v[100:103], v2 offset:58368
ds_read_b128 v[104:107], v2 offset:59392
ds_read_b128 v[108:111], v2 offset:60416
s_waitcnt lgkmcnt(4)
v_mfma_f32_16x16x32_bf16 v[64:67], v[180:183], v[112:115], v[64:67]
v_mfma_f32_16x16x32_bf16 v[68:71], v[180:183], v[116:119], v[68:71]
v_mfma_f32_16x16x32_bf16 v[72:75], v[180:183], v[120:123], v[72:75]
v_mfma_f32_16x16x32_bf16 v[76:79], v[180:183], v[124:127], v[76:79]
s_add_u32 s23, s42, 6144
buffer_load_dwordx4 v[180:183], v1, s[8:11], s23 offen
ds_read_b128 v[112:115], v2 offset:61440
ds_read_b128 v[116:119], v2 offset:62464
ds_read_b128 v[120:123], v2 offset:63488
ds_read_b128 v[124:127], v2 offset:64512
s_waitcnt lgkmcnt(4)
v_mfma_f32_16x16x32_bf16 v[64:67], v[184:187], v[96:99], v[64:67]
v_mfma_f32_16x16x32_bf16 v[68:71], v[184:187], v[100:103], v[68:71]
v_mfma_f32_16x16x32_bf16 v[72:75], v[184:187], v[104:107], v[72:75]
v_mfma_f32_16x16x32_bf16 v[76:79], v[184:187], v[108:111], v[76:79]
s_add_u32 s23, s41, 7168
buffer_load_dwordx4 v[184:187], v1, s[8:11], s23 offen
s_waitcnt vmcnt(15)
s_barrier
ds_read_b128 v[96:99], v3 offset:0
ds_read_b128 v[100:103], v3 offset:1024
ds_read_b128 v[104:107], v3 offset:2048
ds_read_b128 v[108:111], v3 offset:3072
s_waitcnt lgkmcnt(4)
v_mfma_f32_16x16x32_bf16 v[64:67], v[188:191], v[112:115], v[64:67]
v_mfma_f32_16x16x32_bf16 v[68:71], v[188:191], v[116:119], v[68:71]
v_mfma_f32_16x16x32_bf16 v[72:75], v[188:191], v[120:123], v[72:75]
v_mfma_f32_16x16x32_bf16 v[76:79], v[188:191], v[124:127], v[76:79]
s_add_u32 s23, s42, 7168
buffer_load_dwordx4 v[188:191], v1, s[8:11], s23 offen
ds_read_b128 v[112:115], v3 offset:4096
ds_read_b128 v[116:119], v3 offset:5120
ds_read_b128 v[120:123], v3 offset:6144
ds_read_b128 v[124:127], v3 offset:7168
s_waitcnt lgkmcnt(4)
v_mfma_f32_16x16x32_bf16 v[64:67], v[192:195], v[96:99], v[64:67]
v_mfma_f32_16x16x32_bf16 v[68:71], v[192:195], v[100:103], v[68:71]
v_mfma_f32_16x16x32_bf16 v[72:75], v[192:195], v[104:107], v[72:75]
v_mfma_f32_16x16x32_bf16 v[76:79], v[192:195], v[108:111], v[76:79]
s_add_u32 s23, s41, 8192
buffer_load_dwordx4 v[192:195], v1, s[8:11], s23 offen
ds_read_b128 v[96:99], v3 offset:8192
ds_read_b128 v[100:103], v3 offset:9216
ds_read_b128 v[104:107], v3 offset:10240
ds_read_b128 v[108:111], v3 offset:11264
s_waitcnt lgkmcnt(4)
v_mfma_f32_16x16x32_bf16 v[64:67], v[196:199], v[112:115], v[64:67]
v_mfma_f32_16x16x32_bf16 v[68:71], v[196:199], v[116:119], v[68:71]
v_mfma_f32_16x16x32_bf16 v[72:75], v[196:199], v[120:123], v[72:75]
v_mfma_f32_16x16x32_bf16 v[76:79], v[196:199], v[124:127], v[76:79]
s_add_u32 s23, s42, 8192
buffer_load_dwordx4 v[196:199], v1, s[8:11], s23 offen
ds_read_b128 v[112:115], v3 offset:12288
ds_read_b128 v[116:119], v3 offset:13312
ds_read_b128 v[120:123], v3 offset:14336
ds_read_b128 v[124:127], v3 offset:15360
s_waitcnt lgkmcnt(4)
v_mfma_f32_16x16x32_bf16 v[64:67], v[200:203], v[96:99], v[64:67]
v_mfma_f32_16x16x32_bf16 v[68:71], v[200:203], v[100:103], v[68:71]
v_mfma_f32_16x16x32_bf16 v[72:75], v[200:203], v[104:107], v[72:75]
v_mfma_f32_16x16x32_bf16 v[76:79], v[200:203], v[108:111], v[76:79]
s_add_u32 s23, s41, 9216
buffer_load_dwordx4 v[200:203], v1, s[8:11], s23 offen
s_waitcnt lgkmcnt(0)
v_mfma_f32_16x16x32_bf16 v[64:67], v[204:207], v[112:115], v[64:67]
v_mfma_f32_16x16x32_bf16 v[68:71], v[204:207], v[116:119], v[68:71]
v_mfma_f32_16x16x32_bf16 v[72:75], v[204:207], v[120:123], v[72:75]
v_mfma_f32_16x16x32_bf16 v[76:79], v[204:207], v[124:127], v[76:79]
s_add_u32 s23, s42, 9216
buffer_load_dwordx4 v[204:207], v1, s[8:11], s23 offen
s_add_u32 s23, s41, 10240
buffer_load_dwordx4 v[208:211], v1, s[8:11], s23 offen
s_add_u32 s23, s42, 10240
buffer_load_dwordx4 v[212:215], v1, s[8:11], s23 offen
s_add_u32 s23, s41, 11264
buffer_load_dwordx4 v[216:219], v1, s[8:11], s23 offen
s_add_u32 s23, s42, 11264
buffer_load_dwordx4 v[220:223], v1, s[8:11], s23 offen
v_lshlrev_b32 v60, 3, v4
v_add_u32 v60, 132096, v60
ds_read_b64 v[224:225], v60 offset:0
ds_read_b64 v[226:227], v60 offset:128
ds_read_b64 v[228:229], v60 offset:256
ds_read_b64 v[230:231], v60 offset:384
v_cmp_eq_u32 vcc, 0, v4
v_mov_b32 v46, 0x3f803f80
s_nop 0
v_cndmask_b32 v232, 0, v46, vcc
v_mov_b32 v233, v232
v_cmp_eq_u32 vcc, 1, v4
s_nop 1
v_cndmask_b32 v234, 0, v46, vcc
v_mov_b32 v235, v234
s_add_u32 s34, s33, 11534336
v_add_u32 v61, s19, v4
v_mul_u32_u24 v61, 320, v61
s_lshl_b32 s24, s31, 3
s_add_u32 s24, s24, 262144
s_waitcnt lgkmcnt(0)
v_lshlrev_b32 v14, 16, v6
v_and_b32 v15, 0xffff0000, v6
v_lshlrev_b32 v16, 16, v7
v_and_b32 v17, 0xffff0000, v7
v_fma_f32 v14, v14, v224, -v225
v_fma_f32 v15, v15, v224, -v225
v_fma_f32 v16, v16, v224, -v225
v_fma_f32 v17, v17, v224, -v225
v_fma_f32 v14, v14, v30, v34
v_fma_f32 v15, v15, v31, v35
v_fma_f32 v16, v16, v32, v36
v_fma_f32 v17, v17, v33, v37
v_add_f32 v14, v14, v64
v_add_f32 v15, v15, v65
v_add_f32 v16, v16, v66
v_add_f32 v17, v17, v67
v_mul_f32 v64, v14, v14
v_mul_f32 v65, v15, v15
v_mul_f32 v66, v16, v16
v_mul_f32 v67, v17, v17
v_cvt_pk_bf16_f32 v236, v14, v15
v_cvt_pk_bf16_f32 v237, v16, v17
v_cvt_pk_bf16_f32 v238, v64, v65
v_cvt_pk_bf16_f32 v239, v66, v67
buffer_store_dwordx2 v[236:237], v1, s[8:11], s34 offen sc0 sc1
s_add_u32 s34, s34, 20480
v_mfma_f32_16x16x32_bf16 v[244:247], v[232:235], v[236:239], 0
s_nop 7
s_mov_b64 exec, 0xffff
buffer_store_dwordx2 v[244:245], v61, s[8:11], s24 offen sc0 sc1
s_mov_b64 exec, -1
s_add_u32 s24, s24, 5120
v_lshlrev_b32 v18, 16, v8
v_and_b32 v19, 0xffff0000, v8
v_lshlrev_b32 v20, 16, v9
v_and_b32 v21, 0xffff0000, v9
v_fma_f32 v18, v18, v226, -v227
v_fma_f32 v19, v19, v226, -v227
v_fma_f32 v20, v20, v226, -v227
v_fma_f32 v21, v21, v226, -v227
v_fma_f32 v18, v18, v30, v34
v_fma_f32 v19, v19, v31, v35
v_fma_f32 v20, v20, v32, v36
v_fma_f32 v21, v21, v33, v37
v_add_f32 v18, v18, v68
v_add_f32 v19, v19, v69
v_add_f32 v20, v20, v70
v_add_f32 v21, v21, v71
v_mul_f32 v68, v18, v18
v_mul_f32 v69, v19, v19
v_mul_f32 v70, v20, v20
v_mul_f32 v71, v21, v21
v_cvt_pk_bf16_f32 v240, v18, v19
v_cvt_pk_bf16_f32 v241, v20, v21
v_cvt_pk_bf16_f32 v242, v68, v69
v_cvt_pk_bf16_f32 v243, v70, v71
buffer_store_dwordx2 v[240:241], v1, s[8:11], s34 offen sc0 sc1
s_add_u32 s34, s34, 20480
v_mfma_f32_16x16x32_bf16 v[244:247], v[232:235], v[240:243], 0
s_nop 7
s_mov_b64 exec, 0xffff
buffer_store_dwordx2 v[244:245], v61, s[8:11], s24 offen sc0 sc1
s_mov_b64 exec, -1
s_add_u32 s24, s24, 5120
v_lshlrev_b32 v22, 16, v10
v_and_b32 v23, 0xffff0000, v10
v_lshlrev_b32 v24, 16, v11
v_and_b32 v25, 0xffff0000, v11
v_fma_f32 v22, v22, v228, -v229
v_fma_f32 v23, v23, v228, -v229
v_fma_f32 v24, v24, v228, -v229
v_fma_f32 v25, v25, v228, -v229
v_fma_f32 v22, v22, v30, v34
v_fma_f32 v23, v23, v31, v35
v_fma_f32 v24, v24, v32, v36
v_fma_f32 v25, v25, v33, v37
v_add_f32 v22, v22, v72
v_add_f32 v23, v23, v73
v_add_f32 v24, v24, v74
v_add_f32 v25, v25, v75
v_mul_f32 v72, v22, v22
v_mul_f32 v73, v23, v23
v_mul_f32 v74, v24, v24
v_mul_f32 v75, v25, v25
v_cvt_pk_bf16_f32 v236, v22, v23
v_cvt_pk_bf16_f32 v237, v24, v25
v_cvt_pk_bf16_f32 v238, v72, v73
v_cvt_pk_bf16_f32 v239, v74, v75
buffer_store_dwordx2 v[236:237], v1, s[8:11], s34 offen sc0 sc1
s_add_u32 s34, s34, 20480
v_mfma_f32_16x16x32_bf16 v[244:247], v[232:235], v[236:239], 0
s_nop 7
s_mov_b64 exec, 0xffff
buffer_store_dwordx2 v[244:245], v61, s[8:11], s24 offen sc0 sc1
s_mov_b64 exec, -1
s_add_u32 s24, s24, 5120
v_lshlrev_b32 v26, 16, v12
v_and_b32 v27, 0xffff0000, v12
v_lshlrev_b32 v28, 16, v13
v_and_b32 v29, 0xffff0000, v13
v_fma_f32 v26, v26, v230, -v231
v_fma_f32 v27, v27, v230, -v231
v_fma_f32 v28, v28, v230, -v231
v_fma_f32 v29, v29, v230, -v231
v_fma_f32 v26, v26, v30, v34
v_fma_f32 v27, v27, v31, v35
v_fma_f32 v28, v28, v32, v36
v_fma_f32 v29, v29, v33, v37
v_add_f32 v26, v26, v76
v_add_f32 v27, v27, v77
v_add_f32 v28, v28, v78
v_add_f32 v29, v29, v79
v_mul_f32 v76, v26, v26
v_mul_f32 v77, v27, v27
v_mul_f32 v78, v28, v28
v_mul_f32 v79, v29, v29
v_cvt_pk_bf16_f32 v240, v26, v27
v_cvt_pk_bf16_f32 v241, v28, v29
v_cvt_pk_bf16_f32 v242, v76, v77
v_cvt_pk_bf16_f32 v243, v78, v79
buffer_store_dwordx2 v[240:241], v1, s[8:11], s34 offen sc0 sc1
s_add_u32 s34, s34, 20480
v_mfma_f32_16x16x32_bf16 v[244:247], v[232:235], v[240:243], 0
s_nop 7
s_mov_b64 exec, 0xffff
buffer_store_dwordx2 v[244:245], v61, s[8:11], s24 offen sc0 sc1
s_mov_b64 exec, -1
s_add_u32 s24, s24, 5120
s_add_u32 s35, s35, 1024
s_add_u32 s36, s36, 1024
s_waitcnt vmcnt(0)
s_barrier
s_cmp_lg_u32 s18, 0
s_cbranch_scc1 L_47
v_mov_b32 v46, 0
v_mov_b32 v47, 1
buffer_store_dword v47, v46, s[8:11], s36 offen sc0 sc1
L_47:
s_and_b32 s24, s18, 3
s_lshl_b32 s24, s24, 4
s_add_u32 s24, s24, s19
v_add_u32 v46, s24, v4
v_lshrrev_b32 v47, 4, v46
v_mul_u32_u24 v47, 20480, v47
v_and_b32 v46, 15, v46
v_lshlrev_b32 v46, 4, v46
v_add_u32 v47, v47, v46
v_lshlrev_b32 v46, 8, v5
v_add_u32 v42, v47, v46
s_lshr_b32 s24, s18, 2
s_lshl_b32 s24, s24, 10
s_add_u32 s28, s24, 11534336
v_lshrrev_b32 v46, 2, v1
v_min_u32 v46, 28, v46
s_mov_b32 s30, 40000
L_48:
buffer_load_dword v47, v46, s[8:11], s35 offen sc0 sc1
s_waitcnt vmcnt(0)
v_cmp_ne_u32 vcc, 1, v47
s_nop 4
s_cbranch_vccz L_49
s_sub_u32 s30, s30, 1
s_cmp_lg_u32 s30, 0
s_cbranch_scc1 L_48
L_49:
s_add_u32 m0, s21, 0
s_add_u32 s22, s28, 0
buffer_load_dwordx4 v42, s[8:11], s22 offen sc0 sc1 lds
s_add_u32 m0, s21, 8192
s_add_u32 s22, s28, 2048
buffer_load_dwordx4 v42, s[8:11], s22 offen sc0 sc1 lds
s_add_u32 m0, s21, 16384
s_add_u32 s22, s28, 4096
buffer_load_dwordx4 v42, s[8:11], s22 offen sc0 sc1 lds
s_add_u32 m0, s21, 24576
s_add_u32 s22, s28, 6144
buffer_load_dwordx4 v42, s[8:11], s22 offen sc0 sc1 lds
s_add_u32 m0, s21, 32768
s_add_u32 s22, s28, 8192
buffer_load_dwordx4 v42, s[8:11], s22 offen sc0 sc1 lds
s_add_u32 m0, s21, 40960
s_add_u32 s22, s28, 10240
buffer_load_dwordx4 v42, s[8:11], s22 offen sc0 sc1 lds
s_add_u32 m0, s21, 49152
s_add_u32 s22, s28, 12288
buffer_load_dwordx4 v42, s[8:11], s22 offen sc0 sc1 lds
s_add_u32 m0, s21, 57344
s_add_u32 s22, s28, 14336
buffer_load_dwordx4 v42, s[8:11], s22 offen sc0 sc1 lds
s_add_u32 m0, s21, 65536
s_add_u32 s22, s28, 16384
buffer_load_dwordx4 v42, s[8:11], s22 offen sc0 sc1 lds
s_add_u32 m0, s21, 73728
s_add_u32 s22, s28, 18432
buffer_load_dwordx4 v42, s[8:11], s22 offen sc0 sc1 lds
v_mov_b32 v64, 0
v_mov_b32 v65, 0
v_mov_b32 v66, 0
v_mov_b32 v67, 0
v_mov_b32 v68, 0
v_mov_b32 v69, 0
v_mov_b32 v70, 0
v_mov_b32 v71, 0
v_mov_b32 v72, 0
v_mov_b32 v73, 0
v_mov_b32 v74, 0
v_mov_b32 v75, 0
v_mov_b32 v76, 0
v_mov_b32 v77, 0
v_mov_b32 v78, 0
v_mov_b32 v79, 0
v_mov_b32 v80, 0
v_mov_b32 v81, 0
v_mov_b32 v82, 0
v_mov_b32 v83, 0
v_mov_b32 v84, 0
v_mov_b32 v85, 0
v_mov_b32 v86, 0
v_mov_b32 v87, 0
v_mov_b32 v88, 0
v_mov_b32 v89, 0
v_mov_b32 v90, 0
v_mov_b32 v91, 0
v_mov_b32 v92, 0
v_mov_b32 v93, 0
v_mov_b32 v94, 0
v_mov_b32 v95, 0
s_waitcnt vmcnt(8)
s_barrier
ds_read_b128 v[96:99], v2 offset:0
ds_read_b128 v[100:103], v2 offset:1024
ds_read_b128 v[104:107], v2 offset:2048
ds_read_b128 v[108:111], v2 offset:3072
ds_read_b128 v[112:115], v2 offset:4096
ds_read_b128 v[116:119], v2 offset:5120
ds_read_b128 v[120:123], v2 offset:6144
ds_read_b128 v[124:127], v2 offset:7168
s_waitcnt lgkmcnt(4)
v_mfma_f32_16x16x32_bf16 v[64:67], v[128:131], v[96:99], v[64:67]
v_mfma_f32_16x16x32_bf16 v[68:71], v[128:131], v[100:103], v[68:71]
v_mfma_f32_16x16x32_bf16 v[72:75], v[128:131], v[104:107], v[72:75]
v_mfma_f32_16x16x32_bf16 v[76:79], v[128:131], v[108:111], v[76:79]
v_mfma_f32_16x16x32_bf16 v[80:83], v[132:135], v[96:99], v[80:83]
v_mfma_f32_16x16x32_bf16 v[84:87], v[132:135], v[100:103], v[84:87]
v_mfma_f32_16x16x32_bf16 v[88:91], v[132:135], v[104:107], v[88:91]
v_mfma_f32_16x16x32_bf16 v[92:95], v[132:135], v[108:111], v[92:95]
s_add_u32 s23, s41, 12288
buffer_load_dwordx4 v[128:131], v1, s[8:11], s23 offen
s_add_u32 s23, s42, 12288
buffer_load_dwordx4 v[132:135], v1, s[8:11], s23 offen
ds_read_b128 v[96:99], v2 offset:8192
ds_read_b128 v[100:103], v2 offset:9216
ds_read_b128 v[104:107], v2 offset:10240
ds_read_b128 v[108:111], v2 offset:11264
s_waitcnt lgkmcnt(4)
v_mfma_f32_16x16x32_bf16 v[64:67], v[136:139], v[112:115], v[64:67]
v_mfma_f32_16x16x32_bf16 v[68:71], v[136:139], v[116:119], v[68:71]
v_mfma_f32_16x16x32_bf16 v[72:75], v[136:139], v[120:123], v[72:75]
v_mfma_f32_16x16x32_bf16 v[76:79], v[136:139], v[124:127], v[76:79]
v_mfma_f32_16x16x32_bf16 v[80:83], v[140:143], v[112:115], v[80:83]
v_mfma_f32_16x16x32_bf16 v[84:87], v[140:143], v[116:119], v[84:87]
v_mfma_f32_16x16x32_bf16 v[88:91], v[140:143], v[120:123], v[88:91]
v_mfma_f32_16x16x32_bf16 v[92:95], v[140:143], v[124:127], v[92:95]
s_add_u32 s23, s41, 13312
buffer_load_dwordx4 v[136:139], v1, s[8:11], s23 offen
s_add_u32 s23, s42, 13312
buffer_load_dwordx4 v[140:143], v1, s[8:11], s23 offen
ds_read_b128 v[112:115], v2 offset:12288
ds_read_b128 v[116:119], v2 offset:13312
ds_read_b128 v[120:123], v2 offset:14336
ds_read_b128 v[124:127], v2 offset:15360
s_waitcnt lgkmcnt(4)
v_mfma_f32_16x16x32_bf16 v[64:67], v[144:147], v[96:99], v[64:67]
v_mfma_f32_16x16x32_bf16 v[68:71], v[144:147], v[100:103], v[68:71]
v_mfma_f32_16x16x32_bf16 v[72:75], v[144:147], v[104:107], v[72:75]
v_mfma_f32_16x16x32_bf16 v[76:79], v[144:147], v[108:111], v[76:79]
v_mfma_f32_16x16x32_bf16 v[80:83], v[148:151], v[96:99], v[80:83]
v_mfma_f32_16x16x32_bf16 v[84:87], v[148:151], v[100:103], v[84:87]
v_mfma_f32_16x16x32_bf16 v[88:91], v[148:151], v[104:107], v[88:91]
v_mfma_f32_16x16x32_bf16 v[92:95], v[148:151], v[108:111], v[92:95]
s_add_u32 s23, s41, 14336
buffer_load_dwordx4 v[144:147], v1, s[8:11], s23 offen
s_add_u32 s23, s42, 14336
buffer_load_dwordx4 v[148:151], v1, s[8:11], s23 offen
s_waitcnt vmcnt(12)
s_barrier
ds_read_b128 v[96:99], v2 offset:16384
ds_read_b128 v[100:103], v2 offset:17408
ds_read_b128 v[104:107], v2 offset:18432
ds_read_b128 v[108:111], v2 offset:19456
s_waitcnt lgkmcnt(4)
v_mfma_f32_16x16x32_bf16 v[64:67], v[152:155], v[112:115], v[64:67]
v_mfma_f32_16x16x32_bf16 v[68:71], v[152:155], v[116:119], v[68:71]
v_mfma_f32_16x16x32_bf16 v[72:75], v[152:155], v[120:123], v[72:75]
v_mfma_f32_16x16x32_bf16 v[76:79], v[152:155], v[124:127], v[76:79]
v_mfma_f32_16x16x32_bf16 v[80:83], v[156:159], v[112:115], v[80:83]
v_mfma_f32_16x16x32_bf16 v[84:87], v[156:159], v[116:119], v[84:87]
v_mfma_f32_16x16x32_bf16 v[88:91], v[156:159], v[120:123], v[88:91]
v_mfma_f32_16x16x32_bf16 v[92:95], v[156:159], v[124:127], v[92:95]
s_add_u32 s23, s41, 15360
buffer_load_dwordx4 v[152:155], v1, s[8:11], s23 offen
s_add_u32 s23, s42, 15360
buffer_load_dwordx4 v[156:159], v1, s[8:11], s23 offen
ds_read_b128 v[112:115], v2 offset:20480
ds_read_b128 v[116:119], v2 offset:21504
ds_read_b128 v[120:123], v2 offset:22528
ds_read_b128 v[124:127], v2 offset:23552
s_waitcnt lgkmcnt(4)
v_mfma_f32_16x16x32_bf16 v[64:67], v[160:163], v[96:99], v[64:67]
v_mfma_f32_16x16x32_bf16 v[68:71], v[160:163], v[100:103], v[68:71]
v_mfma_f32_16x16x32_bf16 v[72:75], v[160:163], v[104:107], v[72:75]
v_mfma_f32_16x16x32_bf16 v[76:79], v[160:163], v[108:111], v[76:79]
v_mfma_f32_16x16x32_bf16 v[80:83], v[164:167], v[96:99], v[80:83]
v_mfma_f32_16x16x32_bf16 v[84:87], v[164:167], v[100:103], v[84:87]
v_mfma_f32_16x16x32_bf16 v[88:91], v[164:167], v[104:107], v[88:91]
v_mfma_f32_16x16x32_bf16 v[92:95], v[164:167], v[108:111], v[92:95]
s_add_u32 s23, s41, 16384
buffer_load_dwordx4 v[160:163], v1, s[8:11], s23 offen
s_add_u32 s23, s42, 16384
buffer_load_dwordx4 v[164:167], v1, s[8:11], s23 offen
ds_read_b128 v[96:99], v2 offset:24576
ds_read_b128 v[100:103], v2 offset:25600
ds_read_b128 v[104:107], v2 offset:26624
ds_read_b128 v[108:111], v2 offset:27648
s_waitcnt lgkmcnt(4)
v_mfma_f32_16x16x32_bf16 v[64:67], v[168:171], v[112:115], v[64:67]
v_mfma_f32_16x16x32_bf16 v[68:71], v[168:171], v[116:119], v[68:71]
v_mfma_f32_16x16x32_bf16 v[72:75], v[168:171], v[120:123], v[72:75]
v_mfma_f32_16x16x32_bf16 v[76:79], v[168:171], v[124:127], v[76:79]
v_mfma_f32_16x16x32_bf16 v[80:83], v[172:175], v[112:115], v[80:83]
v_mfma_f32_16x16x32_bf16 v[84:87], v[172:175], v[116:119], v[84:87]
v_mfma_f32_16x16x32_bf16 v[88:91], v[172:175], v[120:123], v[88:91]
v_mfma_f32_16x16x32_bf16 v[92:95], v[172:175], v[124:127], v[92:95]
s_add_u32 s23, s41, 17408
buffer_load_dwordx4 v[168:171], v1, s[8:11], s23 offen
s_add_u32 s23, s42, 17408
buffer_load_dwordx4 v[172:175], v1, s[8:11], s23 offen
ds_read_b128 v[112:115], v2 offset:28672
ds_read_b128 v[116:119], v2 offset:29696
ds_read_b128 v[120:123], v2 offset:30720
ds_read_b128 v[124:127], v2 offset:31744
s_waitcnt lgkmcnt(4)
v_mfma_f32_16x16x32_bf16 v[64:67], v[176:179], v[96:99], v[64:67]
v_mfma_f32_16x16x32_bf16 v[68:71], v[176:179], v[100:103], v[68:71]
v_mfma_f32_16x16x32_bf16 v[72:75], v[176:179], v[104:107], v[72:75]
v_mfma_f32_16x16x32_bf16 v[76:79], v[176:179], v[108:111], v[76:79]
v_mfma_f32_16x16x32_bf16 v[80:83], v[180:183], v[96:99], v[80:83]
v_mfma_f32_16x16x32_bf16 v[84:87], v[180:183], v[100:103], v[84:87]
v_mfma_f32_16x16x32_bf16 v[88:91], v[180:183], v[104:107], v[88:91]
v_mfma_f32_16x16x32_bf16 v[92:95], v[180:183], v[108:111], v[92:95]
s_add_u32 s23, s41, 18432
buffer_load_dwordx4 v[176:179], v1, s[8:11], s23 offen
s_add_u32 s23, s42, 18432
buffer_load_dwordx4 v[180:183], v1, s[8:11], s23 offen
s_waitcnt vmcnt(18)
s_barrier
ds_read_b128 v[96:99], v2 offset:32768
ds_read_b128 v[100:103], v2 offset:33792
ds_read_b128 v[104:107], v2 offset:34816
ds_read_b128 v[108:111], v2 offset:35840
s_waitcnt lgkmcnt(4)
v_mfma_f32_16x16x32_bf16 v[64:67], v[184:187], v[112:115], v[64:67]
v_mfma_f32_16x16x32_bf16 v[68:71], v[184:187], v[116:119], v[68:71]
v_mfma_f32_16x16x32_bf16 v[72:75], v[184:187], v[120:123], v[72:75]
v_mfma_f32_16x16x32_bf16 v[76:79], v[184:187], v[124:127], v[76:79]
v_mfma_f32_16x16x32_bf16 v[80:83], v[188:191], v[112:115], v[80:83]
v_mfma_f32_16x16x32_bf16 v[84:87], v[188:191], v[116:119], v[84:87]
v_mfma_f32_16x16x32_bf16 v[88:91], v[188:191], v[120:123], v[88:91]
v_mfma_f32_16x16x32_bf16 v[92:95], v[188:191], v[124:127], v[92:95]
s_add_u32 s23, s41, 19456
buffer_load_dwordx4 v[184:187], v1, s[8:11], s23 offen
s_add_u32 s23, s42, 19456
buffer_load_dwordx4 v[188:191], v1, s[8:11], s23 offen
ds_read_b128 v[112:115], v2 offset:36864
ds_read_b128 v[116:119], v2 offset:37888
ds_read_b128 v[120:123], v2 offset:38912
ds_read_b128 v[124:127], v2 offset:39936
s_waitcnt lgkmcnt(4)
v_mfma_f32_16x16x32_bf16 v[64:67], v[192:195], v[96:99], v[64:67]
v_mfma_f32_16x16x32_bf16 v[68:71], v[192:195], v[100:103], v[68:71]
v_mfma_f32_16x16x32_bf16 v[72:75], v[192:195], v[104:107], v[72:75]
v_mfma_f32_16x16x32_bf16 v[76:79], v[192:195], v[108:111], v[76:79]
v_mfma_f32_16x16x32_bf16 v[80:83], v[196:199], v[96:99], v[80:83]
v_mfma_f32_16x16x32_bf16 v[84:87], v[196:199], v[100:103], v[84:87]
v_mfma_f32_16x16x32_bf16 v[88:91], v[196:199], v[104:107], v[88:91]
v_mfma_f32_16x16x32_bf16 v[92:95], v[196:199], v[108:111], v[92:95]
s_add_u32 s23, s50, 16384
buffer_load_dwordx4 v[192:195], v1, s[8:11], s23 offen
s_add_u32 s23, s50, 17408
buffer_load_dwordx4 v[196:199], v1, s[8:11], s23 offen
ds_read_b128 v[96:99], v2 offset:40960
ds_read_b128 v[100:103], v2 offset:41984
ds_read_b128 v[104:107], v2 offset:43008
ds_read_b128 v[108:111], v2 offset:44032
s_waitcnt lgkmcnt(4)
v_mfma_f32_16x16x32_bf16 v[64:67], v[200:203], v[112:115], v[64:67]
v_mfma_f32_16x16x32_bf16 v[68:71], v[200:203], v[116:119], v[68:71]
v_mfma_f32_16x16x32_bf16 v[72:75], v[200:203], v[120:123], v[72:75]
v_mfma_f32_16x16x32_bf16 v[76:79], v[200:203], v[124:127], v[76:79]
v_mfma_f32_16x16x32_bf16 v[80:83], v[204:207], v[112:115], v[80:83]
v_mfma_f32_16x16x32_bf16 v[84:87], v[204:207], v[116:119], v[84:87]
v_mfma_f32_16x16x32_bf16 v[88:91], v[204:207], v[120:123], v[88:91]
v_mfma_f32_16x16x32_bf16 v[92:95], v[204:207], v[124:127], v[92:95]
s_add_u32 s23, s50, 18432
buffer_load_dwordx4 v[200:203], v1, s[8:11], s23 offen
s_add_u32 s23, s50, 19456
buffer_load_dwordx4 v[204:207], v1, s[8:11], s23 offen
ds_read_b128 v[112:115], v2 offset:45056
ds_read_b128 v[116:119], v2 offset:46080
ds_read_b128 v[120:123], v2 offset:47104
ds_read_b128 v[124:127], v2 offset:48128
s_waitcnt lgkmcnt(4)
v_mfma_f32_16x16x32_bf16 v[64:67], v[208:211], v[96:99], v[64:67]
v_mfma_f32_16x16x32_bf16 v[68:71], v[208:211], v[100:103], v[68:71]
v_mfma_f32_16x16x32_bf16 v[72:75], v[208:211], v[104:107], v[72:75]
v_mfma_f32_16x16x32_bf16 v[76:79], v[208:211], v[108:111], v[76:79]
v_mfma_f32_16x16x32_bf16 v[80:83], v[212:215], v[96:99], v[80:83]
v_mfma_f32_16x16x32_bf16 v[84:87], v[212:215], v[100:103], v[84:87]
v_mfma_f32_16x16x32_bf16 v[88:91], v[212:215], v[104:107], v[88:91]
v_mfma_f32_16x16x32_bf16 v[92:95], v[212:215], v[108:111], v[92:95]
s_add_u32 s23, s50, 20480
buffer_load_dwordx4 v[208:211], v1, s[8:11], s23 offen
s_add_u32 s23, s50, 21504
buffer_load_dwordx4 v[212:215], v1, s[8:11], s23 offen
s_waitcnt vmcnt(24)
s_barrier
ds_read_b128 v[96:99], v2 offset:49152
ds_read_b128 v[100:103], v2 offset:50176
ds_read_b128 v[104:107], v2 offset:51200
ds_read_b128 v[108:111], v2 offset:52224
s_waitcnt lgkmcnt(4)
v_mfma_f32_16x16x32_bf16 v[64:67], v[216:219], v[112:115], v[64:67]
v_mfma_f32_16x16x32_bf16 v[68:71], v[216:219], v[116:119], v[68:71]
v_mfma_f32_16x16x32_bf16 v[72:75], v[216:219], v[120:123], v[72:75]
v_mfma_f32_16x16x32_bf16 v[76:79], v[216:219], v[124:127], v[76:79]
v_mfma_f32_16x16x32_bf16 v[80:83], v[220:223], v[112:115], v[80:83]
v_mfma_f32_16x16x32_bf16 v[84:87], v[220:223], v[116:119], v[84:87]
v_mfma_f32_16x16x32_bf16 v[88:91], v[220:223], v[120:123], v[88:91]
v_mfma_f32_16x16x32_bf16 v[92:95], v[220:223], v[124:127], v[92:95]
s_add_u32 s23, s50, 22528
buffer_load_dwordx4 v[216:219], v1, s[8:11], s23 offen
s_add_u32 s23, s50, 23552
buffer_load_dwordx4 v[220:223], v1, s[8:11], s23 offen
ds_read_b128 v[112:115], v2 offset:53248
ds_read_b128 v[116:119], v2 offset:54272
ds_read_b128 v[120:123], v2 offset:55296
ds_read_b128 v[124:127], v2 offset:56320
s_waitcnt vmcnt(22)
s_waitcnt lgkmcnt(4)
v_mfma_f32_16x16x32_bf16 v[64:67], v[128:131], v[96:99], v[64:67]
v_mfma_f32_16x16x32_bf16 v[68:71], v[128:131], v[100:103], v[68:71]
v_mfma_f32_16x16x32_bf16 v[72:75], v[128:131], v[104:107], v[72:75]
v_mfma_f32_16x16x32_bf16 v[76:79], v[128:131], v[108:111], v[76:79]
v_mfma_f32_16x16x32_bf16 v[80:83], v[132:135], v[96:99], v[80:83]
v_mfma_f32_16x16x32_bf16 v[84:87], v[132:135], v[100:103], v[84:87]
v_mfma_f32_16x16x32_bf16 v[88:91], v[132:135], v[104:107], v[88:91]
v_mfma_f32_16x16x32_bf16 v[92:95], v[132:135], v[108:111], v[92:95]
s_add_u32 s23, s50, 0
buffer_load_dwordx4 v[128:131], v1, s[8:11], s23 offen
s_add_u32 s23, s50, 1024
buffer_load_dwordx4 v[132:135], v1, s[8:11], s23 offen
ds_read_b128 v[96:99], v2 offset:57344
ds_read_b128 v[100:103], v2 offset:58368
ds_read_b128 v[104:107], v2 offset:59392
ds_read_b128 v[108:111], v2 offset:60416
s_waitcnt vmcnt(22)
s_waitcnt lgkmcnt(4)
v_mfma_f32_16x16x32_bf16 v[64:67], v[136:139], v[112:115], v[64:67]
v_mfma_f32_16x16x32_bf16 v[68:71], v[136:139], v[116:119], v[68:71]
v_mfma_f32_16x16x32_bf16 v[72:75], v[136:139], v[120:123], v[72:75]
v_mfma_f32_16x16x32_bf16 v[76:79], v[136:139], v[124:127], v[76:79]
v_mfma_f32_16x16x32_bf16 v[80:83], v[140:143], v[112:115], v[80:83]
v_mfma_f32_16x16x32_bf16 v[84:87], v[140:143], v[116:119], v[84:87]
v_mfma_f32_16x16x32_bf16 v[88:91], v[140:143], v[120:123], v[88:91]
v_mfma_f32_16x16x32_bf16 v[92:95], v[140:143], v[124:127], v[92:95]
s_add_u32 s23, s50, 2048
buffer_load_dwordx4 v[136:139], v1, s[8:11], s23 offen
s_add_u32 s23, s50, 3072
buffer_load_dwordx4 v[140:143], v1, s[8:11], s23 offen
ds_read_b128 v[112:115], v2 offset:61440
ds_read_b128 v[116:119], v2 offset:62464
ds_read_b128 v[120:123], v2 offset:63488
ds_read_b128 v[124:127], v2 offset:64512
s_waitcnt vmcnt(22)
s_waitcnt lgkmcnt(4)
v_mfma_f32_16x16x32_bf16 v[64:67], v[144:147], v[96:99], v[64:67]
v_mfma_f32_16x16x32_bf16 v[68:71], v[144:147], v[100:103], v[68:71]
v_mfma_f32_16x16x32_bf16 v[72:75], v[144:147], v[104:107], v[72:75]
v_mfma_f32_16x16x32_bf16 v[76:79], v[144:147], v[108:111], v[76:79]
v_mfma_f32_16x16x32_bf16 v[80:83], v[148:151], v[96:99], v[80:83]
v_mfma_f32_16x16x32_bf16 v[84:87], v[148:151], v[100:103], v[84:87]
v_mfma_f32_16x16x32_bf16 v[88:91], v[148:151], v[104:107], v[88:91]
v_mfma_f32_16x16x32_bf16 v[92:95], v[148:151], v[108:111], v[92:95]
s_add_u32 s23, s50, 4096
buffer_load_dwordx4 v[144:147], v1, s[8:11], s23 offen
s_add_u32 s23, s50, 5120
buffer_load_dwordx4 v[148:151], v1, s[8:11], s23 offen
s_waitcnt vmcnt(30)
s_barrier
s_lshl_b32 s24, s38, 6
s_add_u32 s24, s24, 138752
v_lshlrev_b32 v48, 4, v5
buffer_load_dwordx4 v[248:251], v48, s[8:11], s24 offen
s_lshl_b32 s24, s39, 6
s_add_u32 s24, s24, 138752
v_lshlrev_b32 v48, 4, v5
buffer_load_dwordx4 v[252:255], v48, s[8:11], s24 offen
ds_read_b128 v[96:99], v3 offset:0
ds_read_b128 v[100:103], v3 offset:1024
ds_read_b128 v[104:107], v3 offset:2048
ds_read_b128 v[108:111], v3 offset:3072
s_waitcnt vmcnt(24)
s_waitcnt lgkmcnt(4)
v_mfma_f32_16x16x32_bf16 v[64:67], v[152:155], v[112:115], v[64:67]
v_mfma_f32_16x16x32_bf16 v[68:71], v[152:155], v[116:119], v[68:71]
v_mfma_f32_16x16x32_bf16 v[72:75], v[152:155], v[120:123], v[72:75]
v_mfma_f32_16x16x32_bf16 v[76:79], v[152:155], v[124:127], v[76:79]
v_mfma_f32_16x16x32_bf16 v[80:83], v[156:159], v[112:115], v[80:83]
v_mfma_f32_16x16x32_bf16 v[84:87], v[156:159], v[116:119], v[84:87]
v_mfma_f32_16x16x32_bf16 v[88:91], v[156:159], v[120:123], v[88:91]
v_mfma_f32_16x16x32_bf16 v[92:95], v[156:159], v[124:127], v[92:95]
s_add_u32 s23, s50, 6144
buffer_load_dwordx4 v[152:155], v1, s[8:11], s23 offen
s_add_u32 s23, s50, 7168
buffer_load_dwordx4 v[156:159], v1, s[8:11], s23 offen
ds_read_b128 v[112:115], v3 offset:4096
ds_read_b128 v[116:119], v3 offset:5120
ds_read_b128 v[120:123], v3 offset:6144
ds_read_b128 v[124:127], v3 offset:7168
s_waitcnt vmcnt(24)
s_waitcnt lgkmcnt(4)
v_mfma_f32_16x16x32_bf16 v[64:67], v[160:163], v[96:99], v[64:67]
v_mfma_f32_16x16x32_bf16 v[68:71], v[160:163], v[100:103], v[68:71]
v_mfma_f32_16x16x32_bf16 v[72:75], v[160:163], v[104:107], v[72:75]
v_mfma_f32_16x16x32_bf16 v[76:79], v[160:163], v[108:111], v[76:79]
v_mfma_f32_16x16x32_bf16 v[80:83], v[164:167], v[96:99], v[80:83]
v_mfma_f32_16x16x32_bf16 v[84:87], v[164:167], v[100:103], v[84:87]
v_mfma_f32_16x16x32_bf16 v[88:91], v[164:167], v[104:107], v[88:91]
v_mfma_f32_16x16x32_bf16 v[92:95], v[164:167], v[108:111], v[92:95]
s_add_u32 s23, s50, 8192
buffer_load_dwordx4 v[160:163], v1, s[8:11], s23 offen
s_add_u32 s23, s50, 9216
buffer_load_dwordx4 v[164:167], v1, s[8:11], s23 offen
ds_read_b128 v[96:99], v3 offset:8192
ds_read_b128 v[100:103], v3 offset:9216
ds_read_b128 v[104:107], v3 offset:10240
ds_read_b128 v[108:111], v3 offset:11264
s_waitcnt vmcnt(24)
s_waitcnt lgkmcnt(4)
v_mfma_f32_16x16x32_bf16 v[64:67], v[168:171], v[112:115], v[64:67]
v_mfma_f32_16x16x32_bf16 v[68:71], v[168:171], v[116:119], v[68:71]
v_mfma_f32_16x16x32_bf16 v[72:75], v[168:171], v[120:123], v[72:75]
v_mfma_f32_16x16x32_bf16 v[76:79], v[168:171], v[124:127], v[76:79]
v_mfma_f32_16x16x32_bf16 v[80:83], v[172:175], v[112:115], v[80:83]
v_mfma_f32_16x16x32_bf16 v[84:87], v[172:175], v[116:119], v[84:87]
v_mfma_f32_16x16x32_bf16 v[88:91], v[172:175], v[120:123], v[88:91]
v_mfma_f32_16x16x32_bf16 v[92:95], v[172:175], v[124:127], v[92:95]
s_add_u32 s23, s50, 10240
buffer_load_dwordx4 v[168:171], v1, s[8:11], s23 offen
s_add_u32 s23, s50, 11264
buffer_load_dwordx4 v[172:175], v1, s[8:11], s23 offen
ds_read_b128 v[112:115], v3 offset:12288
ds_read_b128 v[116:119], v3 offset:13312
ds_read_b128 v[120:123], v3 offset:14336
ds_read_b128 v[124:127], v3 offset:15360
s_waitcnt vmcnt(24)
s_waitcnt lgkmcnt(4)
v_mfma_f32_16x16x32_bf16 v[64:67], v[176:179], v[96:99], v[64:67]
v_mfma_f32_16x16x32_bf16 v[68:71], v[176:179], v[100:103], v[68:71]
v_mfma_f32_16x16x32_bf16 v[72:75], v[176:179], v[104:107], v[72:75]
v_mfma_f32_16x16x32_bf16 v[76:79], v[176:179], v[108:111], v[76:79]
v_mfma_f32_16x16x32_bf16 v[80:83], v[180:183], v[96:99], v[80:83]
v_mfma_f32_16x16x32_bf16 v[84:87], v[180:183], v[100:103], v[84:87]
v_mfma_f32_16x16x32_bf16 v[88:91], v[180:183], v[104:107], v[88:91]
v_mfma_f32_16x16x32_bf16 v[92:95], v[180:183], v[108:111], v[92:95]
s_add_u32 s23, s50, 12288
buffer_load_dwordx4 v[176:179], v1, s[8:11], s23 offen
s_add_u32 s23, s50, 13312
buffer_load_dwordx4 v[180:183], v1, s[8:11], s23 offen
s_waitcnt vmcnt(24)
s_waitcnt lgkmcnt(0)
v_mfma_f32_16x16x32_bf16 v[64:67], v[184:187], v[112:115], v[64:67]
v_mfma_f32_16x16x32_bf16 v[68:71], v[184:187], v[116:119], v[68:71]
v_mfma_f32_16x16x32_bf16 v[72:75], v[184:187], v[120:123], v[72:75]
v_mfma_f32_16x16x32_bf16 v[76:79], v[184:187], v[124:127], v[76:79]
v_mfma_f32_16x16x32_bf16 v[80:83], v[188:191], v[112:115], v[80:83]
v_mfma_f32_16x16x32_bf16 v[84:87], v[188:191], v[116:119], v[84:87]
v_mfma_f32_16x16x32_bf16 v[88:91], v[188:191], v[120:123], v[88:91]
v_mfma_f32_16x16x32_bf16 v[92:95], v[188:191], v[124:127], v[92:95]
s_add_u32 s23, s50, 14336
buffer_load_dwordx4 v[184:187], v1, s[8:11], s23 offen
s_add_u32 s23, s50, 15360
buffer_load_dwordx4 v[188:191], v1, s[8:11], s23 offen
s_waitcnt vmcnt(10)
v_lshlrev_b32 v60, 3, v4
v_add_u32 v60, 132608, v60
ds_read_b64 v[224:225], v60 offset:0
ds_read_b64 v[226:227], v60 offset:128
ds_read_b64 v[228:229], v60 offset:256
ds_read_b64 v[230:231], v60 offset:384
s_waitcnt lgkmcnt(0)
s_lshr_b32 s24, s38, 1
s_lshl_b32 s24, s24, 10
s_and_b32 s25, s38, 1
s_lshl_b32 s25, s25, 3
s_add_u32 s24, s24, s25
s_mul_i32 s25, s16, 221184
s_add_u32 s24, s24, s25
s_add_u32 s34, s24, 0
s_add_u32 s34, s34, 3670016
v_mul_f32 v64, v64, v224
v_mul_f32 v65, v65, v224
v_mul_f32 v66, v66, v224
v_mul_f32 v67, v67, v224
v_fmac_f32 v64, v225, v248
v_fmac_f32 v65, v225, v249
v_fmac_f32 v66, v225, v250
v_fmac_f32 v67, v225, v251
v_mul_f32 v240, v64, v64
v_mul_f32 v241, v65, v65
v_mul_f32 v242, v66, v66
v_mul_f32 v243, v67, v67
v_fma_f32 v240, v240, s40, v63
v_fma_f32 v241, v241, s40, v63
v_fma_f32 v242, v242, s40, v63
v_fma_f32 v243, v243, s40, v63
v_mul_f32 v240, v240, v64
v_mul_f32 v241, v241, v65
v_mul_f32 v242, v242, v66
v_mul_f32 v243, v243, v67
v_exp_f32 v240, v240
v_exp_f32 v241, v241
v_exp_f32 v242, v242
v_exp_f32 v243, v243
v_add_f32 v240, 1.0, v240
v_add_f32 v241, 1.0, v241
v_add_f32 v242, 1.0, v242
v_add_f32 v243, 1.0, v243
v_rcp_f32 v240, v240
v_rcp_f32 v241, v241
v_rcp_f32 v242, v242
v_rcp_f32 v243, v243
v_mul_f32 v64, v64, v240
v_mul_f32 v65, v65, v241
v_mul_f32 v66, v66, v242
v_mul_f32 v67, v67, v243
v_cvt_pk_bf16_f32 v232, v64, v65
v_cvt_pk_bf16_f32 v233, v66, v67
buffer_store_dwordx2 v[232:233], v1, s[8:11], s34 offen sc0 sc1
s_add_u32 s34, s34, 55296
v_mul_f32 v68, v68, v226
v_mul_f32 v69, v69, v226
v_mul_f32 v70, v70, v226
v_mul_f32 v71, v71, v226
v_fmac_f32 v68, v227, v248
v_fmac_f32 v69, v227, v249
v_fmac_f32 v70, v227, v250
v_fmac_f32 v71, v227, v251
v_mul_f32 v240, v68, v68
v_mul_f32 v241, v69, v69
v_mul_f32 v242, v70, v70
v_mul_f32 v243, v71, v71
v_fma_f32 v240, v240, s40, v63
v_fma_f32 v241, v241, s40, v63
v_fma_f32 v242, v242, s40, v63
v_fma_f32 v243, v243, s40, v63
v_mul_f32 v240, v240, v68
v_mul_f32 v241, v241, v69
v_mul_f32 v242, v242, v70
v_mul_f32 v243, v243, v71
v_exp_f32 v240, v240
v_exp_f32 v241, v241
v_exp_f32 v242, v242
v_exp_f32 v243, v243
v_add_f32 v240, 1.0, v240
v_add_f32 v241, 1.0, v241
v_add_f32 v242, 1.0, v242
v_add_f32 v243, 1.0, v243
v_rcp_f32 v240, v240
v_rcp_f32 v241, v241
v_rcp_f32 v242, v242
v_rcp_f32 v243, v243
v_mul_f32 v68, v68, v240
v_mul_f32 v69, v69, v241
v_mul_f32 v70, v70, v242
v_mul_f32 v71, v71, v243
v_cvt_pk_bf16_f32 v234, v68, v69
v_cvt_pk_bf16_f32 v235, v70, v71
buffer_store_dwordx2 v[234:235], v1, s[8:11], s34 offen sc0 sc1
s_add_u32 s34, s34, 55296
v_mul_f32 v72, v72, v228
v_mul_f32 v73, v73, v228
v_mul_f32 v74, v74, v228
v_mul_f32 v75, v75, v228
v_fmac_f32 v72, v229, v248
v_fmac_f32 v73, v229, v249
v_fmac_f32 v74, v229, v250
v_fmac_f32 v75, v229, v251
v_mul_f32 v240, v72, v72
v_mul_f32 v241, v73, v73
v_mul_f32 v242, v74, v74
v_mul_f32 v243, v75, v75
v_fma_f32 v240, v240, s40, v63
v_fma_f32 v241, v241, s40, v63
v_fma_f32 v242, v242, s40, v63
v_fma_f32 v243, v243, s40, v63
v_mul_f32 v240, v240, v72
v_mul_f32 v241, v241, v73
v_mul_f32 v242, v242, v74
v_mul_f32 v243, v243, v75
v_exp_f32 v240, v240
v_exp_f32 v241, v241
v_exp_f32 v242, v242
v_exp_f32 v243, v243
v_add_f32 v240, 1.0, v240
v_add_f32 v241, 1.0, v241
v_add_f32 v242, 1.0, v242
v_add_f32 v243, 1.0, v243
v_rcp_f32 v240, v240
v_rcp_f32 v241, v241
v_rcp_f32 v242, v242
v_rcp_f32 v243, v243
v_mul_f32 v72, v72, v240
v_mul_f32 v73, v73, v241
v_mul_f32 v74, v74, v242
v_mul_f32 v75, v75, v243
v_cvt_pk_bf16_f32 v236, v72, v73
v_cvt_pk_bf16_f32 v237, v74, v75
buffer_store_dwordx2 v[236:237], v1, s[8:11], s34 offen sc0 sc1
s_add_u32 s34, s34, 55296
v_mul_f32 v76, v76, v230
v_mul_f32 v77, v77, v230
v_mul_f32 v78, v78, v230
v_mul_f32 v79, v79, v230
v_fmac_f32 v76, v231, v248
v_fmac_f32 v77, v231, v249
v_fmac_f32 v78, v231, v250
v_fmac_f32 v79, v231, v251
v_mul_f32 v240, v76, v76
v_mul_f32 v241, v77, v77
v_mul_f32 v242, v78, v78
v_mul_f32 v243, v79, v79
v_fma_f32 v240, v240, s40, v63
v_fma_f32 v241, v241, s40, v63
v_fma_f32 v242, v242, s40, v63
v_fma_f32 v243, v243, s40, v63
v_mul_f32 v240, v240, v76
v_mul_f32 v241, v241, v77
v_mul_f32 v242, v242, v78
v_mul_f32 v243, v243, v79
v_exp_f32 v240, v240
v_exp_f32 v241, v241
v_exp_f32 v242, v242
v_exp_f32 v243, v243
v_add_f32 v240, 1.0, v240
v_add_f32 v241, 1.0, v241
v_add_f32 v242, 1.0, v242
v_add_f32 v243, 1.0, v243
v_rcp_f32 v240, v240
v_rcp_f32 v241, v241
v_rcp_f32 v242, v242
v_rcp_f32 v243, v243
v_mul_f32 v76, v76, v240
v_mul_f32 v77, v77, v241
v_mul_f32 v78, v78, v242
v_mul_f32 v79, v79, v243
v_cvt_pk_bf16_f32 v238, v76, v77
v_cvt_pk_bf16_f32 v239, v78, v79
buffer_store_dwordx2 v[238:239], v1, s[8:11], s34 offen sc0 sc1
s_add_u32 s34, s34, 55296
s_lshr_b32 s24, s39, 1
s_lshl_b32 s24, s24, 10
s_and_b32 s25, s39, 1
s_lshl_b32 s25, s25, 3
s_add_u32 s24, s24, s25
s_mul_i32 s25, s16, 221184
s_add_u32 s24, s24, s25
s_add_u32 s34, s24, 0
s_add_u32 s34, s34, 3670016
v_mul_f32 v80, v80, v224
v_mul_f32 v81, v81, v224
v_mul_f32 v82, v82, v224
v_mul_f32 v83, v83, v224
v_fmac_f32 v80, v225, v252
v_fmac_f32 v81, v225, v253
v_fmac_f32 v82, v225, v254
v_fmac_f32 v83, v225, v255
v_mul_f32 v240, v80, v80
v_mul_f32 v241, v81, v81
v_mul_f32 v242, v82, v82
v_mul_f32 v243, v83, v83
v_fma_f32 v240, v240, s40, v63
v_fma_f32 v241, v241, s40, v63
v_fma_f32 v242, v242, s40, v63
v_fma_f32 v243, v243, s40, v63
v_mul_f32 v240, v240, v80
v_mul_f32 v241, v241, v81
v_mul_f32 v242, v242, v82
v_mul_f32 v243, v243, v83
v_exp_f32 v240, v240
v_exp_f32 v241, v241
v_exp_f32 v242, v242
v_exp_f32 v243, v243
v_add_f32 v240, 1.0, v240
v_add_f32 v241, 1.0, v241
v_add_f32 v242, 1.0, v242
v_add_f32 v243, 1.0, v243
v_rcp_f32 v240, v240
v_rcp_f32 v241, v241
v_rcp_f32 v242, v242
v_rcp_f32 v243, v243
v_mul_f32 v80, v80, v240
v_mul_f32 v81, v81, v241
v_mul_f32 v82, v82, v242
v_mul_f32 v83, v83, v243
v_cvt_pk_bf16_f32 v232, v80, v81
v_cvt_pk_bf16_f32 v233, v82, v83
buffer_store_dwordx2 v[232:233], v1, s[8:11], s34 offen sc0 sc1
s_add_u32 s34, s34, 55296
v_mul_f32 v84, v84, v226
v_mul_f32 v85, v85, v226
v_mul_f32 v86, v86, v226
v_mul_f32 v87, v87, v226
v_fmac_f32 v84, v227, v252
v_fmac_f32 v85, v227, v253
v_fmac_f32 v86, v227, v254
v_fmac_f32 v87, v227, v255
v_mul_f32 v240, v84, v84
v_mul_f32 v241, v85, v85
v_mul_f32 v242, v86, v86
v_mul_f32 v243, v87, v87
v_fma_f32 v240, v240, s40, v63
v_fma_f32 v241, v241, s40, v63
v_fma_f32 v242, v242, s40, v63
v_fma_f32 v243, v243, s40, v63
v_mul_f32 v240, v240, v84
v_mul_f32 v241, v241, v85
v_mul_f32 v242, v242, v86
v_mul_f32 v243, v243, v87
v_exp_f32 v240, v240
v_exp_f32 v241, v241
v_exp_f32 v242, v242
v_exp_f32 v243, v243
v_add_f32 v240, 1.0, v240
v_add_f32 v241, 1.0, v241
v_add_f32 v242, 1.0, v242
v_add_f32 v243, 1.0, v243
v_rcp_f32 v240, v240
v_rcp_f32 v241, v241
v_rcp_f32 v242, v242
v_rcp_f32 v243, v243
v_mul_f32 v84, v84, v240
v_mul_f32 v85, v85, v241
v_mul_f32 v86, v86, v242
v_mul_f32 v87, v87, v243
v_cvt_pk_bf16_f32 v234, v84, v85
v_cvt_pk_bf16_f32 v235, v86, v87
buffer_store_dwordx2 v[234:235], v1, s[8:11], s34 offen sc0 sc1
s_add_u32 s34, s34, 55296
v_mul_f32 v88, v88, v228
v_mul_f32 v89, v89, v228
v_mul_f32 v90, v90, v228
v_mul_f32 v91, v91, v228
v_fmac_f32 v88, v229, v252
v_fmac_f32 v89, v229, v253
v_fmac_f32 v90, v229, v254
v_fmac_f32 v91, v229, v255
v_mul_f32 v240, v88, v88
v_mul_f32 v241, v89, v89
v_mul_f32 v242, v90, v90
v_mul_f32 v243, v91, v91
v_fma_f32 v240, v240, s40, v63
v_fma_f32 v241, v241, s40, v63
v_fma_f32 v242, v242, s40, v63
v_fma_f32 v243, v243, s40, v63
v_mul_f32 v240, v240, v88
v_mul_f32 v241, v241, v89
v_mul_f32 v242, v242, v90
v_mul_f32 v243, v243, v91
v_exp_f32 v240, v240
v_exp_f32 v241, v241
v_exp_f32 v242, v242
v_exp_f32 v243, v243
v_add_f32 v240, 1.0, v240
v_add_f32 v241, 1.0, v241
v_add_f32 v242, 1.0, v242
v_add_f32 v243, 1.0, v243
v_rcp_f32 v240, v240
v_rcp_f32 v241, v241
v_rcp_f32 v242, v242
v_rcp_f32 v243, v243
v_mul_f32 v88, v88, v240
v_mul_f32 v89, v89, v241
v_mul_f32 v90, v90, v242
v_mul_f32 v91, v91, v243
v_cvt_pk_bf16_f32 v236, v88, v89
v_cvt_pk_bf16_f32 v237, v90, v91
buffer_store_dwordx2 v[236:237], v1, s[8:11], s34 offen sc0 sc1
s_add_u32 s34, s34, 55296
v_mul_f32 v92, v92, v230
v_mul_f32 v93, v93, v230
v_mul_f32 v94, v94, v230
v_mul_f32 v95, v95, v230
v_fmac_f32 v92, v231, v252
v_fmac_f32 v93, v231, v253
v_fmac_f32 v94, v231, v254
v_fmac_f32 v95, v231, v255
v_mul_f32 v240, v92, v92
v_mul_f32 v241, v93, v93
v_mul_f32 v242, v94, v94
v_mul_f32 v243, v95, v95
v_fma_f32 v240, v240, s40, v63
v_fma_f32 v241, v241, s40, v63
v_fma_f32 v242, v242, s40, v63
v_fma_f32 v243, v243, s40, v63
v_mul_f32 v240, v240, v92
v_mul_f32 v241, v241, v93
v_mul_f32 v242, v242, v94
v_mul_f32 v243, v243, v95
v_exp_f32 v240, v240
v_exp_f32 v241, v241
v_exp_f32 v242, v242
v_exp_f32 v243, v243
v_add_f32 v240, 1.0, v240
v_add_f32 v241, 1.0, v241
v_add_f32 v242, 1.0, v242
v_add_f32 v243, 1.0, v243
v_rcp_f32 v240, v240
v_rcp_f32 v241, v241
v_rcp_f32 v242, v242
v_rcp_f32 v243, v243
v_mul_f32 v92, v92, v240
v_mul_f32 v93, v93, v241
v_mul_f32 v94, v94, v242
v_mul_f32 v95, v95, v243
v_cvt_pk_bf16_f32 v238, v92, v93
v_cvt_pk_bf16_f32 v239, v94, v95
buffer_store_dwordx2 v[238:239], v1, s[8:11], s34 offen sc0 sc1
s_add_u32 s34, s34, 55296
s_add_u32 s35, s35, 1024
s_add_u32 s36, s36, 1024
s_waitcnt vmcnt(0)
s_barrier
s_cmp_lg_u32 s18, 0
s_cbranch_scc1 L_50
v_mov_b32 v46, 0
v_mov_b32 v47, 1
buffer_store_dword v47, v46, s[8:11], s36 offen sc0 sc1
L_50:
s_and_b32 s24, s18, 3
s_lshl_b32 s24, s24, 4
s_add_u32 s24, s24, s19
v_add_u32 v46, s24, v4
v_lshrrev_b32 v47, 4, v46
v_mul_u32_u24 v47, 55296, v47
v_and_b32 v46, 15, v46
v_lshlrev_b32 v46, 4, v46
v_add_u32 v47, v47, v46
v_lshlrev_b32 v46, 8, v5
v_add_u32 v42, v47, v46
s_lshr_b32 s24, s18, 2
s_lshl_b32 s24, s24, 10
s_add_u32 s28, s24, 3670016
v_lshrrev_b32 v46, 2, v1
v_min_u32 v46, 28, v46
s_mov_b32 s30, 40000
L_51:
buffer_load_dword v47, v46, s[8:11], s35 offen sc0 sc1
s_waitcnt vmcnt(0)
v_cmp_ne_u32 vcc, 1, v47
s_nop 4
s_cbranch_vccz L_52
s_sub_u32 s30, s30, 1
s_cmp_lg_u32 s30, 0
s_cbranch_scc1 L_51
L_52:
s_add_u32 m0, s21, 0
s_add_u32 s22, s28, 0
buffer_load_dwordx4 v42, s[8:11], s22 offen sc0 sc1 lds
s_add_u32 m0, s21, 8192
s_add_u32 s22, s28, 2048
buffer_load_dwordx4 v42, s[8:11], s22 offen sc0 sc1 lds
s_add_u32 m0, s21, 16384
s_add_u32 s22, s28, 4096
buffer_load_dwordx4 v42, s[8:11], s22 offen sc0 sc1 lds
s_add_u32 m0, s21, 24576
s_add_u32 s22, s28, 6144
buffer_load_dwordx4 v42, s[8:11], s22 offen sc0 sc1 lds
s_add_u32 m0, s21, 32768
s_add_u32 s22, s28, 8192
buffer_load_dwordx4 v42, s[8:11], s22 offen sc0 sc1 lds
s_add_u32 m0, s21, 40960
s_add_u32 s22, s28, 10240
buffer_load_dwordx4 v42, s[8:11], s22 offen sc0 sc1 lds
s_add_u32 m0, s21, 49152
s_add_u32 s22, s28, 12288
buffer_load_dwordx4 v42, s[8:11], s22 offen sc0 sc1 lds
s_add_u32 m0, s21, 57344
s_add_u32 s22, s28, 14336
buffer_load_dwordx4 v42, s[8:11], s22 offen sc0 sc1 lds
s_add_u32 m0, s21, 65536
s_add_u32 s22, s28, 16384
buffer_load_dwordx4 v42, s[8:11], s22 offen sc0 sc1 lds
s_add_u32 m0, s21, 73728
s_add_u32 s22, s28, 18432
buffer_load_dwordx4 v42, s[8:11], s22 offen sc0 sc1 lds
s_add_u32 m0, s21, 81920
s_add_u32 s22, s28, 20480
buffer_load_dwordx4 v42, s[8:11], s22 offen sc0 sc1 lds
s_add_u32 m0, s21, 90112
s_add_u32 s22, s28, 22528
buffer_load_dwordx4 v42, s[8:11], s22 offen sc0 sc1 lds
s_add_u32 m0, s21, 98304
s_add_u32 s22, s28, 24576
buffer_load_dwordx4 v42, s[8:11], s22 offen sc0 sc1 lds
s_add_u32 m0, s21, 106496
s_add_u32 s22, s28, 26624
buffer_load_dwordx4 v42, s[8:11], s22 offen sc0 sc1 lds
s_add_u32 m0, s21, 114688
s_add_u32 s22, s28, 28672
buffer_load_dwordx4 v42, s[8:11], s22 offen sc0 sc1 lds
s_add_u32 m0, s21, 122880
s_add_u32 s22, s28, 30720
buffer_load_dwordx4 v42, s[8:11], s22 offen sc0 sc1 lds
v_mov_b32 v64, 0
v_mov_b32 v65, 0
v_mov_b32 v66, 0
v_mov_b32 v67, 0
v_mov_b32 v68, 0
v_mov_b32 v69, 0
v_mov_b32 v70, 0
v_mov_b32 v71, 0
v_mov_b32 v72, 0
v_mov_b32 v73, 0
v_mov_b32 v74, 0
v_mov_b32 v75, 0
v_mov_b32 v76, 0
v_mov_b32 v77, 0
v_mov_b32 v78, 0
v_mov_b32 v79, 0
s_waitcnt vmcnt(14)
s_barrier
ds_read_b128 v[96:99], v2 offset:0
ds_read_b128 v[100:103], v2 offset:1024
ds_read_b128 v[104:107], v2 offset:2048
ds_read_b128 v[108:111], v2 offset:3072
ds_read_b128 v[112:115], v2 offset:4096
ds_read_b128 v[116:119], v2 offset:5120
ds_read_b128 v[120:123], v2 offset:6144
ds_read_b128 v[124:127], v2 offset:7168
s_waitcnt lgkmcnt(4)
v_mfma_f32_16x16x32_bf16 v[64:67], v[128:131], v[96:99], v[64:67]
v_mfma_f32_16x16x32_bf16 v[68:71], v[128:131], v[100:103], v[68:71]
v_mfma_f32_16x16x32_bf16 v[72:75], v[128:131], v[104:107], v[72:75]
v_mfma_f32_16x16x32_bf16 v[76:79], v[128:131], v[108:111], v[76:79]
s_add_u32 s23, s50, 24576
buffer_load_dwordx4 v[128:131], v1, s[8:11], s23 offen
ds_read_b128 v[96:99], v2 offset:8192
ds_read_b128 v[100:103], v2 offset:9216
ds_read_b128 v[104:107], v2 offset:10240
ds_read_b128 v[108:111], v2 offset:11264
s_waitcnt lgkmcnt(4)
v_mfma_f32_16x16x32_bf16 v[64:67], v[132:135], v[112:115], v[64:67]
v_mfma_f32_16x16x32_bf16 v[68:71], v[132:135], v[116:119], v[68:71]
v_mfma_f32_16x16x32_bf16 v[72:75], v[132:135], v[120:123], v[72:75]
v_mfma_f32_16x16x32_bf16 v[76:79], v[132:135], v[124:127], v[76:79]
s_add_u32 s23, s50, 25600
buffer_load_dwordx4 v[132:135], v1, s[8:11], s23 offen
ds_read_b128 v[112:115], v2 offset:12288
ds_read_b128 v[116:119], v2 offset:13312
ds_read_b128 v[120:123], v2 offset:14336
ds_read_b128 v[124:127], v2 offset:15360
s_waitcnt lgkmcnt(4)
v_mfma_f32_16x16x32_bf16 v[64:67], v[136:139], v[96:99], v[64:67]
v_mfma_f32_16x16x32_bf16 v[68:71], v[136:139], v[100:103], v[68:71]
v_mfma_f32_16x16x32_bf16 v[72:75], v[136:139], v[104:107], v[72:75]
v_mfma_f32_16x16x32_bf16 v[76:79], v[136:139], v[108:111], v[76:79]
s_add_u32 s23, s50, 26624
buffer_load_dwordx4 v[136:139], v1, s[8:11], s23 offen
s_waitcnt vmcnt(15)
s_barrier
ds_read_b128 v[96:99], v2 offset:16384
ds_read_b128 v[100:103], v2 offset:17408
ds_read_b128 v[104:107], v2 offset:18432
ds_read_b128 v[108:111], v2 offset:19456
s_waitcnt lgkmcnt(4)
v_mfma_f32_16x16x32_bf16 v[64:67], v[140:143], v[112:115], v[64:67]
v_mfma_f32_16x16x32_bf16 v[68:71], v[140:143], v[116:119], v[68:71]
v_mfma_f32_16x16x32_bf16 v[72:75], v[140:143], v[120:123], v[72:75]
v_mfma_f32_16x16x32_bf16 v[76:79], v[140:143], v[124:127], v[76:79]
s_add_u32 s23, s50, 27648
buffer_load_dwordx4 v[140:143], v1, s[8:11], s23 offen
ds_read_b128 v[112:115], v2 offset:20480
ds_read_b128 v[116:119], v2 offset:21504
ds_read_b128 v[120:123], v2 offset:22528
ds_read_b128 v[124:127], v2 offset:23552
s_waitcnt lgkmcnt(4)
v_mfma_f32_16x16x32_bf16 v[64:67], v[144:147], v[96:99], v[64:67]
v_mfma_f32_16x16x32_bf16 v[68:71], v[144:147], v[100:103], v[68:71]
v_mfma_f32_16x16x32_bf16 v[72:75], v[144:147], v[104:107], v[72:75]
v_mfma_f32_16x16x32_bf16 v[76:79], v[144:147], v[108:111], v[76:79]
s_add_u32 s23, s50, 28672
buffer_load_dwordx4 v[144:147], v1, s[8:11], s23 offen
ds_read_b128 v[96:99], v2 offset:24576
ds_read_b128 v[100:103], v2 offset:25600
ds_read_b128 v[104:107], v2 offset:26624
ds_read_b128 v[108:111], v2 offset:27648
s_waitcnt lgkmcnt(4)
v_mfma_f32_16x16x32_bf16 v[64:67], v[148:151], v[112:115], v[64:67]
v_mfma_f32_16x16x32_bf16 v[68:71], v[148:151], v[116:119], v[68:71]
v_mfma_f32_16x16x32_bf16 v[72:75], v[148:151], v[120:123], v[72:75]
v_mfma_f32_16x16x32_bf16 v[76:79], v[148:151], v[124:127], v[76:79]
s_add_u32 s23, s50, 29696
buffer_load_dwordx4 v[148:151], v1, s[8:11], s23 offen
ds_read_b128 v[112:115], v2 offset:28672
ds_read_b128 v[116:119], v2 offset:29696
ds_read_b128 v[120:123], v2 offset:30720
ds_read_b128 v[124:127], v2 offset:31744
s_waitcnt lgkmcnt(4)
v_mfma_f32_16x16x32_bf16 v[64:67], v[152:155], v[96:99], v[64:67]
v_mfma_f32_16x16x32_bf16 v[68:71], v[152:155], v[100:103], v[68:71]
v_mfma_f32_16x16x32_bf16 v[72:75], v[152:155], v[104:107], v[72:75]
v_mfma_f32_16x16x32_bf16 v[76:79], v[152:155], v[108:111], v[76:79]
s_add_u32 s23, s50, 30720
buffer_load_dwordx4 v[152:155], v1, s[8:11], s23 offen
s_waitcnt vmcnt(17)
s_barrier
s_add_u32 m0, s21, 0
s_add_u32 s22, s28, 32768
buffer_load_dwordx4 v42, s[8:11], s22 offen sc0 sc1 lds
s_add_u32 m0, s21, 8192
s_add_u32 s22, s28, 34816
buffer_load_dwordx4 v42, s[8:11], s22 offen sc0 sc1 lds
ds_read_b128 v[96:99], v2 offset:32768
ds_read_b128 v[100:103], v2 offset:33792
ds_read_b128 v[104:107], v2 offset:34816
ds_read_b128 v[108:111], v2 offset:35840
s_waitcnt lgkmcnt(4)
v_mfma_f32_16x16x32_bf16 v[64:67], v[156:159], v[112:115], v[64:67]
v_mfma_f32_16x16x32_bf16 v[68:71], v[156:159], v[116:119], v[68:71]
v_mfma_f32_16x16x32_bf16 v[72:75], v[156:159], v[120:123], v[72:75]
v_mfma_f32_16x16x32_bf16 v[76:79], v[156:159], v[124:127], v[76:79]
s_add_u32 s23, s50, 31744
buffer_load_dwordx4 v[156:159], v1, s[8:11], s23 offen
ds_read_b128 v[112:115], v2 offset:36864
ds_read_b128 v[116:119], v2 offset:37888
ds_read_b128 v[120:123], v2 offset:38912
ds_read_b128 v[124:127], v2 offset:39936
s_waitcnt lgkmcnt(4)
v_mfma_f32_16x16x32_bf16 v[64:67], v[160:163], v[96:99], v[64:67]
v_mfma_f32_16x16x32_bf16 v[68:71], v[160:163], v[100:103], v[68:71]
v_mfma_f32_16x16x32_bf16 v[72:75], v[160:163], v[104:107], v[72:75]
v_mfma_f32_16x16x32_bf16 v[76:79], v[160:163], v[108:111], v[76:79]
s_add_u32 s23, s50, 32768
buffer_load_dwordx4 v[160:163], v1, s[8:11], s23 offen
ds_read_b128 v[96:99], v2 offset:40960
ds_read_b128 v[100:103], v2 offset:41984
ds_read_b128 v[104:107], v2 offset:43008
ds_read_b128 v[108:111], v2 offset:44032
s_waitcnt lgkmcnt(4)
v_mfma_f32_16x16x32_bf16 v[64:67], v[164:167], v[112:115], v[64:67]
v_mfma_f32_16x16x32_bf16 v[68:71], v[164:167], v[116:119], v[68:71]
v_mfma_f32_16x16x32_bf16 v[72:75], v[164:167], v[120:123], v[72:75]
v_mfma_f32_16x16x32_bf16 v[76:79], v[164:167], v[124:127], v[76:79]
s_add_u32 s23, s50, 33792
buffer_load_dwordx4 v[164:167], v1, s[8:11], s23 offen
ds_read_b128 v[112:115], v2 offset:45056
ds_read_b128 v[116:119], v2 offset:46080
ds_read_b128 v[120:123], v2 offset:47104
ds_read_b128 v[124:127], v2 offset:48128
s_waitcnt lgkmcnt(4)
v_mfma_f32_16x16x32_bf16 v[64:67], v[168:171], v[96:99], v[64:67]
v_mfma_f32_16x16x32_bf16 v[68:71], v[168:171], v[100:103], v[68:71]
v_mfma_f32_16x16x32_bf16 v[72:75], v[168:171], v[104:107], v[72:75]
v_mfma_f32_16x16x32_bf16 v[76:79], v[168:171], v[108:111], v[76:79]
s_add_u32 s23, s50, 34816
buffer_load_dwordx4 v[168:171], v1, s[8:11], s23 offen
s_waitcnt vmcnt(21)
s_barrier
s_add_u32 m0, s21, 16384
s_add_u32 s22, s28, 36864
buffer_load_dwordx4 v42, s[8:11], s22 offen sc0 sc1 lds
s_add_u32 m0, s21, 24576
s_add_u32 s22, s28, 38912
buffer_load_dwordx4 v42, s[8:11], s22 offen sc0 sc1 lds
ds_read_b128 v[96:99], v2 offset:49152
ds_read_b128 v[100:103], v2 offset:50176
ds_read_b128 v[104:107], v2 offset:51200
ds_read_b128 v[108:111], v2 offset:52224
s_waitcnt lgkmcnt(4)
v_mfma_f32_16x16x32_bf16 v[64:67], v[172:175], v[112:115], v[64:67]
v_mfma_f32_16x16x32_bf16 v[68:71], v[172:175], v[116:119], v[68:71]
v_mfma_f32_16x16x32_bf16 v[72:75], v[172:175], v[120:123], v[72:75]
v_mfma_f32_16x16x32_bf16 v[76:79], v[172:175], v[124:127], v[76:79]
s_add_u32 s23, s50, 35840
buffer_load_dwordx4 v[172:175], v1, s[8:11], s23 offen
ds_read_b128 v[112:115], v2 offset:53248
ds_read_b128 v[116:119], v2 offset:54272
ds_read_b128 v[120:123], v2 offset:55296
ds_read_b128 v[124:127], v2 offset:56320
s_waitcnt lgkmcnt(4)
v_mfma_f32_16x16x32_bf16 v[64:67], v[176:179], v[96:99], v[64:67]
v_mfma_f32_16x16x32_bf16 v[68:71], v[176:179], v[100:103], v[68:71]
v_mfma_f32_16x16x32_bf16 v[72:75], v[176:179], v[104:107], v[72:75]
v_mfma_f32_16x16x32_bf16 v[76:79], v[176:179], v[108:111], v[76:79]
s_add_u32 s23, s50, 36864
buffer_load_dwordx4 v[176:179], v1, s[8:11], s23 offen
ds_read_b128 v[96:99], v2 offset:57344
ds_read_b128 v[100:103], v2 offset:58368
ds_read_b128 v[104:107], v2 offset:59392
ds_read_b128 v[108:111], v2 offset:60416
s_waitcnt lgkmcnt(4)
v_mfma_f32_16x16x32_bf16 v[64:67], v[180:183], v[112:115], v[64:67]
v_mfma_f32_16x16x32_bf16 v[68:71], v[180:183], v[116:119], v[68:71]
v_mfma_f32_16x16x32_bf16 v[72:75], v[180:183], v[120:123], v[72:75]
v_mfma_f32_16x16x32_bf16 v[76:79], v[180:183], v[124:127], v[76:79]
s_add_u32 s23, s50, 37888
buffer_load_dwordx4 v[180:183], v1, s[8:11], s23 offen
ds_read_b128 v[112:115], v2 offset:61440
ds_read_b128 v[116:119], v2 offset:62464
ds_read_b128 v[120:123], v2 offset:63488
ds_read_b128 v[124:127], v2 offset:64512
s_waitcnt lgkmcnt(4)
v_mfma_f32_16x16x32_bf16 v[64:67], v[184:187], v[96:99], v[64:67]
v_mfma_f32_16x16x32_bf16 v[68:71], v[184:187], v[100:103], v[68:71]
v_mfma_f32_16x16x32_bf16 v[72:75], v[184:187], v[104:107], v[72:75]
v_mfma_f32_16x16x32_bf16 v[76:79], v[184:187], v[108:111], v[76:79]
s_add_u32 s23, s50, 38912
buffer_load_dwordx4 v[184:187], v1, s[8:11], s23 offen
s_waitcnt vmcnt(25)
s_barrier
s_add_u32 m0, s21, 32768
s_add_u32 s22, s28, 40960
buffer_load_dwordx4 v42, s[8:11], s22 offen sc0 sc1 lds
s_add_u32 m0, s21, 40960
s_add_u32 s22, s28, 43008
buffer_load_dwordx4 v42, s[8:11], s22 offen sc0 sc1 lds
ds_read_b128 v[96:99], v3 offset:0
ds_read_b128 v[100:103], v3 offset:1024
ds_read_b128 v[104:107], v3 offset:2048
ds_read_b128 v[108:111], v3 offset:3072
s_waitcnt lgkmcnt(4)
v_mfma_f32_16x16x32_bf16 v[64:67], v[188:191], v[112:115], v[64:67]
v_mfma_f32_16x16x32_bf16 v[68:71], v[188:191], v[116:119], v[68:71]
v_mfma_f32_16x16x32_bf16 v[72:75], v[188:191], v[120:123], v[72:75]
v_mfma_f32_16x16x32_bf16 v[76:79], v[188:191], v[124:127], v[76:79]
s_add_u32 s23, s50, 39936
buffer_load_dwordx4 v[188:191], v1, s[8:11], s23 offen
ds_read_b128 v[112:115], v3 offset:4096
ds_read_b128 v[116:119], v3 offset:5120
ds_read_b128 v[120:123], v3 offset:6144
ds_read_b128 v[124:127], v3 offset:7168
s_waitcnt lgkmcnt(4)
v_mfma_f32_16x16x32_bf16 v[64:67], v[192:195], v[96:99], v[64:67]
v_mfma_f32_16x16x32_bf16 v[68:71], v[192:195], v[100:103], v[68:71]
v_mfma_f32_16x16x32_bf16 v[72:75], v[192:195], v[104:107], v[72:75]
v_mfma_f32_16x16x32_bf16 v[76:79], v[192:195], v[108:111], v[76:79]
s_add_u32 s23, s50, 40960
buffer_load_dwordx4 v[192:195], v1, s[8:11], s23 offen
ds_read_b128 v[96:99], v3 offset:8192
ds_read_b128 v[100:103], v3 offset:9216
ds_read_b128 v[104:107], v3 offset:10240
ds_read_b128 v[108:111], v3 offset:11264
s_waitcnt lgkmcnt(4)
v_mfma_f32_16x16x32_bf16 v[64:67], v[196:199], v[112:115], v[64:67]
v_mfma_f32_16x16x32_bf16 v[68:71], v[196:199], v[116:119], v[68:71]
v_mfma_f32_16x16x32_bf16 v[72:75], v[196:199], v[120:123], v[72:75]
v_mfma_f32_16x16x32_bf16 v[76:79], v[196:199], v[124:127], v[76:79]
s_add_u32 s23, s50, 41984
buffer_load_dwordx4 v[196:199], v1, s[8:11], s23 offen
ds_read_b128 v[112:115], v3 offset:12288
ds_read_b128 v[116:119], v3 offset:13312
ds_read_b128 v[120:123], v3 offset:14336
ds_read_b128 v[124:127], v3 offset:15360
s_waitcnt lgkmcnt(4)
v_mfma_f32_16x16x32_bf16 v[64:67], v[200:203], v[96:99], v[64:67]
v_mfma_f32_16x16x32_bf16 v[68:71], v[200:203], v[100:103], v[68:71]
v_mfma_f32_16x16x32_bf16 v[72:75], v[200:203], v[104:107], v[72:75]
v_mfma_f32_16x16x32_bf16 v[76:79], v[200:203], v[108:111], v[76:79]
s_add_u32 s23, s50, 43008
buffer_load_dwordx4 v[200:203], v1, s[8:11], s23 offen
s_waitcnt vmcnt(29)
s_barrier
s_add_u32 m0, s21, 49152
s_add_u32 s22, s28, 45056
buffer_load_dwordx4 v42, s[8:11], s22 offen sc0 sc1 lds
s_add_u32 m0, s21, 57344
s_add_u32 s22, s28, 47104
buffer_load_dwordx4 v42, s[8:11], s22 offen sc0 sc1 lds
ds_read_b128 v[96:99], v3 offset:16384
ds_read_b128 v[100:103], v3 offset:17408
ds_read_b128 v[104:107], v3 offset:18432
ds_read_b128 v[108:111], v3 offset:19456
s_waitcnt lgkmcnt(4)
v_mfma_f32_16x16x32_bf16 v[64:67], v[204:207], v[112:115], v[64:67]
v_mfma_f32_16x16x32_bf16 v[68:71], v[204:207], v[116:119], v[68:71]
v_mfma_f32_16x16x32_bf16 v[72:75], v[204:207], v[120:123], v[72:75]
v_mfma_f32_16x16x32_bf16 v[76:79], v[204:207], v[124:127], v[76:79]
s_add_u32 s23, s50, 44032
buffer_load_dwordx4 v[204:207], v1, s[8:11], s23 offen
ds_read_b128 v[112:115], v3 offset:20480
ds_read_b128 v[116:119], v3 offset:21504
ds_read_b128 v[120:123], v3 offset:22528
ds_read_b128 v[124:127], v3 offset:23552
s_waitcnt lgkmcnt(4)
v_mfma_f32_16x16x32_bf16 v[64:67], v[208:211], v[96:99], v[64:67]
v_mfma_f32_16x16x32_bf16 v[68:71], v[208:211], v[100:103], v[68:71]
v_mfma_f32_16x16x32_bf16 v[72:75], v[208:211], v[104:107], v[72:75]
v_mfma_f32_16x16x32_bf16 v[76:79], v[208:211], v[108:111], v[76:79]
s_add_u32 s23, s50, 45056
buffer_load_dwordx4 v[208:211], v1, s[8:11], s23 offen
ds_read_b128 v[96:99], v3 offset:24576
ds_read_b128 v[100:103], v3 offset:25600
ds_read_b128 v[104:107], v3 offset:26624
ds_read_b128 v[108:111], v3 offset:27648
s_waitcnt lgkmcnt(4)
v_mfma_f32_16x16x32_bf16 v[64:67], v[212:215], v[112:115], v[64:67]
v_mfma_f32_16x16x32_bf16 v[68:71], v[212:215], v[116:119], v[68:71]
v_mfma_f32_16x16x32_bf16 v[72:75], v[212:215], v[120:123], v[72:75]
v_mfma_f32_16x16x32_bf16 v[76:79], v[212:215], v[124:127], v[76:79]
s_add_u32 s23, s50, 46080
buffer_load_dwordx4 v[212:215], v1, s[8:11], s23 offen
ds_read_b128 v[112:115], v3 offset:28672
ds_read_b128 v[116:119], v3 offset:29696
ds_read_b128 v[120:123], v3 offset:30720
ds_read_b128 v[124:127], v3 offset:31744
s_waitcnt lgkmcnt(4)
v_mfma_f32_16x16x32_bf16 v[64:67], v[216:219], v[96:99], v[64:67]
v_mfma_f32_16x16x32_bf16 v[68:71], v[216:219], v[100:103], v[68:71]
v_mfma_f32_16x16x32_bf16 v[72:75], v[216:219], v[104:107], v[72:75]
v_mfma_f32_16x16x32_bf16 v[76:79], v[216:219], v[108:111], v[76:79]
s_add_u32 s23, s50, 47104
buffer_load_dwordx4 v[216:219], v1, s[8:11], s23 offen
s_waitcnt vmcnt(33)
s_barrier
s_add_u32 m0, s21, 65536
s_add_u32 s22, s28, 49152
buffer_load_dwordx4 v42, s[8:11], s22 offen sc0 sc1 lds
s_add_u32 m0, s21, 73728
s_add_u32 s22, s28, 51200
buffer_load_dwordx4 v42, s[8:11], s22 offen sc0 sc1 lds
ds_read_b128 v[96:99], v3 offset:32768
ds_read_b128 v[100:103], v3 offset:33792
ds_read_b128 v[104:107], v3 offset:34816
ds_read_b128 v[108:111], v3 offset:35840
s_waitcnt lgkmcnt(4)
v_mfma_f32_16x16x32_bf16 v[64:67], v[220:223], v[112:115], v[64:67]
v_mfma_f32_16x16x32_bf16 v[68:71], v[220:223], v[116:119], v[68:71]
v_mfma_f32_16x16x32_bf16 v[72:75], v[220:223], v[120:123], v[72:75]
v_mfma_f32_16x16x32_bf16 v[76:79], v[220:223], v[124:127], v[76:79]
s_add_u32 s23, s50, 48128
buffer_load_dwordx4 v[220:223], v1, s[8:11], s23 offen
ds_read_b128 v[112:115], v3 offset:36864
ds_read_b128 v[116:119], v3 offset:37888
ds_read_b128 v[120:123], v3 offset:38912
ds_read_b128 v[124:127], v3 offset:39936
s_waitcnt vmcnt(33)
s_waitcnt lgkmcnt(4)
v_mfma_f32_16x16x32_bf16 v[64:67], v[128:131], v[96:99], v[64:67]
v_mfma_f32_16x16x32_bf16 v[68:71], v[128:131], v[100:103], v[68:71]
v_mfma_f32_16x16x32_bf16 v[72:75], v[128:131], v[104:107], v[72:75]
v_mfma_f32_16x16x32_bf16 v[76:79], v[128:131], v[108:111], v[76:79]
s_add_u32 s23, s50, 49152
buffer_load_dwordx4 v[128:131], v1, s[8:11], s23 offen
ds_read_b128 v[96:99], v3 offset:40960
ds_read_b128 v[100:103], v3 offset:41984
ds_read_b128 v[104:107], v3 offset:43008
ds_read_b128 v[108:111], v3 offset:44032
s_waitcnt vmcnt(33)
s_waitcnt lgkmcnt(4)
v_mfma_f32_16x16x32_bf16 v[64:67], v[132:135], v[112:115], v[64:67]
v_mfma_f32_16x16x32_bf16 v[68:71], v[132:135], v[116:119], v[68:71]
v_mfma_f32_16x16x32_bf16 v[72:75], v[132:135], v[120:123], v[72:75]
v_mfma_f32_16x16x32_bf16 v[76:79], v[132:135], v[124:127], v[76:79]
s_add_u32 s23, s50, 50176
buffer_load_dwordx4 v[132:135], v1, s[8:11], s23 offen
ds_read_b128 v[112:115], v3 offset:45056
ds_read_b128 v[116:119], v3 offset:46080
ds_read_b128 v[120:123], v3 offset:47104
ds_read_b128 v[124:127], v3 offset:48128
s_waitcnt vmcnt(33)
s_waitcnt lgkmcnt(4)
v_mfma_f32_16x16x32_bf16 v[64:67], v[136:139], v[96:99], v[64:67]
v_mfma_f32_16x16x32_bf16 v[68:71], v[136:139], v[100:103], v[68:71]
v_mfma_f32_16x16x32_bf16 v[72:75], v[136:139], v[104:107], v[72:75]
v_mfma_f32_16x16x32_bf16 v[76:79], v[136:139], v[108:111], v[76:79]
s_add_u32 s23, s50, 51200
buffer_load_dwordx4 v[136:139], v1, s[8:11], s23 offen
s_waitcnt vmcnt(37)
s_barrier
s_add_u32 m0, s21, 81920
s_add_u32 s22, s28, 53248
buffer_load_dwordx4 v42, s[8:11], s22 offen sc0 sc1 lds
ds_read_b128 v[96:99], v3 offset:49152
ds_read_b128 v[100:103], v3 offset:50176
ds_read_b128 v[104:107], v3 offset:51200
ds_read_b128 v[108:111], v3 offset:52224
s_waitcnt vmcnt(34)
s_waitcnt lgkmcnt(4)
v_mfma_f32_16x16x32_bf16 v[64:67], v[140:143], v[112:115], v[64:67]
v_mfma_f32_16x16x32_bf16 v[68:71], v[140:143], v[116:119], v[68:71]
v_mfma_f32_16x16x32_bf16 v[72:75], v[140:143], v[120:123], v[72:75]
v_mfma_f32_16x16x32_bf16 v[76:79], v[140:143], v[124:127], v[76:79]
s_add_u32 s23, s50, 52224
buffer_load_dwordx4 v[140:143], v1, s[8:11], s23 offen
ds_read_b128 v[112:115], v3 offset:53248
ds_read_b128 v[116:119], v3 offset:54272
ds_read_b128 v[120:123], v3 offset:55296
ds_read_b128 v[124:127], v3 offset:56320
s_waitcnt vmcnt(34)
s_waitcnt lgkmcnt(4)
v_mfma_f32_16x16x32_bf16 v[64:67], v[144:147], v[96:99], v[64:67]
v_mfma_f32_16x16x32_bf16 v[68:71], v[144:147], v[100:103], v[68:71]
v_mfma_f32_16x16x32_bf16 v[72:75], v[144:147], v[104:107], v[72:75]
v_mfma_f32_16x16x32_bf16 v[76:79], v[144:147], v[108:111], v[76:79]
s_add_u32 s23, s50, 53248
buffer_load_dwordx4 v[144:147], v1, s[8:11], s23 offen
ds_read_b128 v[96:99], v3 offset:57344
ds_read_b128 v[100:103], v3 offset:58368
ds_read_b128 v[104:107], v3 offset:59392
ds_read_b128 v[108:111], v3 offset:60416
s_waitcnt vmcnt(34)
s_waitcnt lgkmcnt(4)
v_mfma_f32_16x16x32_bf16 v[64:67], v[148:151], v[112:115], v[64:67]
v_mfma_f32_16x16x32_bf16 v[68:71], v[148:151], v[116:119], v[68:71]
v_mfma_f32_16x16x32_bf16 v[72:75], v[148:151], v[120:123], v[72:75]
v_mfma_f32_16x16x32_bf16 v[76:79], v[148:151], v[124:127], v[76:79]
s_add_u32 s23, s50, 54272
buffer_load_dwordx4 v[148:151], v1, s[8:11], s23 offen
ds_read_b128 v[112:115], v3 offset:61440
ds_read_b128 v[116:119], v3 offset:62464
ds_read_b128 v[120:123], v3 offset:63488
ds_read_b128 v[124:127], v3 offset:64512
s_waitcnt vmcnt(34)
s_waitcnt lgkmcnt(4)
v_mfma_f32_16x16x32_bf16 v[64:67], v[152:155], v[96:99], v[64:67]
v_mfma_f32_16x16x32_bf16 v[68:71], v[152:155], v[100:103], v[68:71]
v_mfma_f32_16x16x32_bf16 v[72:75], v[152:155], v[104:107], v[72:75]
v_mfma_f32_16x16x32_bf16 v[76:79], v[152:155], v[108:111], v[76:79]
s_waitcnt vmcnt(32)
s_barrier
ds_read_b128 v[96:99], v2 offset:0
ds_read_b128 v[100:103], v2 offset:1024
ds_read_b128 v[104:107], v2 offset:2048
ds_read_b128 v[108:111], v2 offset:3072
s_waitcnt vmcnt(31)
s_waitcnt lgkmcnt(4)
v_mfma_f32_16x16x32_bf16 v[64:67], v[156:159], v[112:115], v[64:67]
v_mfma_f32_16x16x32_bf16 v[68:71], v[156:159], v[116:119], v[68:71]
v_mfma_f32_16x16x32_bf16 v[72:75], v[156:159], v[120:123], v[72:75]
v_mfma_f32_16x16x32_bf16 v[76:79], v[156:159], v[124:127], v[76:79]
ds_read_b128 v[112:115], v2 offset:4096
ds_read_b128 v[116:119], v2 offset:5120
ds_read_b128 v[120:123], v2 offset:6144
ds_read_b128 v[124:127], v2 offset:7168
s_waitcnt vmcnt(30)
s_waitcnt lgkmcnt(4)
v_mfma_f32_16x16x32_bf16 v[64:67], v[160:163], v[96:99], v[64:67]
v_mfma_f32_16x16x32_bf16 v[68:71], v[160:163], v[100:103], v[68:71]
v_mfma_f32_16x16x32_bf16 v[72:75], v[160:163], v[104:107], v[72:75]
v_mfma_f32_16x16x32_bf16 v[76:79], v[160:163], v[108:111], v[76:79]
ds_read_b128 v[96:99], v2 offset:8192
ds_read_b128 v[100:103], v2 offset:9216
ds_read_b128 v[104:107], v2 offset:10240
ds_read_b128 v[108:111], v2 offset:11264
s_waitcnt vmcnt(29)
s_waitcnt lgkmcnt(4)
v_mfma_f32_16x16x32_bf16 v[64:67], v[164:167], v[112:115], v[64:67]
v_mfma_f32_16x16x32_bf16 v[68:71], v[164:167], v[116:119], v[68:71]
v_mfma_f32_16x16x32_bf16 v[72:75], v[164:167], v[120:123], v[72:75]
v_mfma_f32_16x16x32_bf16 v[76:79], v[164:167], v[124:127], v[76:79]
ds_read_b128 v[112:115], v2 offset:12288
ds_read_b128 v[116:119], v2 offset:13312
ds_read_b128 v[120:123], v2 offset:14336
ds_read_b128 v[124:127], v2 offset:15360
s_waitcnt vmcnt(28)
s_waitcnt lgkmcnt(4)
v_mfma_f32_16x16x32_bf16 v[64:67], v[168:171], v[96:99], v[64:67]
v_mfma_f32_16x16x32_bf16 v[68:71], v[168:171], v[100:103], v[68:71]
v_mfma_f32_16x16x32_bf16 v[72:75], v[168:171], v[104:107], v[72:75]
v_mfma_f32_16x16x32_bf16 v[76:79], v[168:171], v[108:111], v[76:79]
s_waitcnt vmcnt(26)
s_barrier
ds_read_b128 v[96:99], v2 offset:16384
ds_read_b128 v[100:103], v2 offset:17408
ds_read_b128 v[104:107], v2 offset:18432
ds_read_b128 v[108:111], v2 offset:19456
s_waitcnt vmcnt(25)
s_waitcnt lgkmcnt(4)
v_mfma_f32_16x16x32_bf16 v[64:67], v[172:175], v[112:115], v[64:67]
v_mfma_f32_16x16x32_bf16 v[68:71], v[172:175], v[116:119], v[68:71]
v_mfma_f32_16x16x32_bf16 v[72:75], v[172:175], v[120:123], v[72:75]
v_mfma_f32_16x16x32_bf16 v[76:79], v[172:175], v[124:127], v[76:79]
ds_read_b128 v[112:115], v2 offset:20480
ds_read_b128 v[116:119], v2 offset:21504
ds_read_b128 v[120:123], v2 offset:22528
ds_read_b128 v[124:127], v2 offset:23552
s_waitcnt vmcnt(24)
s_waitcnt lgkmcnt(4)
v_mfma_f32_16x16x32_bf16 v[64:67], v[176:179], v[96:99], v[64:67]
v_mfma_f32_16x16x32_bf16 v[68:71], v[176:179], v[100:103], v[68:71]
v_mfma_f32_16x16x32_bf16 v[72:75], v[176:179], v[104:107], v[72:75]
v_mfma_f32_16x16x32_bf16 v[76:79], v[176:179], v[108:111], v[76:79]
ds_read_b128 v[96:99], v2 offset:24576
ds_read_b128 v[100:103], v2 offset:25600
ds_read_b128 v[104:107], v2 offset:26624
ds_read_b128 v[108:111], v2 offset:27648
s_waitcnt vmcnt(23)
s_waitcnt lgkmcnt(4)
v_mfma_f32_16x16x32_bf16 v[64:67], v[180:183], v[112:115], v[64:67]
v_mfma_f32_16x16x32_bf16 v[68:71], v[180:183], v[116:119], v[68:71]
v_mfma_f32_16x16x32_bf16 v[72:75], v[180:183], v[120:123], v[72:75]
v_mfma_f32_16x16x32_bf16 v[76:79], v[180:183], v[124:127], v[76:79]
ds_read_b128 v[112:115], v2 offset:28672
ds_read_b128 v[116:119], v2 offset:29696
ds_read_b128 v[120:123], v2 offset:30720
ds_read_b128 v[124:127], v2 offset:31744
s_waitcnt vmcnt(22)
s_waitcnt lgkmcnt(4)
v_mfma_f32_16x16x32_bf16 v[64:67], v[184:187], v[96:99], v[64:67]
v_mfma_f32_16x16x32_bf16 v[68:71], v[184:187], v[100:103], v[68:71]
v_mfma_f32_16x16x32_bf16 v[72:75], v[184:187], v[104:107], v[72:75]
v_mfma_f32_16x16x32_bf16 v[76:79], v[184:187], v[108:111], v[76:79]
s_waitcnt vmcnt(20)
s_barrier
ds_read_b128 v[96:99], v2 offset:32768
ds_read_b128 v[100:103], v2 offset:33792
ds_read_b128 v[104:107], v2 offset:34816
ds_read_b128 v[108:111], v2 offset:35840
s_waitcnt vmcnt(19)
s_waitcnt lgkmcnt(4)
v_mfma_f32_16x16x32_bf16 v[64:67], v[188:191], v[112:115], v[64:67]
v_mfma_f32_16x16x32_bf16 v[68:71], v[188:191], v[116:119], v[68:71]
v_mfma_f32_16x16x32_bf16 v[72:75], v[188:191], v[120:123], v[72:75]
v_mfma_f32_16x16x32_bf16 v[76:79], v[188:191], v[124:127], v[76:79]
ds_read_b128 v[112:115], v2 offset:36864
ds_read_b128 v[116:119], v2 offset:37888
ds_read_b128 v[120:123], v2 offset:38912
ds_read_b128 v[124:127], v2 offset:39936
s_waitcnt vmcnt(18)
s_waitcnt lgkmcnt(4)
v_mfma_f32_16x16x32_bf16 v[64:67], v[192:195], v[96:99], v[64:67]
v_mfma_f32_16x16x32_bf16 v[68:71], v[192:195], v[100:103], v[68:71]
v_mfma_f32_16x16x32_bf16 v[72:75], v[192:195], v[104:107], v[72:75]
v_mfma_f32_16x16x32_bf16 v[76:79], v[192:195], v[108:111], v[76:79]
ds_read_b128 v[96:99], v2 offset:40960
ds_read_b128 v[100:103], v2 offset:41984
ds_read_b128 v[104:107], v2 offset:43008
ds_read_b128 v[108:111], v2 offset:44032
s_waitcnt vmcnt(17)
s_waitcnt lgkmcnt(4)
v_mfma_f32_16x16x32_bf16 v[64:67], v[196:199], v[112:115], v[64:67]
v_mfma_f32_16x16x32_bf16 v[68:71], v[196:199], v[116:119], v[68:71]
v_mfma_f32_16x16x32_bf16 v[72:75], v[196:199], v[120:123], v[72:75]
v_mfma_f32_16x16x32_bf16 v[76:79], v[196:199], v[124:127], v[76:79]
ds_read_b128 v[112:115], v2 offset:45056
ds_read_b128 v[116:119], v2 offset:46080
ds_read_b128 v[120:123], v2 offset:47104
ds_read_b128 v[124:127], v2 offset:48128
s_waitcnt vmcnt(16)
s_waitcnt lgkmcnt(4)
v_mfma_f32_16x16x32_bf16 v[64:67], v[200:203], v[96:99], v[64:67]
v_mfma_f32_16x16x32_bf16 v[68:71], v[200:203], v[100:103], v[68:71]
v_mfma_f32_16x16x32_bf16 v[72:75], v[200:203], v[104:107], v[72:75]
v_mfma_f32_16x16x32_bf16 v[76:79], v[200:203], v[108:111], v[76:79]
s_waitcnt vmcnt(14)
s_barrier
ds_read_b128 v[96:99], v2 offset:49152
ds_read_b128 v[100:103], v2 offset:50176
ds_read_b128 v[104:107], v2 offset:51200
ds_read_b128 v[108:111], v2 offset:52224
s_waitcnt vmcnt(13)
s_waitcnt lgkmcnt(4)
v_mfma_f32_16x16x32_bf16 v[64:67], v[204:207], v[112:115], v[64:67]
v_mfma_f32_16x16x32_bf16 v[68:71], v[204:207], v[116:119], v[68:71]
v_mfma_f32_16x16x32_bf16 v[72:75], v[204:207], v[120:123], v[72:75]
v_mfma_f32_16x16x32_bf16 v[76:79], v[204:207], v[124:127], v[76:79]
ds_read_b128 v[112:115], v2 offset:53248
ds_read_b128 v[116:119], v2 offset:54272
ds_read_b128 v[120:123], v2 offset:55296
ds_read_b128 v[124:127], v2 offset:56320
s_waitcnt vmcnt(12)
s_waitcnt lgkmcnt(4)
v_mfma_f32_16x16x32_bf16 v[64:67], v[208:211], v[96:99], v[64:67]
v_mfma_f32_16x16x32_bf16 v[68:71], v[208:211], v[100:103], v[68:71]
v_mfma_f32_16x16x32_bf16 v[72:75], v[208:211], v[104:107], v[72:75]
v_mfma_f32_16x16x32_bf16 v[76:79], v[208:211], v[108:111], v[76:79]
ds_read_b128 v[96:99], v2 offset:57344
ds_read_b128 v[100:103], v2 offset:58368
ds_read_b128 v[104:107], v2 offset:59392
ds_read_b128 v[108:111], v2 offset:60416
s_waitcnt vmcnt(11)
s_waitcnt lgkmcnt(4)
v_mfma_f32_16x16x32_bf16 v[64:67], v[212:215], v[112:115], v[64:67]
v_mfma_f32_16x16x32_bf16 v[68:71], v[212:215], v[116:119], v[68:71]
v_mfma_f32_16x16x32_bf16 v[72:75], v[212:215], v[120:123], v[72:75]
v_mfma_f32_16x16x32_bf16 v[76:79], v[212:215], v[124:127], v[76:79]
ds_read_b128 v[112:115], v2 offset:61440
ds_read_b128 v[116:119], v2 offset:62464
ds_read_b128 v[120:123], v2 offset:63488
ds_read_b128 v[124:127], v2 offset:64512
s_waitcnt vmcnt(10)
s_waitcnt lgkmcnt(4)
v_mfma_f32_16x16x32_bf16 v[64:67], v[216:219], v[96:99], v[64:67]
v_mfma_f32_16x16x32_bf16 v[68:71], v[216:219], v[100:103], v[68:71]
v_mfma_f32_16x16x32_bf16 v[72:75], v[216:219], v[104:107], v[72:75]
v_mfma_f32_16x16x32_bf16 v[76:79], v[216:219], v[108:111], v[76:79]
s_waitcnt vmcnt(8)
s_barrier
ds_read_b128 v[96:99], v3 offset:0
ds_read_b128 v[100:103], v3 offset:1024
ds_read_b128 v[104:107], v3 offset:2048
ds_read_b128 v[108:111], v3 offset:3072
s_waitcnt vmcnt(7)
s_waitcnt lgkmcnt(4)
v_mfma_f32_16x16x32_bf16 v[64:67], v[220:223], v[112:115], v[64:67]
v_mfma_f32_16x16x32_bf16 v[68:71], v[220:223], v[116:119], v[68:71]
v_mfma_f32_16x16x32_bf16 v[72:75], v[220:223], v[120:123], v[72:75]
v_mfma_f32_16x16x32_bf16 v[76:79], v[220:223], v[124:127], v[76:79]
ds_read_b128 v[112:115], v3 offset:4096
ds_read_b128 v[116:119], v3 offset:5120
ds_read_b128 v[120:123], v3 offset:6144
ds_read_b128 v[124:127], v3 offset:7168
s_waitcnt vmcnt(6)
s_waitcnt lgkmcnt(4)
v_mfma_f32_16x16x32_bf16 v[64:67], v[128:131], v[96:99], v[64:67]
v_mfma_f32_16x16x32_bf16 v[68:71], v[128:131], v[100:103], v[68:71]
v_mfma_f32_16x16x32_bf16 v[72:75], v[128:131], v[104:107], v[72:75]
v_mfma_f32_16x16x32_bf16 v[76:79], v[128:131], v[108:111], v[76:79]
ds_read_b128 v[96:99], v3 offset:8192
ds_read_b128 v[100:103], v3 offset:9216
ds_read_b128 v[104:107], v3 offset:10240
ds_read_b128 v[108:111], v3 offset:11264
s_waitcnt vmcnt(5)
s_waitcnt lgkmcnt(4)
v_mfma_f32_16x16x32_bf16 v[64:67], v[132:135], v[112:115], v[64:67]
v_mfma_f32_16x16x32_bf16 v[68:71], v[132:135], v[116:119], v[68:71]
v_mfma_f32_16x16x32_bf16 v[72:75], v[132:135], v[120:123], v[72:75]
v_mfma_f32_16x16x32_bf16 v[76:79], v[132:135], v[124:127], v[76:79]
ds_read_b128 v[112:115], v3 offset:12288
ds_read_b128 v[116:119], v3 offset:13312
ds_read_b128 v[120:123], v3 offset:14336
ds_read_b128 v[124:127], v3 offset:15360
s_waitcnt vmcnt(4)
s_waitcnt lgkmcnt(4)
v_mfma_f32_16x16x32_bf16 v[64:67], v[136:139], v[96:99], v[64:67]
v_mfma_f32_16x16x32_bf16 v[68:71], v[136:139], v[100:103], v[68:71]
v_mfma_f32_16x16x32_bf16 v[72:75], v[136:139], v[104:107], v[72:75]
v_mfma_f32_16x16x32_bf16 v[76:79], v[136:139], v[108:111], v[76:79]
s_waitcnt vmcnt(3)
s_barrier
ds_read_b128 v[96:99], v3 offset:16384
ds_read_b128 v[100:103], v3 offset:17408
ds_read_b128 v[104:107], v3 offset:18432
ds_read_b128 v[108:111], v3 offset:19456
s_waitcnt vmcnt(2)
s_waitcnt lgkmcnt(4)
v_mfma_f32_16x16x32_bf16 v[64:67], v[140:143], v[112:115], v[64:67]
v_mfma_f32_16x16x32_bf16 v[68:71], v[140:143], v[116:119], v[68:71]
v_mfma_f32_16x16x32_bf16 v[72:75], v[140:143], v[120:123], v[72:75]
v_mfma_f32_16x16x32_bf16 v[76:79], v[140:143], v[124:127], v[76:79]
ds_read_b128 v[112:115], v3 offset:20480
ds_read_b128 v[116:119], v3 offset:21504
ds_read_b128 v[120:123], v3 offset:22528
ds_read_b128 v[124:127], v3 offset:23552
s_waitcnt vmcnt(1)
s_waitcnt lgkmcnt(4)
v_mfma_f32_16x16x32_bf16 v[64:67], v[144:147], v[96:99], v[64:67]
v_mfma_f32_16x16x32_bf16 v[68:71], v[144:147], v[100:103], v[68:71]
v_mfma_f32_16x16x32_bf16 v[72:75], v[144:147], v[104:107], v[72:75]
v_mfma_f32_16x16x32_bf16 v[76:79], v[144:147], v[108:111], v[76:79]
s_waitcnt vmcnt(0)
s_waitcnt lgkmcnt(0)
v_mfma_f32_16x16x32_bf16 v[64:67], v[148:151], v[112:115], v[64:67]
v_mfma_f32_16x16x32_bf16 v[68:71], v[148:151], v[116:119], v[68:71]
v_mfma_f32_16x16x32_bf16 v[72:75], v[148:151], v[120:123], v[72:75]
v_mfma_f32_16x16x32_bf16 v[76:79], v[148:151], v[124:127], v[76:79]
v_add_u32 v61, s19, v4
v_mul_u32_u24 v61, 1280, v61
v_lshlrev_b32 v60, 3, v5
v_add_u32 v61, v61, v60
s_lshl_b32 s24, s31, 5
v_lshlrev_b32 v224, 16, v6
v_and_b32 v225, 0xffff0000, v6
v_lshlrev_b32 v226, 16, v7
v_and_b32 v227, 0xffff0000, v7
v_add_f32 v64, v64, v14
v_add_f32 v65, v65, v15
v_add_f32 v66, v66, v16
v_add_f32 v67, v67, v17
v_fmac_f32 v224, v64, v38
v_fmac_f32 v225, v65, v39
v_fmac_f32 v226, v66, v40
v_fmac_f32 v227, v67, v41
v_cvt_pk_bf16_f32 v232, v224, v225
v_cvt_pk_bf16_f32 v233, v226, v227
buffer_store_dwordx2 v[232:233], v61, s[12:15], s24 offen
s_add_u32 s24, s24, 20480
v_lshlrev_b32 v228, 16, v8
v_and_b32 v229, 0xffff0000, v8
v_lshlrev_b32 v230, 16, v9
v_and_b32 v231, 0xffff0000, v9
v_add_f32 v68, v68, v18
v_add_f32 v69, v69, v19
v_add_f32 v70, v70, v20
v_add_f32 v71, v71, v21
v_fmac_f32 v228, v68, v38
v_fmac_f32 v229, v69, v39
v_fmac_f32 v230, v70, v40
v_fmac_f32 v231, v71, v41
v_cvt_pk_bf16_f32 v234, v228, v229
v_cvt_pk_bf16_f32 v235, v230, v231
buffer_store_dwordx2 v[234:235], v61, s[12:15], s24 offen
s_add_u32 s24, s24, 20480
v_lshlrev_b32 v224, 16, v10
v_and_b32 v225, 0xffff0000, v10
v_lshlrev_b32 v226, 16, v11
v_and_b32 v227, 0xffff0000, v11
v_add_f32 v72, v72, v22
v_add_f32 v73, v73, v23
v_add_f32 v74, v74, v24
v_add_f32 v75, v75, v25
v_fmac_f32 v224, v72, v38
v_fmac_f32 v225, v73, v39
v_fmac_f32 v226, v74, v40
v_fmac_f32 v227, v75, v41
v_cvt_pk_bf16_f32 v236, v224, v225
v_cvt_pk_bf16_f32 v237, v226, v227
buffer_store_dwordx2 v[236:237], v61, s[12:15], s24 offen
s_add_u32 s24, s24, 20480
v_lshlrev_b32 v228, 16, v12
v_and_b32 v229, 0xffff0000, v12
v_lshlrev_b32 v230, 16, v13
v_and_b32 v231, 0xffff0000, v13
v_add_f32 v76, v76, v26
v_add_f32 v77, v77, v27
v_add_f32 v78, v78, v28
v_add_f32 v79, v79, v29
v_fmac_f32 v228, v76, v38
v_fmac_f32 v229, v77, v39
v_fmac_f32 v230, v78, v40
v_fmac_f32 v231, v79, v41
v_cvt_pk_bf16_f32 v238, v228, v229
v_cvt_pk_bf16_f32 v239, v230, v231
buffer_store_dwordx2 v[238:239], v61, s[12:15], s24 offen
s_add_u32 s24, s24, 20480
s_endpgm
L_28:
s_cmp_eq_u32 s18, 7
s_cbranch_scc1 L_29
s_mul_i32 s31, s17, 5
s_add_u32 s31, s31, s18
s_lshl_b32 s24, s17, 3
s_add_u32 s24, s24, s18
s_add_u32 s44, s24, s19
s_lshr_b32 s24, s44, 4
s_mul_i32 s24, s24, 20480
s_and_b32 s25, s44, 15
s_lshl_b32 s25, s25, 4
s_add_u32 s24, s24, s25
s_add_u32 s24, s24, 11534336
v_lshrrev_b32 v50, 4, v1
v_min_u32 v50, 39, v50
v_lshrrev_b32 v51, 1, v50
v_lshlrev_b32 v51, 10, v51
v_and_b32 v52, 1, v50
v_lshlrev_b32 v52, 9, v52
v_add_u32 v51, v51, v52
v_lshlrev_b32 v52, 6, v50
buffer_load_dwordx4 v[240:243], v51, s[8:11], s24 offen
buffer_load_dwordx4 v[244:247], v51, s[8:11], s24 offen offset:256
s_mov_b32 s25, 155648
s_mov_b32 s26, 158208
buffer_load_dwordx4 v[112:115], v52, s[8:11], s25 offen offset:0
buffer_load_dwordx4 v[224:227], v52, s[8:11], s26 offen offset:0
buffer_load_dwordx4 v[116:119], v52, s[8:11], s25 offen offset:16
buffer_load_dwordx4 v[228:231], v52, s[8:11], s26 offen offset:16
buffer_load_dwordx4 v[120:123], v52, s[8:11], s25 offen offset:32
buffer_load_dwordx4 v[232:235], v52, s[8:11], s26 offen offset:32
buffer_load_dwordx4 v[124:127], v52, s[8:11], s25 offen offset:48
buffer_load_dwordx4 v[236:239], v52, s[8:11], s26 offen offset:48
s_mul_i32 s37, s17, 14
s_sub_u32 s24, s17, 4
s_max_i32 s24, s24, 0
s_sub_u32 s37, s37, s24
s_add_u32 s38, s37, s18
s_add_u32 s39, s38, 8
s_mul_i32 s41, s38, 20480
s_add_u32 s41, s41, 32505856
s_mul_i32 s42, s39, 20480
s_add_u32 s42, s42, 32505856
s_mul_i32 s49, s31, 20480
s_add_u32 s49, s49, 31457280
s_mul_i32 s50, s31, 55296
s_add_u32 s50, s50, 35651584
s_lshr_b32 s24, s31, 1
s_lshl_b32 s24, s24, 10
s_and_b32 s25, s31, 1
s_lshl_b32 s25, s25, 3
s_add_u32 s24, s24, s25
s_mul_i32 s25, s16, 81920
s_add_u32 s24, s24, s25
s_add_u32 s33, s24, 0
s_mul_i32 s52, s17, 5
s_and_b32 s24, s18, 3
s_lshl_b32 s24, s24, 4
s_add_u32 s24, s24, s19
v_add_u32 v46, s24, v4
v_add_u32 v46, s27, v46
v_min_i32 v46, 2047, v46
v_max_i32 v46, 0, v46
v_lshrrev_b32 v47, 4, v46
v_mul_u32_u24 v47, 20480, v47
v_and_b32 v46, 15, v46
v_lshlrev_b32 v46, 4, v46
v_add_u32 v47, v47, v46
v_lshlrev_b32 v46, 8, v5
v_add_u32 v42, v47, v46
s_lshr_b32 s24, s18, 2
s_lshl_b32 s24, s24, 10
s_add_u32 s28, s24, 14680064
s_add_u32 m0, s21, 0
s_add_u32 s22, s28, 0
buffer_load_dwordx4 v42, s[8:11], s22 offen  lds
s_add_u32 m0, s21, 8192
s_add_u32 s22, s28, 2048
buffer_load_dwordx4 v42, s[8:11], s22 offen  lds
s_add_u32 m0, s21, 16384
s_add_u32 s22, s28, 4096
buffer_load_dwordx4 v42, s[8:11], s22 offen  lds
s_add_u32 m0, s21, 24576
s_add_u32 s22, s28, 6144
buffer_load_dwordx4 v42, s[8:11], s22 offen  lds
s_add_u32 m0, s21, 32768
s_add_u32 s22, s28, 8192
buffer_load_dwordx4 v42, s[8:11], s22 offen  lds
s_add_u32 m0, s21, 40960
s_add_u32 s22, s28, 10240
buffer_load_dwordx4 v42, s[8:11], s22 offen  lds
s_add_u32 m0, s21, 49152
s_add_u32 s22, s28, 12288
buffer_load_dwordx4 v42, s[8:11], s22 offen  lds
s_add_u32 m0, s21, 57344
s_add_u32 s22, s28, 14336
buffer_load_dwordx4 v42, s[8:11], s22 offen  lds
s_add_u32 m0, s21, 65536
s_add_u32 s22, s28, 16384
buffer_load_dwordx4 v42, s[8:11], s22 offen  lds
s_add_u32 m0, s21, 73728
s_add_u32 s22, s28, 18432
buffer_load_dwordx4 v42, s[8:11], s22 offen  lds
s_waitcnt vmcnt(10)
v_cmp_gt_u32 vcc, 640, v1
v_lshlrev_b32 v96, 16, v240
v_and_b32 v97, 0xffff0000, v240
v_lshlrev_b32 v98, 16, v241
v_and_b32 v99, 0xffff0000, v241
v_lshlrev_b32 v100, 16, v242
v_and_b32 v101, 0xffff0000, v242
v_lshlrev_b32 v102, 16, v243
v_and_b32 v103, 0xffff0000, v243
v_lshlrev_b32 v104, 16, v244
v_and_b32 v105, 0xffff0000, v244
v_lshlrev_b32 v106, 16, v245
v_and_b32 v107, 0xffff0000, v245
v_lshlrev_b32 v108, 16, v246
v_and_b32 v109, 0xffff0000, v246
v_lshlrev_b32 v110, 16, v247
v_and_b32 v111, 0xffff0000, v247
v_add_f32 v53, v96, v98
v_add_f32 v54, v97, v99
v_add_f32 v53, v53, v100
v_add_f32 v54, v54, v101
v_add_f32 v53, v53, v102
v_add_f32 v54, v54, v103
v_add_f32 v53, v53, v104
v_add_f32 v54, v54, v105
v_add_f32 v53, v53, v106
v_add_f32 v54, v54, v107
v_add_f32 v53, v53, v108
v_add_f32 v54, v54, v109
v_add_f32 v53, v53, v110
v_add_f32 v54, v54, v111
v_add_f32 v53, v53, v54
v_cndmask_b32 v53, 0, v53, vcc
s_nop 1
v_add_f32_dpp v53, v53, v53 row_ror:8 row_mask:0xf bank_mask:0xf
s_nop 1
v_add_f32_dpp v53, v53, v53 row_ror:4 row_mask:0xf bank_mask:0xf
s_nop 1
v_add_f32_dpp v53, v53, v53 row_ror:2 row_mask:0xf bank_mask:0xf
s_nop 1
v_add_f32_dpp v53, v53, v53 row_ror:1 row_mask:0xf bank_mask:0xf
s_nop 1
v_add_f32_dpp v53, v53, v53 row_bcast:15 row_mask:0xa bank_mask:0xf
s_nop 1
v_add_f32_dpp v53, v53, v53 row_bcast:31 row_mask:0xc bank_mask:0xf
v_mul_f32 v53, 0x3acccccd, v53
s_nop 0
v_readlane_b32 s45, v53, 63
s_nop 1
v_subrev_f32 v96, s45, v96
v_subrev_f32 v97, s45, v97
v_subrev_f32 v98, s45, v98
v_subrev_f32 v99, s45, v99
v_subrev_f32 v100, s45, v100
v_subrev_f32 v101, s45, v101
v_subrev_f32 v102, s45, v102
v_subrev_f32 v103, s45, v103
v_subrev_f32 v104, s45, v104
v_subrev_f32 v105, s45, v105
v_subrev_f32 v106, s45, v106
v_subrev_f32 v107, s45, v107
v_subrev_f32 v108, s45, v108
v_subrev_f32 v109, s45, v109
v_subrev_f32 v110, s45, v110
v_subrev_f32 v111, s45, v111
v_mul_f32 v53, v96, v96
v_mul_f32 v54, v97, v97
v_fmac_f32 v53, v98, v98
v_fmac_f32 v54, v99, v99
v_fmac_f32 v53, v100, v100
v_fmac_f32 v54, v101, v101
v_fmac_f32 v53, v102, v102
v_fmac_f32 v54, v103, v103
v_fmac_f32 v53, v104, v104
v_fmac_f32 v54, v105, v105
v_fmac_f32 v53, v106, v106
v_fmac_f32 v54, v107, v107
v_fmac_f32 v53, v108, v108
v_fmac_f32 v54, v109, v109
v_fmac_f32 v53, v110, v110
v_fmac_f32 v54, v111, v111
v_add_f32 v53, v53, v54
v_cndmask_b32 v53, 0, v53, vcc
s_nop 1
v_add_f32_dpp v53, v53, v53 row_ror:8 row_mask:0xf bank_mask:0xf
s_nop 1
v_add_f32_dpp v53, v53, v53 row_ror:4 row_mask:0xf bank_mask:0xf
s_nop 1
v_add_f32_dpp v53, v53, v53 row_ror:2 row_mask:0xf bank_mask:0xf
s_nop 1
v_add_f32_dpp v53, v53, v53 row_ror:1 row_mask:0xf bank_mask:0xf
s_nop 1
v_add_f32_dpp v53, v53, v53 row_bcast:15 row_mask:0xa bank_mask:0xf
s_nop 1
v_add_f32_dpp v53, v53, v53 row_bcast:31 row_mask:0xc bank_mask:0xf
v_mov_b32 v54, 0x3727c5ac
v_fmac_f32 v54, 0x3acccccd, v53
v_rsq_f32 v54, v54
s_nop 0
v_readlane_b32 s46, v54, 63
s_nop 1
v_mul_f32 v112, s46, v112
v_mul_f32 v113, s46, v113
v_mul_f32 v114, s46, v114
v_mul_f32 v115, s46, v115
v_mul_f32 v116, s46, v116
v_mul_f32 v117, s46, v117
v_mul_f32 v118, s46, v118
v_mul_f32 v119, s46, v119
v_mul_f32 v120, s46, v120
v_mul_f32 v121, s46, v121
v_mul_f32 v122, s46, v122
v_mul_f32 v123, s46, v123
v_mul_f32 v124, s46, v124
v_mul_f32 v125, s46, v125
v_mul_f32 v126, s46, v126
v_mul_f32 v127, s46, v127
v_fma_f32 v96, v96, v112, v224
v_fma_f32 v97, v97, v113, v225
v_fma_f32 v98, v98, v114, v226
v_fma_f32 v99, v99, v115, v227
v_fma_f32 v100, v100, v116, v228
v_fma_f32 v101, v101, v117, v229
v_fma_f32 v102, v102, v118, v230
v_fma_f32 v103, v103, v119, v231
v_fma_f32 v104, v104, v120, v232
v_fma_f32 v105, v105, v121, v233
v_fma_f32 v106, v106, v122, v234
v_fma_f32 v107, v107, v123, v235
v_fma_f32 v108, v108, v124, v236
v_fma_f32 v109, v109, v125, v237
v_fma_f32 v110, v110, v126, v238
v_fma_f32 v111, v111, v127, v239
v_add_f32 v53, v96, v98
v_add_f32 v54, v97, v99
v_add_f32 v53, v53, v100
v_add_f32 v54, v54, v101
v_add_f32 v53, v53, v102
v_add_f32 v54, v54, v103
v_add_f32 v53, v53, v104
v_add_f32 v54, v54, v105
v_add_f32 v53, v53, v106
v_add_f32 v54, v54, v107
v_add_f32 v53, v53, v108
v_add_f32 v54, v54, v109
v_add_f32 v53, v53, v110
v_add_f32 v54, v54, v111
v_add_f32 v53, v53, v54
v_cndmask_b32 v53, 0, v53, vcc
s_nop 1
v_add_f32_dpp v53, v53, v53 row_ror:8 row_mask:0xf bank_mask:0xf
s_nop 1
v_add_f32_dpp v53, v53, v53 row_ror:4 row_mask:0xf bank_mask:0xf
s_nop 1
v_add_f32_dpp v53, v53, v53 row_ror:2 row_mask:0xf bank_mask:0xf
s_nop 1
v_add_f32_dpp v53, v53, v53 row_ror:1 row_mask:0xf bank_mask:0xf
s_nop 1
v_add_f32_dpp v53, v53, v53 row_bcast:15 row_mask:0xa bank_mask:0xf
s_nop 1
v_add_f32_dpp v53, v53, v53 row_bcast:31 row_mask:0xc bank_mask:0xf
v_mul_f32 v53, 0x3acccccd, v53
s_nop 0
v_readlane_b32 s47, v53, 63
s_nop 1
v_subrev_f32 v96, s47, v96
v_subrev_f32 v97, s47, v97
v_subrev_f32 v98, s47, v98
v_subrev_f32 v99, s47, v99
v_subrev_f32 v100, s47, v100
v_subrev_f32 v101, s47, v101
v_subrev_f32 v102, s47, v102
v_subrev_f32 v103, s47, v103
v_subrev_f32 v104, s47, v104
v_subrev_f32 v105, s47, v105
v_subrev_f32 v106, s47, v106
v_subrev_f32 v107, s47, v107
v_subrev_f32 v108, s47, v108
v_subrev_f32 v109, s47, v109
v_subrev_f32 v110, s47, v110
v_subrev_f32 v111, s47, v111
v_mul_f32 v53, v96, v96
v_mul_f32 v54, v97, v97
v_fmac_f32 v53, v98, v98
v_fmac_f32 v54, v99, v99
v_fmac_f32 v53, v100, v100
v_fmac_f32 v54, v101, v101
v_fmac_f32 v53, v102, v102
v_fmac_f32 v54, v103, v103
v_fmac_f32 v53, v104, v104
v_fmac_f32 v54, v105, v105
v_fmac_f32 v53, v106, v106
v_fmac_f32 v54, v107, v107
v_fmac_f32 v53, v108, v108
v_fmac_f32 v54, v109, v109
v_fmac_f32 v53, v110, v110
v_fmac_f32 v54, v111, v111
v_add_f32 v53, v53, v54
v_cndmask_b32 v53, 0, v53, vcc
s_nop 1
v_add_f32_dpp v53, v53, v53 row_ror:8 row_mask:0xf bank_mask:0xf
s_nop 1
v_add_f32_dpp v53, v53, v53 row_ror:4 row_mask:0xf bank_mask:0xf
s_nop 1
v_add_f32_dpp v53, v53, v53 row_ror:2 row_mask:0xf bank_mask:0xf
s_nop 1
v_add_f32_dpp v53, v53, v53 row_ror:1 row_mask:0xf bank_mask:0xf
s_nop 1
v_add_f32_dpp v53, v53, v53 row_bcast:15 row_mask:0xa bank_mask:0xf
s_nop 1
v_add_f32_dpp v53, v53, v53 row_bcast:31 row_mask:0xc bank_mask:0xf
v_mov_b32 v54, 0x3727c5ac
v_fmac_f32 v54, 0x3acccccd, v53
v_rsq_f32 v54, v54
s_nop 0
v_readlane_b32 s48, v54, 63
v_mov_b32 v228, s46
s_nop 0
v_mov_b32 v226, s48
v_mul_f32 v224, s48, v228
v_mul_f32 v225, s45, v224
v_sub_f32 v225, 0, v225
v_mul_f32 v227, s47, v226
v_sub_f32 v227, 0, v227
v_mul_f32 v229, s45, v228
v_mov_b32 v230, s43
v_mov_b32 v231, 0
s_lshl_b32 s24, s44, 5
s_add_u32 s24, s24, 196608
v_mov_b32 v53, 0
s_mov_b64 exec, 1
buffer_store_dwordx4 v[224:227], v53, s[8:11], s24 offen sc0 sc1
buffer_store_dwordx4 v[228:231], v53, s[8:11], s24 offen offset:16 sc0 sc1
s_mov_b64 exec, -1
s_waitcnt vmcnt(0)
s_barrier
s_barrier
v_mov_b32 v48, 133120
ds_read_b32 v48, v48
s_waitcnt lgkmcnt(0)
v_readfirstlane_b32 s24, v48
s_cmp_eq_u32 s24, 0
s_cbranch_scc1 L_53
s_lshl_b32 s35, s16, 5
s_add_u32 s35, s35, 165888
s_lshl_b32 s24, s17, 2
s_add_u32 s36, s35, s24
s_barrier
s_cmp_lg_u32 s18, 0
s_cbranch_scc1 L_54
v_mov_b32 v46, 0
v_mov_b32 v47, 1
buffer_store_dword v47, v46, s[8:11], s36 offen
L_54:
s_and_b32 s24, s18, 3
s_lshl_b32 s24, s24, 4
s_add_u32 s24, s24, s19
v_add_u32 v46, s24, v4
v_lshrrev_b32 v47, 4, v46
v_mul_u32_u24 v47, 20480, v47
v_and_b32 v46, 15, v46
v_lshlrev_b32 v46, 4, v46
v_add_u32 v47, v47, v46
v_lshlrev_b32 v46, 8, v5
v_add_u32 v42, v47, v46
s_lshr_b32 s24, s18, 2
s_lshl_b32 s24, s24, 10
s_add_u32 s28, s24, 1048576
v_lshrrev_b32 v46, 2, v1
v_min_u32 v46, 28, v46
s_mov_b32 s30, 40000
L_55:
buffer_load_dword v47, v46, s[8:11], s35 offen sc1
s_waitcnt vmcnt(0)
v_cmp_ne_u32 vcc, 1, v47
s_nop 4
s_cbranch_vccz L_56
s_sub_u32 s30, s30, 1
s_cmp_lg_u32 s30, 0
s_cbranch_scc1 L_55
L_56:
s_add_u32 m0, s21, 0
s_add_u32 s22, s28, 0
buffer_load_dwordx4 v42, s[8:11], s22 offen  lds
s_add_u32 m0, s21, 8192
s_add_u32 s22, s28, 2048
buffer_load_dwordx4 v42, s[8:11], s22 offen  lds
s_add_u32 m0, s21, 16384
s_add_u32 s22, s28, 4096
buffer_load_dwordx4 v42, s[8:11], s22 offen  lds
s_add_u32 m0, s21, 24576
s_add_u32 s22, s28, 6144
buffer_load_dwordx4 v42, s[8:11], s22 offen  lds
s_add_u32 m0, s21, 32768
s_add_u32 s22, s28, 8192
buffer_load_dwordx4 v42, s[8:11], s22 offen  lds
s_add_u32 m0, s21, 40960
s_add_u32 s22, s28, 10240
buffer_load_dwordx4 v42, s[8:11], s22 offen  lds
s_add_u32 m0, s21, 49152
s_add_u32 s22, s28, 12288
buffer_load_dwordx4 v42, s[8:11], s22 offen  lds
s_add_u32 m0, s21, 57344
s_add_u32 s22, s28, 14336
buffer_load_dwordx4 v42, s[8:11], s22 offen  lds
s_add_u32 m0, s21, 65536
s_add_u32 s22, s28, 16384
buffer_load_dwordx4 v42, s[8:11], s22 offen  lds
s_add_u32 m0, s21, 73728
s_add_u32 s22, s28, 18432
buffer_load_dwordx4 v42, s[8:11], s22 offen  lds
s_waitcnt vmcnt(8)
s_barrier
s_waitcnt vmcnt(6)
s_barrier
s_waitcnt vmcnt(4)
s_barrier
s_waitcnt vmcnt(2)
s_barrier
s_waitcnt vmcnt(0)
s_barrier
s_cmp_eq_u32 s18, 5
s_cselect_b32 s24, s17, 7
s_cmp_lt_u32 s24, 4
s_cbranch_scc0 L_57
s_add_u32 s23, s41, 0
buffer_load_dwordx4 v[128:131], v1, s[8:11], s23 offen
s_add_u32 s23, s42, 0
buffer_load_dwordx4 v[132:135], v1, s[8:11], s23 offen
s_add_u32 s23, s41, 1024
buffer_load_dwordx4 v[136:139], v1, s[8:11], s23 offen
s_add_u32 s23, s42, 1024
buffer_load_dwordx4 v[140:143], v1, s[8:11], s23 offen
s_add_u32 s23, s41, 2048
buffer_load_dwordx4 v[144:147], v1, s[8:11], s23 offen
s_add_u32 s23, s42, 2048
buffer_load_dwordx4 v[148:151], v1, s[8:11], s23 offen
s_add_u32 s23, s41, 3072
buffer_load_dwordx4 v[152:155], v1, s[8:11], s23 offen
s_add_u32 s23, s42, 3072
buffer_load_dwordx4 v[156:159], v1, s[8:11], s23 offen
s_add_u32 s23, s41, 4096
buffer_load_dwordx4 v[160:163], v1, s[8:11], s23 offen
s_add_u32 s23, s42, 4096
buffer_load_dwordx4 v[164:167], v1, s[8:11], s23 offen
s_add_u32 s23, s41, 5120
buffer_load_dwordx4 v[168:171], v1, s[8:11], s23 offen
s_add_u32 s23, s42, 5120
buffer_load_dwordx4 v[172:175], v1, s[8:11], s23 offen
s_add_u32 s23, s41, 6144
buffer_load_dwordx4 v[176:179], v1, s[8:11], s23 offen
s_add_u32 s23, s42, 6144
buffer_load_dwordx4 v[180:183], v1, s[8:11], s23 offen
s_add_u32 s23, s41, 7168
buffer_load_dwordx4 v[184:187], v1, s[8:11], s23 offen
s_add_u32 s23, s42, 7168
buffer_load_dwordx4 v[188:191], v1, s[8:11], s23 offen
s_add_u32 s23, s41, 8192
buffer_load_dwordx4 v[192:195], v1, s[8:11], s23 offen
s_add_u32 s23, s42, 8192
buffer_load_dwordx4 v[196:199], v1, s[8:11], s23 offen
s_add_u32 s23, s41, 9216
buffer_load_dwordx4 v[200:203], v1, s[8:11], s23 offen
s_add_u32 s23, s42, 9216
buffer_load_dwordx4 v[204:207], v1, s[8:11], s23 offen
s_add_u32 s23, s41, 10240
buffer_load_dwordx4 v[208:211], v1, s[8:11], s23 offen
s_add_u32 s23, s42, 10240
buffer_load_dwordx4 v[212:215], v1, s[8:11], s23 offen
s_add_u32 s23, s41, 11264
buffer_load_dwordx4 v[216:219], v1, s[8:11], s23 offen
s_add_u32 s23, s42, 11264
buffer_load_dwordx4 v[220:223], v1, s[8:11], s23 offen
s_add_u32 s35, s35, 1024
s_add_u32 s36, s36, 1024
s_barrier
s_cmp_lg_u32 s18, 0
s_cbranch_scc1 L_59
v_mov_b32 v46, 0
v_mov_b32 v47, 1
buffer_store_dword v47, v46, s[8:11], s36 offen
L_59:
s_and_b32 s24, s18, 3
s_lshl_b32 s24, s24, 4
s_add_u32 s24, s24, s19
v_add_u32 v46, s24, v4
v_lshrrev_b32 v47, 4, v46
v_mul_u32_u24 v47, 20480, v47
v_and_b32 v46, 15, v46
v_lshlrev_b32 v46, 4, v46
v_add_u32 v47, v47, v46
v_lshlrev_b32 v46, 8, v5
v_add_u32 v42, v47, v46
s_lshr_b32 s24, s18, 2
s_lshl_b32 s24, s24, 10
s_add_u32 s28, s24, 11534336
v_lshrrev_b32 v46, 2, v1
v_min_u32 v46, 28, v46
s_mov_b32 s30, 40000
L_60:
buffer_load_dword v47, v46, s[8:11], s35 offen sc1
s_waitcnt vmcnt(0)
v_cmp_ne_u32 vcc, 1, v47
s_nop 4
s_cbranch_vccz L_61
s_sub_u32 s30, s30, 1
s_cmp_lg_u32 s30, 0
s_cbranch_scc1 L_60
L_61:
s_add_u32 m0, s21, 0
s_add_u32 s22, s28, 0
buffer_load_dwordx4 v42, s[8:11], s22 offen sc1 lds
s_add_u32 m0, s21, 8192
s_add_u32 s22, s28, 2048
buffer_load_dwordx4 v42, s[8:11], s22 offen sc1 lds
s_add_u32 m0, s21, 16384
s_add_u32 s22, s28, 4096
buffer_load_dwordx4 v42, s[8:11], s22 offen sc1 lds
s_add_u32 m0, s21, 24576
s_add_u32 s22, s28, 6144
buffer_load_dwordx4 v42, s[8:11], s22 offen sc1 lds
s_add_u32 m0, s21, 32768
s_add_u32 s22, s28, 8192
buffer_load_dwordx4 v42, s[8:11], s22 offen sc1 lds
s_add_u32 m0, s21, 40960
s_add_u32 s22, s28, 10240
buffer_load_dwordx4 v42, s[8:11], s22 offen sc1 lds
s_add_u32 m0, s21, 49152
s_add_u32 s22, s28, 12288
buffer_load_dwordx4 v42, s[8:11], s22 offen sc1 lds
s_add_u32 m0, s21, 57344
s_add_u32 s22, s28, 14336
buffer_load_dwordx4 v42, s[8:11], s22 offen sc1 lds
s_add_u32 m0, s21, 65536
s_add_u32 s22, s28, 16384
buffer_load_dwordx4 v42, s[8:11], s22 offen sc1 lds
s_add_u32 m0, s21, 73728
s_add_u32 s22, s28, 18432
buffer_load_dwordx4 v42, s[8:11], s22 offen sc1 lds
v_mov_b32 v64, 0
v_mov_b32 v65, 0
v_mov_b32 v66, 0
v_mov_b32 v67, 0
v_mov_b32 v68, 0
v_mov_b32 v69, 0
v_mov_b32 v70, 0
v_mov_b32 v71, 0
v_mov_b32 v72, 0
v_mov_b32 v73, 0
v_mov_b32 v74, 0
v_mov_b32 v75, 0
v_mov_b32 v76, 0
v_mov_b32 v77, 0
v_mov_b32 v78, 0
v_mov_b32 v79, 0
v_mov_b32 v80, 0
v_mov_b32 v81, 0
v_mov_b32 v82, 0
v_mov_b32 v83, 0
v_mov_b32 v84, 0
v_mov_b32 v85, 0
v_mov_b32 v86, 0
v_mov_b32 v87, 0
v_mov_b32 v88, 0
v_mov_b32 v89, 0
v_mov_b32 v90, 0
v_mov_b32 v91, 0
v_mov_b32 v92, 0
v_mov_b32 v93, 0
v_mov_b32 v94, 0
v_mov_b32 v95, 0
s_waitcnt vmcnt(8)
s_barrier
ds_read_b128 v[96:99], v2 offset:0
ds_read_b128 v[100:103], v2 offset:1024
ds_read_b128 v[104:107], v2 offset:2048
ds_read_b128 v[108:111], v2 offset:3072
ds_read_b128 v[112:115], v2 offset:4096
ds_read_b128 v[116:119], v2 offset:5120
ds_read_b128 v[120:123], v2 offset:6144
ds_read_b128 v[124:127], v2 offset:7168
s_waitcnt lgkmcnt(4)
v_mfma_f32_16x16x32_bf16 v[64:67], v[128:131], v[96:99], v[64:67]
v_mfma_f32_16x16x32_bf16 v[68:71], v[128:131], v[100:103], v[68:71]
v_mfma_f32_16x16x32_bf16 v[72:75], v[128:131], v[104:107], v[72:75]
v_mfma_f32_16x16x32_bf16 v[76:79], v[128:131], v[108:111], v[76:79]
v_mfma_f32_16x16x32_bf16 v[80:83], v[132:135], v[96:99], v[80:83]
v_mfma_f32_16x16x32_bf16 v[84:87], v[132:135], v[100:103], v[84:87]
v_mfma_f32_16x16x32_bf16 v[88:91], v[132:135], v[104:107], v[88:91]
v_mfma_f32_16x16x32_bf16 v[92:95], v[132:135], v[108:111], v[92:95]
s_add_u32 s23, s41, 12288
buffer_load_dwordx4 v[128:131], v1, s[8:11], s23 offen
s_add_u32 s23, s42, 12288
buffer_load_dwordx4 v[132:135], v1, s[8:11], s23 offen
ds_read_b128 v[96:99], v2 offset:8192
ds_read_b128 v[100:103], v2 offset:9216
ds_read_b128 v[104:107], v2 offset:10240
ds_read_b128 v[108:111], v2 offset:11264
s_waitcnt lgkmcnt(4)
v_mfma_f32_16x16x32_bf16 v[64:67], v[136:139], v[112:115], v[64:67]
v_mfma_f32_16x16x32_bf16 v[68:71], v[136:139], v[116:119], v[68:71]
v_mfma_f32_16x16x32_bf16 v[72:75], v[136:139], v[120:123], v[72:75]
v_mfma_f32_16x16x32_bf16 v[76:79], v[136:139], v[124:127], v[76:79]
v_mfma_f32_16x16x32_bf16 v[80:83], v[140:143], v[112:115], v[80:83]
v_mfma_f32_16x16x32_bf16 v[84:87], v[140:143], v[116:119], v[84:87]
v_mfma_f32_16x16x32_bf16 v[88:91], v[140:143], v[120:123], v[88:91]
v_mfma_f32_16x16x32_bf16 v[92:95], v[140:143], v[124:127], v[92:95]
s_add_u32 s23, s41, 13312
buffer_load_dwordx4 v[136:139], v1, s[8:11], s23 offen
s_add_u32 s23, s42, 13312
buffer_load_dwordx4 v[140:143], v1, s[8:11], s23 offen
ds_read_b128 v[112:115], v2 offset:12288
ds_read_b128 v[116:119], v2 offset:13312
ds_read_b128 v[120:123], v2 offset:14336
ds_read_b128 v[124:127], v2 offset:15360
s_waitcnt lgkmcnt(4)
v_mfma_f32_16x16x32_bf16 v[64:67], v[144:147], v[96:99], v[64:67]
v_mfma_f32_16x16x32_bf16 v[68:71], v[144:147], v[100:103], v[68:71]
v_mfma_f32_16x16x32_bf16 v[72:75], v[144:147], v[104:107], v[72:75]
v_mfma_f32_16x16x32_bf16 v[76:79], v[144:147], v[108:111], v[76:79]
v_mfma_f32_16x16x32_bf16 v[80:83], v[148:151], v[96:99], v[80:83]
v_mfma_f32_16x16x32_bf16 v[84:87], v[148:151], v[100:103], v[84:87]
v_mfma_f32_16x16x32_bf16 v[88:91], v[148:151], v[104:107], v[88:91]
v_mfma_f32_16x16x32_bf16 v[92:95], v[148:151], v[108:111], v[92:95]
s_add_u32 s23, s41, 14336
buffer_load_dwordx4 v[144:147], v1, s[8:11], s23 offen
s_add_u32 s23, s42, 14336
buffer_load_dwordx4 v[148:151], v1, s[8:11], s23 offen
s_waitcnt vmcnt(12)
s_barrier
ds_read_b128 v[96:99], v2 offset:16384
ds_read_b128 v[100:103], v2 offset:17408
ds_read_b128 v[104:107], v2 offset:18432
ds_read_b128 v[108:111], v2 offset:19456
s_waitcnt lgkmcnt(4)
v_mfma_f32_16x16x32_bf16 v[64:67], v[152:155], v[112:115], v[64:67]
v_mfma_f32_16x16x32_bf16 v[68:71], v[152:155], v[116:119], v[68:71]
v_mfma_f32_16x16x32_bf16 v[72:75], v[152:155], v[120:123], v[72:75]
v_mfma_f32_16x16x32_bf16 v[76:79], v[152:155], v[124:127], v[76:79]
v_mfma_f32_16x16x32_bf16 v[80:83], v[156:159], v[112:115], v[80:83]
v_mfma_f32_16x16x32_bf16 v[84:87], v[156:159], v[116:119], v[84:87]
v_mfma_f32_16x16x32_bf16 v[88:91], v[156:159], v[120:123], v[88:91]
v_mfma_f32_16x16x32_bf16 v[92:95], v[156:159], v[124:127], v[92:95]
s_add_u32 s23, s41, 15360
buffer_load_dwordx4 v[152:155], v1, s[8:11], s23 offen
s_add_u32 s23, s42, 15360
buffer_load_dwordx4 v[156:159], v1, s[8:11], s23 offen
ds_read_b128 v[112:115], v2 offset:20480
ds_read_b128 v[116:119], v2 offset:21504
ds_read_b128 v[120:123], v2 offset:22528
ds_read_b128 v[124:127], v2 offset:23552
s_waitcnt lgkmcnt(4)
v_mfma_f32_16x16x32_bf16 v[64:67], v[160:163], v[96:99], v[64:67]
v_mfma_f32_16x16x32_bf16 v[68:71], v[160:163], v[100:103], v[68:71]
v_mfma_f32_16x16x32_bf16 v[72:75], v[160:163], v[104:107], v[72:75]
v_mfma_f32_16x16x32_bf16 v[76:79], v[160:163], v[108:111], v[76:79]
v_mfma_f32_16x16x32_bf16 v[80:83], v[164:167], v[96:99], v[80:83]
v_mfma_f32_16x16x32_bf16 v[84:87], v[164:167], v[100:103], v[84:87]
v_mfma_f32_16x16x32_bf16 v[88:91], v[164:167], v[104:107], v[88:91]
v_mfma_f32_16x16x32_bf16 v[92:95], v[164:167], v[108:111], v[92:95]
s_add_u32 s23, s41, 16384
buffer_load_dwordx4 v[160:163], v1, s[8:11], s23 offen
s_add_u32 s23, s42, 16384
buffer_load_dwordx4 v[164:167], v1, s[8:11], s23 offen
ds_read_b128 v[96:99], v2 offset:24576
ds_read_b128 v[100:103], v2 offset:25600
ds_read_b128 v[104:107], v2 offset:26624
ds_read_b128 v[108:111], v2 offset:27648
s_waitcnt lgkmcnt(4)
v_mfma_f32_16x16x32_bf16 v[64:67], v[168:171], v[112:115], v[64:67]
v_mfma_f32_16x16x32_bf16 v[68:71], v[168:171], v[116:119], v[68:71]
v_mfma_f32_16x16x32_bf16 v[72:75], v[168:171], v[120:123], v[72:75]
v_mfma_f32_16x16x32_bf16 v[76:79], v[168:171], v[124:127], v[76:79]
v_mfma_f32_16x16x32_bf16 v[80:83], v[172:175], v[112:115], v[80:83]
v_mfma_f32_16x16x32_bf16 v[84:87], v[172:175], v[116:119], v[84:87]
v_mfma_f32_16x16x32_bf16 v[88:91], v[172:175], v[120:123], v[88:91]
v_mfma_f32_16x16x32_bf16 v[92:95], v[172:175], v[124:127], v[92:95]
s_add_u32 s23, s41, 17408
buffer_load_dwordx4 v[168:171], v1, s[8:11], s23 offen
s_add_u32 s23, s42, 17408
buffer_load_dwordx4 v[172:175], v1, s[8:11], s23 offen
ds_read_b128 v[112:115], v2 offset:28672
ds_read_b128 v[116:119], v2 offset:29696
ds_read_b128 v[120:123], v2 offset:30720
ds_read_b128 v[124:127], v2 offset:31744
s_waitcnt lgkmcnt(4)
v_mfma_f32_16x16x32_bf16 v[64:67], v[176:179], v[96:99], v[64:67]
v_mfma_f32_16x16x32_bf16 v[68:71], v[176:179], v[100:103], v[68:71]
v_mfma_f32_16x16x32_bf16 v[72:75], v[176:179], v[104:107], v[72:75]
v_mfma_f32_16x16x32_bf16 v[76:79], v[176:179], v[108:111], v[76:79]
v_mfma_f32_16x16x32_bf16 v[80:83], v[180:183], v[96:99], v[80:83]
v_mfma_f32_16x16x32_bf16 v[84:87], v[180:183], v[100:103], v[84:87]
v_mfma_f32_16x16x32_bf16 v[88:91], v[180:183], v[104:107], v[88:91]
v_mfma_f32_16x16x32_bf16 v[92:95], v[180:183], v[108:111], v[92:95]
s_add_u32 s23, s41, 18432
buffer_load_dwordx4 v[176:179], v1, s[8:11], s23 offen
s_add_u32 s23, s42, 18432
buffer_load_dwordx4 v[180:183], v1, s[8:11], s23 offen
s_waitcnt vmcnt(18)
s_barrier
ds_read_b128 v[96:99], v2 offset:32768
ds_read_b128 v[100:103], v2 offset:33792
ds_read_b128 v[104:107], v2 offset:34816
ds_read_b128 v[108:111], v2 offset:35840
s_waitcnt lgkmcnt(4)
v_mfma_f32_16x16x32_bf16 v[64:67], v[184:187], v[112:115], v[64:67]
v_mfma_f32_16x16x32_bf16 v[68:71], v[184:187], v[116:119], v[68:71]
v_mfma_f32_16x16x32_bf16 v[72:75], v[184:187], v[120:123], v[72:75]
v_mfma_f32_16x16x32_bf16 v[76:79], v[184:187], v[124:127], v[76:79]
v_mfma_f32_16x16x32_bf16 v[80:83], v[188:191], v[112:115], v[80:83]
v_mfma_f32_16x16x32_bf16 v[84:87], v[188:191], v[116:119], v[84:87]
v_mfma_f32_16x16x32_bf16 v[88:91], v[188:191], v[120:123], v[88:91]
v_mfma_f32_16x16x32_bf16 v[92:95], v[188:191], v[124:127], v[92:95]
s_add_u32 s23, s41, 19456
buffer_load_dwordx4 v[184:187], v1, s[8:11], s23 offen
s_add_u32 s23, s42, 19456
buffer_load_dwordx4 v[188:191], v1, s[8:11], s23 offen
ds_read_b128 v[112:115], v2 offset:36864
ds_read_b128 v[116:119], v2 offset:37888
ds_read_b128 v[120:123], v2 offset:38912
ds_read_b128 v[124:127], v2 offset:39936
s_waitcnt lgkmcnt(4)
v_mfma_f32_16x16x32_bf16 v[64:67], v[192:195], v[96:99], v[64:67]
v_mfma_f32_16x16x32_bf16 v[68:71], v[192:195], v[100:103], v[68:71]
v_mfma_f32_16x16x32_bf16 v[72:75], v[192:195], v[104:107], v[72:75]
v_mfma_f32_16x16x32_bf16 v[76:79], v[192:195], v[108:111], v[76:79]
v_mfma_f32_16x16x32_bf16 v[80:83], v[196:199], v[96:99], v[80:83]
v_mfma_f32_16x16x32_bf16 v[84:87], v[196:199], v[100:103], v[84:87]
v_mfma_f32_16x16x32_bf16 v[88:91], v[196:199], v[104:107], v[88:91]
v_mfma_f32_16x16x32_bf16 v[92:95], v[196:199], v[108:111], v[92:95]
ds_read_b128 v[96:99], v2 offset:40960
ds_read_b128 v[100:103], v2 offset:41984
ds_read_b128 v[104:107], v2 offset:43008
ds_read_b128 v[108:111], v2 offset:44032
s_waitcnt lgkmcnt(4)
v_mfma_f32_16x16x32_bf16 v[64:67], v[200:203], v[112:115], v[64:67]
v_mfma_f32_16x16x32_bf16 v[68:71], v[200:203], v[116:119], v[68:71]
v_mfma_f32_16x16x32_bf16 v[72:75], v[200:203], v[120:123], v[72:75]
v_mfma_f32_16x16x32_bf16 v[76:79], v[200:203], v[124:127], v[76:79]
v_mfma_f32_16x16x32_bf16 v[80:83], v[204:207], v[112:115], v[80:83]
v_mfma_f32_16x16x32_bf16 v[84:87], v[204:207], v[116:119], v[84:87]
v_mfma_f32_16x16x32_bf16 v[88:91], v[204:207], v[120:123], v[88:91]
v_mfma_f32_16x16x32_bf16 v[92:95], v[204:207], v[124:127], v[92:95]
ds_read_b128 v[112:115], v2 offset:45056
ds_read_b128 v[116:119], v2 offset:46080
ds_read_b128 v[120:123], v2 offset:47104
ds_read_b128 v[124:127], v2 offset:48128
s_waitcnt lgkmcnt(4)
v_mfma_f32_16x16x32_bf16 v[64:67], v[208:211], v[96:99], v[64:67]
v_mfma_f32_16x16x32_bf16 v[68:71], v[208:211], v[100:103], v[68:71]
v_mfma_f32_16x16x32_bf16 v[72:75], v[208:211], v[104:107], v[72:75]
v_mfma_f32_16x16x32_bf16 v[76:79], v[208:211], v[108:111], v[76:79]
v_mfma_f32_16x16x32_bf16 v[80:83], v[212:215], v[96:99], v[80:83]
v_mfma_f32_16x16x32_bf16 v[84:87], v[212:215], v[100:103], v[84:87]
v_mfma_f32_16x16x32_bf16 v[88:91], v[212:215], v[104:107], v[88:91]
v_mfma_f32_16x16x32_bf16 v[92:95], v[212:215], v[108:111], v[92:95]
s_waitcnt vmcnt(18)
s_barrier
ds_read_b128 v[96:99], v2 offset:49152
ds_read_b128 v[100:103], v2 offset:50176
ds_read_b128 v[104:107], v2 offset:51200
ds_read_b128 v[108:111], v2 offset:52224
s_waitcnt lgkmcnt(4)
v_mfma_f32_16x16x32_bf16 v[64:67], v[216:219], v[112:115], v[64:67]
v_mfma_f32_16x16x32_bf16 v[68:71], v[216:219], v[116:119], v[68:71]
v_mfma_f32_16x16x32_bf16 v[72:75], v[216:219], v[120:123], v[72:75]
v_mfma_f32_16x16x32_bf16 v[76:79], v[216:219], v[124:127], v[76:79]
v_mfma_f32_16x16x32_bf16 v[80:83], v[220:223], v[112:115], v[80:83]
v_mfma_f32_16x16x32_bf16 v[84:87], v[220:223], v[116:119], v[84:87]
v_mfma_f32_16x16x32_bf16 v[88:91], v[220:223], v[120:123], v[88:91]
v_mfma_f32_16x16x32_bf16 v[92:95], v[220:223], v[124:127], v[92:95]
ds_read_b128 v[112:115], v2 offset:53248
ds_read_b128 v[116:119], v2 offset:54272
ds_read_b128 v[120:123], v2 offset:55296
ds_read_b128 v[124:127], v2 offset:56320
s_waitcnt vmcnt(14)
s_waitcnt lgkmcnt(4)
v_mfma_f32_16x16x32_bf16 v[64:67], v[128:131], v[96:99], v[64:67]
v_mfma_f32_16x16x32_bf16 v[68:71], v[128:131], v[100:103], v[68:71]
v_mfma_f32_16x16x32_bf16 v[72:75], v[128:131], v[104:107], v[72:75]
v_mfma_f32_16x16x32_bf16 v[76:79], v[128:131], v[108:111], v[76:79]
v_mfma_f32_16x16x32_bf16 v[80:83], v[132:135], v[96:99], v[80:83]
v_mfma_f32_16x16x32_bf16 v[84:87], v[132:135], v[100:103], v[84:87]
v_mfma_f32_16x16x32_bf16 v[88:91], v[132:135], v[104:107], v[88:91]
v_mfma_f32_16x16x32_bf16 v[92:95], v[132:135], v[108:111], v[92:95]
ds_read_b128 v[96:99], v2 offset:57344
ds_read_b128 v[100:103], v2 offset:58368
ds_read_b128 v[104:107], v2 offset:59392
ds_read_b128 v[108:111], v2 offset:60416
s_waitcnt vmcnt(12)
s_waitcnt lgkmcnt(4)
v_mfma_f32_16x16x32_bf16 v[64:67], v[136:139], v[112:115], v[64:67]
v_mfma_f32_16x16x32_bf16 v[68:71], v[136:139], v[116:119], v[68:71]
v_mfma_f32_16x16x32_bf16 v[72:75], v[136:139], v[120:123], v[72:75]
v_mfma_f32_16x16x32_bf16 v[76:79], v[136:139], v[124:127], v[76:79]
v_mfma_f32_16x16x32_bf16 v[80:83], v[140:143], v[112:115], v[80:83]
v_mfma_f32_16x16x32_bf16 v[84:87], v[140:143], v[116:119], v[84:87]
v_mfma_f32_16x16x32_bf16 v[88:91], v[140:143], v[120:123], v[88:91]
v_mfma_f32_16x16x32_bf16 v[92:95], v[140:143], v[124:127], v[92:95]
ds_read_b128 v[112:115], v2 offset:61440
ds_read_b128 v[116:119], v2 offset:62464
ds_read_b128 v[120:123], v2 offset:63488
ds_read_b128 v[124:127], v2 offset:64512
s_waitcnt vmcnt(10)
s_waitcnt lgkmcnt(4)
v_mfma_f32_16x16x32_bf16 v[64:67], v[144:147], v[96:99], v[64:67]
v_mfma_f32_16x16x32_bf16 v[68:71], v[144:147], v[100:103], v[68:71]
v_mfma_f32_16x16x32_bf16 v[72:75], v[144:147], v[104:107], v[72:75]
v_mfma_f32_16x16x32_bf16 v[76:79], v[144:147], v[108:111], v[76:79]
v_mfma_f32_16x16x32_bf16 v[80:83], v[148:151], v[96:99], v[80:83]
v_mfma_f32_16x16x32_bf16 v[84:87], v[148:151], v[100:103], v[84:87]
v_mfma_f32_16x16x32_bf16 v[88:91], v[148:151], v[104:107], v[88:91]
v_mfma_f32_16x16x32_bf16 v[92:95], v[148:151], v[108:111], v[92:95]
s_waitcnt vmcnt(16)
s_barrier
s_lshl_b32 s24, s38, 6
s_add_u32 s24, s24, 138752
v_lshlrev_b32 v48, 4, v5
buffer_load_dwordx4 v[248:251], v48, s[8:11], s24 offen
s_lshl_b32 s24, s39, 6
s_add_u32 s24, s24, 138752
v_lshlrev_b32 v48, 4, v5
buffer_load_dwordx4 v[252:255], v48, s[8:11], s24 offen
ds_read_b128 v[96:99], v3 offset:0
ds_read_b128 v[100:103], v3 offset:1024
ds_read_b128 v[104:107], v3 offset:2048
ds_read_b128 v[108:111], v3 offset:3072
s_waitcnt vmcnt(10)
s_waitcnt lgkmcnt(4)
v_mfma_f32_16x16x32_bf16 v[64:67], v[152:155], v[112:115], v[64:67]
v_mfma_f32_16x16x32_bf16 v[68:71], v[152:155], v[116:119], v[68:71]
v_mfma_f32_16x16x32_bf16 v[72:75], v[152:155], v[120:123], v[72:75]
v_mfma_f32_16x16x32_bf16 v[76:79], v[152:155], v[124:127], v[76:79]
v_mfma_f32_16x16x32_bf16 v[80:83], v[156:159], v[112:115], v[80:83]
v_mfma_f32_16x16x32_bf16 v[84:87], v[156:159], v[116:119], v[84:87]
v_mfma_f32_16x16x32_bf16 v[88:91], v[156:159], v[120:123], v[88:91]
v_mfma_f32_16x16x32_bf16 v[92:95], v[156:159], v[124:127], v[92:95]
ds_read_b128 v[112:115], v3 offset:4096
ds_read_b128 v[116:119], v3 offset:5120
ds_read_b128 v[120:123], v3 offset:6144
ds_read_b128 v[124:127], v3 offset:7168
s_waitcnt vmcnt(8)
s_waitcnt lgkmcnt(4)
v_mfma_f32_16x16x32_bf16 v[64:67], v[160:163], v[96:99], v[64:67]
v_mfma_f32_16x16x32_bf16 v[68:71], v[160:163], v[100:103], v[68:71]
v_mfma_f32_16x16x32_bf16 v[72:75], v[160:163], v[104:107], v[72:75]
v_mfma_f32_16x16x32_bf16 v[76:79], v[160:163], v[108:111], v[76:79]
v_mfma_f32_16x16x32_bf16 v[80:83], v[164:167], v[96:99], v[80:83]
v_mfma_f32_16x16x32_bf16 v[84:87], v[164:167], v[100:103], v[84:87]
v_mfma_f32_16x16x32_bf16 v[88:91], v[164:167], v[104:107], v[88:91]
v_mfma_f32_16x16x32_bf16 v[92:95], v[164:167], v[108:111], v[92:95]
ds_read_b128 v[96:99], v3 offset:8192
ds_read_b128 v[100:103], v3 offset:9216
ds_read_b128 v[104:107], v3 offset:10240
ds_read_b128 v[108:111], v3 offset:11264
s_waitcnt vmcnt(6)
s_waitcnt lgkmcnt(4)
v_mfma_f32_16x16x32_bf16 v[64:67], v[168:171], v[112:115], v[64:67]
v_mfma_f32_16x16x32_bf16 v[68:71], v[168:171], v[116:119], v[68:71]
v_mfma_f32_16x16x32_bf16 v[72:75], v[168:171], v[120:123], v[72:75]
v_mfma_f32_16x16x32_bf16 v[76:79], v[168:171], v[124:127], v[76:79]
v_mfma_f32_16x16x32_bf16 v[80:83], v[172:175], v[112:115], v[80:83]
v_mfma_f32_16x16x32_bf16 v[84:87], v[172:175], v[116:119], v[84:87]
v_mfma_f32_16x16x32_bf16 v[88:91], v[172:175], v[120:123], v[88:91]
v_mfma_f32_16x16x32_bf16 v[92:95], v[172:175], v[124:127], v[92:95]
ds_read_b128 v[112:115], v3 offset:12288
ds_read_b128 v[116:119], v3 offset:13312
ds_read_b128 v[120:123], v3 offset:14336
ds_read_b128 v[124:127], v3 offset:15360
s_waitcnt vmcnt(4)
s_waitcnt lgkmcnt(4)
v_mfma_f32_16x16x32_bf16 v[64:67], v[176:179], v[96:99], v[64:67]
v_mfma_f32_16x16x32_bf16 v[68:71], v[176:179], v[100:103], v[68:71]
v_mfma_f32_16x16x32_bf16 v[72:75], v[176:179], v[104:107], v[72:75]
v_mfma_f32_16x16x32_bf16 v[76:79], v[176:179], v[108:111], v[76:79]
v_mfma_f32_16x16x32_bf16 v[80:83], v[180:183], v[96:99], v[80:83]
v_mfma_f32_16x16x32_bf16 v[84:87], v[180:183], v[100:103], v[84:87]
v_mfma_f32_16x16x32_bf16 v[88:91], v[180:183], v[104:107], v[88:91]
v_mfma_f32_16x16x32_bf16 v[92:95], v[180:183], v[108:111], v[92:95]
s_waitcnt vmcnt(2)
s_waitcnt lgkmcnt(0)
v_mfma_f32_16x16x32_bf16 v[64:67], v[184:187], v[112:115], v[64:67]
v_mfma_f32_16x16x32_bf16 v[68:71], v[184:187], v[116:119], v[68:71]
v_mfma_f32_16x16x32_bf16 v[72:75], v[184:187], v[120:123], v[72:75]
v_mfma_f32_16x16x32_bf16 v[76:79], v[184:187], v[124:127], v[76:79]
v_mfma_f32_16x16x32_bf16 v[80:83], v[188:191], v[112:115], v[80:83]
v_mfma_f32_16x16x32_bf16 v[84:87], v[188:191], v[116:119], v[84:87]
v_mfma_f32_16x16x32_bf16 v[88:91], v[188:191], v[120:123], v[88:91]
v_mfma_f32_16x16x32_bf16 v[92:95], v[188:191], v[124:127], v[92:95]
s_waitcnt vmcnt(0)
v_lshlrev_b32 v60, 3, v4
v_add_u32 v60, 132608, v60
ds_read_b64 v[224:225], v60 offset:0
ds_read_b64 v[226:227], v60 offset:128
ds_read_b64 v[228:229], v60 offset:256
ds_read_b64 v[230:231], v60 offset:384
s_waitcnt lgkmcnt(0)
s_lshr_b32 s24, s38, 1
s_lshl_b32 s24, s24, 10
s_and_b32 s25, s38, 1
s_lshl_b32 s25, s25, 3
s_add_u32 s24, s24, s25
s_mul_i32 s25, s16, 221184
s_add_u32 s24, s24, s25
s_add_u32 s34, s24, 0
s_add_u32 s34, s34, 3670016
v_mul_f32 v64, v64, v224
v_mul_f32 v65, v65, v224
v_mul_f32 v66, v66, v224
v_mul_f32 v67, v67, v224
v_fmac_f32 v64, v225, v248
v_fmac_f32 v65, v225, v249
v_fmac_f32 v66, v225, v250
v_fmac_f32 v67, v225, v251
v_mul_f32 v240, v64, v64
v_mul_f32 v241, v65, v65
v_mul_f32 v242, v66, v66
v_mul_f32 v243, v67, v67
v_fma_f32 v240, v240, s40, v63
v_fma_f32 v241, v241, s40, v63
v_fma_f32 v242, v242, s40, v63
v_fma_f32 v243, v243, s40, v63
v_mul_f32 v240, v240, v64
v_mul_f32 v241, v241, v65
v_mul_f32 v242, v242, v66
v_mul_f32 v243, v243, v67
v_exp_f32 v240, v240
v_exp_f32 v241, v241
v_exp_f32 v242, v242
v_exp_f32 v243, v243
v_add_f32 v240, 1.0, v240
v_add_f32 v241, 1.0, v241
v_add_f32 v242, 1.0, v242
v_add_f32 v243, 1.0, v243
v_rcp_f32 v240, v240
v_rcp_f32 v241, v241
v_rcp_f32 v242, v242
v_rcp_f32 v243, v243
v_mul_f32 v64, v64, v240
v_mul_f32 v65, v65, v241
v_mul_f32 v66, v66, v242
v_mul_f32 v67, v67, v243
v_cvt_pk_bf16_f32 v232, v64, v65
v_cvt_pk_bf16_f32 v233, v66, v67
buffer_store_dwordx2 v[232:233], v1, s[8:11], s34 offen
s_add_u32 s34, s34, 55296
v_mul_f32 v68, v68, v226
v_mul_f32 v69, v69, v226
v_mul_f32 v70, v70, v226
v_mul_f32 v71, v71, v226
v_fmac_f32 v68, v227, v248
v_fmac_f32 v69, v227, v249
v_fmac_f32 v70, v227, v250
v_fmac_f32 v71, v227, v251
v_mul_f32 v240, v68, v68
v_mul_f32 v241, v69, v69
v_mul_f32 v242, v70, v70
v_mul_f32 v243, v71, v71
v_fma_f32 v240, v240, s40, v63
v_fma_f32 v241, v241, s40, v63
v_fma_f32 v242, v242, s40, v63
v_fma_f32 v243, v243, s40, v63
v_mul_f32 v240, v240, v68
v_mul_f32 v241, v241, v69
v_mul_f32 v242, v242, v70
v_mul_f32 v243, v243, v71
v_exp_f32 v240, v240
v_exp_f32 v241, v241
v_exp_f32 v242, v242
v_exp_f32 v243, v243
v_add_f32 v240, 1.0, v240
v_add_f32 v241, 1.0, v241
v_add_f32 v242, 1.0, v242
v_add_f32 v243, 1.0, v243
v_rcp_f32 v240, v240
v_rcp_f32 v241, v241
v_rcp_f32 v242, v242
v_rcp_f32 v243, v243
v_mul_f32 v68, v68, v240
v_mul_f32 v69, v69, v241
v_mul_f32 v70, v70, v242
v_mul_f32 v71, v71, v243
v_cvt_pk_bf16_f32 v234, v68, v69
v_cvt_pk_bf16_f32 v235, v70, v71
buffer_store_dwordx2 v[234:235], v1, s[8:11], s34 offen
s_add_u32 s34, s34, 55296
v_mul_f32 v72, v72, v228
v_mul_f32 v73, v73, v228
v_mul_f32 v74, v74, v228
v_mul_f32 v75, v75, v228
v_fmac_f32 v72, v229, v248
v_fmac_f32 v73, v229, v249
v_fmac_f32 v74, v229, v250
v_fmac_f32 v75, v229, v251
v_mul_f32 v240, v72, v72
v_mul_f32 v241, v73, v73
v_mul_f32 v242, v74, v74
v_mul_f32 v243, v75, v75
v_fma_f32 v240, v240, s40, v63
v_fma_f32 v241, v241, s40, v63
v_fma_f32 v242, v242, s40, v63
v_fma_f32 v243, v243, s40, v63
v_mul_f32 v240, v240, v72
v_mul_f32 v241, v241, v73
v_mul_f32 v242, v242, v74
v_mul_f32 v243, v243, v75
v_exp_f32 v240, v240
v_exp_f32 v241, v241
v_exp_f32 v242, v242
v_exp_f32 v243, v243
v_add_f32 v240, 1.0, v240
v_add_f32 v241, 1.0, v241
v_add_f32 v242, 1.0, v242
v_add_f32 v243, 1.0, v243
v_rcp_f32 v240, v240
v_rcp_f32 v241, v241
v_rcp_f32 v242, v242
v_rcp_f32 v243, v243
v_mul_f32 v72, v72, v240
v_mul_f32 v73, v73, v241
v_mul_f32 v74, v74, v242
v_mul_f32 v75, v75, v243
v_cvt_pk_bf16_f32 v236, v72, v73
v_cvt_pk_bf16_f32 v237, v74, v75
buffer_store_dwordx2 v[236:237], v1, s[8:11], s34 offen
s_add_u32 s34, s34, 55296
v_mul_f32 v76, v76, v230
v_mul_f32 v77, v77, v230
v_mul_f32 v78, v78, v230
v_mul_f32 v79, v79, v230
v_fmac_f32 v76, v231, v248
v_fmac_f32 v77, v231, v249
v_fmac_f32 v78, v231, v250
v_fmac_f32 v79, v231, v251
v_mul_f32 v240, v76, v76
v_mul_f32 v241, v77, v77
v_mul_f32 v242, v78, v78
v_mul_f32 v243, v79, v79
v_fma_f32 v240, v240, s40, v63
v_fma_f32 v241, v241, s40, v63
v_fma_f32 v242, v242, s40, v63
v_fma_f32 v243, v243, s40, v63
v_mul_f32 v240, v240, v76
v_mul_f32 v241, v241, v77
v_mul_f32 v242, v242, v78
v_mul_f32 v243, v243, v79
v_exp_f32 v240, v240
v_exp_f32 v241, v241
v_exp_f32 v242, v242
v_exp_f32 v243, v243
v_add_f32 v240, 1.0, v240
v_add_f32 v241, 1.0, v241
v_add_f32 v242, 1.0, v242
v_add_f32 v243, 1.0, v243
v_rcp_f32 v240, v240
v_rcp_f32 v241, v241
v_rcp_f32 v242, v242
v_rcp_f32 v243, v243
v_mul_f32 v76, v76, v240
v_mul_f32 v77, v77, v241
v_mul_f32 v78, v78, v242
v_mul_f32 v79, v79, v243
v_cvt_pk_bf16_f32 v238, v76, v77
v_cvt_pk_bf16_f32 v239, v78, v79
buffer_store_dwordx2 v[238:239], v1, s[8:11], s34 offen
s_add_u32 s34, s34, 55296
s_lshr_b32 s24, s39, 1
s_lshl_b32 s24, s24, 10
s_and_b32 s25, s39, 1
s_lshl_b32 s25, s25, 3
s_add_u32 s24, s24, s25
s_mul_i32 s25, s16, 221184
s_add_u32 s24, s24, s25
s_add_u32 s34, s24, 0
s_add_u32 s34, s34, 3670016
v_mul_f32 v80, v80, v224
v_mul_f32 v81, v81, v224
v_mul_f32 v82, v82, v224
v_mul_f32 v83, v83, v224
v_fmac_f32 v80, v225, v252
v_fmac_f32 v81, v225, v253
v_fmac_f32 v82, v225, v254
v_fmac_f32 v83, v225, v255
v_mul_f32 v240, v80, v80
v_mul_f32 v241, v81, v81
v_mul_f32 v242, v82, v82
v_mul_f32 v243, v83, v83
v_fma_f32 v240, v240, s40, v63
v_fma_f32 v241, v241, s40, v63
v_fma_f32 v242, v242, s40, v63
v_fma_f32 v243, v243, s40, v63
v_mul_f32 v240, v240, v80
v_mul_f32 v241, v241, v81
v_mul_f32 v242, v242, v82
v_mul_f32 v243, v243, v83
v_exp_f32 v240, v240
v_exp_f32 v241, v241
v_exp_f32 v242, v242
v_exp_f32 v243, v243
v_add_f32 v240, 1.0, v240
v_add_f32 v241, 1.0, v241
v_add_f32 v242, 1.0, v242
v_add_f32 v243, 1.0, v243
v_rcp_f32 v240, v240
v_rcp_f32 v241, v241
v_rcp_f32 v242, v242
v_rcp_f32 v243, v243
v_mul_f32 v80, v80, v240
v_mul_f32 v81, v81, v241
v_mul_f32 v82, v82, v242
v_mul_f32 v83, v83, v243
v_cvt_pk_bf16_f32 v232, v80, v81
v_cvt_pk_bf16_f32 v233, v82, v83
buffer_store_dwordx2 v[232:233], v1, s[8:11], s34 offen
s_add_u32 s34, s34, 55296
v_mul_f32 v84, v84, v226
v_mul_f32 v85, v85, v226
v_mul_f32 v86, v86, v226
v_mul_f32 v87, v87, v226
v_fmac_f32 v84, v227, v252
v_fmac_f32 v85, v227, v253
v_fmac_f32 v86, v227, v254
v_fmac_f32 v87, v227, v255
v_mul_f32 v240, v84, v84
v_mul_f32 v241, v85, v85
v_mul_f32 v242, v86, v86
v_mul_f32 v243, v87, v87
v_fma_f32 v240, v240, s40, v63
v_fma_f32 v241, v241, s40, v63
v_fma_f32 v242, v242, s40, v63
v_fma_f32 v243, v243, s40, v63
v_mul_f32 v240, v240, v84
v_mul_f32 v241, v241, v85
v_mul_f32 v242, v242, v86
v_mul_f32 v243, v243, v87
v_exp_f32 v240, v240
v_exp_f32 v241, v241
v_exp_f32 v242, v242
v_exp_f32 v243, v243
v_add_f32 v240, 1.0, v240
v_add_f32 v241, 1.0, v241
v_add_f32 v242, 1.0, v242
v_add_f32 v243, 1.0, v243
v_rcp_f32 v240, v240
v_rcp_f32 v241, v241
v_rcp_f32 v242, v242
v_rcp_f32 v243, v243
v_mul_f32 v84, v84, v240
v_mul_f32 v85, v85, v241
v_mul_f32 v86, v86, v242
v_mul_f32 v87, v87, v243
v_cvt_pk_bf16_f32 v234, v84, v85
v_cvt_pk_bf16_f32 v235, v86, v87
buffer_store_dwordx2 v[234:235], v1, s[8:11], s34 offen
s_add_u32 s34, s34, 55296
v_mul_f32 v88, v88, v228
v_mul_f32 v89, v89, v228
v_mul_f32 v90, v90, v228
v_mul_f32 v91, v91, v228
v_fmac_f32 v88, v229, v252
v_fmac_f32 v89, v229, v253
v_fmac_f32 v90, v229, v254
v_fmac_f32 v91, v229, v255
v_mul_f32 v240, v88, v88
v_mul_f32 v241, v89, v89
v_mul_f32 v242, v90, v90
v_mul_f32 v243, v91, v91
v_fma_f32 v240, v240, s40, v63
v_fma_f32 v241, v241, s40, v63
v_fma_f32 v242, v242, s40, v63
v_fma_f32 v243, v243, s40, v63
v_mul_f32 v240, v240, v88
v_mul_f32 v241, v241, v89
v_mul_f32 v242, v242, v90
v_mul_f32 v243, v243, v91
v_exp_f32 v240, v240
v_exp_f32 v241, v241
v_exp_f32 v242, v242
v_exp_f32 v243, v243
v_add_f32 v240, 1.0, v240
v_add_f32 v241, 1.0, v241
v_add_f32 v242, 1.0, v242
v_add_f32 v243, 1.0, v243
v_rcp_f32 v240, v240
v_rcp_f32 v241, v241
v_rcp_f32 v242, v242
v_rcp_f32 v243, v243
v_mul_f32 v88, v88, v240
v_mul_f32 v89, v89, v241
v_mul_f32 v90, v90, v242
v_mul_f32 v91, v91, v243
v_cvt_pk_bf16_f32 v236, v88, v89
v_cvt_pk_bf16_f32 v237, v90, v91
buffer_store_dwordx2 v[236:237], v1, s[8:11], s34 offen
s_add_u32 s34, s34, 55296
v_mul_f32 v92, v92, v230
v_mul_f32 v93, v93, v230
v_mul_f32 v94, v94, v230
v_mul_f32 v95, v95, v230
v_fmac_f32 v92, v231, v252
v_fmac_f32 v93, v231, v253
v_fmac_f32 v94, v231, v254
v_fmac_f32 v95, v231, v255
v_mul_f32 v240, v92, v92
v_mul_f32 v241, v93, v93
v_mul_f32 v242, v94, v94
v_mul_f32 v243, v95, v95
v_fma_f32 v240, v240, s40, v63
v_fma_f32 v241, v241, s40, v63
v_fma_f32 v242, v242, s40, v63
v_fma_f32 v243, v243, s40, v63
v_mul_f32 v240, v240, v92
v_mul_f32 v241, v241, v93
v_mul_f32 v242, v242, v94
v_mul_f32 v243, v243, v95
v_exp_f32 v240, v240
v_exp_f32 v241, v241
v_exp_f32 v242, v242
v_exp_f32 v243, v243
v_add_f32 v240, 1.0, v240
v_add_f32 v241, 1.0, v241
v_add_f32 v242, 1.0, v242
v_add_f32 v243, 1.0, v243
v_rcp_f32 v240, v240
v_rcp_f32 v241, v241
v_rcp_f32 v242, v242
v_rcp_f32 v243, v243
v_mul_f32 v92, v92, v240
v_mul_f32 v93, v93, v241
v_mul_f32 v94, v94, v242
v_mul_f32 v95, v95, v243
v_cvt_pk_bf16_f32 v238, v92, v93
v_cvt_pk_bf16_f32 v239, v94, v95
buffer_store_dwordx2 v[238:239], v1, s[8:11], s34 offen
s_add_u32 s34, s34, 55296
s_add_u32 s35, s35, 1024
s_add_u32 s36, s36, 1024
s_waitcnt vmcnt(0)
s_barrier
s_cmp_lg_u32 s18, 0
s_cbranch_scc1 L_62
v_mov_b32 v46, 0
v_mov_b32 v47, 1
buffer_store_dword v47, v46, s[8:11], s36 offen
L_62:
s_branch L_58
L_57:
s_add_u32 s23, s41, 0
buffer_load_dwordx4 v[128:131], v1, s[8:11], s23 offen
s_add_u32 s23, s41, 1024
buffer_load_dwordx4 v[132:135], v1, s[8:11], s23 offen
s_add_u32 s23, s41, 2048
buffer_load_dwordx4 v[136:139], v1, s[8:11], s23 offen
s_add_u32 s23, s41, 3072
buffer_load_dwordx4 v[140:143], v1, s[8:11], s23 offen
s_add_u32 s23, s41, 4096
buffer_load_dwordx4 v[144:147], v1, s[8:11], s23 offen
s_add_u32 s23, s41, 5120
buffer_load_dwordx4 v[148:151], v1, s[8:11], s23 offen
s_add_u32 s23, s41, 6144
buffer_load_dwordx4 v[152:155], v1, s[8:11], s23 offen
s_add_u32 s23, s41, 7168
buffer_load_dwordx4 v[156:159], v1, s[8:11], s23 offen
s_add_u32 s23, s41, 8192
buffer_load_dwordx4 v[160:163], v1, s[8:11], s23 offen
s_add_u32 s23, s41, 9216
buffer_load_dwordx4 v[164:167], v1, s[8:11], s23 offen
s_add_u32 s23, s41, 10240
buffer_load_dwordx4 v[168:171], v1, s[8:11], s23 offen
s_add_u32 s23, s41, 11264
buffer_load_dwordx4 v[172:175], v1, s[8:11], s23 offen
s_add_u32 s35, s35, 1024
s_add_u32 s36, s36, 1024
s_barrier
s_cmp_lg_u32 s18, 0
s_cbranch_scc1 L_63
v_mov_b32 v46, 0
v_mov_b32 v47, 1
buffer_store_dword v47, v46, s[8:11], s36 offen
L_63:
s_and_b32 s24, s18, 3
s_lshl_b32 s24, s24, 4
s_add_u32 s24, s24, s19
v_add_u32 v46, s24, v4
v_lshrrev_b32 v47, 4, v46
v_mul_u32_u24 v47, 20480, v47
v_and_b32 v46, 15, v46
v_lshlrev_b32 v46, 4, v46
v_add_u32 v47, v47, v46
v_lshlrev_b32 v46, 8, v5
v_add_u32 v42, v47, v46
s_lshr_b32 s24, s18, 2
s_lshl_b32 s24, s24, 10
s_add_u32 s28, s24, 11534336
v_lshrrev_b32 v46, 2, v1
v_min_u32 v46, 28, v46
s_mov_b32 s30, 40000
L_64:
buffer_load_dword v47, v46, s[8:11], s35 offen sc1
s_waitcnt vmcnt(0)
v_cmp_ne_u32 vcc, 1, v47
s_nop 4
s_cbranch_vccz L_65
s_sub_u32 s30, s30, 1
s_cmp_lg_u32 s30, 0
s_cbranch_scc1 L_64
L_65:
s_add_u32 m0, s21, 0
s_add_u32 s22, s28, 0
buffer_load_dwordx4 v42, s[8:11], s22 offen sc1 lds
s_add_u32 m0, s21, 8192
s_add_u32 s22, s28, 2048
buffer_load_dwordx4 v42, s[8:11], s22 offen sc1 lds
s_add_u32 m0, s21, 16384
s_add_u32 s22, s28, 4096
buffer_load_dwordx4 v42, s[8:11], s22 offen sc1 lds
s_add_u32 m0, s21, 24576
s_add_u32 s22, s28, 6144
buffer_load_dwordx4 v42, s[8:11], s22 offen sc1 lds
s_add_u32 m0, s21, 32768
s_add_u32 s22, s28, 8192
buffer_load_dwordx4 v42, s[8:11], s22 offen sc1 lds
s_add_u32 m0, s21, 40960
s_add_u32 s22, s28, 10240
buffer_load_dwordx4 v42, s[8:11], s22 offen sc1 lds
s_add_u32 m0, s21, 49152
s_add_u32 s22, s28, 12288
buffer_load_dwordx4 v42, s[8:11], s22 offen sc1 lds
s_add_u32 m0, s21, 57344
s_add_u32 s22, s28, 14336
buffer_load_dwordx4 v42, s[8:11], s22 offen sc1 lds
s_add_u32 m0, s21, 65536
s_add_u32 s22, s28, 16384
buffer_load_dwordx4 v42, s[8:11], s22 offen sc1 lds
s_add_u32 m0, s21, 73728
s_add_u32 s22, s28, 18432
buffer_load_dwordx4 v42, s[8:11], s22 offen sc1 lds
v_mov_b32 v64, 0
v_mov_b32 v65, 0
v_mov_b32 v66, 0
v_mov_b32 v67, 0
v_mov_b32 v68, 0
v_mov_b32 v69, 0
v_mov_b32 v70, 0
v_mov_b32 v71, 0
v_mov_b32 v72, 0
v_mov_b32 v73, 0
v_mov_b32 v74, 0
v_mov_b32 v75, 0
v_mov_b32 v76, 0
v_mov_b32 v77, 0
v_mov_b32 v78, 0
v_mov_b32 v79, 0
s_waitcnt vmcnt(8)
s_barrier
ds_read_b128 v[96:99], v2 offset:0
ds_read_b128 v[100:103], v2 offset:1024
ds_read_b128 v[104:107], v2 offset:2048
ds_read_b128 v[108:111], v2 offset:3072
ds_read_b128 v[112:115], v2 offset:4096
ds_read_b128 v[116:119], v2 offset:5120
ds_read_b128 v[120:123], v2 offset:6144
ds_read_b128 v[124:127], v2 offset:7168
s_waitcnt lgkmcnt(4)
v_mfma_f32_16x16x32_bf16 v[64:67], v[128:131], v[96:99], v[64:67]
v_mfma_f32_16x16x32_bf16 v[68:71], v[128:131], v[100:103], v[68:71]
v_mfma_f32_16x16x32_bf16 v[72:75], v[128:131], v[104:107], v[72:75]
v_mfma_f32_16x16x32_bf16 v[76:79], v[128:131], v[108:111], v[76:79]
s_add_u32 s23, s41, 12288
buffer_load_dwordx4 v[128:131], v1, s[8:11], s23 offen
ds_read_b128 v[96:99], v2 offset:8192
ds_read_b128 v[100:103], v2 offset:9216
ds_read_b128 v[104:107], v2 offset:10240
ds_read_b128 v[108:111], v2 offset:11264
s_waitcnt lgkmcnt(4)
v_mfma_f32_16x16x32_bf16 v[64:67], v[132:135], v[112:115], v[64:67]
v_mfma_f32_16x16x32_bf16 v[68:71], v[132:135], v[116:119], v[68:71]
v_mfma_f32_16x16x32_bf16 v[72:75], v[132:135], v[120:123], v[72:75]
v_mfma_f32_16x16x32_bf16 v[76:79], v[132:135], v[124:127], v[76:79]
s_add_u32 s23, s41, 13312
buffer_load_dwordx4 v[132:135], v1, s[8:11], s23 offen
ds_read_b128 v[112:115], v2 offset:12288
ds_read_b128 v[116:119], v2 offset:13312
ds_read_b128 v[120:123], v2 offset:14336
ds_read_b128 v[124:127], v2 offset:15360
s_waitcnt lgkmcnt(4)
v_mfma_f32_16x16x32_bf16 v[64:67], v[136:139], v[96:99], v[64:67]
v_mfma_f32_16x16x32_bf16 v[68:71], v[136:139], v[100:103], v[68:71]
v_mfma_f32_16x16x32_bf16 v[72:75], v[136:139], v[104:107], v[72:75]
v_mfma_f32_16x16x32_bf16 v[76:79], v[136:139], v[108:111], v[76:79]
s_add_u32 s23, s41, 14336
buffer_load_dwordx4 v[136:139], v1, s[8:11], s23 offen
s_waitcnt vmcnt(9)
s_barrier
ds_read_b128 v[96:99], v2 offset:16384
ds_read_b128 v[100:103], v2 offset:17408
ds_read_b128 v[104:107], v2 offset:18432
ds_read_b128 v[108:111], v2 offset:19456
s_waitcnt lgkmcnt(4)
v_mfma_f32_16x16x32_bf16 v[64:67], v[140:143], v[112:115], v[64:67]
v_mfma_f32_16x16x32_bf16 v[68:71], v[140:143], v[116:119], v[68:71]
v_mfma_f32_16x16x32_bf16 v[72:75], v[140:143], v[120:123], v[72:75]
v_mfma_f32_16x16x32_bf16 v[76:79], v[140:143], v[124:127], v[76:79]
s_add_u32 s23, s41, 15360
buffer_load_dwordx4 v[140:143], v1, s[8:11], s23 offen
ds_read_b128 v[112:115], v2 offset:20480
ds_read_b128 v[116:119], v2 offset:21504
ds_read_b128 v[120:123], v2 offset:22528
ds_read_b128 v[124:127], v2 offset:23552
s_waitcnt lgkmcnt(4)
v_mfma_f32_16x16x32_bf16 v[64:67], v[144:147], v[96:99], v[64:67]
v_mfma_f32_16x16x32_bf16 v[68:71], v[144:147], v[100:103], v[68:71]
v_mfma_f32_16x16x32_bf16 v[72:75], v[144:147], v[104:107], v[72:75]
v_mfma_f32_16x16x32_bf16 v[76:79], v[144:147], v[108:111], v[76:79]
s_add_u32 s23, s41, 16384
buffer_load_dwordx4 v[144:147], v1, s[8:11], s23 offen
ds_read_b128 v[96:99], v2 offset:24576
ds_read_b128 v[100:103], v2 offset:25600
ds_read_b128 v[104:107], v2 offset:26624
ds_read_b128 v[108:111], v2 offset:27648
s_waitcnt lgkmcnt(4)
v_mfma_f32_16x16x32_bf16 v[64:67], v[148:151], v[112:115], v[64:67]
v_mfma_f32_16x16x32_bf16 v[68:71], v[148:151], v[116:119], v[68:71]
v_mfma_f32_16x16x32_bf16 v[72:75], v[148:151], v[120:123], v[72:75]
v_mfma_f32_16x16x32_bf16 v[76:79], v[148:151], v[124:127], v[76:79]
s_add_u32 s23, s41, 17408
buffer_load_dwordx4 v[148:151], v1, s[8:11], s23 offen
ds_read_b128 v[112:115], v2 offset:28672
ds_read_b128 v[116:119], v2 offset:29696
ds_read_b128 v[120:123], v2 offset:30720
ds_read_b128 v[124:127], v2 offset:31744
s_waitcnt lgkmcnt(4)
v_mfma_f32_16x16x32_bf16 v[64:67], v[152:155], v[96:99], v[64:67]
v_mfma_f32_16x16x32_bf16 v[68:71], v[152:155], v[100:103], v[68:71]
v_mfma_f32_16x16x32_bf16 v[72:75], v[152:155], v[104:107], v[72:75]
v_mfma_f32_16x16x32_bf16 v[76:79], v[152:155], v[108:111], v[76:79]
s_add_u32 s23, s41, 18432
buffer_load_dwordx4 v[152:155], v1, s[8:11], s23 offen
s_waitcnt vmcnt(11)
s_barrier
ds_read_b128 v[96:99], v2 offset:32768
ds_read_b128 v[100:103], v2 offset:33792
ds_read_b128 v[104:107], v2 offset:34816
ds_read_b128 v[108:111], v2 offset:35840
s_waitcnt lgkmcnt(4)
v_mfma_f32_16x16x32_bf16 v[64:67], v[156:159], v[112:115], v[64:67]
v_mfma_f32_16x16x32_bf16 v[68:71], v[156:159], v[116:119], v[68:71]
v_mfma_f32_16x16x32_bf16 v[72:75], v[156:159], v[120:123], v[72:75]
v_mfma_f32_16x16x32_bf16 v[76:79], v[156:159], v[124:127], v[76:79]
s_add_u32 s23, s41, 19456
buffer_load_dwordx4 v[156:159], v1, s[8:11], s23 offen
ds_read_b128 v[112:115], v2 offset:36864
ds_read_b128 v[116:119], v2 offset:37888
ds_read_b128 v[120:123], v2 offset:38912
ds_read_b128 v[124:127], v2 offset:39936
s_waitcnt lgkmcnt(4)
v_mfma_f32_16x16x32_bf16 v[64:67], v[160:163], v[96:99], v[64:67]
v_mfma_f32_16x16x32_bf16 v[68:71], v[160:163], v[100:103], v[68:71]
v_mfma_f32_16x16x32_bf16 v[72:75], v[160:163], v[104:107], v[72:75]
v_mfma_f32_16x16x32_bf16 v[76:79], v[160:163], v[108:111], v[76:79]
ds_read_b128 v[96:99], v2 offset:40960
ds_read_b128 v[100:103], v2 offset:41984
ds_read_b128 v[104:107], v2 offset:43008
ds_read_b128 v[108:111], v2 offset:44032
s_waitcnt lgkmcnt(4)
v_mfma_f32_16x16x32_bf16 v[64:67], v[164:167], v[112:115], v[64:67]
v_mfma_f32_16x16x32_bf16 v[68:71], v[164:167], v[116:119], v[68:71]
v_mfma_f32_16x16x32_bf16 v[72:75], v[164:167], v[120:123], v[72:75]
v_mfma_f32_16x16x32_bf16 v[76:79], v[164:167], v[124:127], v[76:79]
ds_read_b128 v[112:115], v2 offset:45056
ds_read_b128 v[116:119], v2 offset:46080
ds_read_b128 v[120:123], v2 offset:47104
ds_read_b128 v[124:127], v2 offset:48128
s_waitcnt lgkmcnt(4)
v_mfma_f32_16x16x32_bf16 v[64:67], v[168:171], v[96:99], v[64:67]
v_mfma_f32_16x16x32_bf16 v[68:71], v[168:171], v[100:103], v[68:71]
v_mfma_f32_16x16x32_bf16 v[72:75], v[168:171], v[104:107], v[72:75]
v_mfma_f32_16x16x32_bf16 v[76:79], v[168:171], v[108:111], v[76:79]
s_waitcnt vmcnt(10)
s_barrier
ds_read_b128 v[96:99], v2 offset:49152
ds_read_b128 v[100:103], v2 offset:50176
ds_read_b128 v[104:107], v2 offset:51200
ds_read_b128 v[108:111], v2 offset:52224
s_waitcnt lgkmcnt(4)
v_mfma_f32_16x16x32_bf16 v[64:67], v[172:175], v[112:115], v[64:67]
v_mfma_f32_16x16x32_bf16 v[68:71], v[172:175], v[116:119], v[68:71]
v_mfma_f32_16x16x32_bf16 v[72:75], v[172:175], v[120:123], v[72:75]
v_mfma_f32_16x16x32_bf16 v[76:79], v[172:175], v[124:127], v[76:79]
ds_read_b128 v[112:115], v2 offset:53248
ds_read_b128 v[116:119], v2 offset:54272
ds_read_b128 v[120:123], v2 offset:55296
ds_read_b128 v[124:127], v2 offset:56320
s_waitcnt vmcnt(7)
s_waitcnt lgkmcnt(4)
v_mfma_f32_16x16x32_bf16 v[64:67], v[128:131], v[96:99], v[64:67]
v_mfma_f32_16x16x32_bf16 v[68:71], v[128:131], v[100:103], v[68:71]
v_mfma_f32_16x16x32_bf16 v[72:75], v[128:131], v[104:107], v[72:75]
v_mfma_f32_16x16x32_bf16 v[76:79], v[128:131], v[108:111], v[76:79]
ds_read_b128 v[96:99], v2 offset:57344
ds_read_b128 v[100:103], v2 offset:58368
ds_read_b128 v[104:107], v2 offset:59392
ds_read_b128 v[108:111], v2 offset:60416
s_waitcnt vmcnt(6)
s_waitcnt lgkmcnt(4)
v_mfma_f32_16x16x32_bf16 v[64:67], v[132:135], v[112:115], v[64:67]
v_mfma_f32_16x16x32_bf16 v[68:71], v[132:135], v[116:119], v[68:71]
v_mfma_f32_16x16x32_bf16 v[72:75], v[132:135], v[120:123], v[72:75]
v_mfma_f32_16x16x32_bf16 v[76:79], v[132:135], v[124:127], v[76:79]
ds_read_b128 v[112:115], v2 offset:61440
ds_read_b128 v[116:119], v2 offset:62464
ds_read_b128 v[120:123], v2 offset:63488
ds_read_b128 v[124:127], v2 offset:64512
s_waitcnt vmcnt(5)
s_waitcnt lgkmcnt(4)
v_mfma_f32_16x16x32_bf16 v[64:67], v[136:139], v[96:99], v[64:67]
v_mfma_f32_16x16x32_bf16 v[68:71], v[136:139], v[100:103], v[68:71]
v_mfma_f32_16x16x32_bf16 v[72:75], v[136:139], v[104:107], v[72:75]
v_mfma_f32_16x16x32_bf16 v[76:79], v[136:139], v[108:111], v[76:79]
s_waitcnt vmcnt(8)
s_barrier
s_lshl_b32 s24, s38, 6
s_add_u32 s24, s24, 138752
v_lshlrev_b32 v48, 4, v5
buffer_load_dwordx4 v[248:251], v48, s[8:11], s24 offen
ds_read_b128 v[96:99], v3 offset:0
ds_read_b128 v[100:103], v3 offset:1024
ds_read_b128 v[104:107], v3 offset:2048
ds_read_b128 v[108:111], v3 offset:3072
s_waitcnt vmcnt(5)
s_waitcnt lgkmcnt(4)
v_mfma_f32_16x16x32_bf16 v[64:67], v[140:143], v[112:115], v[64:67]
v_mfma_f32_16x16x32_bf16 v[68:71], v[140:143], v[116:119], v[68:71]
v_mfma_f32_16x16x32_bf16 v[72:75], v[140:143], v[120:123], v[72:75]
v_mfma_f32_16x16x32_bf16 v[76:79], v[140:143], v[124:127], v[76:79]
ds_read_b128 v[112:115], v3 offset:4096
ds_read_b128 v[116:119], v3 offset:5120
ds_read_b128 v[120:123], v3 offset:6144
ds_read_b128 v[124:127], v3 offset:7168
s_waitcnt vmcnt(4)
s_waitcnt lgkmcnt(4)
v_mfma_f32_16x16x32_bf16 v[64:67], v[144:147], v[96:99], v[64:67]
v_mfma_f32_16x16x32_bf16 v[68:71], v[144:147], v[100:103], v[68:71]
v_mfma_f32_16x16x32_bf16 v[72:75], v[144:147], v[104:107], v[72:75]
v_mfma_f32_16x16x32_bf16 v[76:79], v[144:147], v[108:111], v[76:79]
ds_read_b128 v[96:99], v3 offset:8192
ds_read_b128 v[100:103], v3 offset:9216
ds_read_b128 v[104:107], v3 offset:10240
ds_read_b128 v[108:111], v3 offset:11264
s_waitcnt vmcnt(3)
s_waitcnt lgkmcnt(4)
v_mfma_f32_16x16x32_bf16 v[64:67], v[148:151], v[112:115], v[64:67]
v_mfma_f32_16x16x32_bf16 v[68:71], v[148:151], v[116:119], v[68:71]
v_mfma_f32_16x16x32_bf16 v[72:75], v[148:151], v[120:123], v[72:75]
v_mfma_f32_16x16x32_bf16 v[76:79], v[148:151], v[124:127], v[76:79]
ds_read_b128 v[112:115], v3 offset:12288
ds_read_b128 v[116:119], v3 offset:13312
ds_read_b128 v[120:123], v3 offset:14336
ds_read_b128 v[124:127], v3 offset:15360
s_waitcnt vmcnt(2)
s_waitcnt lgkmcnt(4)
v_mfma_f32_16x16x32_bf16 v[64:67], v[152:155], v[96:99], v[64:67]
v_mfma_f32_16x16x32_bf16 v[68:71], v[152:155], v[100:103], v[68:71]
v_mfma_f32_16x16x32_bf16 v[72:75], v[152:155], v[104:107], v[72:75]
v_mfma_f32_16x16x32_bf16 v[76:79], v[152:155], v[108:111], v[76:79]
s_waitcnt vmcnt(1)
s_waitcnt lgkmcnt(0)
v_mfma_f32_16x16x32_bf16 v[64:67], v[156:159], v[112:115], v[64:67]
v_mfma_f32_16x16x32_bf16 v[68:71], v[156:159], v[116:119], v[68:71]
v_mfma_f32_16x16x32_bf16 v[72:75], v[156:159], v[120:123], v[72:75]
v_mfma_f32_16x16x32_bf16 v[76:79], v[156:159], v[124:127], v[76:79]
s_waitcnt vmcnt(0)
v_lshlrev_b32 v60, 3, v4
v_add_u32 v60, 132608, v60
ds_read_b64 v[224:225], v60 offset:0
ds_read_b64 v[226:227], v60 offset:128
ds_read_b64 v[228:229], v60 offset:256
ds_read_b64 v[230:231], v60 offset:384
s_waitcnt lgkmcnt(0)
s_lshr_b32 s24, s38, 1
s_lshl_b32 s24, s24, 10
s_and_b32 s25, s38, 1
s_lshl_b32 s25, s25, 3
s_add_u32 s24, s24, s25
s_mul_i32 s25, s16, 221184
s_add_u32 s24, s24, s25
s_add_u32 s34, s24, 0
s_add_u32 s34, s34, 3670016
v_mul_f32 v64, v64, v224
v_mul_f32 v65, v65, v224
v_mul_f32 v66, v66, v224
v_mul_f32 v67, v67, v224
v_fmac_f32 v64, v225, v248
v_fmac_f32 v65, v225, v249
v_fmac_f32 v66, v225, v250
v_fmac_f32 v67, v225, v251
v_mul_f32 v240, v64, v64
v_mul_f32 v241, v65, v65
v_mul_f32 v242, v66, v66
v_mul_f32 v243, v67, v67
v_fma_f32 v240, v240, s40, v63
v_fma_f32 v241, v241, s40, v63
v_fma_f32 v242, v242, s40, v63
v_fma_f32 v243, v243, s40, v63
v_mul_f32 v240, v240, v64
v_mul_f32 v241, v241, v65
v_mul_f32 v242, v242, v66
v_mul_f32 v243, v243, v67
v_exp_f32 v240, v240
v_exp_f32 v241, v241
v_exp_f32 v242, v242
v_exp_f32 v243, v243
v_add_f32 v240, 1.0, v240
v_add_f32 v241, 1.0, v241
v_add_f32 v242, 1.0, v242
v_add_f32 v243, 1.0, v243
v_rcp_f32 v240, v240
v_rcp_f32 v241, v241
v_rcp_f32 v242, v242
v_rcp_f32 v243, v243
v_mul_f32 v64, v64, v240
v_mul_f32 v65, v65, v241
v_mul_f32 v66, v66, v242
v_mul_f32 v67, v67, v243
v_cvt_pk_bf16_f32 v232, v64, v65
v_cvt_pk_bf16_f32 v233, v66, v67
buffer_store_dwordx2 v[232:233], v1, s[8:11], s34 offen
s_add_u32 s34, s34, 55296
v_mul_f32 v68, v68, v226
v_mul_f32 v69, v69, v226
v_mul_f32 v70, v70, v226
v_mul_f32 v71, v71, v226
v_fmac_f32 v68, v227, v248
v_fmac_f32 v69, v227, v249
v_fmac_f32 v70, v227, v250
v_fmac_f32 v71, v227, v251
v_mul_f32 v240, v68, v68
v_mul_f32 v241, v69, v69
v_mul_f32 v242, v70, v70
v_mul_f32 v243, v71, v71
v_fma_f32 v240, v240, s40, v63
v_fma_f32 v241, v241, s40, v63
v_fma_f32 v242, v242, s40, v63
v_fma_f32 v243, v243, s40, v63
v_mul_f32 v240, v240, v68
v_mul_f32 v241, v241, v69
v_mul_f32 v242, v242, v70
v_mul_f32 v243, v243, v71
v_exp_f32 v240, v240
v_exp_f32 v241, v241
v_exp_f32 v242, v242
v_exp_f32 v243, v243
v_add_f32 v240, 1.0, v240
v_add_f32 v241, 1.0, v241
v_add_f32 v242, 1.0, v242
v_add_f32 v243, 1.0, v243
v_rcp_f32 v240, v240
v_rcp_f32 v241, v241
v_rcp_f32 v242, v242
v_rcp_f32 v243, v243
v_mul_f32 v68, v68, v240
v_mul_f32 v69, v69, v241
v_mul_f32 v70, v70, v242
v_mul_f32 v71, v71, v243
v_cvt_pk_bf16_f32 v234, v68, v69
v_cvt_pk_bf16_f32 v235, v70, v71
buffer_store_dwordx2 v[234:235], v1, s[8:11], s34 offen
s_add_u32 s34, s34, 55296
v_mul_f32 v72, v72, v228
v_mul_f32 v73, v73, v228
v_mul_f32 v74, v74, v228
v_mul_f32 v75, v75, v228
v_fmac_f32 v72, v229, v248
v_fmac_f32 v73, v229, v249
v_fmac_f32 v74, v229, v250
v_fmac_f32 v75, v229, v251
v_mul_f32 v240, v72, v72
v_mul_f32 v241, v73, v73
v_mul_f32 v242, v74, v74
v_mul_f32 v243, v75, v75
v_fma_f32 v240, v240, s40, v63
v_fma_f32 v241, v241, s40, v63
v_fma_f32 v242, v242, s40, v63
v_fma_f32 v243, v243, s40, v63
v_mul_f32 v240, v240, v72
v_mul_f32 v241, v241, v73
v_mul_f32 v242, v242, v74
v_mul_f32 v243, v243, v75
v_exp_f32 v240, v240
v_exp_f32 v241, v241
v_exp_f32 v242, v242
v_exp_f32 v243, v243
v_add_f32 v240, 1.0, v240
v_add_f32 v241, 1.0, v241
v_add_f32 v242, 1.0, v242
v_add_f32 v243, 1.0, v243
v_rcp_f32 v240, v240
v_rcp_f32 v241, v241
v_rcp_f32 v242, v242
v_rcp_f32 v243, v243
v_mul_f32 v72, v72, v240
v_mul_f32 v73, v73, v241
v_mul_f32 v74, v74, v242
v_mul_f32 v75, v75, v243
v_cvt_pk_bf16_f32 v236, v72, v73
v_cvt_pk_bf16_f32 v237, v74, v75
buffer_store_dwordx2 v[236:237], v1, s[8:11], s34 offen
s_add_u32 s34, s34, 55296
v_mul_f32 v76, v76, v230
v_mul_f32 v77, v77, v230
v_mul_f32 v78, v78, v230
v_mul_f32 v79, v79, v230
v_fmac_f32 v76, v231, v248
v_fmac_f32 v77, v231, v249
v_fmac_f32 v78, v231, v250
v_fmac_f32 v79, v231, v251
v_mul_f32 v240, v76, v76
v_mul_f32 v241, v77, v77
v_mul_f32 v242, v78, v78
v_mul_f32 v243, v79, v79
v_fma_f32 v240, v240, s40, v63
v_fma_f32 v241, v241, s40, v63
v_fma_f32 v242, v242, s40, v63
v_fma_f32 v243, v243, s40, v63
v_mul_f32 v240, v240, v76
v_mul_f32 v241, v241, v77
v_mul_f32 v242, v242, v78
v_mul_f32 v243, v243, v79
v_exp_f32 v240, v240
v_exp_f32 v241, v241
v_exp_f32 v242, v242
v_exp_f32 v243, v243
v_add_f32 v240, 1.0, v240
v_add_f32 v241, 1.0, v241
v_add_f32 v242, 1.0, v242
v_add_f32 v243, 1.0, v243
v_rcp_f32 v240, v240
v_rcp_f32 v241, v241
v_rcp_f32 v242, v242
v_rcp_f32 v243, v243
v_mul_f32 v76, v76, v240
v_mul_f32 v77, v77, v241
v_mul_f32 v78, v78, v242
v_mul_f32 v79, v79, v243
v_cvt_pk_bf16_f32 v238, v76, v77
v_cvt_pk_bf16_f32 v239, v78, v79
buffer_store_dwordx2 v[238:239], v1, s[8:11], s34 offen
s_add_u32 s34, s34, 55296
s_add_u32 s35, s35, 1024
s_add_u32 s36, s36, 1024
s_waitcnt vmcnt(0)
s_barrier
s_cmp_lg_u32 s18, 0
s_cbranch_scc1 L_66
v_mov_b32 v46, 0
v_mov_b32 v47, 1
buffer_store_dword v47, v46, s[8:11], s36 offen
L_66:
L_58:
s_and_b32 s24, s18, 3
s_lshl_b32 s24, s24, 4
s_add_u32 s24, s24, s19
v_add_u32 v46, s24, v4
v_lshrrev_b32 v47, 4, v46
v_mul_u32_u24 v47, 55296, v47
v_and_b32 v46, 15, v46
v_lshlrev_b32 v46, 4, v46
v_add_u32 v47, v47, v46
v_lshlrev_b32 v46, 8, v5
v_add_u32 v42, v47, v46
s_lshr_b32 s24, s18, 2
s_lshl_b32 s24, s24, 10
s_add_u32 s28, s24, 3670016
v_lshrrev_b32 v46, 2, v1
v_min_u32 v46, 28, v46
s_mov_b32 s30, 40000
L_67:
buffer_load_dword v47, v46, s[8:11], s35 offen sc1
s_waitcnt vmcnt(0)
v_cmp_ne_u32 vcc, 1, v47
s_nop 4
s_cbranch_vccz L_68
s_sub_u32 s30, s30, 1
s_cmp_lg_u32 s30, 0
s_cbranch_scc1 L_67
L_68:
s_add_u32 m0, s21, 0
s_add_u32 s22, s28, 0
buffer_load_dwordx4 v42, s[8:11], s22 offen  lds
s_add_u32 m0, s21, 8192
s_add_u32 s22, s28, 2048
buffer_load_dwordx4 v42, s[8:11], s22 offen  lds
s_add_u32 m0, s21, 16384
s_add_u32 s22, s28, 4096
buffer_load_dwordx4 v42, s[8:11], s22 offen  lds
s_add_u32 m0, s21, 24576
s_add_u32 s22, s28, 6144
buffer_load_dwordx4 v42, s[8:11], s22 offen  lds
s_add_u32 m0, s21, 32768
s_add_u32 s22, s28, 8192
buffer_load_dwordx4 v42, s[8:11], s22 offen  lds
s_add_u32 m0, s21, 40960
s_add_u32 s22, s28, 10240
buffer_load_dwordx4 v42, s[8:11], s22 offen  lds
s_add_u32 m0, s21, 49152
s_add_u32 s22, s28, 12288
buffer_load_dwordx4 v42, s[8:11], s22 offen  lds
s_add_u32 m0, s21, 57344
s_add_u32 s22, s28, 14336
buffer_load_dwordx4 v42, s[8:11], s22 offen  lds
s_add_u32 m0, s21, 65536
s_add_u32 s22, s28, 16384
buffer_load_dwordx4 v42, s[8:11], s22 offen  lds
s_add_u32 m0, s21, 73728
s_add_u32 s22, s28, 18432
buffer_load_dwordx4 v42, s[8:11], s22 offen  lds
s_add_u32 m0, s21, 81920
s_add_u32 s22, s28, 20480
buffer_load_dwordx4 v42, s[8:11], s22 offen  lds
s_add_u32 m0, s21, 90112
s_add_u32 s22, s28, 22528
buffer_load_dwordx4 v42, s[8:11], s22 offen  lds
s_add_u32 m0, s21, 98304
s_add_u32 s22, s28, 24576
buffer_load_dwordx4 v42, s[8:11], s22 offen  lds
s_add_u32 m0, s21, 106496
s_add_u32 s22, s28, 26624
buffer_load_dwordx4 v42, s[8:11], s22 offen  lds
s_add_u32 m0, s21, 114688
s_add_u32 s22, s28, 28672
buffer_load_dwordx4 v42, s[8:11], s22 offen  lds
s_add_u32 m0, s21, 122880
s_add_u32 s22, s28, 30720
buffer_load_dwordx4 v42, s[8:11], s22 offen  lds
s_waitcnt vmcnt(14)
s_barrier
s_waitcnt vmcnt(12)
s_barrier
s_waitcnt vmcnt(10)
s_barrier
s_add_u32 m0, s21, 0
s_add_u32 s22, s28, 32768
buffer_load_dwordx4 v42, s[8:11], s22 offen  lds
s_add_u32 m0, s21, 8192
s_add_u32 s22, s28, 34816
buffer_load_dwordx4 v42, s[8:11], s22 offen  lds
s_waitcnt vmcnt(10)
s_barrier
s_add_u32 m0, s21, 16384
s_add_u32 s22, s28, 36864
buffer_load_dwordx4 v42, s[8:11], s22 offen  lds
s_add_u32 m0, s21, 24576
s_add_u32 s22, s28, 38912
buffer_load_dwordx4 v42, s[8:11], s22 offen  lds
s_waitcnt vmcnt(10)
s_barrier
s_add_u32 m0, s21, 32768
s_add_u32 s22, s28, 40960
buffer_load_dwordx4 v42, s[8:11], s22 offen  lds
s_add_u32 m0, s21, 40960
s_add_u32 s22, s28, 43008
buffer_load_dwordx4 v42, s[8:11], s22 offen  lds
s_waitcnt vmcnt(10)
s_barrier
s_add_u32 m0, s21, 49152
s_add_u32 s22, s28, 45056
buffer_load_dwordx4 v42, s[8:11], s22 offen  lds
s_add_u32 m0, s21, 57344
s_add_u32 s22, s28, 47104
buffer_load_dwordx4 v42, s[8:11], s22 offen  lds
s_waitcnt vmcnt(10)
s_barrier
s_add_u32 m0, s21, 65536
s_add_u32 s22, s28, 49152
buffer_load_dwordx4 v42, s[8:11], s22 offen  lds
s_add_u32 m0, s21, 73728
s_add_u32 s22, s28, 51200
buffer_load_dwordx4 v42, s[8:11], s22 offen  lds
s_waitcnt vmcnt(10)
s_barrier
s_add_u32 m0, s21, 81920
s_add_u32 s22, s28, 53248
buffer_load_dwordx4 v42, s[8:11], s22 offen  lds
s_waitcnt vmcnt(9)
s_barrier
s_waitcnt vmcnt(7)
s_barrier
s_waitcnt vmcnt(5)
s_barrier
s_waitcnt vmcnt(3)
s_barrier
s_waitcnt vmcnt(1)
s_barrier
s_waitcnt vmcnt(0)
s_barrier
s_endpgm
L_53:
s_lshl_b32 s35, s16, 5
s_add_u32 s35, s35, 165888
s_lshl_b32 s24, s17, 2
s_add_u32 s36, s35, s24
s_barrier
s_cmp_lg_u32 s18, 0
s_cbranch_scc1 L_69
v_mov_b32 v46, 0
v_mov_b32 v47, 1
buffer_store_dword v47, v46, s[8:11], s36 offen sc0 sc1
L_69:
s_and_b32 s24, s18, 3
s_lshl_b32 s24, s24, 4
s_add_u32 s24, s24, s19
v_add_u32 v46, s24, v4
v_lshrrev_b32 v47, 4, v46
v_mul_u32_u24 v47, 20480, v47
v_and_b32 v46, 15, v46
v_lshlrev_b32 v46, 4, v46
v_add_u32 v47, v47, v46
v_lshlrev_b32 v46, 8, v5
v_add_u32 v42, v47, v46
s_lshr_b32 s24, s18, 2
s_lshl_b32 s24, s24, 10
s_add_u32 s28, s24, 1048576
v_lshrrev_b32 v46, 2, v1
v_min_u32 v46, 28, v46
s_mov_b32 s30, 40000
L_70:
buffer_load_dword v47, v46, s[8:11], s35 offen sc0 sc1
s_waitcnt vmcnt(0)
v_cmp_ne_u32 vcc, 1, v47
s_nop 4
s_cbranch_vccz L_71
s_sub_u32 s30, s30, 1
s_cmp_lg_u32 s30, 0
s_cbranch_scc1 L_70
L_71:
s_add_u32 m0, s21, 0
s_add_u32 s22, s28, 0
buffer_load_dwordx4 v42, s[8:11], s22 offen sc0 sc1 lds
s_add_u32 m0, s21, 8192
s_add_u32 s22, s28, 2048
buffer_load_dwordx4 v42, s[8:11], s22 offen sc0 sc1 lds
s_add_u32 m0, s21, 16384
s_add_u32 s22, s28, 4096
buffer_load_dwordx4 v42, s[8:11], s22 offen sc0 sc1 lds
s_add_u32 m0, s21, 24576
s_add_u32 s22, s28, 6144
buffer_load_dwordx4 v42, s[8:11], s22 offen sc0 sc1 lds
s_add_u32 m0, s21, 32768
s_add_u32 s22, s28, 8192
buffer_load_dwordx4 v42, s[8:11], s22 offen sc0 sc1 lds
s_add_u32 m0, s21, 40960
s_add_u32 s22, s28, 10240
buffer_load_dwordx4 v42, s[8:11], s22 offen sc0 sc1 lds
s_add_u32 m0, s21, 49152
s_add_u32 s22, s28, 12288
buffer_load_dwordx4 v42, s[8:11], s22 offen sc0 sc1 lds
s_add_u32 m0, s21, 57344
s_add_u32 s22, s28, 14336
buffer_load_dwordx4 v42, s[8:11], s22 offen sc0 sc1 lds
s_add_u32 m0, s21, 65536
s_add_u32 s22, s28, 16384
buffer_load_dwordx4 v42, s[8:11], s22 offen sc0 sc1 lds
s_add_u32 m0, s21, 73728
s_add_u32 s22, s28, 18432
buffer_load_dwordx4 v42, s[8:11], s22 offen sc0 sc1 lds
s_waitcnt vmcnt(8)
s_barrier
s_waitcnt vmcnt(6)
s_barrier
s_waitcnt vmcnt(4)
s_barrier
s_waitcnt vmcnt(2)
s_barrier
s_waitcnt vmcnt(0)
s_barrier
s_cmp_eq_u32 s18, 5
s_cselect_b32 s24, s17, 7
s_cmp_lt_u32 s24, 4
s_cbranch_scc0 L_72
s_add_u32 s23, s41, 0
buffer_load_dwordx4 v[128:131], v1, s[8:11], s23 offen
s_add_u32 s23, s42, 0
buffer_load_dwordx4 v[132:135], v1, s[8:11], s23 offen
s_add_u32 s23, s41, 1024
buffer_load_dwordx4 v[136:139], v1, s[8:11], s23 offen
s_add_u32 s23, s42, 1024
buffer_load_dwordx4 v[140:143], v1, s[8:11], s23 offen
s_add_u32 s23, s41, 2048
buffer_load_dwordx4 v[144:147], v1, s[8:11], s23 offen
s_add_u32 s23, s42, 2048
buffer_load_dwordx4 v[148:151], v1, s[8:11], s23 offen
s_add_u32 s23, s41, 3072
buffer_load_dwordx4 v[152:155], v1, s[8:11], s23 offen
s_add_u32 s23, s42, 3072
buffer_load_dwordx4 v[156:159], v1, s[8:11], s23 offen
s_add_u32 s23, s41, 4096
buffer_load_dwordx4 v[160:163], v1, s[8:11], s23 offen
s_add_u32 s23, s42, 4096
buffer_load_dwordx4 v[164:167], v1, s[8:11], s23 offen
s_add_u32 s23, s41, 5120
buffer_load_dwordx4 v[168:171], v1, s[8:11], s23 offen
s_add_u32 s23, s42, 5120
buffer_load_dwordx4 v[172:175], v1, s[8:11], s23 offen
s_add_u32 s23, s41, 6144
buffer_load_dwordx4 v[176:179], v1, s[8:11], s23 offen
s_add_u32 s23, s42, 6144
buffer_load_dwordx4 v[180:183], v1, s[8:11], s23 offen
s_add_u32 s23, s41, 7168
buffer_load_dwordx4 v[184:187], v1, s[8:11], s23 offen
s_add_u32 s23, s42, 7168
buffer_load_dwordx4 v[188:191], v1, s[8:11], s23 offen
s_add_u32 s23, s41, 8192
buffer_load_dwordx4 v[192:195], v1, s[8:11], s23 offen
s_add_u32 s23, s42, 8192
buffer_load_dwordx4 v[196:199], v1, s[8:11], s23 offen
s_add_u32 s23, s41, 9216
buffer_load_dwordx4 v[200:203], v1, s[8:11], s23 offen
s_add_u32 s23, s42, 9216
buffer_load_dwordx4 v[204:207], v1, s[8:11], s23 offen
s_add_u32 s23, s41, 10240
buffer_load_dwordx4 v[208:211], v1, s[8:11], s23 offen
s_add_u32 s23, s42, 10240
buffer_load_dwordx4 v[212:215], v1, s[8:11], s23 offen
s_add_u32 s23, s41, 11264
buffer_load_dwordx4 v[216:219], v1, s[8:11], s23 offen
s_add_u32 s23, s42, 11264
buffer_load_dwordx4 v[220:223], v1, s[8:11], s23 offen
s_add_u32 s35, s35, 1024
s_add_u32 s36, s36, 1024
s_barrier
s_cmp_lg_u32 s18, 0
s_cbranch_scc1 L_74
v_mov_b32 v46, 0
v_mov_b32 v47, 1
buffer_store_dword v47, v46, s[8:11], s36 offen sc0 sc1
L_74:
s_and_b32 s24, s18, 3
s_lshl_b32 s24, s24, 4
s_add_u32 s24, s24, s19
v_add_u32 v46, s24, v4
v_lshrrev_b32 v47, 4, v46
v_mul_u32_u24 v47, 20480, v47
v_and_b32 v46, 15, v46
v_lshlrev_b32 v46, 4, v46
v_add_u32 v47, v47, v46
v_lshlrev_b32 v46, 8, v5
v_add_u32 v42, v47, v46
s_lshr_b32 s24, s18, 2
s_lshl_b32 s24, s24, 10
s_add_u32 s28, s24, 11534336
v_lshrrev_b32 v46, 2, v1
v_min_u32 v46, 28, v46
s_mov_b32 s30, 40000
L_75:
buffer_load_dword v47, v46, s[8:11], s35 offen sc0 sc1
s_waitcnt vmcnt(0)
v_cmp_ne_u32 vcc, 1, v47
s_nop 4
s_cbranch_vccz L_76
s_sub_u32 s30, s30, 1
s_cmp_lg_u32 s30, 0
s_cbranch_scc1 L_75
L_76:
s_add_u32 m0, s21, 0
s_add_u32 s22, s28, 0
buffer_load_dwordx4 v42, s[8:11], s22 offen sc0 sc1 lds
s_add_u32 m0, s21, 8192
s_add_u32 s22, s28, 2048
buffer_load_dwordx4 v42, s[8:11], s22 offen sc0 sc1 lds
s_add_u32 m0, s21, 16384
s_add_u32 s22, s28, 4096
buffer_load_dwordx4 v42, s[8:11], s22 offen sc0 sc1 lds
s_add_u32 m0, s21, 24576
s_add_u32 s22, s28, 6144
buffer_load_dwordx4 v42, s[8:11], s22 offen sc0 sc1 lds
s_add_u32 m0, s21, 32768
s_add_u32 s22, s28, 8192
buffer_load_dwordx4 v42, s[8:11], s22 offen sc0 sc1 lds
s_add_u32 m0, s21, 40960
s_add_u32 s22, s28, 10240
buffer_load_dwordx4 v42, s[8:11], s22 offen sc0 sc1 lds
s_add_u32 m0, s21, 49152
s_add_u32 s22, s28, 12288
buffer_load_dwordx4 v42, s[8:11], s22 offen sc0 sc1 lds
s_add_u32 m0, s21, 57344
s_add_u32 s22, s28, 14336
buffer_load_dwordx4 v42, s[8:11], s22 offen sc0 sc1 lds
s_add_u32 m0, s21, 65536
s_add_u32 s22, s28, 16384
buffer_load_dwordx4 v42, s[8:11], s22 offen sc0 sc1 lds
s_add_u32 m0, s21, 73728
s_add_u32 s22, s28, 18432
buffer_load_dwordx4 v42, s[8:11], s22 offen sc0 sc1 lds
v_mov_b32 v64, 0
v_mov_b32 v65, 0
v_mov_b32 v66, 0
v_mov_b32 v67, 0
v_mov_b32 v68, 0
v_mov_b32 v69, 0
v_mov_b32 v70, 0
v_mov_b32 v71, 0
v_mov_b32 v72, 0
v_mov_b32 v73, 0
v_mov_b32 v74, 0
v_mov_b32 v75, 0
v_mov_b32 v76, 0
v_mov_b32 v77, 0
v_mov_b32 v78, 0
v_mov_b32 v79, 0
v_mov_b32 v80, 0
v_mov_b32 v81, 0
v_mov_b32 v82, 0
v_mov_b32 v83, 0
v_mov_b32 v84, 0
v_mov_b32 v85, 0
v_mov_b32 v86, 0
v_mov_b32 v87, 0
v_mov_b32 v88, 0
v_mov_b32 v89, 0
v_mov_b32 v90, 0
v_mov_b32 v91, 0
v_mov_b32 v92, 0
v_mov_b32 v93, 0
v_mov_b32 v94, 0
v_mov_b32 v95, 0
s_waitcnt vmcnt(8)
s_barrier
ds_read_b128 v[96:99], v2 offset:0
ds_read_b128 v[100:103], v2 offset:1024
ds_read_b128 v[104:107], v2 offset:2048
ds_read_b128 v[108:111], v2 offset:3072
ds_read_b128 v[112:115], v2 offset:4096
ds_read_b128 v[116:119], v2 offset:5120
ds_read_b128 v[120:123], v2 offset:6144
ds_read_b128 v[124:127], v2 offset:7168
s_waitcnt lgkmcnt(4)
v_mfma_f32_16x16x32_bf16 v[64:67], v[128:131], v[96:99], v[64:67]
v_mfma_f32_16x16x32_bf16 v[68:71], v[128:131], v[100:103], v[68:71]
v_mfma_f32_16x16x32_bf16 v[72:75], v[128:131], v[104:107], v[72:75]
v_mfma_f32_16x16x32_bf16 v[76:79], v[128:131], v[108:111], v[76:79]
v_mfma_f32_16x16x32_bf16 v[80:83], v[132:135], v[96:99], v[80:83]
v_mfma_f32_16x16x32_bf16 v[84:87], v[132:135], v[100:103], v[84:87]
v_mfma_f32_16x16x32_bf16 v[88:91], v[132:135], v[104:107], v[88:91]
v_mfma_f32_16x16x32_bf16 v[92:95], v[132:135], v[108:111], v[92:95]
s_add_u32 s23, s41, 12288
buffer_load_dwordx4 v[128:131], v1, s[8:11], s23 offen
s_add_u32 s23, s42, 12288
buffer_load_dwordx4 v[132:135], v1, s[8:11], s23 offen
ds_read_b128 v[96:99], v2 offset:8192
ds_read_b128 v[100:103], v2 offset:9216
ds_read_b128 v[104:107], v2 offset:10240
ds_read_b128 v[108:111], v2 offset:11264
s_waitcnt lgkmcnt(4)
v_mfma_f32_16x16x32_bf16 v[64:67], v[136:139], v[112:115], v[64:67]
v_mfma_f32_16x16x32_bf16 v[68:71], v[136:139], v[116:119], v[68:71]
v_mfma_f32_16x16x32_bf16 v[72:75], v[136:139], v[120:123], v[72:75]
v_mfma_f32_16x16x32_bf16 v[76:79], v[136:139], v[124:127], v[76:79]
v_mfma_f32_16x16x32_bf16 v[80:83], v[140:143], v[112:115], v[80:83]
v_mfma_f32_16x16x32_bf16 v[84:87], v[140:143], v[116:119], v[84:87]
v_mfma_f32_16x16x32_bf16 v[88:91], v[140:143], v[120:123], v[88:91]
v_mfma_f32_16x16x32_bf16 v[92:95], v[140:143], v[124:127], v[92:95]
s_add_u32 s23, s41, 13312
buffer_load_dwordx4 v[136:139], v1, s[8:11], s23 offen
s_add_u32 s23, s42, 13312
buffer_load_dwordx4 v[140:143], v1, s[8:11], s23 offen
ds_read_b128 v[112:115], v2 offset:12288
ds_read_b128 v[116:119], v2 offset:13312
ds_read_b128 v[120:123], v2 offset:14336
ds_read_b128 v[124:127], v2 offset:15360
s_waitcnt lgkmcnt(4)
v_mfma_f32_16x16x32_bf16 v[64:67], v[144:147], v[96:99], v[64:67]
v_mfma_f32_16x16x32_bf16 v[68:71], v[144:147], v[100:103], v[68:71]
v_mfma_f32_16x16x32_bf16 v[72:75], v[144:147], v[104:107], v[72:75]
v_mfma_f32_16x16x32_bf16 v[76:79], v[144:147], v[108:111], v[76:79]
v_mfma_f32_16x16x32_bf16 v[80:83], v[148:151], v[96:99], v[80:83]
v_mfma_f32_16x16x32_bf16 v[84:87], v[148:151], v[100:103], v[84:87]
v_mfma_f32_16x16x32_bf16 v[88:91], v[148:151], v[104:107], v[88:91]
v_mfma_f32_16x16x32_bf16 v[92:95], v[148:151], v[108:111], v[92:95]
s_add_u32 s23, s41, 14336
buffer_load_dwordx4 v[144:147], v1, s[8:11], s23 offen
s_add_u32 s23, s42, 14336
buffer_load_dwordx4 v[148:151], v1, s[8:11], s23 offen
s_waitcnt vmcnt(12)
s_barrier
ds_read_b128 v[96:99], v2 offset:16384
ds_read_b128 v[100:103], v2 offset:17408
ds_read_b128 v[104:107], v2 offset:18432
ds_read_b128 v[108:111], v2 offset:19456
s_waitcnt lgkmcnt(4)
v_mfma_f32_16x16x32_bf16 v[64:67], v[152:155], v[112:115], v[64:67]
v_mfma_f32_16x16x32_bf16 v[68:71], v[152:155], v[116:119], v[68:71]
v_mfma_f32_16x16x32_bf16 v[72:75], v[152:155], v[120:123], v[72:75]
v_mfma_f32_16x16x32_bf16 v[76:79], v[152:155], v[124:127], v[76:79]
v_mfma_f32_16x16x32_bf16 v[80:83], v[156:159], v[112:115], v[80:83]
v_mfma_f32_16x16x32_bf16 v[84:87], v[156:159], v[116:119], v[84:87]
v_mfma_f32_16x16x32_bf16 v[88:91], v[156:159], v[120:123], v[88:91]
v_mfma_f32_16x16x32_bf16 v[92:95], v[156:159], v[124:127], v[92:95]
s_add_u32 s23, s41, 15360
buffer_load_dwordx4 v[152:155], v1, s[8:11], s23 offen
s_add_u32 s23, s42, 15360
buffer_load_dwordx4 v[156:159], v1, s[8:11], s23 offen
ds_read_b128 v[112:115], v2 offset:20480
ds_read_b128 v[116:119], v2 offset:21504
ds_read_b128 v[120:123], v2 offset:22528
ds_read_b128 v[124:127], v2 offset:23552
s_waitcnt lgkmcnt(4)
v_mfma_f32_16x16x32_bf16 v[64:67], v[160:163], v[96:99], v[64:67]
v_mfma_f32_16x16x32_bf16 v[68:71], v[160:163], v[100:103], v[68:71]
v_mfma_f32_16x16x32_bf16 v[72:75], v[160:163], v[104:107], v[72:75]
v_mfma_f32_16x16x32_bf16 v[76:79], v[160:163], v[108:111], v[76:79]
v_mfma_f32_16x16x32_bf16 v[80:83], v[164:167], v[96:99], v[80:83]
v_mfma_f32_16x16x32_bf16 v[84:87], v[164:167], v[100:103], v[84:87]
v_mfma_f32_16x16x32_bf16 v[88:91], v[164:167], v[104:107], v[88:91]
v_mfma_f32_16x16x32_bf16 v[92:95], v[164:167], v[108:111], v[92:95]
s_add_u32 s23, s41, 16384
buffer_load_dwordx4 v[160:163], v1, s[8:11], s23 offen
s_add_u32 s23, s42, 16384
buffer_load_dwordx4 v[164:167], v1, s[8:11], s23 offen
ds_read_b128 v[96:99], v2 offset:24576
ds_read_b128 v[100:103], v2 offset:25600
ds_read_b128 v[104:107], v2 offset:26624
ds_read_b128 v[108:111], v2 offset:27648
s_waitcnt lgkmcnt(4)
v_mfma_f32_16x16x32_bf16 v[64:67], v[168:171], v[112:115], v[64:67]
v_mfma_f32_16x16x32_bf16 v[68:71], v[168:171], v[116:119], v[68:71]
v_mfma_f32_16x16x32_bf16 v[72:75], v[168:171], v[120:123], v[72:75]
v_mfma_f32_16x16x32_bf16 v[76:79], v[168:171], v[124:127], v[76:79]
v_mfma_f32_16x16x32_bf16 v[80:83], v[172:175], v[112:115], v[80:83]
v_mfma_f32_16x16x32_bf16 v[84:87], v[172:175], v[116:119], v[84:87]
v_mfma_f32_16x16x32_bf16 v[88:91], v[172:175], v[120:123], v[88:91]
v_mfma_f32_16x16x32_bf16 v[92:95], v[172:175], v[124:127], v[92:95]
s_add_u32 s23, s41, 17408
buffer_load_dwordx4 v[168:171], v1, s[8:11], s23 offen
s_add_u32 s23, s42, 17408
buffer_load_dwordx4 v[172:175], v1, s[8:11], s23 offen
ds_read_b128 v[112:115], v2 offset:28672
ds_read_b128 v[116:119], v2 offset:29696
ds_read_b128 v[120:123], v2 offset:30720
ds_read_b128 v[124:127], v2 offset:31744
s_waitcnt lgkmcnt(4)
v_mfma_f32_16x16x32_bf16 v[64:67], v[176:179], v[96:99], v[64:67]
v_mfma_f32_16x16x32_bf16 v[68:71], v[176:179], v[100:103], v[68:71]
v_mfma_f32_16x16x32_bf16 v[72:75], v[176:179], v[104:107], v[72:75]
v_mfma_f32_16x16x32_bf16 v[76:79], v[176:179], v[108:111], v[76:79]
v_mfma_f32_16x16x32_bf16 v[80:83], v[180:183], v[96:99], v[80:83]
v_mfma_f32_16x16x32_bf16 v[84:87], v[180:183], v[100:103], v[84:87]
v_mfma_f32_16x16x32_bf16 v[88:91], v[180:183], v[104:107], v[88:91]
v_mfma_f32_16x16x32_bf16 v[92:95], v[180:183], v[108:111], v[92:95]
s_add_u32 s23, s41, 18432
buffer_load_dwordx4 v[176:179], v1, s[8:11], s23 offen
s_add_u32 s23, s42, 18432
buffer_load_dwordx4 v[180:183], v1, s[8:11], s23 offen
s_waitcnt vmcnt(18)
s_barrier
ds_read_b128 v[96:99], v2 offset:32768
ds_read_b128 v[100:103], v2 offset:33792
ds_read_b128 v[104:107], v2 offset:34816
ds_read_b128 v[108:111], v2 offset:35840
s_waitcnt lgkmcnt(4)
v_mfma_f32_16x16x32_bf16 v[64:67], v[184:187], v[112:115], v[64:67]
v_mfma_f32_16x16x32_bf16 v[68:71], v[184:187], v[116:119], v[68:71]
v_mfma_f32_16x16x32_bf16 v[72:75], v[184:187], v[120:123], v[72:75]
v_mfma_f32_16x16x32_bf16 v[76:79], v[184:187], v[124:127], v[76:79]
v_mfma_f32_16x16x32_bf16 v[80:83], v[188:191], v[112:115], v[80:83]
v_mfma_f32_16x16x32_bf16 v[84:87], v[188:191], v[116:119], v[84:87]
v_mfma_f32_16x16x32_bf16 v[88:91], v[188:191], v[120:123], v[88:91]
v_mfma_f32_16x16x32_bf16 v[92:95], v[188:191], v[124:127], v[92:95]
s_add_u32 s23, s41, 19456
buffer_load_dwordx4 v[184:187], v1, s[8:11], s23 offen
s_add_u32 s23, s42, 19456
buffer_load_dwordx4 v[188:191], v1, s[8:11], s23 offen
ds_read_b128 v[112:115], v2 offset:36864
ds_read_b128 v[116:119], v2 offset:37888
ds_read_b128 v[120:123], v2 offset:38912
ds_read_b128 v[124:127], v2 offset:39936
s_waitcnt lgkmcnt(4)
v_mfma_f32_16x16x32_bf16 v[64:67], v[192:195], v[96:99], v[64:67]
v_mfma_f32_16x16x32_bf16 v[68:71], v[192:195], v[100:103], v[68:71]
v_mfma_f32_16x16x32_bf16 v[72:75], v[192:195], v[104:107], v[72:75]
v_mfma_f32_16x16x32_bf16 v[76:79], v[192:195], v[108:111], v[76:79]
v_mfma_f32_16x16x32_bf16 v[80:83], v[196:199], v[96:99], v[80:83]
v_mfma_f32_16x16x32_bf16 v[84:87], v[196:199], v[100:103], v[84:87]
v_mfma_f32_16x16x32_bf16 v[88:91], v[196:199], v[104:107], v[88:91]
v_mfma_f32_16x16x32_bf16 v[92:95], v[196:199], v[108:111], v[92:95]
ds_read_b128 v[96:99], v2 offset:40960
ds_read_b128 v[100:103], v2 offset:41984
ds_read_b128 v[104:107], v2 offset:43008
ds_read_b128 v[108:111], v2 offset:44032
s_waitcnt lgkmcnt(4)
v_mfma_f32_16x16x32_bf16 v[64:67], v[200:203], v[112:115], v[64:67]
v_mfma_f32_16x16x32_bf16 v[68:71], v[200:203], v[116:119], v[68:71]
v_mfma_f32_16x16x32_bf16 v[72:75], v[200:203], v[120:123], v[72:75]
v_mfma_f32_16x16x32_bf16 v[76:79], v[200:203], v[124:127], v[76:79]
v_mfma_f32_16x16x32_bf16 v[80:83], v[204:207], v[112:115], v[80:83]
v_mfma_f32_16x16x32_bf16 v[84:87], v[204:207], v[116:119], v[84:87]
v_mfma_f32_16x16x32_bf16 v[88:91], v[204:207], v[120:123], v[88:91]
v_mfma_f32_16x16x32_bf16 v[92:95], v[204:207], v[124:127], v[92:95]
ds_read_b128 v[112:115], v2 offset:45056
ds_read_b128 v[116:119], v2 offset:46080
ds_read_b128 v[120:123], v2 offset:47104
ds_read_b128 v[124:127], v2 offset:48128
s_waitcnt lgkmcnt(4)
v_mfma_f32_16x16x32_bf16 v[64:67], v[208:211], v[96:99], v[64:67]
v_mfma_f32_16x16x32_bf16 v[68:71], v[208:211], v[100:103], v[68:71]
v_mfma_f32_16x16x32_bf16 v[72:75], v[208:211], v[104:107], v[72:75]
v_mfma_f32_16x16x32_bf16 v[76:79], v[208:211], v[108:111], v[76:79]
v_mfma_f32_16x16x32_bf16 v[80:83], v[212:215], v[96:99], v[80:83]
v_mfma_f32_16x16x32_bf16 v[84:87], v[212:215], v[100:103], v[84:87]
v_mfma_f32_16x16x32_bf16 v[88:91], v[212:215], v[104:107], v[88:91]
v_mfma_f32_16x16x32_bf16 v[92:95], v[212:215], v[108:111], v[92:95]
s_waitcnt vmcnt(18)
s_barrier
ds_read_b128 v[96:99], v2 offset:49152
ds_read_b128 v[100:103], v2 offset:50176
ds_read_b128 v[104:107], v2 offset:51200
ds_read_b128 v[108:111], v2 offset:52224
s_waitcnt lgkmcnt(4)
v_mfma_f32_16x16x32_bf16 v[64:67], v[216:219], v[112:115], v[64:67]
v_mfma_f32_16x16x32_bf16 v[68:71], v[216:219], v[116:119], v[68:71]
v_mfma_f32_16x16x32_bf16 v[72:75], v[216:219], v[120:123], v[72:75]
v_mfma_f32_16x16x32_bf16 v[76:79], v[216:219], v[124:127], v[76:79]
v_mfma_f32_16x16x32_bf16 v[80:83], v[220:223], v[112:115], v[80:83]
v_mfma_f32_16x16x32_bf16 v[84:87], v[220:223], v[116:119], v[84:87]
v_mfma_f32_16x16x32_bf16 v[88:91], v[220:223], v[120:123], v[88:91]
v_mfma_f32_16x16x32_bf16 v[92:95], v[220:223], v[124:127], v[92:95]
ds_read_b128 v[112:115], v2 offset:53248
ds_read_b128 v[116:119], v2 offset:54272
ds_read_b128 v[120:123], v2 offset:55296
ds_read_b128 v[124:127], v2 offset:56320
s_waitcnt vmcnt(14)
s_waitcnt lgkmcnt(4)
v_mfma_f32_16x16x32_bf16 v[64:67], v[128:131], v[96:99], v[64:67]
v_mfma_f32_16x16x32_bf16 v[68:71], v[128:131], v[100:103], v[68:71]
v_mfma_f32_16x16x32_bf16 v[72:75], v[128:131], v[104:107], v[72:75]
v_mfma_f32_16x16x32_bf16 v[76:79], v[128:131], v[108:111], v[76:79]
v_mfma_f32_16x16x32_bf16 v[80:83], v[132:135], v[96:99], v[80:83]
v_mfma_f32_16x16x32_bf16 v[84:87], v[132:135], v[100:103], v[84:87]
v_mfma_f32_16x16x32_bf16 v[88:91], v[132:135], v[104:107], v[88:91]
v_mfma_f32_16x16x32_bf16 v[92:95], v[132:135], v[108:111], v[92:95]
ds_read_b128 v[96:99], v2 offset:57344
ds_read_b128 v[100:103], v2 offset:58368
ds_read_b128 v[104:107], v2 offset:59392
ds_read_b128 v[108:111], v2 offset:60416
s_waitcnt vmcnt(12)
s_waitcnt lgkmcnt(4)
v_mfma_f32_16x16x32_bf16 v[64:67], v[136:139], v[112:115], v[64:67]
v_mfma_f32_16x16x32_bf16 v[68:71], v[136:139], v[116:119], v[68:71]
v_mfma_f32_16x16x32_bf16 v[72:75], v[136:139], v[120:123], v[72:75]
v_mfma_f32_16x16x32_bf16 v[76:79], v[136:139], v[124:127], v[76:79]
v_mfma_f32_16x16x32_bf16 v[80:83], v[140:143], v[112:115], v[80:83]
v_mfma_f32_16x16x32_bf16 v[84:87], v[140:143], v[116:119], v[84:87]
v_mfma_f32_16x16x32_bf16 v[88:91], v[140:143], v[120:123], v[88:91]
v_mfma_f32_16x16x32_bf16 v[92:95], v[140:143], v[124:127], v[92:95]
ds_read_b128 v[112:115], v2 offset:61440
ds_read_b128 v[116:119], v2 offset:62464
ds_read_b128 v[120:123], v2 offset:63488
ds_read_b128 v[124:127], v2 offset:64512
s_waitcnt vmcnt(10)
s_waitcnt lgkmcnt(4)
v_mfma_f32_16x16x32_bf16 v[64:67], v[144:147], v[96:99], v[64:67]
v_mfma_f32_16x16x32_bf16 v[68:71], v[144:147], v[100:103], v[68:71]
v_mfma_f32_16x16x32_bf16 v[72:75], v[144:147], v[104:107], v[72:75]
v_mfma_f32_16x16x32_bf16 v[76:79], v[144:147], v[108:111], v[76:79]
v_mfma_f32_16x16x32_bf16 v[80:83], v[148:151], v[96:99], v[80:83]
v_mfma_f32_16x16x32_bf16 v[84:87], v[148:151], v[100:103], v[84:87]
v_mfma_f32_16x16x32_bf16 v[88:91], v[148:151], v[104:107], v[88:91]
v_mfma_f32_16x16x32_bf16 v[92:95], v[148:151], v[108:111], v[92:95]
s_waitcnt vmcnt(16)
s_barrier
s_lshl_b32 s24, s38, 6
s_add_u32 s24, s24, 138752
v_lshlrev_b32 v48, 4, v5
buffer_load_dwordx4 v[248:251], v48, s[8:11], s24 offen
s_lshl_b32 s24, s39, 6
s_add_u32 s24, s24, 138752
v_lshlrev_b32 v48, 4, v5
buffer_load_dwordx4 v[252:255], v48, s[8:11], s24 offen
ds_read_b128 v[96:99], v3 offset:0
ds_read_b128 v[100:103], v3 offset:1024
ds_read_b128 v[104:107], v3 offset:2048
ds_read_b128 v[108:111], v3 offset:3072
s_waitcnt vmcnt(10)
s_waitcnt lgkmcnt(4)
v_mfma_f32_16x16x32_bf16 v[64:67], v[152:155], v[112:115], v[64:67]
v_mfma_f32_16x16x32_bf16 v[68:71], v[152:155], v[116:119], v[68:71]
v_mfma_f32_16x16x32_bf16 v[72:75], v[152:155], v[120:123], v[72:75]
v_mfma_f32_16x16x32_bf16 v[76:79], v[152:155], v[124:127], v[76:79]
v_mfma_f32_16x16x32_bf16 v[80:83], v[156:159], v[112:115], v[80:83]
v_mfma_f32_16x16x32_bf16 v[84:87], v[156:159], v[116:119], v[84:87]
v_mfma_f32_16x16x32_bf16 v[88:91], v[156:159], v[120:123], v[88:91]
v_mfma_f32_16x16x32_bf16 v[92:95], v[156:159], v[124:127], v[92:95]
ds_read_b128 v[112:115], v3 offset:4096
ds_read_b128 v[116:119], v3 offset:5120
ds_read_b128 v[120:123], v3 offset:6144
ds_read_b128 v[124:127], v3 offset:7168
s_waitcnt vmcnt(8)
s_waitcnt lgkmcnt(4)
v_mfma_f32_16x16x32_bf16 v[64:67], v[160:163], v[96:99], v[64:67]
v_mfma_f32_16x16x32_bf16 v[68:71], v[160:163], v[100:103], v[68:71]
v_mfma_f32_16x16x32_bf16 v[72:75], v[160:163], v[104:107], v[72:75]
v_mfma_f32_16x16x32_bf16 v[76:79], v[160:163], v[108:111], v[76:79]
v_mfma_f32_16x16x32_bf16 v[80:83], v[164:167], v[96:99], v[80:83]
v_mfma_f32_16x16x32_bf16 v[84:87], v[164:167], v[100:103], v[84:87]
v_mfma_f32_16x16x32_bf16 v[88:91], v[164:167], v[104:107], v[88:91]
v_mfma_f32_16x16x32_bf16 v[92:95], v[164:167], v[108:111], v[92:95]
ds_read_b128 v[96:99], v3 offset:8192
ds_read_b128 v[100:103], v3 offset:9216
ds_read_b128 v[104:107], v3 offset:10240
ds_read_b128 v[108:111], v3 offset:11264
s_waitcnt vmcnt(6)
s_waitcnt lgkmcnt(4)
v_mfma_f32_16x16x32_bf16 v[64:67], v[168:171], v[112:115], v[64:67]
v_mfma_f32_16x16x32_bf16 v[68:71], v[168:171], v[116:119], v[68:71]
v_mfma_f32_16x16x32_bf16 v[72:75], v[168:171], v[120:123], v[72:75]
v_mfma_f32_16x16x32_bf16 v[76:79], v[168:171], v[124:127], v[76:79]
v_mfma_f32_16x16x32_bf16 v[80:83], v[172:175], v[112:115], v[80:83]
v_mfma_f32_16x16x32_bf16 v[84:87], v[172:175], v[116:119], v[84:87]
v_mfma_f32_16x16x32_bf16 v[88:91], v[172:175], v[120:123], v[88:91]
v_mfma_f32_16x16x32_bf16 v[92:95], v[172:175], v[124:127], v[92:95]
ds_read_b128 v[112:115], v3 offset:12288
ds_read_b128 v[116:119], v3 offset:13312
ds_read_b128 v[120:123], v3 offset:14336
ds_read_b128 v[124:127], v3 offset:15360
s_waitcnt vmcnt(4)
s_waitcnt lgkmcnt(4)
v_mfma_f32_16x16x32_bf16 v[64:67], v[176:179], v[96:99], v[64:67]
v_mfma_f32_16x16x32_bf16 v[68:71], v[176:179], v[100:103], v[68:71]
v_mfma_f32_16x16x32_bf16 v[72:75], v[176:179], v[104:107], v[72:75]
v_mfma_f32_16x16x32_bf16 v[76:79], v[176:179], v[108:111], v[76:79]
v_mfma_f32_16x16x32_bf16 v[80:83], v[180:183], v[96:99], v[80:83]
v_mfma_f32_16x16x32_bf16 v[84:87], v[180:183], v[100:103], v[84:87]
v_mfma_f32_16x16x32_bf16 v[88:91], v[180:183], v[104:107], v[88:91]
v_mfma_f32_16x16x32_bf16 v[92:95], v[180:183], v[108:111], v[92:95]
s_waitcnt vmcnt(2)
s_waitcnt lgkmcnt(0)
v_mfma_f32_16x16x32_bf16 v[64:67], v[184:187], v[112:115], v[64:67]
v_mfma_f32_16x16x32_bf16 v[68:71], v[184:187], v[116:119], v[68:71]
v_mfma_f32_16x16x32_bf16 v[72:75], v[184:187], v[120:123], v[72:75]
v_mfma_f32_16x16x32_bf16 v[76:79], v[184:187], v[124:127], v[76:79]
v_mfma_f32_16x16x32_bf16 v[80:83], v[188:191], v[112:115], v[80:83]
v_mfma_f32_16x16x32_bf16 v[84:87], v[188:191], v[116:119], v[84:87]
v_mfma_f32_16x16x32_bf16 v[88:91], v[188:191], v[120:123], v[88:91]
v_mfma_f32_16x16x32_bf16 v[92:95], v[188:191], v[124:127], v[92:95]
s_waitcnt vmcnt(0)
v_lshlrev_b32 v60, 3, v4
v_add_u32 v60, 132608, v60
ds_read_b64 v[224:225], v60 offset:0
ds_read_b64 v[226:227], v60 offset:128
ds_read_b64 v[228:229], v60 offset:256
ds_read_b64 v[230:231], v60 offset:384
s_waitcnt lgkmcnt(0)
s_lshr_b32 s24, s38, 1
s_lshl_b32 s24, s24, 10
s_and_b32 s25, s38, 1
s_lshl_b32 s25, s25, 3
s_add_u32 s24, s24, s25
s_mul_i32 s25, s16, 221184
s_add_u32 s24, s24, s25
s_add_u32 s34, s24, 0
s_add_u32 s34, s34, 3670016
v_mul_f32 v64, v64, v224
v_mul_f32 v65, v65, v224
v_mul_f32 v66, v66, v224
v_mul_f32 v67, v67, v224
v_fmac_f32 v64, v225, v248
v_fmac_f32 v65, v225, v249
v_fmac_f32 v66, v225, v250
v_fmac_f32 v67, v225, v251
v_mul_f32 v240, v64, v64
v_mul_f32 v241, v65, v65
v_mul_f32 v242, v66, v66
v_mul_f32 v243, v67, v67
v_fma_f32 v240, v240, s40, v63
v_fma_f32 v241, v241, s40, v63
v_fma_f32 v242, v242, s40, v63
v_fma_f32 v243, v243, s40, v63
v_mul_f32 v240, v240, v64
v_mul_f32 v241, v241, v65
v_mul_f32 v242, v242, v66
v_mul_f32 v243, v243, v67
v_exp_f32 v240, v240
v_exp_f32 v241, v241
v_exp_f32 v242, v242
v_exp_f32 v243, v243
v_add_f32 v240, 1.0, v240
v_add_f32 v241, 1.0, v241
v_add_f32 v242, 1.0, v242
v_add_f32 v243, 1.0, v243
v_rcp_f32 v240, v240
v_rcp_f32 v241, v241
v_rcp_f32 v242, v242
v_rcp_f32 v243, v243
v_mul_f32 v64, v64, v240
v_mul_f32 v65, v65, v241
v_mul_f32 v66, v66, v242
v_mul_f32 v67, v67, v243
v_cvt_pk_bf16_f32 v232, v64, v65
v_cvt_pk_bf16_f32 v233, v66, v67
buffer_store_dwordx2 v[232:233], v1, s[8:11], s34 offen sc0 sc1
s_add_u32 s34, s34, 55296
v_mul_f32 v68, v68, v226
v_mul_f32 v69, v69, v226
v_mul_f32 v70, v70, v226
v_mul_f32 v71, v71, v226
v_fmac_f32 v68, v227, v248
v_fmac_f32 v69, v227, v249
v_fmac_f32 v70, v227, v250
v_fmac_f32 v71, v227, v251
v_mul_f32 v240, v68, v68
v_mul_f32 v241, v69, v69
v_mul_f32 v242, v70, v70
v_mul_f32 v243, v71, v71
v_fma_f32 v240, v240, s40, v63
v_fma_f32 v241, v241, s40, v63
v_fma_f32 v242, v242, s40, v63
v_fma_f32 v243, v243, s40, v63
v_mul_f32 v240, v240, v68
v_mul_f32 v241, v241, v69
v_mul_f32 v242, v242, v70
v_mul_f32 v243, v243, v71
v_exp_f32 v240, v240
v_exp_f32 v241, v241
v_exp_f32 v242, v242
v_exp_f32 v243, v243
v_add_f32 v240, 1.0, v240
v_add_f32 v241, 1.0, v241
v_add_f32 v242, 1.0, v242
v_add_f32 v243, 1.0, v243
v_rcp_f32 v240, v240
v_rcp_f32 v241, v241
v_rcp_f32 v242, v242
v_rcp_f32 v243, v243
v_mul_f32 v68, v68, v240
v_mul_f32 v69, v69, v241
v_mul_f32 v70, v70, v242
v_mul_f32 v71, v71, v243
v_cvt_pk_bf16_f32 v234, v68, v69
v_cvt_pk_bf16_f32 v235, v70, v71
buffer_store_dwordx2 v[234:235], v1, s[8:11], s34 offen sc0 sc1
s_add_u32 s34, s34, 55296
v_mul_f32 v72, v72, v228
v_mul_f32 v73, v73, v228
v_mul_f32 v74, v74, v228
v_mul_f32 v75, v75, v228
v_fmac_f32 v72, v229, v248
v_fmac_f32 v73, v229, v249
v_fmac_f32 v74, v229, v250
v_fmac_f32 v75, v229, v251
v_mul_f32 v240, v72, v72
v_mul_f32 v241, v73, v73
v_mul_f32 v242, v74, v74
v_mul_f32 v243, v75, v75
v_fma_f32 v240, v240, s40, v63
v_fma_f32 v241, v241, s40, v63
v_fma_f32 v242, v242, s40, v63
v_fma_f32 v243, v243, s40, v63
v_mul_f32 v240, v240, v72
v_mul_f32 v241, v241, v73
v_mul_f32 v242, v242, v74
v_mul_f32 v243, v243, v75
v_exp_f32 v240, v240
v_exp_f32 v241, v241
v_exp_f32 v242, v242
v_exp_f32 v243, v243
v_add_f32 v240, 1.0, v240
v_add_f32 v241, 1.0, v241
v_add_f32 v242, 1.0, v242
v_add_f32 v243, 1.0, v243
v_rcp_f32 v240, v240
v_rcp_f32 v241, v241
v_rcp_f32 v242, v242
v_rcp_f32 v243, v243
v_mul_f32 v72, v72, v240
v_mul_f32 v73, v73, v241
v_mul_f32 v74, v74, v242
v_mul_f32 v75, v75, v243
v_cvt_pk_bf16_f32 v236, v72, v73
v_cvt_pk_bf16_f32 v237, v74, v75
buffer_store_dwordx2 v[236:237], v1, s[8:11], s34 offen sc0 sc1
s_add_u32 s34, s34, 55296
v_mul_f32 v76, v76, v230
v_mul_f32 v77, v77, v230
v_mul_f32 v78, v78, v230
v_mul_f32 v79, v79, v230
v_fmac_f32 v76, v231, v248
v_fmac_f32 v77, v231, v249
v_fmac_f32 v78, v231, v250
v_fmac_f32 v79, v231, v251
v_mul_f32 v240, v76, v76
v_mul_f32 v241, v77, v77
v_mul_f32 v242, v78, v78
v_mul_f32 v243, v79, v79
v_fma_f32 v240, v240, s40, v63
v_fma_f32 v241, v241, s40, v63
v_fma_f32 v242, v242, s40, v63
v_fma_f32 v243, v243, s40, v63
v_mul_f32 v240, v240, v76
v_mul_f32 v241, v241, v77
v_mul_f32 v242, v242, v78
v_mul_f32 v243, v243, v79
v_exp_f32 v240, v240
v_exp_f32 v241, v241
v_exp_f32 v242, v242
v_exp_f32 v243, v243
v_add_f32 v240, 1.0, v240
v_add_f32 v241, 1.0, v241
v_add_f32 v242, 1.0, v242
v_add_f32 v243, 1.0, v243
v_rcp_f32 v240, v240
v_rcp_f32 v241, v241
v_rcp_f32 v242, v242
v_rcp_f32 v243, v243
v_mul_f32 v76, v76, v240
v_mul_f32 v77, v77, v241
v_mul_f32 v78, v78, v242
v_mul_f32 v79, v79, v243
v_cvt_pk_bf16_f32 v238, v76, v77
v_cvt_pk_bf16_f32 v239, v78, v79
buffer_store_dwordx2 v[238:239], v1, s[8:11], s34 offen sc0 sc1
s_add_u32 s34, s34, 55296
s_lshr_b32 s24, s39, 1
s_lshl_b32 s24, s24, 10
s_and_b32 s25, s39, 1
s_lshl_b32 s25, s25, 3
s_add_u32 s24, s24, s25
s_mul_i32 s25, s16, 221184
s_add_u32 s24, s24, s25
s_add_u32 s34, s24, 0
s_add_u32 s34, s34, 3670016
v_mul_f32 v80, v80, v224
v_mul_f32 v81, v81, v224
v_mul_f32 v82, v82, v224
v_mul_f32 v83, v83, v224
v_fmac_f32 v80, v225, v252
v_fmac_f32 v81, v225, v253
v_fmac_f32 v82, v225, v254
v_fmac_f32 v83, v225, v255
v_mul_f32 v240, v80, v80
v_mul_f32 v241, v81, v81
v_mul_f32 v242, v82, v82
v_mul_f32 v243, v83, v83
v_fma_f32 v240, v240, s40, v63
v_fma_f32 v241, v241, s40, v63
v_fma_f32 v242, v242, s40, v63
v_fma_f32 v243, v243, s40, v63
v_mul_f32 v240, v240, v80
v_mul_f32 v241, v241, v81
v_mul_f32 v242, v242, v82
v_mul_f32 v243, v243, v83
v_exp_f32 v240, v240
v_exp_f32 v241, v241
v_exp_f32 v242, v242
v_exp_f32 v243, v243
v_add_f32 v240, 1.0, v240
v_add_f32 v241, 1.0, v241
v_add_f32 v242, 1.0, v242
v_add_f32 v243, 1.0, v243
v_rcp_f32 v240, v240
v_rcp_f32 v241, v241
v_rcp_f32 v242, v242
v_rcp_f32 v243, v243
v_mul_f32 v80, v80, v240
v_mul_f32 v81, v81, v241
v_mul_f32 v82, v82, v242
v_mul_f32 v83, v83, v243
v_cvt_pk_bf16_f32 v232, v80, v81
v_cvt_pk_bf16_f32 v233, v82, v83
buffer_store_dwordx2 v[232:233], v1, s[8:11], s34 offen sc0 sc1
s_add_u32 s34, s34, 55296
v_mul_f32 v84, v84, v226
v_mul_f32 v85, v85, v226
v_mul_f32 v86, v86, v226
v_mul_f32 v87, v87, v226
v_fmac_f32 v84, v227, v252
v_fmac_f32 v85, v227, v253
v_fmac_f32 v86, v227, v254
v_fmac_f32 v87, v227, v255
v_mul_f32 v240, v84, v84
v_mul_f32 v241, v85, v85
v_mul_f32 v242, v86, v86
v_mul_f32 v243, v87, v87
v_fma_f32 v240, v240, s40, v63
v_fma_f32 v241, v241, s40, v63
v_fma_f32 v242, v242, s40, v63
v_fma_f32 v243, v243, s40, v63
v_mul_f32 v240, v240, v84
v_mul_f32 v241, v241, v85
v_mul_f32 v242, v242, v86
v_mul_f32 v243, v243, v87
v_exp_f32 v240, v240
v_exp_f32 v241, v241
v_exp_f32 v242, v242
v_exp_f32 v243, v243
v_add_f32 v240, 1.0, v240
v_add_f32 v241, 1.0, v241
v_add_f32 v242, 1.0, v242
v_add_f32 v243, 1.0, v243
v_rcp_f32 v240, v240
v_rcp_f32 v241, v241
v_rcp_f32 v242, v242
v_rcp_f32 v243, v243
v_mul_f32 v84, v84, v240
v_mul_f32 v85, v85, v241
v_mul_f32 v86, v86, v242
v_mul_f32 v87, v87, v243
v_cvt_pk_bf16_f32 v234, v84, v85
v_cvt_pk_bf16_f32 v235, v86, v87
buffer_store_dwordx2 v[234:235], v1, s[8:11], s34 offen sc0 sc1
s_add_u32 s34, s34, 55296
v_mul_f32 v88, v88, v228
v_mul_f32 v89, v89, v228
v_mul_f32 v90, v90, v228
v_mul_f32 v91, v91, v228
v_fmac_f32 v88, v229, v252
v_fmac_f32 v89, v229, v253
v_fmac_f32 v90, v229, v254
v_fmac_f32 v91, v229, v255
v_mul_f32 v240, v88, v88
v_mul_f32 v241, v89, v89
v_mul_f32 v242, v90, v90
v_mul_f32 v243, v91, v91
v_fma_f32 v240, v240, s40, v63
v_fma_f32 v241, v241, s40, v63
v_fma_f32 v242, v242, s40, v63
v_fma_f32 v243, v243, s40, v63
v_mul_f32 v240, v240, v88
v_mul_f32 v241, v241, v89
v_mul_f32 v242, v242, v90
v_mul_f32 v243, v243, v91
v_exp_f32 v240, v240
v_exp_f32 v241, v241
v_exp_f32 v242, v242
v_exp_f32 v243, v243
v_add_f32 v240, 1.0, v240
v_add_f32 v241, 1.0, v241
v_add_f32 v242, 1.0, v242
v_add_f32 v243, 1.0, v243
v_rcp_f32 v240, v240
v_rcp_f32 v241, v241
v_rcp_f32 v242, v242
v_rcp_f32 v243, v243
v_mul_f32 v88, v88, v240
v_mul_f32 v89, v89, v241
v_mul_f32 v90, v90, v242
v_mul_f32 v91, v91, v243
v_cvt_pk_bf16_f32 v236, v88, v89
v_cvt_pk_bf16_f32 v237, v90, v91
buffer_store_dwordx2 v[236:237], v1, s[8:11], s34 offen sc0 sc1
s_add_u32 s34, s34, 55296
v_mul_f32 v92, v92, v230
v_mul_f32 v93, v93, v230
v_mul_f32 v94, v94, v230
v_mul_f32 v95, v95, v230
v_fmac_f32 v92, v231, v252
v_fmac_f32 v93, v231, v253
v_fmac_f32 v94, v231, v254
v_fmac_f32 v95, v231, v255
v_mul_f32 v240, v92, v92
v_mul_f32 v241, v93, v93
v_mul_f32 v242, v94, v94
v_mul_f32 v243, v95, v95
v_fma_f32 v240, v240, s40, v63
v_fma_f32 v241, v241, s40, v63
v_fma_f32 v242, v242, s40, v63
v_fma_f32 v243, v243, s40, v63
v_mul_f32 v240, v240, v92
v_mul_f32 v241, v241, v93
v_mul_f32 v242, v242, v94
v_mul_f32 v243, v243, v95
v_exp_f32 v240, v240
v_exp_f32 v241, v241
v_exp_f32 v242, v242
v_exp_f32 v243, v243
v_add_f32 v240, 1.0, v240
v_add_f32 v241, 1.0, v241
v_add_f32 v242, 1.0, v242
v_add_f32 v243, 1.0, v243
v_rcp_f32 v240, v240
v_rcp_f32 v241, v241
v_rcp_f32 v242, v242
v_rcp_f32 v243, v243
v_mul_f32 v92, v92, v240
v_mul_f32 v93, v93, v241
v_mul_f32 v94, v94, v242
v_mul_f32 v95, v95, v243
v_cvt_pk_bf16_f32 v238, v92, v93
v_cvt_pk_bf16_f32 v239, v94, v95
buffer_store_dwordx2 v[238:239], v1, s[8:11], s34 offen sc0 sc1
s_add_u32 s34, s34, 55296
s_add_u32 s35, s35, 1024
s_add_u32 s36, s36, 1024
s_waitcnt vmcnt(0)
s_barrier
s_cmp_lg_u32 s18, 0
s_cbranch_scc1 L_77
v_mov_b32 v46, 0
v_mov_b32 v47, 1
buffer_store_dword v47, v46, s[8:11], s36 offen sc0 sc1
L_77:
s_branch L_73
L_72:
s_add_u32 s23, s41, 0
buffer_load_dwordx4 v[128:131], v1, s[8:11], s23 offen
s_add_u32 s23, s41, 1024
buffer_load_dwordx4 v[132:135], v1, s[8:11], s23 offen
s_add_u32 s23, s41, 2048
buffer_load_dwordx4 v[136:139], v1, s[8:11], s23 offen
s_add_u32 s23, s41, 3072
buffer_load_dwordx4 v[140:143], v1, s[8:11], s23 offen
s_add_u32 s23, s41, 4096
buffer_load_dwordx4 v[144:147], v1, s[8:11], s23 offen
s_add_u32 s23, s41, 5120
buffer_load_dwordx4 v[148:151], v1, s[8:11], s23 offen
s_add_u32 s23, s41, 6144
buffer_load_dwordx4 v[152:155], v1, s[8:11], s23 offen
s_add_u32 s23, s41, 7168
buffer_load_dwordx4 v[156:159], v1, s[8:11], s23 offen
s_add_u32 s23, s41, 8192
buffer_load_dwordx4 v[160:163], v1, s[8:11], s23 offen
s_add_u32 s23, s41, 9216
buffer_load_dwordx4 v[164:167], v1, s[8:11], s23 offen
s_add_u32 s23, s41, 10240
buffer_load_dwordx4 v[168:171], v1, s[8:11], s23 offen
s_add_u32 s23, s41, 11264
buffer_load_dwordx4 v[172:175], v1, s[8:11], s23 offen
s_add_u32 s35, s35, 1024
s_add_u32 s36, s36, 1024
s_barrier
s_cmp_lg_u32 s18, 0
s_cbranch_scc1 L_78
v_mov_b32 v46, 0
v_mov_b32 v47, 1
buffer_store_dword v47, v46, s[8:11], s36 offen sc0 sc1
L_78:
s_and_b32 s24, s18, 3
s_lshl_b32 s24, s24, 4
s_add_u32 s24, s24, s19
v_add_u32 v46, s24, v4
v_lshrrev_b32 v47, 4, v46
v_mul_u32_u24 v47, 20480, v47
v_and_b32 v46, 15, v46
v_lshlrev_b32 v46, 4, v46
v_add_u32 v47, v47, v46
v_lshlrev_b32 v46, 8, v5
v_add_u32 v42, v47, v46
s_lshr_b32 s24, s18, 2
s_lshl_b32 s24, s24, 10
s_add_u32 s28, s24, 11534336
v_lshrrev_b32 v46, 2, v1
v_min_u32 v46, 28, v46
s_mov_b32 s30, 40000
L_79:
buffer_load_dword v47, v46, s[8:11], s35 offen sc0 sc1
s_waitcnt vmcnt(0)
v_cmp_ne_u32 vcc, 1, v47
s_nop 4
s_cbranch_vccz L_80
s_sub_u32 s30, s30, 1
s_cmp_lg_u32 s30, 0
s_cbranch_scc1 L_79
L_80:
s_add_u32 m0, s21, 0
s_add_u32 s22, s28, 0
buffer_load_dwordx4 v42, s[8:11], s22 offen sc0 sc1 lds
s_add_u32 m0, s21, 8192
s_add_u32 s22, s28, 2048
buffer_load_dwordx4 v42, s[8:11], s22 offen sc0 sc1 lds
s_add_u32 m0, s21, 16384
s_add_u32 s22, s28, 4096
buffer_load_dwordx4 v42, s[8:11], s22 offen sc0 sc1 lds
s_add_u32 m0, s21, 24576
s_add_u32 s22, s28, 6144
buffer_load_dwordx4 v42, s[8:11], s22 offen sc0 sc1 lds
s_add_u32 m0, s21, 32768
s_add_u32 s22, s28, 8192
buffer_load_dwordx4 v42, s[8:11], s22 offen sc0 sc1 lds
s_add_u32 m0, s21, 40960
s_add_u32 s22, s28, 10240
buffer_load_dwordx4 v42, s[8:11], s22 offen sc0 sc1 lds
s_add_u32 m0, s21, 49152
s_add_u32 s22, s28, 12288
buffer_load_dwordx4 v42, s[8:11], s22 offen sc0 sc1 lds
s_add_u32 m0, s21, 57344
s_add_u32 s22, s28, 14336
buffer_load_dwordx4 v42, s[8:11], s22 offen sc0 sc1 lds
s_add_u32 m0, s21, 65536
s_add_u32 s22, s28, 16384
buffer_load_dwordx4 v42, s[8:11], s22 offen sc0 sc1 lds
s_add_u32 m0, s21, 73728
s_add_u32 s22, s28, 18432
buffer_load_dwordx4 v42, s[8:11], s22 offen sc0 sc1 lds
v_mov_b32 v64, 0
v_mov_b32 v65, 0
v_mov_b32 v66, 0
v_mov_b32 v67, 0
v_mov_b32 v68, 0
v_mov_b32 v69, 0
v_mov_b32 v70, 0
v_mov_b32 v71, 0
v_mov_b32 v72, 0
v_mov_b32 v73, 0
v_mov_b32 v74, 0
v_mov_b32 v75, 0
v_mov_b32 v76, 0
v_mov_b32 v77, 0
v_mov_b32 v78, 0
v_mov_b32 v79, 0
s_waitcnt vmcnt(8)
s_barrier
ds_read_b128 v[96:99], v2 offset:0
ds_read_b128 v[100:103], v2 offset:1024
ds_read_b128 v[104:107], v2 offset:2048
ds_read_b128 v[108:111], v2 offset:3072
ds_read_b128 v[112:115], v2 offset:4096
ds_read_b128 v[116:119], v2 offset:5120
ds_read_b128 v[120:123], v2 offset:6144
ds_read_b128 v[124:127], v2 offset:7168
s_waitcnt lgkmcnt(4)
v_mfma_f32_16x16x32_bf16 v[64:67], v[128:131], v[96:99], v[64:67]
v_mfma_f32_16x16x32_bf16 v[68:71], v[128:131], v[100:103], v[68:71]
v_mfma_f32_16x16x32_bf16 v[72:75], v[128:131], v[104:107], v[72:75]
v_mfma_f32_16x16x32_bf16 v[76:79], v[128:131], v[108:111], v[76:79]
s_add_u32 s23, s41, 12288
buffer_load_dwordx4 v[128:131], v1, s[8:11], s23 offen
ds_read_b128 v[96:99], v2 offset:8192
ds_read_b128 v[100:103], v2 offset:9216
ds_read_b128 v[104:107], v2 offset:10240
ds_read_b128 v[108:111], v2 offset:11264
s_waitcnt lgkmcnt(4)
v_mfma_f32_16x16x32_bf16 v[64:67], v[132:135], v[112:115], v[64:67]
v_mfma_f32_16x16x32_bf16 v[68:71], v[132:135], v[116:119], v[68:71]
v_mfma_f32_16x16x32_bf16 v[72:75], v[132:135], v[120:123], v[72:75]
v_mfma_f32_16x16x32_bf16 v[76:79], v[132:135], v[124:127], v[76:79]
s_add_u32 s23, s41, 13312
buffer_load_dwordx4 v[132:135], v1, s[8:11], s23 offen
ds_read_b128 v[112:115], v2 offset:12288
ds_read_b128 v[116:119], v2 offset:13312
ds_read_b128 v[120:123], v2 offset:14336
ds_read_b128 v[124:127], v2 offset:15360
s_waitcnt lgkmcnt(4)
v_mfma_f32_16x16x32_bf16 v[64:67], v[136:139], v[96:99], v[64:67]
v_mfma_f32_16x16x32_bf16 v[68:71], v[136:139], v[100:103], v[68:71]
v_mfma_f32_16x16x32_bf16 v[72:75], v[136:139], v[104:107], v[72:75]
v_mfma_f32_16x16x32_bf16 v[76:79], v[136:139], v[108:111], v[76:79]
s_add_u32 s23, s41, 14336
buffer_load_dwordx4 v[136:139], v1, s[8:11], s23 offen
s_waitcnt vmcnt(9)
s_barrier
ds_read_b128 v[96:99], v2 offset:16384
ds_read_b128 v[100:103], v2 offset:17408
ds_read_b128 v[104:107], v2 offset:18432
ds_read_b128 v[108:111], v2 offset:19456
s_waitcnt lgkmcnt(4)
v_mfma_f32_16x16x32_bf16 v[64:67], v[140:143], v[112:115], v[64:67]
v_mfma_f32_16x16x32_bf16 v[68:71], v[140:143], v[116:119], v[68:71]
v_mfma_f32_16x16x32_bf16 v[72:75], v[140:143], v[120:123], v[72:75]
v_mfma_f32_16x16x32_bf16 v[76:79], v[140:143], v[124:127], v[76:79]
s_add_u32 s23, s41, 15360
buffer_load_dwordx4 v[140:143], v1, s[8:11], s23 offen
ds_read_b128 v[112:115], v2 offset:20480
ds_read_b128 v[116:119], v2 offset:21504
ds_read_b128 v[120:123], v2 offset:22528
ds_read_b128 v[124:127], v2 offset:23552
s_waitcnt lgkmcnt(4)
v_mfma_f32_16x16x32_bf16 v[64:67], v[144:147], v[96:99], v[64:67]
v_mfma_f32_16x16x32_bf16 v[68:71], v[144:147], v[100:103], v[68:71]
v_mfma_f32_16x16x32_bf16 v[72:75], v[144:147], v[104:107], v[72:75]
v_mfma_f32_16x16x32_bf16 v[76:79], v[144:147], v[108:111], v[76:79]
s_add_u32 s23, s41, 16384
buffer_load_dwordx4 v[144:147], v1, s[8:11], s23 offen
ds_read_b128 v[96:99], v2 offset:24576
ds_read_b128 v[100:103], v2 offset:25600
ds_read_b128 v[104:107], v2 offset:26624
ds_read_b128 v[108:111], v2 offset:27648
s_waitcnt lgkmcnt(4)
v_mfma_f32_16x16x32_bf16 v[64:67], v[148:151], v[112:115], v[64:67]
v_mfma_f32_16x16x32_bf16 v[68:71], v[148:151], v[116:119], v[68:71]
v_mfma_f32_16x16x32_bf16 v[72:75], v[148:151], v[120:123], v[72:75]
v_mfma_f32_16x16x32_bf16 v[76:79], v[148:151], v[124:127], v[76:79]
s_add_u32 s23, s41, 17408
buffer_load_dwordx4 v[148:151], v1, s[8:11], s23 offen
ds_read_b128 v[112:115], v2 offset:28672
ds_read_b128 v[116:119], v2 offset:29696
ds_read_b128 v[120:123], v2 offset:30720
ds_read_b128 v[124:127], v2 offset:31744
s_waitcnt lgkmcnt(4)
v_mfma_f32_16x16x32_bf16 v[64:67], v[152:155], v[96:99], v[64:67]
v_mfma_f32_16x16x32_bf16 v[68:71], v[152:155], v[100:103], v[68:71]
v_mfma_f32_16x16x32_bf16 v[72:75], v[152:155], v[104:107], v[72:75]
v_mfma_f32_16x16x32_bf16 v[76:79], v[152:155], v[108:111], v[76:79]
s_add_u32 s23, s41, 18432
buffer_load_dwordx4 v[152:155], v1, s[8:11], s23 offen
s_waitcnt vmcnt(11)
s_barrier
ds_read_b128 v[96:99], v2 offset:32768
ds_read_b128 v[100:103], v2 offset:33792
ds_read_b128 v[104:107], v2 offset:34816
ds_read_b128 v[108:111], v2 offset:35840
s_waitcnt lgkmcnt(4)
v_mfma_f32_16x16x32_bf16 v[64:67], v[156:159], v[112:115], v[64:67]
v_mfma_f32_16x16x32_bf16 v[68:71], v[156:159], v[116:119], v[68:71]
v_mfma_f32_16x16x32_bf16 v[72:75], v[156:159], v[120:123], v[72:75]
v_mfma_f32_16x16x32_bf16 v[76:79], v[156:159], v[124:127], v[76:79]
s_add_u32 s23, s41, 19456
buffer_load_dwordx4 v[156:159], v1, s[8:11], s23 offen
ds_read_b128 v[112:115], v2 offset:36864
ds_read_b128 v[116:119], v2 offset:37888
ds_read_b128 v[120:123], v2 offset:38912
ds_read_b128 v[124:127], v2 offset:39936
s_waitcnt lgkmcnt(4)
v_mfma_f32_16x16x32_bf16 v[64:67], v[160:163], v[96:99], v[64:67]
v_mfma_f32_16x16x32_bf16 v[68:71], v[160:163], v[100:103], v[68:71]
v_mfma_f32_16x16x32_bf16 v[72:75], v[160:163], v[104:107], v[72:75]
v_mfma_f32_16x16x32_bf16 v[76:79], v[160:163], v[108:111], v[76:79]
ds_read_b128 v[96:99], v2 offset:40960
ds_read_b128 v[100:103], v2 offset:41984
ds_read_b128 v[104:107], v2 offset:43008
ds_read_b128 v[108:111], v2 offset:44032
s_waitcnt lgkmcnt(4)
v_mfma_f32_16x16x32_bf16 v[64:67], v[164:167], v[112:115], v[64:67]
v_mfma_f32_16x16x32_bf16 v[68:71], v[164:167], v[116:119], v[68:71]
v_mfma_f32_16x16x32_bf16 v[72:75], v[164:167], v[120:123], v[72:75]
v_mfma_f32_16x16x32_bf16 v[76:79], v[164:167], v[124:127], v[76:79]
ds_read_b128 v[112:115], v2 offset:45056
ds_read_b128 v[116:119], v2 offset:46080
ds_read_b128 v[120:123], v2 offset:47104
ds_read_b128 v[124:127], v2 offset:48128
s_waitcnt lgkmcnt(4)
v_mfma_f32_16x16x32_bf16 v[64:67], v[168:171], v[96:99], v[64:67]
v_mfma_f32_16x16x32_bf16 v[68:71], v[168:171], v[100:103], v[68:71]
v_mfma_f32_16x16x32_bf16 v[72:75], v[168:171], v[104:107], v[72:75]
v_mfma_f32_16x16x32_bf16 v[76:79], v[168:171], v[108:111], v[76:79]
s_waitcnt vmcnt(10)
s_barrier
ds_read_b128 v[96:99], v2 offset:49152
ds_read_b128 v[100:103], v2 offset:50176
ds_read_b128 v[104:107], v2 offset:51200
ds_read_b128 v[108:111], v2 offset:52224
s_waitcnt lgkmcnt(4)
v_mfma_f32_16x16x32_bf16 v[64:67], v[172:175], v[112:115], v[64:67]
v_mfma_f32_16x16x32_bf16 v[68:71], v[172:175], v[116:119], v[68:71]
v_mfma_f32_16x16x32_bf16 v[72:75], v[172:175], v[120:123], v[72:75]
v_mfma_f32_16x16x32_bf16 v[76:79], v[172:175], v[124:127], v[76:79]
ds_read_b128 v[112:115], v2 offset:53248
ds_read_b128 v[116:119], v2 offset:54272
ds_read_b128 v[120:123], v2 offset:55296
ds_read_b128 v[124:127], v2 offset:56320
s_waitcnt vmcnt(7)
s_waitcnt lgkmcnt(4)
v_mfma_f32_16x16x32_bf16 v[64:67], v[128:131], v[96:99], v[64:67]
v_mfma_f32_16x16x32_bf16 v[68:71], v[128:131], v[100:103], v[68:71]
v_mfma_f32_16x16x32_bf16 v[72:75], v[128:131], v[104:107], v[72:75]
v_mfma_f32_16x16x32_bf16 v[76:79], v[128:131], v[108:111], v[76:79]
ds_read_b128 v[96:99], v2 offset:57344
ds_read_b128 v[100:103], v2 offset:58368
ds_read_b128 v[104:107], v2 offset:59392
ds_read_b128 v[108:111], v2 offset:60416
s_waitcnt vmcnt(6)
s_waitcnt lgkmcnt(4)
v_mfma_f32_16x16x32_bf16 v[64:67], v[132:135], v[112:115], v[64:67]
v_mfma_f32_16x16x32_bf16 v[68:71], v[132:135], v[116:119], v[68:71]
v_mfma_f32_16x16x32_bf16 v[72:75], v[132:135], v[120:123], v[72:75]
v_mfma_f32_16x16x32_bf16 v[76:79], v[132:135], v[124:127], v[76:79]
ds_read_b128 v[112:115], v2 offset:61440
ds_read_b128 v[116:119], v2 offset:62464
ds_read_b128 v[120:123], v2 offset:63488
ds_read_b128 v[124:127], v2 offset:64512
s_waitcnt vmcnt(5)
s_waitcnt lgkmcnt(4)
v_mfma_f32_16x16x32_bf16 v[64:67], v[136:139], v[96:99], v[64:67]
v_mfma_f32_16x16x32_bf16 v[68:71], v[136:139], v[100:103], v[68:71]
v_mfma_f32_16x16x32_bf16 v[72:75], v[136:139], v[104:107], v[72:75]
v_mfma_f32_16x16x32_bf16 v[76:79], v[136:139], v[108:111], v[76:79]
s_waitcnt vmcnt(8)
s_barrier
s_lshl_b32 s24, s38, 6
s_add_u32 s24, s24, 138752
v_lshlrev_b32 v48, 4, v5
buffer_load_dwordx4 v[248:251], v48, s[8:11], s24 offen
ds_read_b128 v[96:99], v3 offset:0
ds_read_b128 v[100:103], v3 offset:1024
ds_read_b128 v[104:107], v3 offset:2048
ds_read_b128 v[108:111], v3 offset:3072
s_waitcnt vmcnt(5)
s_waitcnt lgkmcnt(4)
v_mfma_f32_16x16x32_bf16 v[64:67], v[140:143], v[112:115], v[64:67]
v_mfma_f32_16x16x32_bf16 v[68:71], v[140:143], v[116:119], v[68:71]
v_mfma_f32_16x16x32_bf16 v[72:75], v[140:143], v[120:123], v[72:75]
v_mfma_f32_16x16x32_bf16 v[76:79], v[140:143], v[124:127], v[76:79]
ds_read_b128 v[112:115], v3 offset:4096
ds_read_b128 v[116:119], v3 offset:5120
ds_read_b128 v[120:123], v3 offset:6144
ds_read_b128 v[124:127], v3 offset:7168
s_waitcnt vmcnt(4)
s_waitcnt lgkmcnt(4)
v_mfma_f32_16x16x32_bf16 v[64:67], v[144:147], v[96:99], v[64:67]
v_mfma_f32_16x16x32_bf16 v[68:71], v[144:147], v[100:103], v[68:71]
v_mfma_f32_16x16x32_bf16 v[72:75], v[144:147], v[104:107], v[72:75]
v_mfma_f32_16x16x32_bf16 v[76:79], v[144:147], v[108:111], v[76:79]
ds_read_b128 v[96:99], v3 offset:8192
ds_read_b128 v[100:103], v3 offset:9216
ds_read_b128 v[104:107], v3 offset:10240
ds_read_b128 v[108:111], v3 offset:11264
s_waitcnt vmcnt(3)
s_waitcnt lgkmcnt(4)
v_mfma_f32_16x16x32_bf16 v[64:67], v[148:151], v[112:115], v[64:67]
v_mfma_f32_16x16x32_bf16 v[68:71], v[148:151], v[116:119], v[68:71]
v_mfma_f32_16x16x32_bf16 v[72:75], v[148:151], v[120:123], v[72:75]
v_mfma_f32_16x16x32_bf16 v[76:79], v[148:151], v[124:127], v[76:79]
ds_read_b128 v[112:115], v3 offset:12288
ds_read_b128 v[116:119], v3 offset:13312
ds_read_b128 v[120:123], v3 offset:14336
ds_read_b128 v[124:127], v3 offset:15360
s_waitcnt vmcnt(2)
s_waitcnt lgkmcnt(4)
v_mfma_f32_16x16x32_bf16 v[64:67], v[152:155], v[96:99], v[64:67]
v_mfma_f32_16x16x32_bf16 v[68:71], v[152:155], v[100:103], v[68:71]
v_mfma_f32_16x16x32_bf16 v[72:75], v[152:155], v[104:107], v[72:75]
v_mfma_f32_16x16x32_bf16 v[76:79], v[152:155], v[108:111], v[76:79]
s_waitcnt vmcnt(1)
s_waitcnt lgkmcnt(0)
v_mfma_f32_16x16x32_bf16 v[64:67], v[156:159], v[112:115], v[64:67]
v_mfma_f32_16x16x32_bf16 v[68:71], v[156:159], v[116:119], v[68:71]
v_mfma_f32_16x16x32_bf16 v[72:75], v[156:159], v[120:123], v[72:75]
v_mfma_f32_16x16x32_bf16 v[76:79], v[156:159], v[124:127], v[76:79]
s_waitcnt vmcnt(0)
v_lshlrev_b32 v60, 3, v4
v_add_u32 v60, 132608, v60
ds_read_b64 v[224:225], v60 offset:0
ds_read_b64 v[226:227], v60 offset:128
ds_read_b64 v[228:229], v60 offset:256
ds_read_b64 v[230:231], v60 offset:384
s_waitcnt lgkmcnt(0)
s_lshr_b32 s24, s38, 1
s_lshl_b32 s24, s24, 10
s_and_b32 s25, s38, 1
s_lshl_b32 s25, s25, 3
s_add_u32 s24, s24, s25
s_mul_i32 s25, s16, 221184
s_add_u32 s24, s24, s25
s_add_u32 s34, s24, 0
s_add_u32 s34, s34, 3670016
v_mul_f32 v64, v64, v224
v_mul_f32 v65, v65, v224
v_mul_f32 v66, v66, v224
v_mul_f32 v67, v67, v224
v_fmac_f32 v64, v225, v248
v_fmac_f32 v65, v225, v249
v_fmac_f32 v66, v225, v250
v_fmac_f32 v67, v225, v251
v_mul_f32 v240, v64, v64
v_mul_f32 v241, v65, v65
v_mul_f32 v242, v66, v66
v_mul_f32 v243, v67, v67
v_fma_f32 v240, v240, s40, v63
v_fma_f32 v241, v241, s40, v63
v_fma_f32 v242, v242, s40, v63
v_fma_f32 v243, v243, s40, v63
v_mul_f32 v240, v240, v64
v_mul_f32 v241, v241, v65
v_mul_f32 v242, v242, v66
v_mul_f32 v243, v243, v67
v_exp_f32 v240, v240
v_exp_f32 v241, v241
v_exp_f32 v242, v242
v_exp_f32 v243, v243
v_add_f32 v240, 1.0, v240
v_add_f32 v241, 1.0, v241
v_add_f32 v242, 1.0, v242
v_add_f32 v243, 1.0, v243
v_rcp_f32 v240, v240
v_rcp_f32 v241, v241
v_rcp_f32 v242, v242
v_rcp_f32 v243, v243
v_mul_f32 v64, v64, v240
v_mul_f32 v65, v65, v241
v_mul_f32 v66, v66, v242
v_mul_f32 v67, v67, v243
v_cvt_pk_bf16_f32 v232, v64, v65
v_cvt_pk_bf16_f32 v233, v66, v67
buffer_store_dwordx2 v[232:233], v1, s[8:11], s34 offen sc0 sc1
s_add_u32 s34, s34, 55296
v_mul_f32 v68, v68, v226
v_mul_f32 v69, v69, v226
v_mul_f32 v70, v70, v226
v_mul_f32 v71, v71, v226
v_fmac_f32 v68, v227, v248
v_fmac_f32 v69, v227, v249
v_fmac_f32 v70, v227, v250
v_fmac_f32 v71, v227, v251
v_mul_f32 v240, v68, v68
v_mul_f32 v241, v69, v69
v_mul_f32 v242, v70, v70
v_mul_f32 v243, v71, v71
v_fma_f32 v240, v240, s40, v63
v_fma_f32 v241, v241, s40, v63
v_fma_f32 v242, v242, s40, v63
v_fma_f32 v243, v243, s40, v63
v_mul_f32 v240, v240, v68
v_mul_f32 v241, v241, v69
v_mul_f32 v242, v242, v70
v_mul_f32 v243, v243, v71
v_exp_f32 v240, v240
v_exp_f32 v241, v241
v_exp_f32 v242, v242
v_exp_f32 v243, v243
v_add_f32 v240, 1.0, v240
v_add_f32 v241, 1.0, v241
v_add_f32 v242, 1.0, v242
v_add_f32 v243, 1.0, v243
v_rcp_f32 v240, v240
v_rcp_f32 v241, v241
v_rcp_f32 v242, v242
v_rcp_f32 v243, v243
v_mul_f32 v68, v68, v240
v_mul_f32 v69, v69, v241
v_mul_f32 v70, v70, v242
v_mul_f32 v71, v71, v243
v_cvt_pk_bf16_f32 v234, v68, v69
v_cvt_pk_bf16_f32 v235, v70, v71
buffer_store_dwordx2 v[234:235], v1, s[8:11], s34 offen sc0 sc1
s_add_u32 s34, s34, 55296
v_mul_f32 v72, v72, v228
v_mul_f32 v73, v73, v228
v_mul_f32 v74, v74, v228
v_mul_f32 v75, v75, v228
v_fmac_f32 v72, v229, v248
v_fmac_f32 v73, v229, v249
v_fmac_f32 v74, v229, v250
v_fmac_f32 v75, v229, v251
v_mul_f32 v240, v72, v72
v_mul_f32 v241, v73, v73
v_mul_f32 v242, v74, v74
v_mul_f32 v243, v75, v75
v_fma_f32 v240, v240, s40, v63
v_fma_f32 v241, v241, s40, v63
v_fma_f32 v242, v242, s40, v63
v_fma_f32 v243, v243, s40, v63
v_mul_f32 v240, v240, v72
v_mul_f32 v241, v241, v73
v_mul_f32 v242, v242, v74
v_mul_f32 v243, v243, v75
v_exp_f32 v240, v240
v_exp_f32 v241, v241
v_exp_f32 v242, v242
v_exp_f32 v243, v243
v_add_f32 v240, 1.0, v240
v_add_f32 v241, 1.0, v241
v_add_f32 v242, 1.0, v242
v_add_f32 v243, 1.0, v243
v_rcp_f32 v240, v240
v_rcp_f32 v241, v241
v_rcp_f32 v242, v242
v_rcp_f32 v243, v243
v_mul_f32 v72, v72, v240
v_mul_f32 v73, v73, v241
v_mul_f32 v74, v74, v242
v_mul_f32 v75, v75, v243
v_cvt_pk_bf16_f32 v236, v72, v73
v_cvt_pk_bf16_f32 v237, v74, v75
buffer_store_dwordx2 v[236:237], v1, s[8:11], s34 offen sc0 sc1
s_add_u32 s34, s34, 55296
v_mul_f32 v76, v76, v230
v_mul_f32 v77, v77, v230
v_mul_f32 v78, v78, v230
v_mul_f32 v79, v79, v230
v_fmac_f32 v76, v231, v248
v_fmac_f32 v77, v231, v249
v_fmac_f32 v78, v231, v250
v_fmac_f32 v79, v231, v251
v_mul_f32 v240, v76, v76
v_mul_f32 v241, v77, v77
v_mul_f32 v242, v78, v78
v_mul_f32 v243, v79, v79
v_fma_f32 v240, v240, s40, v63
v_fma_f32 v241, v241, s40, v63
v_fma_f32 v242, v242, s40, v63
v_fma_f32 v243, v243, s40, v63
v_mul_f32 v240, v240, v76
v_mul_f32 v241, v241, v77
v_mul_f32 v242, v242, v78
v_mul_f32 v243, v243, v79
v_exp_f32 v240, v240
v_exp_f32 v241, v241
v_exp_f32 v242, v242
v_exp_f32 v243, v243
v_add_f32 v240, 1.0, v240
v_add_f32 v241, 1.0, v241
v_add_f32 v242, 1.0, v242
v_add_f32 v243, 1.0, v243
v_rcp_f32 v240, v240
v_rcp_f32 v241, v241
v_rcp_f32 v242, v242
v_rcp_f32 v243, v243
v_mul_f32 v76, v76, v240
v_mul_f32 v77, v77, v241
v_mul_f32 v78, v78, v242
v_mul_f32 v79, v79, v243
v_cvt_pk_bf16_f32 v238, v76, v77
v_cvt_pk_bf16_f32 v239, v78, v79
buffer_store_dwordx2 v[238:239], v1, s[8:11], s34 offen sc0 sc1
s_add_u32 s34, s34, 55296
s_add_u32 s35, s35, 1024
s_add_u32 s36, s36, 1024
s_waitcnt vmcnt(0)
s_barrier
s_cmp_lg_u32 s18, 0
s_cbranch_scc1 L_81
v_mov_b32 v46, 0
v_mov_b32 v47, 1
buffer_store_dword v47, v46, s[8:11], s36 offen sc0 sc1
L_81:
L_73:
s_and_b32 s24, s18, 3
s_lshl_b32 s24, s24, 4
s_add_u32 s24, s24, s19
v_add_u32 v46, s24, v4
v_lshrrev_b32 v47, 4, v46
v_mul_u32_u24 v47, 55296, v47
v_and_b32 v46, 15, v46
v_lshlrev_b32 v46, 4, v46
v_add_u32 v47, v47, v46
v_lshlrev_b32 v46, 8, v5
v_add_u32 v42, v47, v46
s_lshr_b32 s24, s18, 2
s_lshl_b32 s24, s24, 10
s_add_u32 s28, s24, 3670016
v_lshrrev_b32 v46, 2, v1
v_min_u32 v46, 28, v46
s_mov_b32 s30, 40000
L_82:
buffer_load_dword v47, v46, s[8:11], s35 offen sc0 sc1
s_waitcnt vmcnt(0)
v_cmp_ne_u32 vcc, 1, v47
s_nop 4
s_cbranch_vccz L_83
s_sub_u32 s30, s30, 1
s_cmp_lg_u32 s30, 0
s_cbranch_scc1 L_82
L_83:
s_add_u32 m0, s21, 0
s_add_u32 s22, s28, 0
buffer_load_dwordx4 v42, s[8:11], s22 offen sc0 sc1 lds
s_add_u32 m0, s21, 8192
s_add_u32 s22, s28, 2048
buffer_load_dwordx4 v42, s[8:11], s22 offen sc0 sc1 lds
s_add_u32 m0, s21, 16384
s_add_u32 s22, s28, 4096
buffer_load_dwordx4 v42, s[8:11], s22 offen sc0 sc1 lds
s_add_u32 m0, s21, 24576
s_add_u32 s22, s28, 6144
buffer_load_dwordx4 v42, s[8:11], s22 offen sc0 sc1 lds
s_add_u32 m0, s21, 32768
s_add_u32 s22, s28, 8192
buffer_load_dwordx4 v42, s[8:11], s22 offen sc0 sc1 lds
s_add_u32 m0, s21, 40960
s_add_u32 s22, s28, 10240
buffer_load_dwordx4 v42, s[8:11], s22 offen sc0 sc1 lds
s_add_u32 m0, s21, 49152
s_add_u32 s22, s28, 12288
buffer_load_dwordx4 v42, s[8:11], s22 offen sc0 sc1 lds
s_add_u32 m0, s21, 57344
s_add_u32 s22, s28, 14336
buffer_load_dwordx4 v42, s[8:11], s22 offen sc0 sc1 lds
s_add_u32 m0, s21, 65536
s_add_u32 s22, s28, 16384
buffer_load_dwordx4 v42, s[8:11], s22 offen sc0 sc1 lds
s_add_u32 m0, s21, 73728
s_add_u32 s22, s28, 18432
buffer_load_dwordx4 v42, s[8:11], s22 offen sc0 sc1 lds
s_add_u32 m0, s21, 81920
s_add_u32 s22, s28, 20480
buffer_load_dwordx4 v42, s[8:11], s22 offen sc0 sc1 lds
s_add_u32 m0, s21, 90112
s_add_u32 s22, s28, 22528
buffer_load_dwordx4 v42, s[8:11], s22 offen sc0 sc1 lds
s_add_u32 m0, s21, 98304
s_add_u32 s22, s28, 24576
buffer_load_dwordx4 v42, s[8:11], s22 offen sc0 sc1 lds
s_add_u32 m0, s21, 106496
s_add_u32 s22, s28, 26624
buffer_load_dwordx4 v42, s[8:11], s22 offen sc0 sc1 lds
s_add_u32 m0, s21, 114688
s_add_u32 s22, s28, 28672
buffer_load_dwordx4 v42, s[8:11], s22 offen sc0 sc1 lds
s_add_u32 m0, s21, 122880
s_add_u32 s22, s28, 30720
buffer_load_dwordx4 v42, s[8:11], s22 offen sc0 sc1 lds
s_waitcnt vmcnt(14)
s_barrier
s_waitcnt vmcnt(12)
s_barrier
s_waitcnt vmcnt(10)
s_barrier
s_add_u32 m0, s21, 0
s_add_u32 s22, s28, 32768
buffer_load_dwordx4 v42, s[8:11], s22 offen sc0 sc1 lds
s_add_u32 m0, s21, 8192
s_add_u32 s22, s28, 34816
buffer_load_dwordx4 v42, s[8:11], s22 offen sc0 sc1 lds
s_waitcnt vmcnt(10)
s_barrier
s_add_u32 m0, s21, 16384
s_add_u32 s22, s28, 36864
buffer_load_dwordx4 v42, s[8:11], s22 offen sc0 sc1 lds
s_add_u32 m0, s21, 24576
s_add_u32 s22, s28, 38912
buffer_load_dwordx4 v42, s[8:11], s22 offen sc0 sc1 lds
s_waitcnt vmcnt(10)
s_barrier
s_add_u32 m0, s21, 32768
s_add_u32 s22, s28, 40960
buffer_load_dwordx4 v42, s[8:11], s22 offen sc0 sc1 lds
s_add_u32 m0, s21, 40960
s_add_u32 s22, s28, 43008
buffer_load_dwordx4 v42, s[8:11], s22 offen sc0 sc1 lds
s_waitcnt vmcnt(10)
s_barrier
s_add_u32 m0, s21, 49152
s_add_u32 s22, s28, 45056
buffer_load_dwordx4 v42, s[8:11], s22 offen sc0 sc1 lds
s_add_u32 m0, s21, 57344
s_add_u32 s22, s28, 47104
buffer_load_dwordx4 v42, s[8:11], s22 offen sc0 sc1 lds
s_waitcnt vmcnt(10)
s_barrier
s_add_u32 m0, s21, 65536
s_add_u32 s22, s28, 49152
buffer_load_dwordx4 v42, s[8:11], s22 offen sc0 sc1 lds
s_add_u32 m0, s21, 73728
s_add_u32 s22, s28, 51200
buffer_load_dwordx4 v42, s[8:11], s22 offen sc0 sc1 lds
s_waitcnt vmcnt(10)
s_barrier
s_add_u32 m0, s21, 81920
s_add_u32 s22, s28, 53248
buffer_load_dwordx4 v42, s[8:11], s22 offen sc0 sc1 lds
s_waitcnt vmcnt(9)
s_barrier
s_waitcnt vmcnt(7)
s_barrier
s_waitcnt vmcnt(5)
s_barrier
s_waitcnt vmcnt(3)
s_barrier
s_waitcnt vmcnt(1)
s_barrier
s_waitcnt vmcnt(0)
s_barrier
s_endpgm
L_29:
s_mul_i32 s31, s17, 5
s_add_u32 s31, s31, s18
s_lshl_b32 s24, s17, 3
s_add_u32 s24, s24, s18
s_add_u32 s44, s24, s19
s_lshr_b32 s24, s44, 4
s_mul_i32 s24, s24, 20480
s_and_b32 s25, s44, 15
s_lshl_b32 s25, s25, 4
s_add_u32 s24, s24, s25
s_add_u32 s24, s24, 11534336
v_lshrrev_b32 v50, 4, v1
v_min_u32 v50, 39, v50
v_lshrrev_b32 v51, 1, v50
v_lshlrev_b32 v51, 10, v51
v_and_b32 v52, 1, v50
v_lshlrev_b32 v52, 9, v52
v_add_u32 v51, v51, v52
v_lshlrev_b32 v52, 6, v50
buffer_load_dwordx4 v[240:243], v51, s[8:11], s24 offen
buffer_load_dwordx4 v[244:247], v51, s[8:11], s24 offen offset:256
s_mov_b32 s25, 155648
s_mov_b32 s26, 158208
buffer_load_dwordx4 v[112:115], v52, s[8:11], s25 offen offset:0
buffer_load_dwordx4 v[224:227], v52, s[8:11], s26 offen offset:0
buffer_load_dwordx4 v[116:119], v52, s[8:11], s25 offen offset:16
buffer_load_dwordx4 v[228:231], v52, s[8:11], s26 offen offset:16
buffer_load_dwordx4 v[120:123], v52, s[8:11], s25 offen offset:32
buffer_load_dwordx4 v[232:235], v52, s[8:11], s26 offen offset:32
buffer_load_dwordx4 v[124:127], v52, s[8:11], s25 offen offset:48
buffer_load_dwordx4 v[236:239], v52, s[8:11], s26 offen offset:48
s_mul_i32 s37, s17, 14
s_sub_u32 s24, s17, 4
s_max_i32 s24, s24, 0
s_sub_u32 s37, s37, s24
s_add_u32 s38, s37, s18
s_add_u32 s39, s38, 8
s_mul_i32 s41, s38, 20480
s_add_u32 s41, s41, 32505856
s_mul_i32 s42, s39, 20480
s_add_u32 s42, s42, 32505856
s_mul_i32 s49, s31, 20480
s_add_u32 s49, s49, 31457280
s_mul_i32 s50, s31, 55296
s_add_u32 s50, s50, 35651584
s_lshr_b32 s24, s31, 1
s_lshl_b32 s24, s24, 10
s_and_b32 s25, s31, 1
s_lshl_b32 s25, s25, 3
s_add_u32 s24, s24, s25
s_mul_i32 s25, s16, 81920
s_add_u32 s24, s24, s25
s_add_u32 s33, s24, 0
s_mul_i32 s52, s17, 5
s_and_b32 s24, s18, 3
s_lshl_b32 s24, s24, 4
s_add_u32 s24, s24, s19
v_add_u32 v46, s24, v4
v_add_u32 v46, s27, v46
v_min_i32 v46, 2047, v46
v_max_i32 v46, 0, v46
v_lshrrev_b32 v47, 4, v46
v_mul_u32_u24 v47, 20480, v47
v_and_b32 v46, 15, v46
v_lshlrev_b32 v46, 4, v46
v_add_u32 v47, v47, v46
v_lshlrev_b32 v46, 8, v5
v_add_u32 v42, v47, v46
s_lshr_b32 s24, s18, 2
s_lshl_b32 s24, s24, 10
s_add_u32 s28, s24, 14680064
s_add_u32 m0, s21, 0
s_add_u32 s22, s28, 0
buffer_load_dwordx4 v42, s[8:11], s22 offen  lds
s_add_u32 m0, s21, 8192
s_add_u32 s22, s28, 2048
buffer_load_dwordx4 v42, s[8:11], s22 offen  lds
s_add_u32 m0, s21, 16384
s_add_u32 s22, s28, 4096
buffer_load_dwordx4 v42, s[8:11], s22 offen  lds
s_add_u32 m0, s21, 24576
s_add_u32 s22, s28, 6144
buffer_load_dwordx4 v42, s[8:11], s22 offen  lds
s_add_u32 m0, s21, 32768
s_add_u32 s22, s28, 8192
buffer_load_dwordx4 v42, s[8:11], s22 offen  lds
s_add_u32 m0, s21, 40960
s_add_u32 s22, s28, 10240
buffer_load_dwordx4 v42, s[8:11], s22 offen  lds
s_add_u32 m0, s21, 49152
s_add_u32 s22, s28, 12288
buffer_load_dwordx4 v42, s[8:11], s22 offen  lds
s_add_u32 m0, s21, 57344
s_add_u32 s22, s28, 14336
buffer_load_dwordx4 v42, s[8:11], s22 offen  lds
s_add_u32 m0, s21, 65536
s_add_u32 s22, s28, 16384
buffer_load_dwordx4 v42, s[8:11], s22 offen  lds
s_add_u32 m0, s21, 73728
s_add_u32 s22, s28, 18432
buffer_load_dwordx4 v42, s[8:11], s22 offen  lds
s_waitcnt vmcnt(10)
v_cmp_gt_u32 vcc, 640, v1
v_lshlrev_b32 v96, 16, v240
v_and_b32 v97, 0xffff0000, v240
v_lshlrev_b32 v98, 16, v241
v_and_b32 v99, 0xffff0000, v241
v_lshlrev_b32 v100, 16, v242
v_and_b32 v101, 0xffff0000, v242
v_lshlrev_b32 v102, 16, v243
v_and_b32 v103, 0xffff0000, v243
v_lshlrev_b32 v104, 16, v244
v_and_b32 v105, 0xffff0000, v244
v_lshlrev_b32 v106, 16, v245
v_and_b32 v107, 0xffff0000, v245
v_lshlrev_b32 v108, 16, v246
v_and_b32 v109, 0xffff0000, v246
v_lshlrev_b32 v110, 16, v247
v_and_b32 v111, 0xffff0000, v247
v_add_f32 v53, v96, v98
v_add_f32 v54, v97, v99
v_add_f32 v53, v53, v100
v_add_f32 v54, v54, v101
v_add_f32 v53, v53, v102
v_add_f32 v54, v54, v103
v_add_f32 v53, v53, v104
v_add_f32 v54, v54, v105
v_add_f32 v53, v53, v106
v_add_f32 v54, v54, v107
v_add_f32 v53, v53, v108
v_add_f32 v54, v54, v109
v_add_f32 v53, v53, v110
v_add_f32 v54, v54, v111
v_add_f32 v53, v53, v54
v_cndmask_b32 v53, 0, v53, vcc
s_nop 1
v_add_f32_dpp v53, v53, v53 row_ror:8 row_mask:0xf bank_mask:0xf
s_nop 1
v_add_f32_dpp v53, v53, v53 row_ror:4 row_mask:0xf bank_mask:0xf
s_nop 1
v_add_f32_dpp v53, v53, v53 row_ror:2 row_mask:0xf bank_mask:0xf
s_nop 1
v_add_f32_dpp v53, v53, v53 row_ror:1 row_mask:0xf bank_mask:0xf
s_nop 1
v_add_f32_dpp v53, v53, v53 row_bcast:15 row_mask:0xa bank_mask:0xf
s_nop 1
v_add_f32_dpp v53, v53, v53 row_bcast:31 row_mask:0xc bank_mask:0xf
v_mul_f32 v53, 0x3acccccd, v53
s_nop 0
v_readlane_b32 s45, v53, 63
s_nop 1
v_subrev_f32 v96, s45, v96
v_subrev_f32 v97, s45, v97
v_subrev_f32 v98, s45, v98
v_subrev_f32 v99, s45, v99
v_subrev_f32 v100, s45, v100
v_subrev_f32 v101, s45, v101
v_subrev_f32 v102, s45, v102
v_subrev_f32 v103, s45, v103
v_subrev_f32 v104, s45, v104
v_subrev_f32 v105, s45, v105
v_subrev_f32 v106, s45, v106
v_subrev_f32 v107, s45, v107
v_subrev_f32 v108, s45, v108
v_subrev_f32 v109, s45, v109
v_subrev_f32 v110, s45, v110
v_subrev_f32 v111, s45, v111
v_mul_f32 v53, v96, v96
v_mul_f32 v54, v97, v97
v_fmac_f32 v53, v98, v98
v_fmac_f32 v54, v99, v99
v_fmac_f32 v53, v100, v100
v_fmac_f32 v54, v101, v101
v_fmac_f32 v53, v102, v102
v_fmac_f32 v54, v103, v103
v_fmac_f32 v53, v104, v104
v_fmac_f32 v54, v105, v105
v_fmac_f32 v53, v106, v106
v_fmac_f32 v54, v107, v107
v_fmac_f32 v53, v108, v108
v_fmac_f32 v54, v109, v109
v_fmac_f32 v53, v110, v110
v_fmac_f32 v54, v111, v111
v_add_f32 v53, v53, v54
v_cndmask_b32 v53, 0, v53, vcc
s_nop 1
v_add_f32_dpp v53, v53, v53 row_ror:8 row_mask:0xf bank_mask:0xf
s_nop 1
v_add_f32_dpp v53, v53, v53 row_ror:4 row_mask:0xf bank_mask:0xf
s_nop 1
v_add_f32_dpp v53, v53, v53 row_ror:2 row_mask:0xf bank_mask:0xf
s_nop 1
v_add_f32_dpp v53, v53, v53 row_ror:1 row_mask:0xf bank_mask:0xf
s_nop 1
v_add_f32_dpp v53, v53, v53 row_bcast:15 row_mask:0xa bank_mask:0xf
s_nop 1
v_add_f32_dpp v53, v53, v53 row_bcast:31 row_mask:0xc bank_mask:0xf
v_mov_b32 v54, 0x3727c5ac
v_fmac_f32 v54, 0x3acccccd, v53
v_rsq_f32 v54, v54
s_nop 0
v_readlane_b32 s46, v54, 63
s_nop 1
v_mul_f32 v112, s46, v112
v_mul_f32 v113, s46, v113
v_mul_f32 v114, s46, v114
v_mul_f32 v115, s46, v115
v_mul_f32 v116, s46, v116
v_mul_f32 v117, s46, v117
v_mul_f32 v118, s46, v118
v_mul_f32 v119, s46, v119
v_mul_f32 v120, s46, v120
v_mul_f32 v121, s46, v121
v_mul_f32 v122, s46, v122
v_mul_f32 v123, s46, v123
v_mul_f32 v124, s46, v124
v_mul_f32 v125, s46, v125
v_mul_f32 v126, s46, v126
v_mul_f32 v127, s46, v127
v_fma_f32 v96, v96, v112, v224
v_fma_f32 v97, v97, v113, v225
v_fma_f32 v98, v98, v114, v226
v_fma_f32 v99, v99, v115, v227
v_fma_f32 v100, v100, v116, v228
v_fma_f32 v101, v101, v117, v229
v_fma_f32 v102, v102, v118, v230
v_fma_f32 v103, v103, v119, v231
v_fma_f32 v104, v104, v120, v232
v_fma_f32 v105, v105, v121, v233
v_fma_f32 v106, v106, v122, v234
v_fma_f32 v107, v107, v123, v235
v_fma_f32 v108, v108, v124, v236
v_fma_f32 v109, v109, v125, v237
v_fma_f32 v110, v110, v126, v238
v_fma_f32 v111, v111, v127, v239
v_add_f32 v53, v96, v98
v_add_f32 v54, v97, v99
v_add_f32 v53, v53, v100
v_add_f32 v54, v54, v101
v_add_f32 v53, v53, v102
v_add_f32 v54, v54, v103
v_add_f32 v53, v53, v104
v_add_f32 v54, v54, v105
v_add_f32 v53, v53, v106
v_add_f32 v54, v54, v107
v_add_f32 v53, v53, v108
v_add_f32 v54, v54, v109
v_add_f32 v53, v53, v110
v_add_f32 v54, v54, v111
v_add_f32 v53, v53, v54
v_cndmask_b32 v53, 0, v53, vcc
s_nop 1
v_add_f32_dpp v53, v53, v53 row_ror:8 row_mask:0xf bank_mask:0xf
s_nop 1
v_add_f32_dpp v53, v53, v53 row_ror:4 row_mask:0xf bank_mask:0xf
s_nop 1
v_add_f32_dpp v53, v53, v53 row_ror:2 row_mask:0xf bank_mask:0xf
s_nop 1
v_add_f32_dpp v53, v53, v53 row_ror:1 row_mask:0xf bank_mask:0xf
s_nop 1
v_add_f32_dpp v53, v53, v53 row_bcast:15 row_mask:0xa bank_mask:0xf
s_nop 1
v_add_f32_dpp v53, v53, v53 row_bcast:31 row_mask:0xc bank_mask:0xf
v_mul_f32 v53, 0x3acccccd, v53
s_nop 0
v_readlane_b32 s47, v53, 63
s_nop 1
v_subrev_f32 v96, s47, v96
v_subrev_f32 v97, s47, v97
v_subrev_f32 v98, s47, v98
v_subrev_f32 v99, s47, v99
v_subrev_f32 v100, s47, v100
v_subrev_f32 v101, s47, v101
v_subrev_f32 v102, s47, v102
v_subrev_f32 v103, s47, v103
v_subrev_f32 v104, s47, v104
v_subrev_f32 v105, s47, v105
v_subrev_f32 v106, s47, v106
v_subrev_f32 v107, s47, v107
v_subrev_f32 v108, s47, v108
v_subrev_f32 v109, s47, v109
v_subrev_f32 v110, s47, v110
v_subrev_f32 v111, s47, v111
v_mul_f32 v53, v96, v96
v_mul_f32 v54, v97, v97
v_fmac_f32 v53, v98, v98
v_fmac_f32 v54, v99, v99
v_fmac_f32 v53, v100, v100
v_fmac_f32 v54, v101, v101
v_fmac_f32 v53, v102, v102
v_fmac_f32 v54, v103, v103
v_fmac_f32 v53, v104, v104
v_fmac_f32 v54, v105, v105
v_fmac_f32 v53, v106, v106
v_fmac_f32 v54, v107, v107
v_fmac_f32 v53, v108, v108
v_fmac_f32 v54, v109, v109
v_fmac_f32 v53, v110, v110
v_fmac_f32 v54, v111, v111
v_add_f32 v53, v53, v54
v_cndmask_b32 v53, 0, v53, vcc
s_nop 1
v_add_f32_dpp v53, v53, v53 row_ror:8 row_mask:0xf bank_mask:0xf
s_nop 1
v_add_f32_dpp v53, v53, v53 row_ror:4 row_mask:0xf bank_mask:0xf
s_nop 1
v_add_f32_dpp v53, v53, v53 row_ror:2 row_mask:0xf bank_mask:0xf
s_nop 1
v_add_f32_dpp v53, v53, v53 row_ror:1 row_mask:0xf bank_mask:0xf
s_nop 1
v_add_f32_dpp v53, v53, v53 row_bcast:15 row_mask:0xa bank_mask:0xf
s_nop 1
v_add_f32_dpp v53, v53, v53 row_bcast:31 row_mask:0xc bank_mask:0xf
v_mov_b32 v54, 0x3727c5ac
v_fmac_f32 v54, 0x3acccccd, v53
v_rsq_f32 v54, v54
s_nop 0
v_readlane_b32 s48, v54, 63
v_mov_b32 v228, s46
s_nop 0
v_mov_b32 v226, s48
v_mul_f32 v224, s48, v228
v_mul_f32 v225, s45, v224
v_sub_f32 v225, 0, v225
v_mul_f32 v227, s47, v226
v_sub_f32 v227, 0, v227
v_mul_f32 v229, s45, v228
v_mov_b32 v230, s43
v_mov_b32 v231, 0
s_lshl_b32 s24, s44, 5
s_add_u32 s24, s24, 196608
v_mov_b32 v53, 0
s_mov_b64 exec, 1
buffer_store_dwordx4 v[224:227], v53, s[8:11], s24 offen sc0 sc1
buffer_store_dwordx4 v[228:231], v53, s[8:11], s24 offen offset:16 sc0 sc1
s_mov_b64 exec, -1
s_waitcnt vmcnt(0)
s_barrier
v_lshrrev_b32 v48, 4, v1
v_add_u32 v49, s19, v48
v_add_u32 v50, s27, v49
v_min_i32 v51, 2047, v50
v_max_i32 v51, 0, v51
v_lshlrev_b32 v51, 5, v51
v_lshlrev_b32 v49, 5, v49
s_mov_b32 s25, 196608
s_mov_b32 s30, 40000
L_84:
buffer_load_dwordx4 v[224:227], v51, s[8:11], s25 offen sc0 sc1
buffer_load_dwordx4 v[228:231], v49, s[8:11], s25 offen offset:16 sc0 sc1
s_waitcnt vmcnt(0)
v_cmp_eq_u32 vcc, 0, v224
v_cmp_eq_u32 s[28:29], 0, v228
s_nop 4
s_or_b64 vcc, vcc, s[28:29]
s_cbranch_vccz L_85
s_sub_u32 s30, s30, 1
s_cmp_lg_u32 s30, 0
s_cbranch_scc1 L_84
L_85:
v_cmp_ne_u32 vcc, s43, v230
s_nop 4
s_cmp_eq_u64 vcc, 0
s_cselect_b32 s25, 1, 0
v_mov_b32 v48, 133120
v_mov_b32 v49, s25
ds_write_b32 v48, v49
v_cmp_gt_u32 vcc, 2048, v50
s_nop 1
v_cndmask_b32 v224, 0, v224, vcc
v_cndmask_b32 v225, 0, v225, vcc
v_cndmask_b32 v226, 0, v226, vcc
v_cndmask_b32 v227, 0, v227, vcc
v_lshrrev_b32 v52, 1, v1
v_add_u32 v53, 131072, v1
v_add_u32 v52, 132096, v52
ds_write_b128 v53, v[224:227]
ds_write_b64 v52, v[228:229]
s_waitcnt lgkmcnt(0)
s_barrier
v_mov_b32 v48, 133120
ds_read_b32 v48, v48
s_waitcnt lgkmcnt(0)
v_readfirstlane_b32 s24, v48
s_cmp_eq_u32 s24, 0
s_cbranch_scc1 L_86
s_lshl_b32 s35, s16, 5
s_add_u32 s35, s35, 165888
s_lshl_b32 s24, s17, 2
s_add_u32 s36, s35, s24
s_barrier
s_cmp_lg_u32 s18, 0
s_cbranch_scc1 L_87
v_mov_b32 v46, 0
v_mov_b32 v47, 1
buffer_store_dword v47, v46, s[8:11], s36 offen
L_87:
s_and_b32 s24, s18, 3
s_lshl_b32 s24, s24, 4
s_add_u32 s24, s24, s19
v_add_u32 v46, s24, v4
v_lshrrev_b32 v47, 4, v46
v_mul_u32_u24 v47, 20480, v47
v_and_b32 v46, 15, v46
v_lshlrev_b32 v46, 4, v46
v_add_u32 v47, v47, v46
v_lshlrev_b32 v46, 8, v5
v_add_u32 v42, v47, v46
s_lshr_b32 s24, s18, 2
s_lshl_b32 s24, s24, 10
s_add_u32 s28, s24, 1048576
v_lshrrev_b32 v46, 2, v1
v_min_u32 v46, 28, v46
s_mov_b32 s30, 40000
L_88:
buffer_load_dword v47, v46, s[8:11], s35 offen sc1
s_waitcnt vmcnt(0)
v_cmp_ne_u32 vcc, 1, v47
s_nop 4
s_cbranch_vccz L_89
s_sub_u32 s30, s30, 1
s_cmp_lg_u32 s30, 0
s_cbranch_scc1 L_88
L_89:
s_add_u32 m0, s21, 0
s_add_u32 s22, s28, 0
buffer_load_dwordx4 v42, s[8:11], s22 offen  lds
s_add_u32 m0, s21, 8192
s_add_u32 s22, s28, 2048
buffer_load_dwordx4 v42, s[8:11], s22 offen  lds
s_add_u32 m0, s21, 16384
s_add_u32 s22, s28, 4096
buffer_load_dwordx4 v42, s[8:11], s22 offen  lds
s_add_u32 m0, s21, 24576
s_add_u32 s22, s28, 6144
buffer_load_dwordx4 v42, s[8:11], s22 offen  lds
s_add_u32 m0, s21, 32768
s_add_u32 s22, s28, 8192
buffer_load_dwordx4 v42, s[8:11], s22 offen  lds
s_add_u32 m0, s21, 40960
s_add_u32 s22, s28, 10240
buffer_load_dwordx4 v42, s[8:11], s22 offen  lds
s_add_u32 m0, s21, 49152
s_add_u32 s22, s28, 12288
buffer_load_dwordx4 v42, s[8:11], s22 offen  lds
s_add_u32 m0, s21, 57344
s_add_u32 s22, s28, 14336
buffer_load_dwordx4 v42, s[8:11], s22 offen  lds
s_add_u32 m0, s21, 65536
s_add_u32 s22, s28, 16384
buffer_load_dwordx4 v42, s[8:11], s22 offen  lds
s_add_u32 m0, s21, 73728
s_add_u32 s22, s28, 18432
buffer_load_dwordx4 v42, s[8:11], s22 offen  lds
s_waitcnt vmcnt(8)
s_barrier
s_waitcnt vmcnt(6)
s_barrier
s_waitcnt vmcnt(4)
s_barrier
s_waitcnt vmcnt(2)
s_barrier
s_waitcnt vmcnt(0)
s_barrier
s_add_u32 s23, s41, 0
buffer_load_dwordx4 v[128:131], v1, s[8:11], s23 offen
s_add_u32 s23, s41, 1024
buffer_load_dwordx4 v[132:135], v1, s[8:11], s23 offen
s_add_u32 s23, s41, 2048
buffer_load_dwordx4 v[136:139], v1, s[8:11], s23 offen
s_add_u32 s23, s41, 3072
buffer_load_dwordx4 v[140:143], v1, s[8:11], s23 offen
s_add_u32 s23, s41, 4096
buffer_load_dwordx4 v[144:147], v1, s[8:11], s23 offen
s_add_u32 s23, s41, 5120
buffer_load_dwordx4 v[148:151], v1, s[8:11], s23 offen
s_add_u32 s23, s41, 6144
buffer_load_dwordx4 v[152:155], v1, s[8:11], s23 offen
s_add_u32 s23, s41, 7168
buffer_load_dwordx4 v[156:159], v1, s[8:11], s23 offen
s_add_u32 s23, s41, 8192
buffer_load_dwordx4 v[160:163], v1, s[8:11], s23 offen
s_add_u32 s23, s41, 9216
buffer_load_dwordx4 v[164:167], v1, s[8:11], s23 offen
s_add_u32 s23, s41, 10240
buffer_load_dwordx4 v[168:171], v1, s[8:11], s23 offen
s_add_u32 s23, s41, 11264
buffer_load_dwordx4 v[172:175], v1, s[8:11], s23 offen
s_add_u32 s35, s35, 1024
s_add_u32 s36, s36, 1024
s_barrier
s_cmp_lg_u32 s18, 0
s_cbranch_scc1 L_92
v_mov_b32 v46, 0
v_mov_b32 v47, 1
buffer_store_dword v47, v46, s[8:11], s36 offen
L_92:
s_and_b32 s24, s18, 3
s_lshl_b32 s24, s24, 4
s_add_u32 s24, s24, s19
v_add_u32 v46, s24, v4
v_lshrrev_b32 v47, 4, v46
v_mul_u32_u24 v47, 20480, v47
v_and_b32 v46, 15, v46
v_lshlrev_b32 v46, 4, v46
v_add_u32 v47, v47, v46
v_lshlrev_b32 v46, 8, v5
v_add_u32 v42, v47, v46
s_lshr_b32 s24, s18, 2
s_lshl_b32 s24, s24, 10
s_add_u32 s28, s24, 11534336
v_lshrrev_b32 v46, 2, v1
v_min_u32 v46, 28, v46
s_mov_b32 s30, 40000
L_93:
buffer_load_dword v47, v46, s[8:11], s35 offen sc1
s_waitcnt vmcnt(0)
v_cmp_ne_u32 vcc, 1, v47
s_nop 4
s_cbranch_vccz L_94
s_sub_u32 s30, s30, 1
s_cmp_lg_u32 s30, 0
s_cbranch_scc1 L_93
L_94:
s_add_u32 m0, s21, 0
s_add_u32 s22, s28, 0
buffer_load_dwordx4 v42, s[8:11], s22 offen sc1 lds
s_add_u32 m0, s21, 8192
s_add_u32 s22, s28, 2048
buffer_load_dwordx4 v42, s[8:11], s22 offen sc1 lds
s_add_u32 m0, s21, 16384
s_add_u32 s22, s28, 4096
buffer_load_dwordx4 v42, s[8:11], s22 offen sc1 lds
s_add_u32 m0, s21, 24576
s_add_u32 s22, s28, 6144
buffer_load_dwordx4 v42, s[8:11], s22 offen sc1 lds
s_add_u32 m0, s21, 32768
s_add_u32 s22, s28, 8192
buffer_load_dwordx4 v42, s[8:11], s22 offen sc1 lds
s_add_u32 m0, s21, 40960
s_add_u32 s22, s28, 10240
buffer_load_dwordx4 v42, s[8:11], s22 offen sc1 lds
s_add_u32 m0, s21, 49152
s_add_u32 s22, s28, 12288
buffer_load_dwordx4 v42, s[8:11], s22 offen sc1 lds
s_add_u32 m0, s21, 57344
s_add_u32 s22, s28, 14336
buffer_load_dwordx4 v42, s[8:11], s22 offen sc1 lds
s_add_u32 m0, s21, 65536
s_add_u32 s22, s28, 16384
buffer_load_dwordx4 v42, s[8:11], s22 offen sc1 lds
s_add_u32 m0, s21, 73728
s_add_u32 s22, s28, 18432
buffer_load_dwordx4 v42, s[8:11], s22 offen sc1 lds
v_lshrrev_b32 v48, 4, v1
v_add_u32 v48, s19, v48
v_mul_u32_u24 v48, 320, v48
s_mov_b32 s24, 262144
buffer_load_dwordx4 v[176:179], v48, s[8:11], s24 offen offset:0
buffer_load_dwordx4 v[180:183], v48, s[8:11], s24 offen offset:16
buffer_load_dwordx4 v[184:187], v48, s[8:11], s24 offen offset:32
buffer_load_dwordx4 v[188:191], v48, s[8:11], s24 offen offset:48
buffer_load_dwordx4 v[192:195], v48, s[8:11], s24 offen offset:64
buffer_load_dwordx4 v[196:199], v48, s[8:11], s24 offen offset:80
buffer_load_dwordx4 v[200:203], v48, s[8:11], s24 offen offset:96
buffer_load_dwordx4 v[204:207], v48, s[8:11], s24 offen offset:112
buffer_load_dwordx4 v[208:211], v48, s[8:11], s24 offen offset:128
buffer_load_dwordx4 v[212:215], v48, s[8:11], s24 offen offset:144
buffer_load_dwordx4 v[216:219], v48, s[8:11], s24 offen offset:160
buffer_load_dwordx4 v[220:223], v48, s[8:11], s24 offen offset:176
buffer_load_dwordx4 v[224:227], v48, s[8:11], s24 offen offset:192
buffer_load_dwordx4 v[228:231], v48, s[8:11], s24 offen offset:208
buffer_load_dwordx4 v[232:235], v48, s[8:11], s24 offen offset:224
buffer_load_dwordx4 v[236:239], v48, s[8:11], s24 offen offset:240
buffer_load_dwordx4 v[240:243], v48, s[8:11], s24 offen offset:256
buffer_load_dwordx4 v[244:247], v48, s[8:11], s24 offen offset:272
buffer_load_dwordx4 v[248:251], v48, s[8:11], s24 offen offset:288
buffer_load_dwordx4 v[252:255], v48, s[8:11], s24 offen offset:304
v_mov_b32 v64, 0
v_mov_b32 v65, 0
v_mov_b32 v66, 0
v_mov_b32 v67, 0
v_mov_b32 v68, 0
v_mov_b32 v69, 0
v_mov_b32 v70, 0
v_mov_b32 v71, 0
v_mov_b32 v72, 0
v_mov_b32 v73, 0
v_mov_b32 v74, 0
v_mov_b32 v75, 0
v_mov_b32 v76, 0
v_mov_b32 v77, 0
v_mov_b32 v78, 0
v_mov_b32 v79, 0
s_waitcnt vmcnt(28)
s_barrier
ds_read_b128 v[96:99], v2 offset:0
ds_read_b128 v[100:103], v2 offset:1024
ds_read_b128 v[104:107], v2 offset:2048
ds_read_b128 v[108:111], v2 offset:3072
ds_read_b128 v[112:115], v2 offset:4096
ds_read_b128 v[116:119], v2 offset:5120
ds_read_b128 v[120:123], v2 offset:6144
ds_read_b128 v[124:127], v2 offset:7168
s_waitcnt lgkmcnt(4)
v_mfma_f32_16x16x32_bf16 v[64:67], v[128:131], v[96:99], v[64:67]
v_mfma_f32_16x16x32_bf16 v[68:71], v[128:131], v[100:103], v[68:71]
v_mfma_f32_16x16x32_bf16 v[72:75], v[128:131], v[104:107], v[72:75]
v_mfma_f32_16x16x32_bf16 v[76:79], v[128:131], v[108:111], v[76:79]
s_add_u32 s23, s41, 12288
buffer_load_dwordx4 v[128:131], v1, s[8:11], s23 offen
ds_read_b128 v[96:99], v2 offset:8192
ds_read_b128 v[100:103], v2 offset:9216
ds_read_b128 v[104:107], v2 offset:10240
ds_read_b128 v[108:111], v2 offset:11264
s_waitcnt lgkmcnt(4)
v_mfma_f32_16x16x32_bf16 v[64:67], v[132:135], v[112:115], v[64:67]
v_mfma_f32_16x16x32_bf16 v[68:71], v[132:135], v[116:119], v[68:71]
v_mfma_f32_16x16x32_bf16 v[72:75], v[132:135], v[120:123], v[72:75]
v_mfma_f32_16x16x32_bf16 v[76:79], v[132:135], v[124:127], v[76:79]
s_add_u32 s23, s41, 13312
buffer_load_dwordx4 v[132:135], v1, s[8:11], s23 offen
ds_read_b128 v[112:115], v2 offset:12288
ds_read_b128 v[116:119], v2 offset:13312
ds_read_b128 v[120:123], v2 offset:14336
ds_read_b128 v[124:127], v2 offset:15360
s_waitcnt lgkmcnt(4)
v_mfma_f32_16x16x32_bf16 v[64:67], v[136:139], v[96:99], v[64:67]
v_mfma_f32_16x16x32_bf16 v[68:71], v[136:139], v[100:103], v[68:71]
v_mfma_f32_16x16x32_bf16 v[72:75], v[136:139], v[104:107], v[72:75]
v_mfma_f32_16x16x32_bf16 v[76:79], v[136:139], v[108:111], v[76:79]
s_add_u32 s23, s41, 14336
buffer_load_dwordx4 v[136:139], v1, s[8:11], s23 offen
s_waitcnt vmcnt(29)
s_barrier
s_waitcnt vmcnt(3)
v_add_f32 v176, v176, v178
v_add_f32 v177, v177, v179
v_add_f32 v176, v176, v180
v_add_f32 v177, v177, v181
v_add_f32 v176, v176, v182
v_add_f32 v177, v177, v183
v_add_f32 v176, v176, v184
v_add_f32 v177, v177, v185
v_add_f32 v176, v176, v186
v_add_f32 v177, v177, v187
v_add_f32 v176, v176, v188
v_add_f32 v177, v177, v189
v_add_f32 v176, v176, v190
v_add_f32 v177, v177, v191
v_add_f32 v176, v176, v192
v_add_f32 v177, v177, v193
v_add_f32 v176, v176, v194
v_add_f32 v177, v177, v195
v_add_f32 v176, v176, v196
v_add_f32 v177, v177, v197
v_add_f32 v176, v176, v198
v_add_f32 v177, v177, v199
v_add_f32 v176, v176, v200
v_add_f32 v177, v177, v201
v_add_f32 v176, v176, v202
v_add_f32 v177, v177, v203
v_add_f32 v176, v176, v204
v_add_f32 v177, v177, v205
v_add_f32 v176, v176, v206
v_add_f32 v177, v177, v207
v_add_f32 v176, v176, v208
v_add_f32 v177, v177, v209
v_add_f32 v176, v176, v210
v_add_f32 v177, v177, v211
v_add_f32 v176, v176, v212
v_add_f32 v177, v177, v213
v_add_f32 v176, v176, v214
v_add_f32 v177, v177, v215
v_add_f32 v176, v176, v216
v_add_f32 v177, v177, v217
v_add_f32 v176, v176, v218
v_add_f32 v177, v177, v219
v_add_f32 v176, v176, v220
v_add_f32 v177, v177, v221
v_add_f32 v176, v176, v222
v_add_f32 v177, v177, v223
v_add_f32 v176, v176, v224
v_add_f32 v177, v177, v225
v_add_f32 v176, v176, v226
v_add_f32 v177, v177, v227
v_add_f32 v176, v176, v228
v_add_f32 v177, v177, v229
v_add_f32 v176, v176, v230
v_add_f32 v177, v177, v231
v_add_f32 v176, v176, v232
v_add_f32 v177, v177, v233
v_add_f32 v176, v176, v234
v_add_f32 v177, v177, v235
v_add_f32 v176, v176, v236
v_add_f32 v177, v177, v237
v_add_f32 v176, v176, v238
v_add_f32 v177, v177, v239
v_add_f32 v176, v176, v240
v_add_f32 v177, v177, v241
v_add_f32 v176, v176, v242
v_add_f32 v177, v177, v243
v_add_f32 v176, v176, v244
v_add_f32 v177, v177, v245
v_add_f32 v176, v176, v246
v_add_f32 v177, v177, v247
v_add_f32 v176, v176, v248
v_add_f32 v177, v177, v249
v_add_f32 v176, v176, v250
v_add_f32 v177, v177, v251
v_add_f32 v176, v176, v252
v_add_f32 v177, v177, v253
v_add_f32 v176, v176, v254
v_add_f32 v177, v177, v255
v_mul_f32 v176, 0x3acccccd, v176
v_mul_f32 v177, 0x3acccccd, v177
v_fma_f32 v177, -v176, v176, v177
v_add_f32 v177, 0x3727c5ac, v177
v_rsq_f32 v178, v177
s_nop 0
v_mul_f32 v179, v176, v178
v_sub_f32 v179, 0, v179
v_lshrrev_b32 v48, 1, v1
v_add_u32 v48, 132608, v48
ds_write_b64 v48, v[178:179]
s_waitcnt lgkmcnt(0)
ds_read_b128 v[96:99], v2 offset:16384
ds_read_b128 v[100:103], v2 offset:17408
ds_read_b128 v[104:107], v2 offset:18432
ds_read_b128 v[108:111], v2 offset:19456
s_waitcnt lgkmcnt(4)
v_mfma_f32_16x16x32_bf16 v[64:67], v[140:143], v[112:115], v[64:67]
v_mfma_f32_16x16x32_bf16 v[68:71], v[140:143], v[116:119], v[68:71]
v_mfma_f32_16x16x32_bf16 v[72:75], v[140:143], v[120:123], v[72:75]
v_mfma_f32_16x16x32_bf16 v[76:79], v[140:143], v[124:127], v[76:79]
s_add_u32 s23, s41, 15360
buffer_load_dwordx4 v[140:143], v1, s[8:11], s23 offen
ds_read_b128 v[112:115], v2 offset:20480
ds_read_b128 v[116:119], v2 offset:21504
ds_read_b128 v[120:123], v2 offset:22528
ds_read_b128 v[124:127], v2 offset:23552
s_waitcnt lgkmcnt(4)
v_mfma_f32_16x16x32_bf16 v[64:67], v[144:147], v[96:99], v[64:67]
v_mfma_f32_16x16x32_bf16 v[68:71], v[144:147], v[100:103], v[68:71]
v_mfma_f32_16x16x32_bf16 v[72:75], v[144:147], v[104:107], v[72:75]
v_mfma_f32_16x16x32_bf16 v[76:79], v[144:147], v[108:111], v[76:79]
s_add_u32 s23, s41, 16384
buffer_load_dwordx4 v[144:147], v1, s[8:11], s23 offen
ds_read_b128 v[96:99], v2 offset:24576
ds_read_b128 v[100:103], v2 offset:25600
ds_read_b128 v[104:107], v2 offset:26624
ds_read_b128 v[108:111], v2 offset:27648
s_waitcnt lgkmcnt(4)
v_mfma_f32_16x16x32_bf16 v[64:67], v[148:151], v[112:115], v[64:67]
v_mfma_f32_16x16x32_bf16 v[68:71], v[148:151], v[116:119], v[68:71]
v_mfma_f32_16x16x32_bf16 v[72:75], v[148:151], v[120:123], v[72:75]
v_mfma_f32_16x16x32_bf16 v[76:79], v[148:151], v[124:127], v[76:79]
s_add_u32 s23, s41, 17408
buffer_load_dwordx4 v[148:151], v1, s[8:11], s23 offen
ds_read_b128 v[112:115], v2 offset:28672
ds_read_b128 v[116:119], v2 offset:29696
ds_read_b128 v[120:123], v2 offset:30720
ds_read_b128 v[124:127], v2 offset:31744
s_waitcnt lgkmcnt(4)
v_mfma_f32_16x16x32_bf16 v[64:67], v[152:155], v[96:99], v[64:67]
v_mfma_f32_16x16x32_bf16 v[68:71], v[152:155], v[100:103], v[68:71]
v_mfma_f32_16x16x32_bf16 v[72:75], v[152:155], v[104:107], v[72:75]
v_mfma_f32_16x16x32_bf16 v[76:79], v[152:155], v[108:111], v[76:79]
s_add_u32 s23, s41, 18432
buffer_load_dwordx4 v[152:155], v1, s[8:11], s23 offen
s_waitcnt vmcnt(31)
s_barrier
ds_read_b128 v[96:99], v2 offset:32768
ds_read_b128 v[100:103], v2 offset:33792
ds_read_b128 v[104:107], v2 offset:34816
ds_read_b128 v[108:111], v2 offset:35840
s_waitcnt lgkmcnt(4)
v_mfma_f32_16x16x32_bf16 v[64:67], v[156:159], v[112:115], v[64:67]
v_mfma_f32_16x16x32_bf16 v[68:71], v[156:159], v[116:119], v[68:71]
v_mfma_f32_16x16x32_bf16 v[72:75], v[156:159], v[120:123], v[72:75]
v_mfma_f32_16x16x32_bf16 v[76:79], v[156:159], v[124:127], v[76:79]
s_add_u32 s23, s41, 19456
buffer_load_dwordx4 v[156:159], v1, s[8:11], s23 offen
ds_read_b128 v[112:115], v2 offset:36864
ds_read_b128 v[116:119], v2 offset:37888
ds_read_b128 v[120:123], v2 offset:38912
ds_read_b128 v[124:127], v2 offset:39936
s_waitcnt lgkmcnt(4)
v_mfma_f32_16x16x32_bf16 v[64:67], v[160:163], v[96:99], v[64:67]
v_mfma_f32_16x16x32_bf16 v[68:71], v[160:163], v[100:103], v[68:71]
v_mfma_f32_16x16x32_bf16 v[72:75], v[160:163], v[104:107], v[72:75]
v_mfma_f32_16x16x32_bf16 v[76:79], v[160:163], v[108:111], v[76:79]
ds_read_b128 v[96:99], v2 offset:40960
ds_read_b128 v[100:103], v2 offset:41984
ds_read_b128 v[104:107], v2 offset:43008
ds_read_b128 v[108:111], v2 offset:44032
s_waitcnt lgkmcnt(4)
v_mfma_f32_16x16x32_bf16 v[64:67], v[164:167], v[112:115], v[64:67]
v_mfma_f32_16x16x32_bf16 v[68:71], v[164:167], v[116:119], v[68:71]
v_mfma_f32_16x16x32_bf16 v[72:75], v[164:167], v[120:123], v[72:75]
v_mfma_f32_16x16x32_bf16 v[76:79], v[164:167], v[124:127], v[76:79]
ds_read_b128 v[112:115], v2 offset:45056
ds_read_b128 v[116:119], v2 offset:46080
ds_read_b128 v[120:123], v2 offset:47104
ds_read_b128 v[124:127], v2 offset:48128
s_waitcnt lgkmcnt(4)
v_mfma_f32_16x16x32_bf16 v[64:67], v[168:171], v[96:99], v[64:67]
v_mfma_f32_16x16x32_bf16 v[68:71], v[168:171], v[100:103], v[68:71]
v_mfma_f32_16x16x32_bf16 v[72:75], v[168:171], v[104:107], v[72:75]
v_mfma_f32_16x16x32_bf16 v[76:79], v[168:171], v[108:111], v[76:79]
s_waitcnt vmcnt(30)
s_barrier
ds_read_b128 v[96:99], v2 offset:49152
ds_read_b128 v[100:103], v2 offset:50176
ds_read_b128 v[104:107], v2 offset:51200
ds_read_b128 v[108:111], v2 offset:52224
s_waitcnt lgkmcnt(4)
v_mfma_f32_16x16x32_bf16 v[64:67], v[172:175], v[112:115], v[64:67]
v_mfma_f32_16x16x32_bf16 v[68:71], v[172:175], v[116:119], v[68:71]
v_mfma_f32_16x16x32_bf16 v[72:75], v[172:175], v[120:123], v[72:75]
v_mfma_f32_16x16x32_bf16 v[76:79], v[172:175], v[124:127], v[76:79]
ds_read_b128 v[112:115], v2 offset:53248
ds_read_b128 v[116:119], v2 offset:54272
ds_read_b128 v[120:123], v2 offset:55296
ds_read_b128 v[124:127], v2 offset:56320
s_waitcnt vmcnt(7)
s_waitcnt lgkmcnt(4)
v_mfma_f32_16x16x32_bf16 v[64:67], v[128:131], v[96:99], v[64:67]
v_mfma_f32_16x16x32_bf16 v[68:71], v[128:131], v[100:103], v[68:71]
v_mfma_f32_16x16x32_bf16 v[72:75], v[128:131], v[104:107], v[72:75]
v_mfma_f32_16x16x32_bf16 v[76:79], v[128:131], v[108:111], v[76:79]
ds_read_b128 v[96:99], v2 offset:57344
ds_read_b128 v[100:103], v2 offset:58368
ds_read_b128 v[104:107], v2 offset:59392
ds_read_b128 v[108:111], v2 offset:60416
s_waitcnt vmcnt(6)
s_waitcnt lgkmcnt(4)
v_mfma_f32_16x16x32_bf16 v[64:67], v[132:135], v[112:115], v[64:67]
v_mfma_f32_16x16x32_bf16 v[68:71], v[132:135], v[116:119], v[68:71]
v_mfma_f32_16x16x32_bf16 v[72:75], v[132:135], v[120:123], v[72:75]
v_mfma_f32_16x16x32_bf16 v[76:79], v[132:135], v[124:127], v[76:79]
ds_read_b128 v[112:115], v2 offset:61440
ds_read_b128 v[116:119], v2 offset:62464
ds_read_b128 v[120:123], v2 offset:63488
ds_read_b128 v[124:127], v2 offset:64512
s_waitcnt vmcnt(5)
s_waitcnt lgkmcnt(4)
v_mfma_f32_16x16x32_bf16 v[64:67], v[136:139], v[96:99], v[64:67]
v_mfma_f32_16x16x32_bf16 v[68:71], v[136:139], v[100:103], v[68:71]
v_mfma_f32_16x16x32_bf16 v[72:75], v[136:139], v[104:107], v[72:75]
v_mfma_f32_16x16x32_bf16 v[76:79], v[136:139], v[108:111], v[76:79]
s_waitcnt vmcnt(28)
s_barrier
s_lshl_b32 s24, s38, 6
s_add_u32 s24, s24, 138752
v_lshlrev_b32 v48, 4, v5
buffer_load_dwordx4 v[248:251], v48, s[8:11], s24 offen
ds_read_b128 v[96:99], v3 offset:0
ds_read_b128 v[100:103], v3 offset:1024
ds_read_b128 v[104:107], v3 offset:2048
ds_read_b128 v[108:111], v3 offset:3072
s_waitcnt vmcnt(5)
s_waitcnt lgkmcnt(4)
v_mfma_f32_16x16x32_bf16 v[64:67], v[140:143], v[112:115], v[64:67]
v_mfma_f32_16x16x32_bf16 v[68:71], v[140:143], v[116:119], v[68:71]
v_mfma_f32_16x16x32_bf16 v[72:75], v[140:143], v[120:123], v[72:75]
v_mfma_f32_16x16x32_bf16 v[76:79], v[140:143], v[124:127], v[76:79]
ds_read_b128 v[112:115], v3 offset:4096
ds_read_b128 v[116:119], v3 offset:5120
ds_read_b128 v[120:123], v3 offset:6144
ds_read_b128 v[124:127], v3 offset:7168
s_waitcnt vmcnt(4)
s_waitcnt lgkmcnt(4)
v_mfma_f32_16x16x32_bf16 v[64:67], v[144:147], v[96:99], v[64:67]
v_mfma_f32_16x16x32_bf16 v[68:71], v[144:147], v[100:103], v[68:71]
v_mfma_f32_16x16x32_bf16 v[72:75], v[144:147], v[104:107], v[72:75]
v_mfma_f32_16x16x32_bf16 v[76:79], v[144:147], v[108:111], v[76:79]
ds_read_b128 v[96:99], v3 offset:8192
ds_read_b128 v[100:103], v3 offset:9216
ds_read_b128 v[104:107], v3 offset:10240
ds_read_b128 v[108:111], v3 offset:11264
s_waitcnt vmcnt(3)
s_waitcnt lgkmcnt(4)
v_mfma_f32_16x16x32_bf16 v[64:67], v[148:151], v[112:115], v[64:67]
v_mfma_f32_16x16x32_bf16 v[68:71], v[148:151], v[116:119], v[68:71]
v_mfma_f32_16x16x32_bf16 v[72:75], v[148:151], v[120:123], v[72:75]
v_mfma_f32_16x16x32_bf16 v[76:79], v[148:151], v[124:127], v[76:79]
ds_read_b128 v[112:115], v3 offset:12288
ds_read_b128 v[116:119], v3 offset:13312
ds_read_b128 v[120:123], v3 offset:14336
ds_read_b128 v[124:127], v3 offset:15360
s_waitcnt vmcnt(2)
s_waitcnt lgkmcnt(4)
v_mfma_f32_16x16x32_bf16 v[64:67], v[152:155], v[96:99], v[64:67]
v_mfma_f32_16x16x32_bf16 v[68:71], v[152:155], v[100:103], v[68:71]
v_mfma_f32_16x16x32_bf16 v[72:75], v[152:155], v[104:107], v[72:75]
v_mfma_f32_16x16x32_bf16 v[76:79], v[152:155], v[108:111], v[76:79]
s_waitcnt vmcnt(1)
s_waitcnt lgkmcnt(0)
v_mfma_f32_16x16x32_bf16 v[64:67], v[156:159], v[112:115], v[64:67]
v_mfma_f32_16x16x32_bf16 v[68:71], v[156:159], v[116:119], v[68:71]
v_mfma_f32_16x16x32_bf16 v[72:75], v[156:159], v[120:123], v[72:75]
v_mfma_f32_16x16x32_bf16 v[76:79], v[156:159], v[124:127], v[76:79]
s_waitcnt vmcnt(0)
v_lshlrev_b32 v60, 3, v4
v_add_u32 v60, 132608, v60
ds_read_b64 v[224:225], v60 offset:0
ds_read_b64 v[226:227], v60 offset:128
ds_read_b64 v[228:229], v60 offset:256
ds_read_b64 v[230:231], v60 offset:384
s_waitcnt lgkmcnt(0)
s_lshr_b32 s24, s38, 1
s_lshl_b32 s24, s24, 10
s_and_b32 s25, s38, 1
s_lshl_b32 s25, s25, 3
s_add_u32 s24, s24, s25
s_mul_i32 s25, s16, 221184
s_add_u32 s24, s24, s25
s_add_u32 s34, s24, 0
s_add_u32 s34, s34, 3670016
v_mul_f32 v64, v64, v224
v_mul_f32 v65, v65, v224
v_mul_f32 v66, v66, v224
v_mul_f32 v67, v67, v224
v_fmac_f32 v64, v225, v248
v_fmac_f32 v65, v225, v249
v_fmac_f32 v66, v225, v250
v_fmac_f32 v67, v225, v251
v_mul_f32 v240, v64, v64
v_mul_f32 v241, v65, v65
v_mul_f32 v242, v66, v66
v_mul_f32 v243, v67, v67
v_fma_f32 v240, v240, s40, v63
v_fma_f32 v241, v241, s40, v63
v_fma_f32 v242, v242, s40, v63
v_fma_f32 v243, v243, s40, v63
v_mul_f32 v240, v240, v64
v_mul_f32 v241, v241, v65
v_mul_f32 v242, v242, v66
v_mul_f32 v243, v243, v67
v_exp_f32 v240, v240
v_exp_f32 v241, v241
v_exp_f32 v242, v242
v_exp_f32 v243, v243
v_add_f32 v240, 1.0, v240
v_add_f32 v241, 1.0, v241
v_add_f32 v242, 1.0, v242
v_add_f32 v243, 1.0, v243
v_rcp_f32 v240, v240
v_rcp_f32 v241, v241
v_rcp_f32 v242, v242
v_rcp_f32 v243, v243
v_mul_f32 v64, v64, v240
v_mul_f32 v65, v65, v241
v_mul_f32 v66, v66, v242
v_mul_f32 v67, v67, v243
v_cvt_pk_bf16_f32 v232, v64, v65
v_cvt_pk_bf16_f32 v233, v66, v67
buffer_store_dwordx2 v[232:233], v1, s[8:11], s34 offen
s_add_u32 s34, s34, 55296
v_mul_f32 v68, v68, v226
v_mul_f32 v69, v69, v226
v_mul_f32 v70, v70, v226
v_mul_f32 v71, v71, v226
v_fmac_f32 v68, v227, v248
v_fmac_f32 v69, v227, v249
v_fmac_f32 v70, v227, v250
v_fmac_f32 v71, v227, v251
v_mul_f32 v240, v68, v68
v_mul_f32 v241, v69, v69
v_mul_f32 v242, v70, v70
v_mul_f32 v243, v71, v71
v_fma_f32 v240, v240, s40, v63
v_fma_f32 v241, v241, s40, v63
v_fma_f32 v242, v242, s40, v63
v_fma_f32 v243, v243, s40, v63
v_mul_f32 v240, v240, v68
v_mul_f32 v241, v241, v69
v_mul_f32 v242, v242, v70
v_mul_f32 v243, v243, v71
v_exp_f32 v240, v240
v_exp_f32 v241, v241
v_exp_f32 v242, v242
v_exp_f32 v243, v243
v_add_f32 v240, 1.0, v240
v_add_f32 v241, 1.0, v241
v_add_f32 v242, 1.0, v242
v_add_f32 v243, 1.0, v243
v_rcp_f32 v240, v240
v_rcp_f32 v241, v241
v_rcp_f32 v242, v242
v_rcp_f32 v243, v243
v_mul_f32 v68, v68, v240
v_mul_f32 v69, v69, v241
v_mul_f32 v70, v70, v242
v_mul_f32 v71, v71, v243
v_cvt_pk_bf16_f32 v234, v68, v69
v_cvt_pk_bf16_f32 v235, v70, v71
buffer_store_dwordx2 v[234:235], v1, s[8:11], s34 offen
s_add_u32 s34, s34, 55296
v_mul_f32 v72, v72, v228
v_mul_f32 v73, v73, v228
v_mul_f32 v74, v74, v228
v_mul_f32 v75, v75, v228
v_fmac_f32 v72, v229, v248
v_fmac_f32 v73, v229, v249
v_fmac_f32 v74, v229, v250
v_fmac_f32 v75, v229, v251
v_mul_f32 v240, v72, v72
v_mul_f32 v241, v73, v73
v_mul_f32 v242, v74, v74
v_mul_f32 v243, v75, v75
v_fma_f32 v240, v240, s40, v63
v_fma_f32 v241, v241, s40, v63
v_fma_f32 v242, v242, s40, v63
v_fma_f32 v243, v243, s40, v63
v_mul_f32 v240, v240, v72
v_mul_f32 v241, v241, v73
v_mul_f32 v242, v242, v74
v_mul_f32 v243, v243, v75
v_exp_f32 v240, v240
v_exp_f32 v241, v241
v_exp_f32 v242, v242
v_exp_f32 v243, v243
v_add_f32 v240, 1.0, v240
v_add_f32 v241, 1.0, v241
v_add_f32 v242, 1.0, v242
v_add_f32 v243, 1.0, v243
v_rcp_f32 v240, v240
v_rcp_f32 v241, v241
v_rcp_f32 v242, v242
v_rcp_f32 v243, v243
v_mul_f32 v72, v72, v240
v_mul_f32 v73, v73, v241
v_mul_f32 v74, v74, v242
v_mul_f32 v75, v75, v243
v_cvt_pk_bf16_f32 v236, v72, v73
v_cvt_pk_bf16_f32 v237, v74, v75
buffer_store_dwordx2 v[236:237], v1, s[8:11], s34 offen
s_add_u32 s34, s34, 55296
v_mul_f32 v76, v76, v230
v_mul_f32 v77, v77, v230
v_mul_f32 v78, v78, v230
v_mul_f32 v79, v79, v230
v_fmac_f32 v76, v231, v248
v_fmac_f32 v77, v231, v249
v_fmac_f32 v78, v231, v250
v_fmac_f32 v79, v231, v251
v_mul_f32 v240, v76, v76
v_mul_f32 v241, v77, v77
v_mul_f32 v242, v78, v78
v_mul_f32 v243, v79, v79
v_fma_f32 v240, v240, s40, v63
v_fma_f32 v241, v241, s40, v63
v_fma_f32 v242, v242, s40, v63
v_fma_f32 v243, v243, s40, v63
v_mul_f32 v240, v240, v76
v_mul_f32 v241, v241, v77
v_mul_f32 v242, v242, v78
v_mul_f32 v243, v243, v79
v_exp_f32 v240, v240
v_exp_f32 v241, v241
v_exp_f32 v242, v242
v_exp_f32 v243, v243
v_add_f32 v240, 1.0, v240
v_add_f32 v241, 1.0, v241
v_add_f32 v242, 1.0, v242
v_add_f32 v243, 1.0, v243
v_rcp_f32 v240, v240
v_rcp_f32 v241, v241
v_rcp_f32 v242, v242
v_rcp_f32 v243, v243
v_mul_f32 v76, v76, v240
v_mul_f32 v77, v77, v241
v_mul_f32 v78, v78, v242
v_mul_f32 v79, v79, v243
v_cvt_pk_bf16_f32 v238, v76, v77
v_cvt_pk_bf16_f32 v239, v78, v79
buffer_store_dwordx2 v[238:239], v1, s[8:11], s34 offen
s_add_u32 s34, s34, 55296
s_add_u32 s35, s35, 1024
s_add_u32 s36, s36, 1024
s_waitcnt vmcnt(0)
s_barrier
s_cmp_lg_u32 s18, 0
s_cbranch_scc1 L_95
v_mov_b32 v46, 0
v_mov_b32 v47, 1
buffer_store_dword v47, v46, s[8:11], s36 offen
L_95:
s_and_b32 s24, s18, 3
s_lshl_b32 s24, s24, 4
s_add_u32 s24, s24, s19
v_add_u32 v46, s24, v4
v_lshrrev_b32 v47, 4, v46
v_mul_u32_u24 v47, 55296, v47
v_and_b32 v46, 15, v46
v_lshlrev_b32 v46, 4, v46
v_add_u32 v47, v47, v46
v_lshlrev_b32 v46, 8, v5
v_add_u32 v42, v47, v46
s_lshr_b32 s24, s18, 2
s_lshl_b32 s24, s24, 10
s_add_u32 s28, s24, 3670016
v_lshrrev_b32 v46, 2, v1
v_min_u32 v46, 28, v46
s_mov_b32 s30, 40000
L_96:
buffer_load_dword v47, v46, s[8:11], s35 offen sc1
s_waitcnt vmcnt(0)
v_cmp_ne_u32 vcc, 1, v47
s_nop 4
s_cbranch_vccz L_97
s_sub_u32 s30, s30, 1
s_cmp_lg_u32 s30, 0
s_cbranch_scc1 L_96
L_97:
s_add_u32 m0, s21, 0
s_add_u32 s22, s28, 0
buffer_load_dwordx4 v42, s[8:11], s22 offen  lds
s_add_u32 m0, s21, 8192
s_add_u32 s22, s28, 2048
buffer_load_dwordx4 v42, s[8:11], s22 offen  lds
s_add_u32 m0, s21, 16384
s_add_u32 s22, s28, 4096
buffer_load_dwordx4 v42, s[8:11], s22 offen  lds
s_add_u32 m0, s21, 24576
s_add_u32 s22, s28, 6144
buffer_load_dwordx4 v42, s[8:11], s22 offen  lds
s_add_u32 m0, s21, 32768
s_add_u32 s22, s28, 8192
buffer_load_dwordx4 v42, s[8:11], s22 offen  lds
s_add_u32 m0, s21, 40960
s_add_u32 s22, s28, 10240
buffer_load_dwordx4 v42, s[8:11], s22 offen  lds
s_add_u32 m0, s21, 49152
s_add_u32 s22, s28, 12288
buffer_load_dwordx4 v42, s[8:11], s22 offen  lds
s_add_u32 m0, s21, 57344
s_add_u32 s22, s28, 14336
buffer_load_dwordx4 v42, s[8:11], s22 offen  lds
s_add_u32 m0, s21, 65536
s_add_u32 s22, s28, 16384
buffer_load_dwordx4 v42, s[8:11], s22 offen  lds
s_add_u32 m0, s21, 73728
s_add_u32 s22, s28, 18432
buffer_load_dwordx4 v42, s[8:11], s22 offen  lds
s_add_u32 m0, s21, 81920
s_add_u32 s22, s28, 20480
buffer_load_dwordx4 v42, s[8:11], s22 offen  lds
s_add_u32 m0, s21, 90112
s_add_u32 s22, s28, 22528
buffer_load_dwordx4 v42, s[8:11], s22 offen  lds
s_add_u32 m0, s21, 98304
s_add_u32 s22, s28, 24576
buffer_load_dwordx4 v42, s[8:11], s22 offen  lds
s_add_u32 m0, s21, 106496
s_add_u32 s22, s28, 26624
buffer_load_dwordx4 v42, s[8:11], s22 offen  lds
s_add_u32 m0, s21, 114688
s_add_u32 s22, s28, 28672
buffer_load_dwordx4 v42, s[8:11], s22 offen  lds
s_add_u32 m0, s21, 122880
s_add_u32 s22, s28, 30720
buffer_load_dwordx4 v42, s[8:11], s22 offen  lds
s_waitcnt vmcnt(14)
s_barrier
s_waitcnt vmcnt(12)
s_barrier
s_waitcnt vmcnt(10)
s_barrier
s_add_u32 m0, s21, 0
s_add_u32 s22, s28, 32768
buffer_load_dwordx4 v42, s[8:11], s22 offen  lds
s_add_u32 m0, s21, 8192
s_add_u32 s22, s28, 34816
buffer_load_dwordx4 v42, s[8:11], s22 offen  lds
s_waitcnt vmcnt(10)
s_barrier
s_add_u32 m0, s21, 16384
s_add_u32 s22, s28, 36864
buffer_load_dwordx4 v42, s[8:11], s22 offen  lds
s_add_u32 m0, s21, 24576
s_add_u32 s22, s28, 38912
buffer_load_dwordx4 v42, s[8:11], s22 offen  lds
s_waitcnt vmcnt(10)
s_barrier
s_add_u32 m0, s21, 32768
s_add_u32 s22, s28, 40960
buffer_load_dwordx4 v42, s[8:11], s22 offen  lds
s_add_u32 m0, s21, 40960
s_add_u32 s22, s28, 43008
buffer_load_dwordx4 v42, s[8:11], s22 offen  lds
s_waitcnt vmcnt(10)
s_barrier
s_add_u32 m0, s21, 49152
s_add_u32 s22, s28, 45056
buffer_load_dwordx4 v42, s[8:11], s22 offen  lds
s_add_u32 m0, s21, 57344
s_add_u32 s22, s28, 47104
buffer_load_dwordx4 v42, s[8:11], s22 offen  lds
s_waitcnt vmcnt(10)
s_barrier
s_add_u32 m0, s21, 65536
s_add_u32 s22, s28, 49152
buffer_load_dwordx4 v42, s[8:11], s22 offen  lds
s_add_u32 m0, s21, 73728
s_add_u32 s22, s28, 51200
buffer_load_dwordx4 v42, s[8:11], s22 offen  lds
s_waitcnt vmcnt(10)
s_barrier
s_add_u32 m0, s21, 81920
s_add_u32 s22, s28, 53248
buffer_load_dwordx4 v42, s[8:11], s22 offen  lds
s_waitcnt vmcnt(9)
s_barrier
s_waitcnt vmcnt(7)
s_barrier
s_waitcnt vmcnt(5)
s_barrier
s_waitcnt vmcnt(3)
s_barrier
s_waitcnt vmcnt(1)
s_barrier
s_waitcnt vmcnt(0)
s_barrier
s_endpgm
L_86:
s_lshl_b32 s35, s16, 5
s_add_u32 s35, s35, 165888
s_lshl_b32 s24, s17, 2
s_add_u32 s36, s35, s24
s_barrier
s_cmp_lg_u32 s18, 0
s_cbranch_scc1 L_98
v_mov_b32 v46, 0
v_mov_b32 v47, 1
buffer_store_dword v47, v46, s[8:11], s36 offen sc0 sc1
L_98:
s_and_b32 s24, s18, 3
s_lshl_b32 s24, s24, 4
s_add_u32 s24, s24, s19
v_add_u32 v46, s24, v4
v_lshrrev_b32 v47, 4, v46
v_mul_u32_u24 v47, 20480, v47
v_and_b32 v46, 15, v46
v_lshlrev_b32 v46, 4, v46
v_add_u32 v47, v47, v46
v_lshlrev_b32 v46, 8, v5
v_add_u32 v42, v47, v46
s_lshr_b32 s24, s18, 2
s_lshl_b32 s24, s24, 10
s_add_u32 s28, s24, 1048576
v_lshrrev_b32 v46, 2, v1
v_min_u32 v46, 28, v46
s_mov_b32 s30, 40000
L_99:
buffer_load_dword v47, v46, s[8:11], s35 offen sc0 sc1
s_waitcnt vmcnt(0)
v_cmp_ne_u32 vcc, 1, v47
s_nop 4
s_cbranch_vccz L_100
s_sub_u32 s30, s30, 1
s_cmp_lg_u32 s30, 0
s_cbranch_scc1 L_99
L_100:
s_add_u32 m0, s21, 0
s_add_u32 s22, s28, 0
buffer_load_dwordx4 v42, s[8:11], s22 offen sc0 sc1 lds
s_add_u32 m0, s21, 8192
s_add_u32 s22, s28, 2048
buffer_load_dwordx4 v42, s[8:11], s22 offen sc0 sc1 lds
s_add_u32 m0, s21, 16384
s_add_u32 s22, s28, 4096
buffer_load_dwordx4 v42, s[8:11], s22 offen sc0 sc1 lds
s_add_u32 m0, s21, 24576
s_add_u32 s22, s28, 6144
buffer_load_dwordx4 v42, s[8:11], s22 offen sc0 sc1 lds
s_add_u32 m0, s21, 32768
s_add_u32 s22, s28, 8192
buffer_load_dwordx4 v42, s[8:11], s22 offen sc0 sc1 lds
s_add_u32 m0, s21, 40960
s_add_u32 s22, s28, 10240
buffer_load_dwordx4 v42, s[8:11], s22 offen sc0 sc1 lds
s_add_u32 m0, s21, 49152
s_add_u32 s22, s28, 12288
buffer_load_dwordx4 v42, s[8:11], s22 offen sc0 sc1 lds
s_add_u32 m0, s21, 57344
s_add_u32 s22, s28, 14336
buffer_load_dwordx4 v42, s[8:11], s22 offen sc0 sc1 lds
s_add_u32 m0, s21, 65536
s_add_u32 s22, s28, 16384
buffer_load_dwordx4 v42, s[8:11], s22 offen sc0 sc1 lds
s_add_u32 m0, s21, 73728
s_add_u32 s22, s28, 18432
buffer_load_dwordx4 v42, s[8:11], s22 offen sc0 sc1 lds
s_waitcnt vmcnt(8)
s_barrier
s_waitcnt vmcnt(6)
s_barrier
s_waitcnt vmcnt(4)
s_barrier
s_waitcnt vmcnt(2)
s_barrier
s_waitcnt vmcnt(0)
s_barrier
s_add_u32 s23, s41, 0
buffer_load_dwordx4 v[128:131], v1, s[8:11], s23 offen
s_add_u32 s23, s41, 1024
buffer_load_dwordx4 v[132:135], v1, s[8:11], s23 offen
s_add_u32 s23, s41, 2048
buffer_load_dwordx4 v[136:139], v1, s[8:11], s23 offen
s_add_u32 s23, s41, 3072
buffer_load_dwordx4 v[140:143], v1, s[8:11], s23 offen
s_add_u32 s23, s41, 4096
buffer_load_dwordx4 v[144:147], v1, s[8:11], s23 offen
s_add_u32 s23, s41, 5120
buffer_load_dwordx4 v[148:151], v1, s[8:11], s23 offen
s_add_u32 s23, s41, 6144
buffer_load_dwordx4 v[152:155], v1, s[8:11], s23 offen
s_add_u32 s23, s41, 7168
buffer_load_dwordx4 v[156:159], v1, s[8:11], s23 offen
s_add_u32 s23, s41, 8192
buffer_load_dwordx4 v[160:163], v1, s[8:11], s23 offen
s_add_u32 s23, s41, 9216
buffer_load_dwordx4 v[164:167], v1, s[8:11], s23 offen
s_add_u32 s23, s41, 10240
buffer_load_dwordx4 v[168:171], v1, s[8:11], s23 offen
s_add_u32 s23, s41, 11264
buffer_load_dwordx4 v[172:175], v1, s[8:11], s23 offen
s_add_u32 s35, s35, 1024
s_add_u32 s36, s36, 1024
s_barrier
s_cmp_lg_u32 s18, 0
s_cbranch_scc1 L_103
v_mov_b32 v46, 0
v_mov_b32 v47, 1
buffer_store_dword v47, v46, s[8:11], s36 offen sc0 sc1
L_103:
s_and_b32 s24, s18, 3
s_lshl_b32 s24, s24, 4
s_add_u32 s24, s24, s19
v_add_u32 v46, s24, v4
v_lshrrev_b32 v47, 4, v46
v_mul_u32_u24 v47, 20480, v47
v_and_b32 v46, 15, v46
v_lshlrev_b32 v46, 4, v46
v_add_u32 v47, v47, v46
v_lshlrev_b32 v46, 8, v5
v_add_u32 v42, v47, v46
s_lshr_b32 s24, s18, 2
s_lshl_b32 s24, s24, 10
s_add_u32 s28, s24, 11534336
v_lshrrev_b32 v46, 2, v1
v_min_u32 v46, 28, v46
s_mov_b32 s30, 40000
L_104:
buffer_load_dword v47, v46, s[8:11], s35 offen sc0 sc1
s_waitcnt vmcnt(0)
v_cmp_ne_u32 vcc, 1, v47
s_nop 4
s_cbranch_vccz L_105
s_sub_u32 s30, s30, 1
s_cmp_lg_u32 s30, 0
s_cbranch_scc1 L_104
L_105:
s_add_u32 m0, s21, 0
s_add_u32 s22, s28, 0
buffer_load_dwordx4 v42, s[8:11], s22 offen sc0 sc1 lds
s_add_u32 m0, s21, 8192
s_add_u32 s22, s28, 2048
buffer_load_dwordx4 v42, s[8:11], s22 offen sc0 sc1 lds
s_add_u32 m0, s21, 16384
s_add_u32 s22, s28, 4096
buffer_load_dwordx4 v42, s[8:11], s22 offen sc0 sc1 lds
s_add_u32 m0, s21, 24576
s_add_u32 s22, s28, 6144
buffer_load_dwordx4 v42, s[8:11], s22 offen sc0 sc1 lds
s_add_u32 m0, s21, 32768
s_add_u32 s22, s28, 8192
buffer_load_dwordx4 v42, s[8:11], s22 offen sc0 sc1 lds
s_add_u32 m0, s21, 40960
s_add_u32 s22, s28, 10240
buffer_load_dwordx4 v42, s[8:11], s22 offen sc0 sc1 lds
s_add_u32 m0, s21, 49152
s_add_u32 s22, s28, 12288
buffer_load_dwordx4 v42, s[8:11], s22 offen sc0 sc1 lds
s_add_u32 m0, s21, 57344
s_add_u32 s22, s28, 14336
buffer_load_dwordx4 v42, s[8:11], s22 offen sc0 sc1 lds
s_add_u32 m0, s21, 65536
s_add_u32 s22, s28, 16384
buffer_load_dwordx4 v42, s[8:11], s22 offen sc0 sc1 lds
s_add_u32 m0, s21, 73728
s_add_u32 s22, s28, 18432
buffer_load_dwordx4 v42, s[8:11], s22 offen sc0 sc1 lds
v_lshrrev_b32 v48, 4, v1
v_add_u32 v48, s19, v48
v_mul_u32_u24 v48, 320, v48
s_mov_b32 s24, 262144
buffer_load_dwordx4 v[176:179], v48, s[8:11], s24 offen offset:0 sc0 sc1
buffer_load_dwordx4 v[180:183], v48, s[8:11], s24 offen offset:16 sc0 sc1
buffer_load_dwordx4 v[184:187], v48, s[8:11], s24 offen offset:32 sc0 sc1
buffer_load_dwordx4 v[188:191], v48, s[8:11], s24 offen offset:48 sc0 sc1
buffer_load_dwordx4 v[192:195], v48, s[8:11], s24 offen offset:64 sc0 sc1
buffer_load_dwordx4 v[196:199], v48, s[8:11], s24 offen offset:80 sc0 sc1
buffer_load_dwordx4 v[200:203], v48, s[8:11], s24 offen offset:96 sc0 sc1
buffer_load_dwordx4 v[204:207], v48, s[8:11], s24 offen offset:112 sc0 sc1
buffer_load_dwordx4 v[208:211], v48, s[8:11], s24 offen offset:128 sc0 sc1
buffer_load_dwordx4 v[212:215], v48, s[8:11], s24 offen offset:144 sc0 sc1
buffer_load_dwordx4 v[216:219], v48, s[8:11], s24 offen offset:160 sc0 sc1
buffer_load_dwordx4 v[220:223], v48, s[8:11], s24 offen offset:176 sc0 sc1
buffer_load_dwordx4 v[224:227], v48, s[8:11], s24 offen offset:192 sc0 sc1
buffer_load_dwordx4 v[228:231], v48, s[8:11], s24 offen offset:208 sc0 sc1
buffer_load_dwordx4 v[232:235], v48, s[8:11], s24 offen offset:224 sc0 sc1
buffer_load_dwordx4 v[236:239], v48, s[8:11], s24 offen offset:240 sc0 sc1
buffer_load_dwordx4 v[240:243], v48, s[8:11], s24 offen offset:256 sc0 sc1
buffer_load_dwordx4 v[244:247], v48, s[8:11], s24 offen offset:272 sc0 sc1
buffer_load_dwordx4 v[248:251], v48, s[8:11], s24 offen offset:288 sc0 sc1
buffer_load_dwordx4 v[252:255], v48, s[8:11], s24 offen offset:304 sc0 sc1
v_mov_b32 v64, 0
v_mov_b32 v65, 0
v_mov_b32 v66, 0
v_mov_b32 v67, 0
v_mov_b32 v68, 0
v_mov_b32 v69, 0
v_mov_b32 v70, 0
v_mov_b32 v71, 0
v_mov_b32 v72, 0
v_mov_b32 v73, 0
v_mov_b32 v74, 0
v_mov_b32 v75, 0
v_mov_b32 v76, 0
v_mov_b32 v77, 0
v_mov_b32 v78, 0
v_mov_b32 v79, 0
s_waitcnt vmcnt(28)
s_barrier
ds_read_b128 v[96:99], v2 offset:0
ds_read_b128 v[100:103], v2 offset:1024
ds_read_b128 v[104:107], v2 offset:2048
ds_read_b128 v[108:111], v2 offset:3072
ds_read_b128 v[112:115], v2 offset:4096
ds_read_b128 v[116:119], v2 offset:5120
ds_read_b128 v[120:123], v2 offset:6144
ds_read_b128 v[124:127], v2 offset:7168
s_waitcnt lgkmcnt(4)
v_mfma_f32_16x16x32_bf16 v[64:67], v[128:131], v[96:99], v[64:67]
v_mfma_f32_16x16x32_bf16 v[68:71], v[128:131], v[100:103], v[68:71]
v_mfma_f32_16x16x32_bf16 v[72:75], v[128:131], v[104:107], v[72:75]
v_mfma_f32_16x16x32_bf16 v[76:79], v[128:131], v[108:111], v[76:79]
s_add_u32 s23, s41, 12288
buffer_load_dwordx4 v[128:131], v1, s[8:11], s23 offen
ds_read_b128 v[96:99], v2 offset:8192
ds_read_b128 v[100:103], v2 offset:9216
ds_read_b128 v[104:107], v2 offset:10240
ds_read_b128 v[108:111], v2 offset:11264
s_waitcnt lgkmcnt(4)
v_mfma_f32_16x16x32_bf16 v[64:67], v[132:135], v[112:115], v[64:67]
v_mfma_f32_16x16x32_bf16 v[68:71], v[132:135], v[116:119], v[68:71]
v_mfma_f32_16x16x32_bf16 v[72:75], v[132:135], v[120:123], v[72:75]
v_mfma_f32_16x16x32_bf16 v[76:79], v[132:135], v[124:127], v[76:79]
s_add_u32 s23, s41, 13312
buffer_load_dwordx4 v[132:135], v1, s[8:11], s23 offen
ds_read_b128 v[112:115], v2 offset:12288
ds_read_b128 v[116:119], v2 offset:13312
ds_read_b128 v[120:123], v2 offset:14336
ds_read_b128 v[124:127], v2 offset:15360
s_waitcnt lgkmcnt(4)
v_mfma_f32_16x16x32_bf16 v[64:67], v[136:139], v[96:99], v[64:67]
v_mfma_f32_16x16x32_bf16 v[68:71], v[136:139], v[100:103], v[68:71]
v_mfma_f32_16x16x32_bf16 v[72:75], v[136:139], v[104:107], v[72:75]
v_mfma_f32_16x16x32_bf16 v[76:79], v[136:139], v[108:111], v[76:79]
s_add_u32 s23, s41, 14336
buffer_load_dwordx4 v[136:139], v1, s[8:11], s23 offen
s_waitcnt vmcnt(29)
s_barrier
s_waitcnt vmcnt(3)
v_add_f32 v176, v176, v178
v_add_f32 v177, v177, v179
v_add_f32 v176, v176, v180
v_add_f32 v177, v177, v181
v_add_f32 v176, v176, v182
v_add_f32 v177, v177, v183
v_add_f32 v176, v176, v184
v_add_f32 v177, v177, v185
v_add_f32 v176, v176, v186
v_add_f32 v177, v177, v187
v_add_f32 v176, v176, v188
v_add_f32 v177, v177, v189
v_add_f32 v176, v176, v190
v_add_f32 v177, v177, v191
v_add_f32 v176, v176, v192
v_add_f32 v177, v177, v193
v_add_f32 v176, v176, v194
v_add_f32 v177, v177, v195
v_add_f32 v176, v176, v196
v_add_f32 v177, v177, v197
v_add_f32 v176, v176, v198
v_add_f32 v177, v177, v199
v_add_f32 v176, v176, v200
v_add_f32 v177, v177, v201
v_add_f32 v176, v176, v202
v_add_f32 v177, v177, v203
v_add_f32 v176, v176, v204
v_add_f32 v177, v177, v205
v_add_f32 v176, v176, v206
v_add_f32 v177, v177, v207
v_add_f32 v176, v176, v208
v_add_f32 v177, v177, v209
v_add_f32 v176, v176, v210
v_add_f32 v177, v177, v211
v_add_f32 v176, v176, v212
v_add_f32 v177, v177, v213
v_add_f32 v176, v176, v214
v_add_f32 v177, v177, v215
v_add_f32 v176, v176, v216
v_add_f32 v177, v177, v217
v_add_f32 v176, v176, v218
v_add_f32 v177, v177, v219
v_add_f32 v176, v176, v220
v_add_f32 v177, v177, v221
v_add_f32 v176, v176, v222
v_add_f32 v177, v177, v223
v_add_f32 v176, v176, v224
v_add_f32 v177, v177, v225
v_add_f32 v176, v176, v226
v_add_f32 v177, v177, v227
v_add_f32 v176, v176, v228
v_add_f32 v177, v177, v229
v_add_f32 v176, v176, v230
v_add_f32 v177, v177, v231
v_add_f32 v176, v176, v232
v_add_f32 v177, v177, v233
v_add_f32 v176, v176, v234
v_add_f32 v177, v177, v235
v_add_f32 v176, v176, v236
v_add_f32 v177, v177, v237
v_add_f32 v176, v176, v238
v_add_f32 v177, v177, v239
v_add_f32 v176, v176, v240
v_add_f32 v177, v177, v241
v_add_f32 v176, v176, v242
v_add_f32 v177, v177, v243
v_add_f32 v176, v176, v244
v_add_f32 v177, v177, v245
v_add_f32 v176, v176, v246
v_add_f32 v177, v177, v247
v_add_f32 v176, v176, v248
v_add_f32 v177, v177, v249
v_add_f32 v176, v176, v250
v_add_f32 v177, v177, v251
v_add_f32 v176, v176, v252
v_add_f32 v177, v177, v253
v_add_f32 v176, v176, v254
v_add_f32 v177, v177, v255
v_mul_f32 v176, 0x3acccccd, v176
v_mul_f32 v177, 0x3acccccd, v177
v_fma_f32 v177, -v176, v176, v177
v_add_f32 v177, 0x3727c5ac, v177
v_rsq_f32 v178, v177
s_nop 0
v_mul_f32 v179, v176, v178
v_sub_f32 v179, 0, v179
v_lshrrev_b32 v48, 1, v1
v_add_u32 v48, 132608, v48
ds_write_b64 v48, v[178:179]
s_waitcnt lgkmcnt(0)
ds_read_b128 v[96:99], v2 offset:16384
ds_read_b128 v[100:103], v2 offset:17408
ds_read_b128 v[104:107], v2 offset:18432
ds_read_b128 v[108:111], v2 offset:19456
s_waitcnt lgkmcnt(4)
v_mfma_f32_16x16x32_bf16 v[64:67], v[140:143], v[112:115], v[64:67]
v_mfma_f32_16x16x32_bf16 v[68:71], v[140:143], v[116:119], v[68:71]
v_mfma_f32_16x16x32_bf16 v[72:75], v[140:143], v[120:123], v[72:75]
v_mfma_f32_16x16x32_bf16 v[76:79], v[140:143], v[124:127], v[76:79]
s_add_u32 s23, s41, 15360
buffer_load_dwordx4 v[140:143], v1, s[8:11], s23 offen
ds_read_b128 v[112:115], v2 offset:20480
ds_read_b128 v[116:119], v2 offset:21504
ds_read_b128 v[120:123], v2 offset:22528
ds_read_b128 v[124:127], v2 offset:23552
s_waitcnt lgkmcnt(4)
v_mfma_f32_16x16x32_bf16 v[64:67], v[144:147], v[96:99], v[64:67]
v_mfma_f32_16x16x32_bf16 v[68:71], v[144:147], v[100:103], v[68:71]
v_mfma_f32_16x16x32_bf16 v[72:75], v[144:147], v[104:107], v[72:75]
v_mfma_f32_16x16x32_bf16 v[76:79], v[144:147], v[108:111], v[76:79]
s_add_u32 s23, s41, 16384
buffer_load_dwordx4 v[144:147], v1, s[8:11], s23 offen
ds_read_b128 v[96:99], v2 offset:24576
ds_read_b128 v[100:103], v2 offset:25600
ds_read_b128 v[104:107], v2 offset:26624
ds_read_b128 v[108:111], v2 offset:27648
s_waitcnt lgkmcnt(4)
v_mfma_f32_16x16x32_bf16 v[64:67], v[148:151], v[112:115], v[64:67]
v_mfma_f32_16x16x32_bf16 v[68:71], v[148:151], v[116:119], v[68:71]
v_mfma_f32_16x16x32_bf16 v[72:75], v[148:151], v[120:123], v[72:75]
v_mfma_f32_16x16x32_bf16 v[76:79], v[148:151], v[124:127], v[76:79]
s_add_u32 s23, s41, 17408
buffer_load_dwordx4 v[148:151], v1, s[8:11], s23 offen
ds_read_b128 v[112:115], v2 offset:28672
ds_read_b128 v[116:119], v2 offset:29696
ds_read_b128 v[120:123], v2 offset:30720
ds_read_b128 v[124:127], v2 offset:31744
s_waitcnt lgkmcnt(4)
v_mfma_f32_16x16x32_bf16 v[64:67], v[152:155], v[96:99], v[64:67]
v_mfma_f32_16x16x32_bf16 v[68:71], v[152:155], v[100:103], v[68:71]
v_mfma_f32_16x16x32_bf16 v[72:75], v[152:155], v[104:107], v[72:75]
v_mfma_f32_16x16x32_bf16 v[76:79], v[152:155], v[108:111], v[76:79]
s_add_u32 s23, s41, 18432
buffer_load_dwordx4 v[152:155], v1, s[8:11], s23 offen
s_waitcnt vmcnt(31)
s_barrier
ds_read_b128 v[96:99], v2 offset:32768
ds_read_b128 v[100:103], v2 offset:33792
ds_read_b128 v[104:107], v2 offset:34816
ds_read_b128 v[108:111], v2 offset:35840
s_waitcnt lgkmcnt(4)
v_mfma_f32_16x16x32_bf16 v[64:67], v[156:159], v[112:115], v[64:67]
v_mfma_f32_16x16x32_bf16 v[68:71], v[156:159], v[116:119], v[68:71]
v_mfma_f32_16x16x32_bf16 v[72:75], v[156:159], v[120:123], v[72:75]
v_mfma_f32_16x16x32_bf16 v[76:79], v[156:159], v[124:127], v[76:79]
s_add_u32 s23, s41, 19456
buffer_load_dwordx4 v[156:159], v1, s[8:11], s23 offen
ds_read_b128 v[112:115], v2 offset:36864
ds_read_b128 v[116:119], v2 offset:37888
ds_read_b128 v[120:123], v2 offset:38912
ds_read_b128 v[124:127], v2 offset:39936
s_waitcnt lgkmcnt(4)
v_mfma_f32_16x16x32_bf16 v[64:67], v[160:163], v[96:99], v[64:67]
v_mfma_f32_16x16x32_bf16 v[68:71], v[160:163], v[100:103], v[68:71]
v_mfma_f32_16x16x32_bf16 v[72:75], v[160:163], v[104:107], v[72:75]
v_mfma_f32_16x16x32_bf16 v[76:79], v[160:163], v[108:111], v[76:79]
ds_read_b128 v[96:99], v2 offset:40960
ds_read_b128 v[100:103], v2 offset:41984
ds_read_b128 v[104:107], v2 offset:43008
ds_read_b128 v[108:111], v2 offset:44032
s_waitcnt lgkmcnt(4)
v_mfma_f32_16x16x32_bf16 v[64:67], v[164:167], v[112:115], v[64:67]
v_mfma_f32_16x16x32_bf16 v[68:71], v[164:167], v[116:119], v[68:71]
v_mfma_f32_16x16x32_bf16 v[72:75], v[164:167], v[120:123], v[72:75]
v_mfma_f32_16x16x32_bf16 v[76:79], v[164:167], v[124:127], v[76:79]
ds_read_b128 v[112:115], v2 offset:45056
ds_read_b128 v[116:119], v2 offset:46080
ds_read_b128 v[120:123], v2 offset:47104
ds_read_b128 v[124:127], v2 offset:48128
s_waitcnt lgkmcnt(4)
v_mfma_f32_16x16x32_bf16 v[64:67], v[168:171], v[96:99], v[64:67]
v_mfma_f32_16x16x32_bf16 v[68:71], v[168:171], v[100:103], v[68:71]
v_mfma_f32_16x16x32_bf16 v[72:75], v[168:171], v[104:107], v[72:75]
v_mfma_f32_16x16x32_bf16 v[76:79], v[168:171], v[108:111], v[76:79]
s_waitcnt vmcnt(30)
s_barrier
ds_read_b128 v[96:99], v2 offset:49152
ds_read_b128 v[100:103], v2 offset:50176
ds_read_b128 v[104:107], v2 offset:51200
ds_read_b128 v[108:111], v2 offset:52224
s_waitcnt lgkmcnt(4)
v_mfma_f32_16x16x32_bf16 v[64:67], v[172:175], v[112:115], v[64:67]
v_mfma_f32_16x16x32_bf16 v[68:71], v[172:175], v[116:119], v[68:71]
v_mfma_f32_16x16x32_bf16 v[72:75], v[172:175], v[120:123], v[72:75]
v_mfma_f32_16x16x32_bf16 v[76:79], v[172:175], v[124:127], v[76:79]
ds_read_b128 v[112:115], v2 offset:53248
ds_read_b128 v[116:119], v2 offset:54272
ds_read_b128 v[120:123], v2 offset:55296
ds_read_b128 v[124:127], v2 offset:56320
s_waitcnt vmcnt(7)
s_waitcnt lgkmcnt(4)
v_mfma_f32_16x16x32_bf16 v[64:67], v[128:131], v[96:99], v[64:67]
v_mfma_f32_16x16x32_bf16 v[68:71], v[128:131], v[100:103], v[68:71]
v_mfma_f32_16x16x32_bf16 v[72:75], v[128:131], v[104:107], v[72:75]
v_mfma_f32_16x16x32_bf16 v[76:79], v[128:131], v[108:111], v[76:79]
ds_read_b128 v[96:99], v2 offset:57344
ds_read_b128 v[100:103], v2 offset:58368
ds_read_b128 v[104:107], v2 offset:59392
ds_read_b128 v[108:111], v2 offset:60416
s_waitcnt vmcnt(6)
s_waitcnt lgkmcnt(4)
v_mfma_f32_16x16x32_bf16 v[64:67], v[132:135], v[112:115], v[64:67]
v_mfma_f32_16x16x32_bf16 v[68:71], v[132:135], v[116:119], v[68:71]
v_mfma_f32_16x16x32_bf16 v[72:75], v[132:135], v[120:123], v[72:75]
v_mfma_f32_16x16x32_bf16 v[76:79], v[132:135], v[124:127], v[76:79]
ds_read_b128 v[112:115], v2 offset:61440
ds_read_b128 v[116:119], v2 offset:62464
ds_read_b128 v[120:123], v2 offset:63488
ds_read_b128 v[124:127], v2 offset:64512
s_waitcnt vmcnt(5)
s_waitcnt lgkmcnt(4)
v_mfma_f32_16x16x32_bf16 v[64:67], v[136:139], v[96:99], v[64:67]
v_mfma_f32_16x16x32_bf16 v[68:71], v[136:139], v[100:103], v[68:71]
v_mfma_f32_16x16x32_bf16 v[72:75], v[136:139], v[104:107], v[72:75]
v_mfma_f32_16x16x32_bf16 v[76:79], v[136:139], v[108:111], v[76:79]
s_waitcnt vmcnt(28)
s_barrier
s_lshl_b32 s24, s38, 6
s_add_u32 s24, s24, 138752
v_lshlrev_b32 v48, 4, v5
buffer_load_dwordx4 v[248:251], v48, s[8:11], s24 offen
ds_read_b128 v[96:99], v3 offset:0
ds_read_b128 v[100:103], v3 offset:1024
ds_read_b128 v[104:107], v3 offset:2048
ds_read_b128 v[108:111], v3 offset:3072
s_waitcnt vmcnt(5)
s_waitcnt lgkmcnt(4)
v_mfma_f32_16x16x32_bf16 v[64:67], v[140:143], v[112:115], v[64:67]
v_mfma_f32_16x16x32_bf16 v[68:71], v[140:143], v[116:119], v[68:71]
v_mfma_f32_16x16x32_bf16 v[72:75], v[140:143], v[120:123], v[72:75]
v_mfma_f32_16x16x32_bf16 v[76:79], v[140:143], v[124:127], v[76:79]
ds_read_b128 v[112:115], v3 offset:4096
ds_read_b128 v[116:119], v3 offset:5120
ds_read_b128 v[120:123], v3 offset:6144
ds_read_b128 v[124:127], v3 offset:7168
s_waitcnt vmcnt(4)
s_waitcnt lgkmcnt(4)
v_mfma_f32_16x16x32_bf16 v[64:67], v[144:147], v[96:99], v[64:67]
v_mfma_f32_16x16x32_bf16 v[68:71], v[144:147], v[100:103], v[68:71]
v_mfma_f32_16x16x32_bf16 v[72:75], v[144:147], v[104:107], v[72:75]
v_mfma_f32_16x16x32_bf16 v[76:79], v[144:147], v[108:111], v[76:79]
ds_read_b128 v[96:99], v3 offset:8192
ds_read_b128 v[100:103], v3 offset:9216
ds_read_b128 v[104:107], v3 offset:10240
ds_read_b128 v[108:111], v3 offset:11264
s_waitcnt vmcnt(3)
s_waitcnt lgkmcnt(4)
v_mfma_f32_16x16x32_bf16 v[64:67], v[148:151], v[112:115], v[64:67]
v_mfma_f32_16x16x32_bf16 v[68:71], v[148:151], v[116:119], v[68:71]
v_mfma_f32_16x16x32_bf16 v[72:75], v[148:151], v[120:123], v[72:75]
v_mfma_f32_16x16x32_bf16 v[76:79], v[148:151], v[124:127], v[76:79]
ds_read_b128 v[112:115], v3 offset:12288
ds_read_b128 v[116:119], v3 offset:13312
ds_read_b128 v[120:123], v3 offset:14336
ds_read_b128 v[124:127], v3 offset:15360
s_waitcnt vmcnt(2)
s_waitcnt lgkmcnt(4)
v_mfma_f32_16x16x32_bf16 v[64:67], v[152:155], v[96:99], v[64:67]
v_mfma_f32_16x16x32_bf16 v[68:71], v[152:155], v[100:103], v[68:71]
v_mfma_f32_16x16x32_bf16 v[72:75], v[152:155], v[104:107], v[72:75]
v_mfma_f32_16x16x32_bf16 v[76:79], v[152:155], v[108:111], v[76:79]
s_waitcnt vmcnt(1)
s_waitcnt lgkmcnt(0)
v_mfma_f32_16x16x32_bf16 v[64:67], v[156:159], v[112:115], v[64:67]
v_mfma_f32_16x16x32_bf16 v[68:71], v[156:159], v[116:119], v[68:71]
v_mfma_f32_16x16x32_bf16 v[72:75], v[156:159], v[120:123], v[72:75]
v_mfma_f32_16x16x32_bf16 v[76:79], v[156:159], v[124:127], v[76:79]
s_waitcnt vmcnt(0)
v_lshlrev_b32 v60, 3, v4
v_add_u32 v60, 132608, v60
ds_read_b64 v[224:225], v60 offset:0
ds_read_b64 v[226:227], v60 offset:128
ds_read_b64 v[228:229], v60 offset:256
ds_read_b64 v[230:231], v60 offset:384
s_waitcnt lgkmcnt(0)
s_lshr_b32 s24, s38, 1
s_lshl_b32 s24, s24, 10
s_and_b32 s25, s38, 1
s_lshl_b32 s25, s25, 3
s_add_u32 s24, s24, s25
s_mul_i32 s25, s16, 221184
s_add_u32 s24, s24, s25
s_add_u32 s34, s24, 0
s_add_u32 s34, s34, 3670016
v_mul_f32 v64, v64, v224
v_mul_f32 v65, v65, v224
v_mul_f32 v66, v66, v224
v_mul_f32 v67, v67, v224
v_fmac_f32 v64, v225, v248
v_fmac_f32 v65, v225, v249
v_fmac_f32 v66, v225, v250
v_fmac_f32 v67, v225, v251
v_mul_f32 v240, v64, v64
v_mul_f32 v241, v65, v65
v_mul_f32 v242, v66, v66
v_mul_f32 v243, v67, v67
v_fma_f32 v240, v240, s40, v63
v_fma_f32 v241, v241, s40, v63
v_fma_f32 v242, v242, s40, v63
v_fma_f32 v243, v243, s40, v63
v_mul_f32 v240, v240, v64
v_mul_f32 v241, v241, v65
v_mul_f32 v242, v242, v66
v_mul_f32 v243, v243, v67
v_exp_f32 v240, v240
v_exp_f32 v241, v241
v_exp_f32 v242, v242
v_exp_f32 v243, v243
v_add_f32 v240, 1.0, v240
v_add_f32 v241, 1.0, v241
v_add_f32 v242, 1.0, v242
v_add_f32 v243, 1.0, v243
v_rcp_f32 v240, v240
v_rcp_f32 v241, v241
v_rcp_f32 v242, v242
v_rcp_f32 v243, v243
v_mul_f32 v64, v64, v240
v_mul_f32 v65, v65, v241
v_mul_f32 v66, v66, v242
v_mul_f32 v67, v67, v243
v_cvt_pk_bf16_f32 v232, v64, v65
v_cvt_pk_bf16_f32 v233, v66, v67
buffer_store_dwordx2 v[232:233], v1, s[8:11], s34 offen sc0 sc1
s_add_u32 s34, s34, 55296
v_mul_f32 v68, v68, v226
v_mul_f32 v69, v69, v226
v_mul_f32 v70, v70, v226
v_mul_f32 v71, v71, v226
v_fmac_f32 v68, v227, v248
v_fmac_f32 v69, v227, v249
v_fmac_f32 v70, v227, v250
v_fmac_f32 v71, v227, v251
v_mul_f32 v240, v68, v68
v_mul_f32 v241, v69, v69
v_mul_f32 v242, v70, v70
v_mul_f32 v243, v71, v71
v_fma_f32 v240, v240, s40, v63
v_fma_f32 v241, v241, s40, v63
v_fma_f32 v242, v242, s40, v63
v_fma_f32 v243, v243, s40, v63
v_mul_f32 v240, v240, v68
v_mul_f32 v241, v241, v69
v_mul_f32 v242, v242, v70
v_mul_f32 v243, v243, v71
v_exp_f32 v240, v240
v_exp_f32 v241, v241
v_exp_f32 v242, v242
v_exp_f32 v243, v243
v_add_f32 v240, 1.0, v240
v_add_f32 v241, 1.0, v241
v_add_f32 v242, 1.0, v242
v_add_f32 v243, 1.0, v243
v_rcp_f32 v240, v240
v_rcp_f32 v241, v241
v_rcp_f32 v242, v242
v_rcp_f32 v243, v243
v_mul_f32 v68, v68, v240
v_mul_f32 v69, v69, v241
v_mul_f32 v70, v70, v242
v_mul_f32 v71, v71, v243
v_cvt_pk_bf16_f32 v234, v68, v69
v_cvt_pk_bf16_f32 v235, v70, v71
buffer_store_dwordx2 v[234:235], v1, s[8:11], s34 offen sc0 sc1
s_add_u32 s34, s34, 55296
v_mul_f32 v72, v72, v228
v_mul_f32 v73, v73, v228
v_mul_f32 v74, v74, v228
v_mul_f32 v75, v75, v228
v_fmac_f32 v72, v229, v248
v_fmac_f32 v73, v229, v249
v_fmac_f32 v74, v229, v250
v_fmac_f32 v75, v229, v251
v_mul_f32 v240, v72, v72
v_mul_f32 v241, v73, v73
v_mul_f32 v242, v74, v74
v_mul_f32 v243, v75, v75
v_fma_f32 v240, v240, s40, v63
v_fma_f32 v241, v241, s40, v63
v_fma_f32 v242, v242, s40, v63
v_fma_f32 v243, v243, s40, v63
v_mul_f32 v240, v240, v72
v_mul_f32 v241, v241, v73
v_mul_f32 v242, v242, v74
v_mul_f32 v243, v243, v75
v_exp_f32 v240, v240
v_exp_f32 v241, v241
v_exp_f32 v242, v242
v_exp_f32 v243, v243
v_add_f32 v240, 1.0, v240
v_add_f32 v241, 1.0, v241
v_add_f32 v242, 1.0, v242
v_add_f32 v243, 1.0, v243
v_rcp_f32 v240, v240
v_rcp_f32 v241, v241
v_rcp_f32 v242, v242
v_rcp_f32 v243, v243
v_mul_f32 v72, v72, v240
v_mul_f32 v73, v73, v241
v_mul_f32 v74, v74, v242
v_mul_f32 v75, v75, v243
v_cvt_pk_bf16_f32 v236, v72, v73
v_cvt_pk_bf16_f32 v237, v74, v75
buffer_store_dwordx2 v[236:237], v1, s[8:11], s34 offen sc0 sc1
s_add_u32 s34, s34, 55296
v_mul_f32 v76, v76, v230
v_mul_f32 v77, v77, v230
v_mul_f32 v78, v78, v230
v_mul_f32 v79, v79, v230
v_fmac_f32 v76, v231, v248
v_fmac_f32 v77, v231, v249
v_fmac_f32 v78, v231, v250
v_fmac_f32 v79, v231, v251
v_mul_f32 v240, v76, v76
v_mul_f32 v241, v77, v77
v_mul_f32 v242, v78, v78
v_mul_f32 v243, v79, v79
v_fma_f32 v240, v240, s40, v63
v_fma_f32 v241, v241, s40, v63
v_fma_f32 v242, v242, s40, v63
v_fma_f32 v243, v243, s40, v63
v_mul_f32 v240, v240, v76
v_mul_f32 v241, v241, v77
v_mul_f32 v242, v242, v78
v_mul_f32 v243, v243, v79
v_exp_f32 v240, v240
v_exp_f32 v241, v241
v_exp_f32 v242, v242
v_exp_f32 v243, v243
v_add_f32 v240, 1.0, v240
v_add_f32 v241, 1.0, v241
v_add_f32 v242, 1.0, v242
v_add_f32 v243, 1.0, v243
v_rcp_f32 v240, v240
v_rcp_f32 v241, v241
v_rcp_f32 v242, v242
v_rcp_f32 v243, v243
v_mul_f32 v76, v76, v240
v_mul_f32 v77, v77, v241
v_mul_f32 v78, v78, v242
v_mul_f32 v79, v79, v243
v_cvt_pk_bf16_f32 v238, v76, v77
v_cvt_pk_bf16_f32 v239, v78, v79
buffer_store_dwordx2 v[238:239], v1, s[8:11], s34 offen sc0 sc1
s_add_u32 s34, s34, 55296
s_add_u32 s35, s35, 1024
s_add_u32 s36, s36, 1024
s_waitcnt vmcnt(0)
s_barrier
s_cmp_lg_u32 s18, 0
s_cbranch_scc1 L_106
v_mov_b32 v46, 0
v_mov_b32 v47, 1
buffer_store_dword v47, v46, s[8:11], s36 offen sc0 sc1
L_106:
s_and_b32 s24, s18, 3
s_lshl_b32 s24, s24, 4
s_add_u32 s24, s24, s19
v_add_u32 v46, s24, v4
v_lshrrev_b32 v47, 4, v46
v_mul_u32_u24 v47, 55296, v47
v_and_b32 v46, 15, v46
v_lshlrev_b32 v46, 4, v46
v_add_u32 v47, v47, v46
v_lshlrev_b32 v46, 8, v5
v_add_u32 v42, v47, v46
s_lshr_b32 s24, s18, 2
s_lshl_b32 s24, s24, 10
s_add_u32 s28, s24, 3670016
v_lshrrev_b32 v46, 2, v1
v_min_u32 v46, 28, v46
s_mov_b32 s30, 40000
L_107:
buffer_load_dword v47, v46, s[8:11], s35 offen sc0 sc1
s_waitcnt vmcnt(0)
v_cmp_ne_u32 vcc, 1, v47
s_nop 4
s_cbranch_vccz L_108
s_sub_u32 s30, s30, 1
s_cmp_lg_u32 s30, 0
s_cbranch_scc1 L_107
L_108:
s_add_u32 m0, s21, 0
s_add_u32 s22, s28, 0
buffer_load_dwordx4 v42, s[8:11], s22 offen sc0 sc1 lds
s_add_u32 m0, s21, 8192
s_add_u32 s22, s28, 2048
buffer_load_dwordx4 v42, s[8:11], s22 offen sc0 sc1 lds
s_add_u32 m0, s21, 16384
s_add_u32 s22, s28, 4096
buffer_load_dwordx4 v42, s[8:11], s22 offen sc0 sc1 lds
s_add_u32 m0, s21, 24576
s_add_u32 s22, s28, 6144
buffer_load_dwordx4 v42, s[8:11], s22 offen sc0 sc1 lds
s_add_u32 m0, s21, 32768
s_add_u32 s22, s28, 8192
buffer_load_dwordx4 v42, s[8:11], s22 offen sc0 sc1 lds
s_add_u32 m0, s21, 40960
s_add_u32 s22, s28, 10240
buffer_load_dwordx4 v42, s[8:11], s22 offen sc0 sc1 lds
s_add_u32 m0, s21, 49152
s_add_u32 s22, s28, 12288
buffer_load_dwordx4 v42, s[8:11], s22 offen sc0 sc1 lds
s_add_u32 m0, s21, 57344
s_add_u32 s22, s28, 14336
buffer_load_dwordx4 v42, s[8:11], s22 offen sc0 sc1 lds
s_add_u32 m0, s21, 65536
s_add_u32 s22, s28, 16384
buffer_load_dwordx4 v42, s[8:11], s22 offen sc0 sc1 lds
s_add_u32 m0, s21, 73728
s_add_u32 s22, s28, 18432
buffer_load_dwordx4 v42, s[8:11], s22 offen sc0 sc1 lds
s_add_u32 m0, s21, 81920
s_add_u32 s22, s28, 20480
buffer_load_dwordx4 v42, s[8:11], s22 offen sc0 sc1 lds
s_add_u32 m0, s21, 90112
s_add_u32 s22, s28, 22528
buffer_load_dwordx4 v42, s[8:11], s22 offen sc0 sc1 lds
s_add_u32 m0, s21, 98304
s_add_u32 s22, s28, 24576
buffer_load_dwordx4 v42, s[8:11], s22 offen sc0 sc1 lds
s_add_u32 m0, s21, 106496
s_add_u32 s22, s28, 26624
buffer_load_dwordx4 v42, s[8:11], s22 offen sc0 sc1 lds
s_add_u32 m0, s21, 114688
s_add_u32 s22, s28, 28672
buffer_load_dwordx4 v42, s[8:11], s22 offen sc0 sc1 lds
s_add_u32 m0, s21, 122880
s_add_u32 s22, s28, 30720
buffer_load_dwordx4 v42, s[8:11], s22 offen sc0 sc1 lds
s_waitcnt vmcnt(14)
s_barrier
s_waitcnt vmcnt(12)
s_barrier
s_waitcnt vmcnt(10)
s_barrier
s_add_u32 m0, s21, 0
s_add_u32 s22, s28, 32768
buffer_load_dwordx4 v42, s[8:11], s22 offen sc0 sc1 lds
s_add_u32 m0, s21, 8192
s_add_u32 s22, s28, 34816
buffer_load_dwordx4 v42, s[8:11], s22 offen sc0 sc1 lds
s_waitcnt vmcnt(10)
s_barrier
s_add_u32 m0, s21, 16384
s_add_u32 s22, s28, 36864
buffer_load_dwordx4 v42, s[8:11], s22 offen sc0 sc1 lds
s_add_u32 m0, s21, 24576
s_add_u32 s22, s28, 38912
buffer_load_dwordx4 v42, s[8:11], s22 offen sc0 sc1 lds
s_waitcnt vmcnt(10)
s_barrier
s_add_u32 m0, s21, 32768
s_add_u32 s22, s28, 40960
buffer_load_dwordx4 v42, s[8:11], s22 offen sc0 sc1 lds
s_add_u32 m0, s21, 40960
s_add_u32 s22, s28, 43008
buffer_load_dwordx4 v42, s[8:11], s22 offen sc0 sc1 lds
s_waitcnt vmcnt(10)
s_barrier
s_add_u32 m0, s21, 49152
s_add_u32 s22, s28, 45056
buffer_load_dwordx4 v42, s[8:11], s22 offen sc0 sc1 lds
s_add_u32 m0, s21, 57344
s_add_u32 s22, s28, 47104
buffer_load_dwordx4 v42, s[8:11], s22 offen sc0 sc1 lds
s_waitcnt vmcnt(10)
s_barrier
s_add_u32 m0, s21, 65536
s_add_u32 s22, s28, 49152
buffer_load_dwordx4 v42, s[8:11], s22 offen sc0 sc1 lds
s_add_u32 m0, s21, 73728
s_add_u32 s22, s28, 51200
buffer_load_dwordx4 v42, s[8:11], s22 offen sc0 sc1 lds
s_waitcnt vmcnt(10)
s_barrier
s_add_u32 m0, s21, 81920
s_add_u32 s22, s28, 53248
buffer_load_dwordx4 v42, s[8:11], s22 offen sc0 sc1 lds
s_waitcnt vmcnt(9)
s_barrier
s_waitcnt vmcnt(7)
s_barrier
s_waitcnt vmcnt(5)
s_barrier
s_waitcnt vmcnt(3)
s_barrier
s_waitcnt vmcnt(1)
s_barrier
s_waitcnt vmcnt(0)
s_barrier
s_endpgm
L_27:
s_endpgm
.section .rodata,"a"
.p2align 6
.amdhsa_kernel adaLN_cond__ssm_conv_s4__mixer_s_mlp__prompt_kernel
  .amdhsa_next_free_vgpr 256
  .amdhsa_next_free_sgpr 102
  .amdhsa_accum_offset 256
  .amdhsa_group_segment_fixed_size 0
  .amdhsa_kernarg_size 152
  .amdhsa_user_sgpr_count 2
  .amdhsa_user_sgpr_kernarg_segment_ptr 1
  .amdhsa_system_sgpr_workgroup_id_x 1
.end_amdhsa_kernel
.p2align 6
.amdhsa_kernel conv_kernel
  .amdhsa_next_free_vgpr 256
  .amdhsa_next_free_sgpr 102
  .amdhsa_accum_offset 256
  .amdhsa_group_segment_fixed_size 0
  .amdhsa_kernarg_size 152
  .amdhsa_user_sgpr_count 2
  .amdhsa_user_sgpr_kernarg_segment_ptr 1
  .amdhsa_system_sgpr_workgroup_id_x 1
.end_amdhsa_kernel
.p2align 6
.amdhsa_kernel mlp_kernel
  .amdhsa_next_free_vgpr 256
  .amdhsa_next_free_sgpr 102
  .amdhsa_accum_offset 256
  .amdhsa_group_segment_fixed_size 0
  .amdhsa_kernarg_size 152
  .amdhsa_user_sgpr_count 2
  .amdhsa_user_sgpr_kernarg_segment_ptr 1
  .amdhsa_system_sgpr_workgroup_id_x 1
.end_amdhsa_kernel
```
